```python
import torch

def _softmax(x, axis=-1):
    return torch.softmax(x, dim=axis)

def _gelu(x):
    return torch.nn.functional.gelu(x, approximate='tanh')

def _silu(x):
    return torch.nn.functional.silu(x)

def _sigmoid(x):
    return torch.sigmoid(x)

def _layernorm(x, axis=-1, eps=1e-05):
    m = x.mean(dim=axis, keepdim=True)
    v = x.var(dim=axis, keepdim=True, unbiased=False)
    return (x - m) / torch.sqrt(v + eps)

def _scatter_add(tgt, idx, src, axis=0):
    return tgt.clone().index_add_(axis, idx, src)

def _segment_sum(src, seg, n):
    out = torch.zeros((n,) + src.shape[1:], dtype=src.dtype)
    return out.index_add_(0, seg, src)

def _pad(x, pw):
    flat = tuple((v for pair in reversed(pw) for v in pair))
    return torch.nn.functional.pad(x, flat)
kernel_name = 'concat_heads__memory_aug_recurrent_mem_tr__linear_kernel_hedgehog__prompt'

def setup_inputs():

    _w = lambda a: (lambda t: t.to(torch.bfloat16) if t.is_floating_point() else t)(torch.as_tensor(a))

    def _A_setup():
        B, S, Dm = (1, 2048, 448)
        H, Dh = (16, 256)
        M, seg = (8, 32)
        seg = min(seg, S)
        S = S // seg * seg
        return {'x': _w((lambda *s: torch.randn(*s, dtype=torch.bfloat16) * 0.05)(B, S, Dm)), 'mem0': _w((lambda *s: torch.randn(*s, dtype=torch.bfloat16) * 0.8)(B, M, Dm)), 'Wq': _w((lambda *s: torch.randn(*s, dtype=torch.bfloat16) * 1.6)(Dm, H, Dh) * Dm ** (-0.5)), 'Wk': _w((lambda *s: torch.randn(*s, dtype=torch.bfloat16) * 1.6)(Dm, H, Dh) * Dm ** (-0.5)), 'Wv': _w((lambda *s: torch.randn(*s, dtype=torch.bfloat16) * 0.8)(Dm, H, Dh) * Dm ** (-0.5)), 'Wo': _w((lambda *s: torch.randn(*s, dtype=torch.bfloat16) * 0.8)(H, Dh, Dm) * (H * Dh) ** (-0.5)), 'seg_len': seg}
    _A_in = _A_setup()

    def _B_setup():
        B, S, D, H = (1, 2048, 448, 16)
        Dh = D // H
        return {'x': _w((lambda *s: torch.randn(*s, dtype=torch.bfloat16) * 0.4)(B, S, D)), 'wqkv': _w((lambda *s: torch.randn(*s, dtype=torch.bfloat16) * 0.4)(D, 3 * D)), 'w_phi': _w((lambda *s: torch.randn(*s, dtype=torch.bfloat16) * 0.4)(H, Dh, Dh) * Dh ** (-0.5)), 'wo': _w((lambda *s: torch.randn(*s, dtype=torch.bfloat16) * 0.05)(D, D))}
    _B_in = _B_setup()
    return {'A_x': _A_in['x'], 'A_mem0': _A_in['mem0'], 'A_Wq': _A_in['Wq'], 'A_Wk': _A_in['Wk'], 'A_Wv': _A_in['Wv'], 'A_Wo': _A_in['Wo'], 'A_seg_len': _A_in['seg_len'], 'B_x': _B_in['x'], 'B_wqkv': _B_in['wqkv'], 'B_w_phi': _B_in['w_phi'], 'B_wo': _B_in['wo']}

def reference(A_x, A_mem0, A_Wq, A_Wk, A_Wv, A_Wo, A_seg_len, B_x, B_wqkv, B_w_phi, B_wo):

    def _A_ref(x, mem0, Wq, Wk, Wv, Wo, seg_len):
        B, S, Dm = x.shape
        H, Dh = (Wq.shape[1], Wq.shape[2])
        M = mem0.shape[1]
        scale = Dh ** (-0.5)
        n_seg = S // seg_len
        L = M + seg_len
        idx = torch.arange(L)
        mask = (idx[:, None] < M) | (idx[:, None] >= idx[None, :])
        mem = mem0
        outs = []
        for s in range(n_seg):
            xs = x[:, s * seg_len:(s + 1) * seg_len, :].clone()
            h = torch.concatenate([mem, xs], axis=1)
            q = torch.einsum('btd,dhe->bhte', h, Wq)
            k = torch.einsum('btd,dhe->bhte', h, Wk)
            v = torch.einsum('btd,dhe->bhte', h, Wv)
            scores = torch.einsum('bhqe,bhke->bhqk', q, k) * scale
            scores = torch.where(mask[None, None], scores, -1000000000.0)
            p = _softmax(scores, axis=-1)
            o = torch.einsum('bhqk,bhke->bhqe', p, v)
            o = torch.einsum('bhte,hed->btd', o, Wo)
            mem = o[:, :M, :].clone()
            outs.append(o[:, M:, :])
        return torch.concatenate(outs, axis=1)

    def _B_ref(x, wqkv, w_phi, wo):
        B, S, D = x.shape
        H = 16
        Dh = D // H
        qkv = (lambda x, *d: x.permute(*d))((x @ wqkv).reshape(B, S, 3, H, Dh), 2, 0, 3, 1, 4)
        q, k, v = (qkv[0], qkv[1], qkv[2])
        pq = torch.einsum('bhsd,hdf->bhsf', q, w_phi)
        pk = torch.einsum('bhsd,hdf->bhsf', k, w_phi)
        phi_q = torch.concatenate([_softmax(pq, axis=-1), _softmax(-pq, axis=-1)], axis=-1)
        phi_k = torch.concatenate([_softmax(pk, axis=-1), _softmax(-pk, axis=-1)], axis=-1)
        kv = torch.einsum('bhsf,bhsd->bhfd', phi_k, v)
        z = torch.einsum('bhsf->bhf', phi_k)
        num = torch.einsum('bhqf,bhfd->bhqd', phi_q, kv)
        den = torch.einsum('bhqf,bhf->bhq', phi_q, z)[..., None] + 1e-06
        o = num / den
        return (lambda x, *d: x.permute(*d))(o, 0, 2, 1, 3).reshape(B, S, D) @ wo
    a = _A_ref(A_x, A_mem0, A_Wq, A_Wk, A_Wv, A_Wo, A_seg_len)
    b = _B_ref(B_x, B_wqkv, B_w_phi, B_wo)
    return torch.concatenate([a, b], axis=-1)
```

```asm
; @launch kernel=prep_kernel grid=(352,1,1) block=(256,1,1) lds=61440
; @launch kernel=main_kernel grid=(256,1,1) block=(256,1,1) lds=135168
.amdgcn_target "amdgcn-amd-amdhsa--gfx950"
.text
.globl prep_kernel
.p2align 8
.type prep_kernel,@function
prep_kernel:
    s_cmp_ge_u32 s2, 352
    s_cbranch_scc1 L_prep_done
    s_load_dwordx2 s[4:5], s[0:1], 0
    s_load_dwordx2 s[24:25], s[0:1], 8
    s_load_dwordx4 s[16:19], s[0:1], 16
    s_load_dwordx4 s[20:23], s[0:1], 32
    s_load_dwordx2 s[6:7], s[0:1], 104
    v_lshrrev_b32 v1, 6, v0
    s_nop 0
    v_readfirstlane_b32 s8, v1
    v_and_b32 v1, 63, v0
    s_waitcnt lgkmcnt(0)

    s_cmp_ge_u32 s2, 256
    s_cbranch_scc1 L_prep_t2

    s_lshr_b32 s10, s2, 7
    s_bfe_u32 s11, s2, 0x10006
    s_lshl_b32 s11, s11, 3
    s_and_b32 s13, s2, 7
    s_add_u32 s11, s11, s13
    s_bfe_u32 s14, s2, 0x20004
    s_bfe_u32 s13, s2, 0x10003
    s_lshl_b32 s13, s13, 2
    s_add_u32 s13, s13, s8
    s_min_u32 s15, s13, 6
    s_cmp_eq_u32 s10, 0
    s_cselect_b32 s30, s16, s20
    s_cselect_b32 s31, s17, s21
    v_and_b32 v2, 15, v1
    v_lshrrev_b32 v3, 4, v1
    v_lshrrev_b32 v4, 2, v2
    v_and_b32 v5, 3, v2
    v_lshrrev_b32 v6, 1, v4
    v_lshlrev_b32 v6, 4, v6
    v_and_b32 v7, 1, v4
    v_lshl_add_u32 v6, v7, 2, v6
    v_lshrrev_b32 v7, 1, v5
    v_lshl_add_u32 v6, v7, 3, v6
    v_and_b32 v7, 1, v5
    v_add_u32 v6, v6, v7
    s_lshl_b32 s15, s15, 6
    v_add_u32 v6, s15, v6
    v_lshlrev_b32 v6, 13, v6
    s_lshl_b32 s15, s11, 9
    v_add_u32 v6, s15, v6
    v_lshl_add_u32 v6, v3, 4, v6
    s_cmp_lg_u32 s10, 0
    s_cbranch_scc1 L_pf_stB

    v_lshrrev_b32 v8, 5, v0
    v_and_b32 v9, 31, v0
    s_mul_i32 s15, s14, 112
    v_add_u32 v10, s15, v8
    v_lshlrev_b32 v10, 13, v10
    s_lshl_b32 s15, s11, 9
    v_add_u32 v10, s15, v10
    v_lshl_add_u32 v10, v9, 4, v10
    v_mul_u32_u24 v11, 528, v8
    v_lshl_add_u32 v11, v9, 4, v11

    global_load_dwordx4 v[160:163], v10, s[18:19]
    v_add_u32 v10, 65536, v10
    global_load_dwordx4 v[164:167], v10, s[18:19]
    v_add_u32 v10, 65536, v10
    global_load_dwordx4 v[168:171], v10, s[18:19]
    v_add_u32 v10, 65536, v10
    global_load_dwordx4 v[172:175], v10, s[18:19]
    v_add_u32 v10, 65536, v10
    global_load_dwordx4 v[176:179], v10, s[18:19]
    v_add_u32 v10, 65536, v10
    global_load_dwordx4 v[180:183], v10, s[18:19]
    v_add_u32 v10, 65536, v10
    global_load_dwordx4 v[184:187], v10, s[18:19]
    v_add_u32 v10, 65536, v10
    global_load_dwordx4 v[188:191], v10, s[18:19]
    v_add_u32 v10, 65536, v10
    global_load_dwordx4 v[192:195], v10, s[18:19]
    v_add_u32 v10, 65536, v10
    global_load_dwordx4 v[196:199], v10, s[18:19]
    v_add_u32 v10, 65536, v10
    global_load_dwordx4 v[200:203], v10, s[18:19]
    v_add_u32 v10, 65536, v10
    global_load_dwordx4 v[204:207], v10, s[18:19]
    v_add_u32 v10, 65536, v10
    global_load_dwordx4 v[208:211], v10, s[18:19]
    v_add_u32 v10, 65536, v10
    global_load_dwordx4 v[212:215], v10, s[18:19]
    v_add_u32 v10, 65536, v10
    s_mov_b32 s26, 4224
    s_branch L_pf_st2
L_pf_stB:
    s_mul_i32 s15, s11, 229376
    s_mul_i32 s26, s14, 224
    s_add_u32 s15, s15, s26
    v_mul_u32_u24 v10, 896, v0
    v_add_u32 v10, s15, v10
    v_mul_u32_u24 v11, 240, v0

    global_load_dwordx4 v[160:163], v10, s[22:23] offset:0
    global_load_dwordx4 v[164:167], v10, s[22:23] offset:16
    global_load_dwordx4 v[168:171], v10, s[22:23] offset:32
    global_load_dwordx4 v[172:175], v10, s[22:23] offset:48
    global_load_dwordx4 v[176:179], v10, s[22:23] offset:64
    global_load_dwordx4 v[180:183], v10, s[22:23] offset:80
    global_load_dwordx4 v[184:187], v10, s[22:23] offset:96
    global_load_dwordx4 v[188:191], v10, s[22:23] offset:112
    global_load_dwordx4 v[192:195], v10, s[22:23] offset:128
    global_load_dwordx4 v[196:199], v10, s[22:23] offset:144
    global_load_dwordx4 v[200:203], v10, s[22:23] offset:160
    global_load_dwordx4 v[204:207], v10, s[22:23] offset:176
    global_load_dwordx4 v[208:211], v10, s[22:23] offset:192
    global_load_dwordx4 v[212:215], v10, s[22:23] offset:208
    s_mov_b32 s26, 16
L_pf_st2:
    v_add_u32 v7, 0, v6
    global_load_dwordx4 v[32:35], v7, s[30:31] offset:0
    global_load_dwordx4 v[36:39], v7, s[30:31] offset:64
    global_load_dwordx4 v[40:43], v7, s[30:31] offset:128
    global_load_dwordx4 v[44:47], v7, s[30:31] offset:192
    global_load_dwordx4 v[48:51], v7, s[30:31] offset:256
    global_load_dwordx4 v[52:55], v7, s[30:31] offset:320
    global_load_dwordx4 v[56:59], v7, s[30:31] offset:384
    global_load_dwordx4 v[60:63], v7, s[30:31] offset:448
    v_add_u32 v7, 16384, v6
    global_load_dwordx4 v[64:67], v7, s[30:31] offset:0
    global_load_dwordx4 v[68:71], v7, s[30:31] offset:64
    global_load_dwordx4 v[72:75], v7, s[30:31] offset:128
    global_load_dwordx4 v[76:79], v7, s[30:31] offset:192
    global_load_dwordx4 v[80:83], v7, s[30:31] offset:256
    global_load_dwordx4 v[84:87], v7, s[30:31] offset:320
    global_load_dwordx4 v[88:91], v7, s[30:31] offset:384
    global_load_dwordx4 v[92:95], v7, s[30:31] offset:448
    v_add_u32 v7, 262144, v6
    global_load_dwordx4 v[96:99], v7, s[30:31] offset:0
    global_load_dwordx4 v[100:103], v7, s[30:31] offset:64
    global_load_dwordx4 v[104:107], v7, s[30:31] offset:128
    global_load_dwordx4 v[108:111], v7, s[30:31] offset:192
    global_load_dwordx4 v[112:115], v7, s[30:31] offset:256
    global_load_dwordx4 v[116:119], v7, s[30:31] offset:320
    global_load_dwordx4 v[120:123], v7, s[30:31] offset:384
    global_load_dwordx4 v[124:127], v7, s[30:31] offset:448
    v_add_u32 v7, 278528, v6
    global_load_dwordx4 v[128:131], v7, s[30:31] offset:0
    global_load_dwordx4 v[132:135], v7, s[30:31] offset:64
    global_load_dwordx4 v[136:139], v7, s[30:31] offset:128
    global_load_dwordx4 v[140:143], v7, s[30:31] offset:192
    global_load_dwordx4 v[144:147], v7, s[30:31] offset:256
    global_load_dwordx4 v[148:151], v7, s[30:31] offset:320
    global_load_dwordx4 v[152:155], v7, s[30:31] offset:384
    global_load_dwordx4 v[156:159], v7, s[30:31] offset:448
    s_waitcnt vmcnt(32)
    ds_write_b128 v11, v[160:163]
    v_add_u32 v11, s26, v11
    ds_write_b128 v11, v[164:167]
    v_add_u32 v11, s26, v11
    ds_write_b128 v11, v[168:171]
    v_add_u32 v11, s26, v11
    ds_write_b128 v11, v[172:175]
    v_add_u32 v11, s26, v11
    ds_write_b128 v11, v[176:179]
    v_add_u32 v11, s26, v11
    ds_write_b128 v11, v[180:183]
    v_add_u32 v11, s26, v11
    ds_write_b128 v11, v[184:187]
    v_add_u32 v11, s26, v11
    ds_write_b128 v11, v[188:191]
    v_add_u32 v11, s26, v11
    ds_write_b128 v11, v[192:195]
    v_add_u32 v11, s26, v11
    ds_write_b128 v11, v[196:199]
    v_add_u32 v11, s26, v11
    ds_write_b128 v11, v[200:203]
    v_add_u32 v11, s26, v11
    ds_write_b128 v11, v[204:207]
    v_add_u32 v11, s26, v11
    ds_write_b128 v11, v[208:211]
    v_add_u32 v11, s26, v11
    ds_write_b128 v11, v[212:215]
    v_add_u32 v11, s26, v11
    s_waitcnt lgkmcnt(0)
    s_barrier
    s_cmp_ge_u32 s13, 7
    s_cbranch_scc1 L_prep_done
    v_mul_u32_u24 v12, 1056, v2
    v_lshl_add_u32 v12, v3, 4, v12
    v_mul_u32_u24 v13, 528, v2
    v_lshl_add_u32 v13, v3, 4, v13
    v_add_u32 v13, 50688, v13
    v_lshl_add_u32 v14, v3, 3, v4
    v_mul_u32_u24 v14, 240, v14
    v_lshl_add_u32 v14, v5, 3, v14
    v_lshlrev_b32 v9, 4, v1
    s_waitcnt vmcnt(0)
    s_cmp_lg_u32 s10, 0
    s_cbranch_scc1 L_pf_cB

    s_mul_i32 s15, s11, 28
    s_mul_i32 s26, s14, 7
    s_add_u32 s15, s15, s26
    s_mul_i32 s15, s15, 7
    s_add_u32 s15, s15, s13
    s_lshl_b32 s15, s15, 11
    s_add_u32 s15, s15, 2097152
    s_add_u32 s26, s6, s15
    s_addc_u32 s27, s7, 0
    s_mov_b32 s28, 0x3d800000
    s_mov_b32 s29, 0x3d800000
    s_mov_b32 s30, 14336

    ds_read_b128 v[160:163], v12 offset:0
    ds_read_b128 v[164:167], v12 offset:64
    ds_read_b128 v[168:171], v12 offset:128
    ds_read_b128 v[172:175], v12 offset:192
    ds_read_b128 v[176:179], v12 offset:256
    ds_read_b128 v[180:183], v12 offset:320
    ds_read_b128 v[184:187], v12 offset:384
    ds_read_b128 v[188:191], v12 offset:448
    s_waitcnt lgkmcnt(0)
    ds_read_b128 v[208:211], v12 offset:528
    ds_read_b128 v[212:215], v12 offset:592
    ds_read_b128 v[216:219], v12 offset:656
    ds_read_b128 v[220:223], v12 offset:720
    ds_read_b128 v[224:227], v12 offset:784
    ds_read_b128 v[228:231], v12 offset:848
    ds_read_b128 v[232:235], v12 offset:912
    ds_read_b128 v[236:239], v12 offset:976
    v_mfma_f32_16x16x32_bf16 v[192:195], v[32:35], v[160:163], 0
    v_mfma_f32_16x16x32_bf16 v[196:199], v[64:67], v[160:163], 0
    v_mfma_f32_16x16x32_bf16 v[200:203], v[96:99], v[160:163], 0
    v_mfma_f32_16x16x32_bf16 v[204:207], v[128:131], v[160:163], 0
    v_mfma_f32_16x16x32_bf16 v[192:195], v[36:39], v[164:167], v[192:195]
    v_mfma_f32_16x16x32_bf16 v[196:199], v[68:71], v[164:167], v[196:199]
    v_mfma_f32_16x16x32_bf16 v[200:203], v[100:103], v[164:167], v[200:203]
    v_mfma_f32_16x16x32_bf16 v[204:207], v[132:135], v[164:167], v[204:207]
    v_mfma_f32_16x16x32_bf16 v[192:195], v[40:43], v[168:171], v[192:195]
    v_mfma_f32_16x16x32_bf16 v[196:199], v[72:75], v[168:171], v[196:199]
    v_mfma_f32_16x16x32_bf16 v[200:203], v[104:107], v[168:171], v[200:203]
    v_mfma_f32_16x16x32_bf16 v[204:207], v[136:139], v[168:171], v[204:207]
    v_mfma_f32_16x16x32_bf16 v[192:195], v[44:47], v[172:175], v[192:195]
    v_mfma_f32_16x16x32_bf16 v[196:199], v[76:79], v[172:175], v[196:199]
    v_mfma_f32_16x16x32_bf16 v[200:203], v[108:111], v[172:175], v[200:203]
    v_mfma_f32_16x16x32_bf16 v[204:207], v[140:143], v[172:175], v[204:207]
    v_mfma_f32_16x16x32_bf16 v[192:195], v[48:51], v[176:179], v[192:195]
    v_mfma_f32_16x16x32_bf16 v[196:199], v[80:83], v[176:179], v[196:199]
    v_mfma_f32_16x16x32_bf16 v[200:203], v[112:115], v[176:179], v[200:203]
    v_mfma_f32_16x16x32_bf16 v[204:207], v[144:147], v[176:179], v[204:207]
    v_mfma_f32_16x16x32_bf16 v[192:195], v[52:55], v[180:183], v[192:195]
    v_mfma_f32_16x16x32_bf16 v[196:199], v[84:87], v[180:183], v[196:199]
    v_mfma_f32_16x16x32_bf16 v[200:203], v[116:119], v[180:183], v[200:203]
    v_mfma_f32_16x16x32_bf16 v[204:207], v[148:151], v[180:183], v[204:207]
    v_mfma_f32_16x16x32_bf16 v[192:195], v[56:59], v[184:187], v[192:195]
    v_mfma_f32_16x16x32_bf16 v[196:199], v[88:91], v[184:187], v[196:199]
    v_mfma_f32_16x16x32_bf16 v[200:203], v[120:123], v[184:187], v[200:203]
    v_mfma_f32_16x16x32_bf16 v[204:207], v[152:155], v[184:187], v[204:207]
    v_mfma_f32_16x16x32_bf16 v[192:195], v[60:63], v[188:191], v[192:195]
    v_mfma_f32_16x16x32_bf16 v[196:199], v[92:95], v[188:191], v[196:199]
    v_mfma_f32_16x16x32_bf16 v[200:203], v[124:127], v[188:191], v[200:203]
    v_mfma_f32_16x16x32_bf16 v[204:207], v[156:159], v[188:191], v[204:207]
    s_waitcnt lgkmcnt(0)
    ds_read_b128 v[160:163], v12 offset:16896
    ds_read_b128 v[164:167], v12 offset:16960
    ds_read_b128 v[168:171], v12 offset:17024
    ds_read_b128 v[172:175], v12 offset:17088
    ds_read_b128 v[176:179], v12 offset:17152
    ds_read_b128 v[180:183], v12 offset:17216
    ds_read_b128 v[184:187], v12 offset:17280
    ds_read_b128 v[188:191], v12 offset:17344
    v_mfma_f32_16x16x32_bf16 v[16:19], v[32:35], v[208:211], 0
    v_mfma_f32_16x16x32_bf16 v[20:23], v[64:67], v[208:211], 0
    v_mfma_f32_16x16x32_bf16 v[24:27], v[96:99], v[208:211], 0
    v_mfma_f32_16x16x32_bf16 v[28:31], v[128:131], v[208:211], 0
    v_mfma_f32_16x16x32_bf16 v[16:19], v[36:39], v[212:215], v[16:19]
    v_pk_mul_f32 v[192:193], v[192:193], s[28:29]
    v_mfma_f32_16x16x32_bf16 v[20:23], v[68:71], v[212:215], v[20:23]
    v_pk_mul_f32 v[194:195], v[194:195], s[28:29]
    v_mfma_f32_16x16x32_bf16 v[24:27], v[100:103], v[212:215], v[24:27]
    v_pk_mul_f32 v[196:197], v[196:197], s[28:29]
    v_mfma_f32_16x16x32_bf16 v[28:31], v[132:135], v[212:215], v[28:31]
    v_pk_mul_f32 v[198:199], v[198:199], s[28:29]
    v_mfma_f32_16x16x32_bf16 v[16:19], v[40:43], v[216:219], v[16:19]
    v_pk_mul_f32 v[200:201], v[200:201], s[28:29]
    v_mfma_f32_16x16x32_bf16 v[20:23], v[72:75], v[216:219], v[20:23]
    v_pk_mul_f32 v[202:203], v[202:203], s[28:29]
    v_mfma_f32_16x16x32_bf16 v[24:27], v[104:107], v[216:219], v[24:27]
    v_pk_mul_f32 v[204:205], v[204:205], s[28:29]
    v_mfma_f32_16x16x32_bf16 v[28:31], v[136:139], v[216:219], v[28:31]
    v_pk_mul_f32 v[206:207], v[206:207], s[28:29]
    v_mfma_f32_16x16x32_bf16 v[16:19], v[44:47], v[220:223], v[16:19]
    v_cvt_pk_bf16_f32 v240, v192, v193
    v_mfma_f32_16x16x32_bf16 v[20:23], v[76:79], v[220:223], v[20:23]
    v_cvt_pk_bf16_f32 v241, v194, v195
    v_mfma_f32_16x16x32_bf16 v[24:27], v[108:111], v[220:223], v[24:27]
    v_cvt_pk_bf16_f32 v242, v196, v197
    v_mfma_f32_16x16x32_bf16 v[28:31], v[140:143], v[220:223], v[28:31]
    v_cvt_pk_bf16_f32 v243, v198, v199
    v_mfma_f32_16x16x32_bf16 v[16:19], v[48:51], v[224:227], v[16:19]
    v_cvt_pk_bf16_f32 v244, v200, v201
    v_mfma_f32_16x16x32_bf16 v[20:23], v[80:83], v[224:227], v[20:23]
    v_cvt_pk_bf16_f32 v245, v202, v203
    v_mfma_f32_16x16x32_bf16 v[24:27], v[112:115], v[224:227], v[24:27]
    v_cvt_pk_bf16_f32 v246, v204, v205
    v_mfma_f32_16x16x32_bf16 v[28:31], v[144:147], v[224:227], v[28:31]
    v_cvt_pk_bf16_f32 v247, v206, v207
    v_mfma_f32_16x16x32_bf16 v[16:19], v[52:55], v[228:231], v[16:19]
    global_store_dwordx4 v9, v[240:243], s[26:27]
    v_mfma_f32_16x16x32_bf16 v[20:23], v[84:87], v[228:231], v[20:23]
    global_store_dwordx4 v9, v[244:247], s[26:27] offset:1024
    v_mfma_f32_16x16x32_bf16 v[24:27], v[116:119], v[228:231], v[24:27]
    s_add_u32 s26, s26, s30
    v_mfma_f32_16x16x32_bf16 v[28:31], v[148:151], v[228:231], v[28:31]
    s_addc_u32 s27, s27, 0
    v_mfma_f32_16x16x32_bf16 v[16:19], v[56:59], v[232:235], v[16:19]
    v_mfma_f32_16x16x32_bf16 v[20:23], v[88:91], v[232:235], v[20:23]
    v_mfma_f32_16x16x32_bf16 v[24:27], v[120:123], v[232:235], v[24:27]
    v_mfma_f32_16x16x32_bf16 v[28:31], v[152:155], v[232:235], v[28:31]
    v_mfma_f32_16x16x32_bf16 v[16:19], v[60:63], v[236:239], v[16:19]
    v_mfma_f32_16x16x32_bf16 v[20:23], v[92:95], v[236:239], v[20:23]
    v_mfma_f32_16x16x32_bf16 v[24:27], v[124:127], v[236:239], v[24:27]
    v_mfma_f32_16x16x32_bf16 v[28:31], v[156:159], v[236:239], v[28:31]
    s_waitcnt lgkmcnt(0)
    ds_read_b128 v[208:211], v12 offset:17424
    ds_read_b128 v[212:215], v12 offset:17488
    ds_read_b128 v[216:219], v12 offset:17552
    ds_read_b128 v[220:223], v12 offset:17616
    ds_read_b128 v[224:227], v12 offset:17680
    ds_read_b128 v[228:231], v12 offset:17744
    ds_read_b128 v[232:235], v12 offset:17808
    ds_read_b128 v[236:239], v12 offset:17872
    v_mfma_f32_16x16x32_bf16 v[192:195], v[32:35], v[160:163], 0
    v_mfma_f32_16x16x32_bf16 v[196:199], v[64:67], v[160:163], 0
    v_mfma_f32_16x16x32_bf16 v[200:203], v[96:99], v[160:163], 0
    v_mfma_f32_16x16x32_bf16 v[204:207], v[128:131], v[160:163], 0
    v_mfma_f32_16x16x32_bf16 v[192:195], v[36:39], v[164:167], v[192:195]
    v_pk_mul_f32 v[16:17], v[16:17], s[28:29]
    v_mfma_f32_16x16x32_bf16 v[196:199], v[68:71], v[164:167], v[196:199]
    v_pk_mul_f32 v[18:19], v[18:19], s[28:29]
    v_mfma_f32_16x16x32_bf16 v[200:203], v[100:103], v[164:167], v[200:203]
    v_pk_mul_f32 v[20:21], v[20:21], s[28:29]
    v_mfma_f32_16x16x32_bf16 v[204:207], v[132:135], v[164:167], v[204:207]
    v_pk_mul_f32 v[22:23], v[22:23], s[28:29]
    v_mfma_f32_16x16x32_bf16 v[192:195], v[40:43], v[168:171], v[192:195]
    v_pk_mul_f32 v[24:25], v[24:25], s[28:29]
    v_mfma_f32_16x16x32_bf16 v[196:199], v[72:75], v[168:171], v[196:199]
    v_pk_mul_f32 v[26:27], v[26:27], s[28:29]
    v_mfma_f32_16x16x32_bf16 v[200:203], v[104:107], v[168:171], v[200:203]
    v_pk_mul_f32 v[28:29], v[28:29], s[28:29]
    v_mfma_f32_16x16x32_bf16 v[204:207], v[136:139], v[168:171], v[204:207]
    v_pk_mul_f32 v[30:31], v[30:31], s[28:29]
    v_mfma_f32_16x16x32_bf16 v[192:195], v[44:47], v[172:175], v[192:195]
    v_cvt_pk_bf16_f32 v240, v16, v17
    v_mfma_f32_16x16x32_bf16 v[196:199], v[76:79], v[172:175], v[196:199]
    v_cvt_pk_bf16_f32 v241, v18, v19
    v_mfma_f32_16x16x32_bf16 v[200:203], v[108:111], v[172:175], v[200:203]
    v_cvt_pk_bf16_f32 v242, v20, v21
    v_mfma_f32_16x16x32_bf16 v[204:207], v[140:143], v[172:175], v[204:207]
    v_cvt_pk_bf16_f32 v243, v22, v23
    v_mfma_f32_16x16x32_bf16 v[192:195], v[48:51], v[176:179], v[192:195]
    v_cvt_pk_bf16_f32 v244, v24, v25
    v_mfma_f32_16x16x32_bf16 v[196:199], v[80:83], v[176:179], v[196:199]
    v_cvt_pk_bf16_f32 v245, v26, v27
    v_mfma_f32_16x16x32_bf16 v[200:203], v[112:115], v[176:179], v[200:203]
    v_cvt_pk_bf16_f32 v246, v28, v29
    v_mfma_f32_16x16x32_bf16 v[204:207], v[144:147], v[176:179], v[204:207]
    v_cvt_pk_bf16_f32 v247, v30, v31
    v_mfma_f32_16x16x32_bf16 v[192:195], v[52:55], v[180:183], v[192:195]
    global_store_dwordx4 v9, v[240:243], s[26:27]
    v_mfma_f32_16x16x32_bf16 v[196:199], v[84:87], v[180:183], v[196:199]
    global_store_dwordx4 v9, v[244:247], s[26:27] offset:1024
    v_mfma_f32_16x16x32_bf16 v[200:203], v[116:119], v[180:183], v[200:203]
    s_add_u32 s26, s26, s30
    v_mfma_f32_16x16x32_bf16 v[204:207], v[148:151], v[180:183], v[204:207]
    s_addc_u32 s27, s27, 0
    v_mfma_f32_16x16x32_bf16 v[192:195], v[56:59], v[184:187], v[192:195]
    v_mfma_f32_16x16x32_bf16 v[196:199], v[88:91], v[184:187], v[196:199]
    v_mfma_f32_16x16x32_bf16 v[200:203], v[120:123], v[184:187], v[200:203]
    v_mfma_f32_16x16x32_bf16 v[204:207], v[152:155], v[184:187], v[204:207]
    v_mfma_f32_16x16x32_bf16 v[192:195], v[60:63], v[188:191], v[192:195]
    v_mfma_f32_16x16x32_bf16 v[196:199], v[92:95], v[188:191], v[196:199]
    v_mfma_f32_16x16x32_bf16 v[200:203], v[124:127], v[188:191], v[200:203]
    v_mfma_f32_16x16x32_bf16 v[204:207], v[156:159], v[188:191], v[204:207]
    s_waitcnt lgkmcnt(0)
    ds_read_b128 v[160:163], v12 offset:33792
    ds_read_b128 v[164:167], v12 offset:33856
    ds_read_b128 v[168:171], v12 offset:33920
    ds_read_b128 v[172:175], v12 offset:33984
    ds_read_b128 v[176:179], v12 offset:34048
    ds_read_b128 v[180:183], v12 offset:34112
    ds_read_b128 v[184:187], v12 offset:34176
    ds_read_b128 v[188:191], v12 offset:34240
    v_mfma_f32_16x16x32_bf16 v[16:19], v[32:35], v[208:211], 0
    v_mfma_f32_16x16x32_bf16 v[20:23], v[64:67], v[208:211], 0
    v_mfma_f32_16x16x32_bf16 v[24:27], v[96:99], v[208:211], 0
    v_mfma_f32_16x16x32_bf16 v[28:31], v[128:131], v[208:211], 0
    v_mfma_f32_16x16x32_bf16 v[16:19], v[36:39], v[212:215], v[16:19]
    v_pk_mul_f32 v[192:193], v[192:193], s[28:29]
    v_mfma_f32_16x16x32_bf16 v[20:23], v[68:71], v[212:215], v[20:23]
    v_pk_mul_f32 v[194:195], v[194:195], s[28:29]
    v_mfma_f32_16x16x32_bf16 v[24:27], v[100:103], v[212:215], v[24:27]
    v_pk_mul_f32 v[196:197], v[196:197], s[28:29]
    v_mfma_f32_16x16x32_bf16 v[28:31], v[132:135], v[212:215], v[28:31]
    v_pk_mul_f32 v[198:199], v[198:199], s[28:29]
    v_mfma_f32_16x16x32_bf16 v[16:19], v[40:43], v[216:219], v[16:19]
    v_pk_mul_f32 v[200:201], v[200:201], s[28:29]
    v_mfma_f32_16x16x32_bf16 v[20:23], v[72:75], v[216:219], v[20:23]
    v_pk_mul_f32 v[202:203], v[202:203], s[28:29]
    v_mfma_f32_16x16x32_bf16 v[24:27], v[104:107], v[216:219], v[24:27]
    v_pk_mul_f32 v[204:205], v[204:205], s[28:29]
    v_mfma_f32_16x16x32_bf16 v[28:31], v[136:139], v[216:219], v[28:31]
    v_pk_mul_f32 v[206:207], v[206:207], s[28:29]
    v_mfma_f32_16x16x32_bf16 v[16:19], v[44:47], v[220:223], v[16:19]
    v_cvt_pk_bf16_f32 v240, v192, v193
    v_mfma_f32_16x16x32_bf16 v[20:23], v[76:79], v[220:223], v[20:23]
    v_cvt_pk_bf16_f32 v241, v194, v195
    v_mfma_f32_16x16x32_bf16 v[24:27], v[108:111], v[220:223], v[24:27]
    v_cvt_pk_bf16_f32 v242, v196, v197
    v_mfma_f32_16x16x32_bf16 v[28:31], v[140:143], v[220:223], v[28:31]
    v_cvt_pk_bf16_f32 v243, v198, v199
    v_mfma_f32_16x16x32_bf16 v[16:19], v[48:51], v[224:227], v[16:19]
    v_cvt_pk_bf16_f32 v244, v200, v201
    v_mfma_f32_16x16x32_bf16 v[20:23], v[80:83], v[224:227], v[20:23]
    v_cvt_pk_bf16_f32 v245, v202, v203
    v_mfma_f32_16x16x32_bf16 v[24:27], v[112:115], v[224:227], v[24:27]
    v_cvt_pk_bf16_f32 v246, v204, v205
    v_mfma_f32_16x16x32_bf16 v[28:31], v[144:147], v[224:227], v[28:31]
    v_cvt_pk_bf16_f32 v247, v206, v207
    v_mfma_f32_16x16x32_bf16 v[16:19], v[52:55], v[228:231], v[16:19]
    global_store_dwordx4 v9, v[240:243], s[26:27]
    v_mfma_f32_16x16x32_bf16 v[20:23], v[84:87], v[228:231], v[20:23]
    global_store_dwordx4 v9, v[244:247], s[26:27] offset:1024
    v_mfma_f32_16x16x32_bf16 v[24:27], v[116:119], v[228:231], v[24:27]
    s_add_u32 s26, s26, s30
    v_mfma_f32_16x16x32_bf16 v[28:31], v[148:151], v[228:231], v[28:31]
    s_addc_u32 s27, s27, 0
    v_mfma_f32_16x16x32_bf16 v[16:19], v[56:59], v[232:235], v[16:19]
    v_mfma_f32_16x16x32_bf16 v[20:23], v[88:91], v[232:235], v[20:23]
    v_mfma_f32_16x16x32_bf16 v[24:27], v[120:123], v[232:235], v[24:27]
    v_mfma_f32_16x16x32_bf16 v[28:31], v[152:155], v[232:235], v[28:31]
    v_mfma_f32_16x16x32_bf16 v[16:19], v[60:63], v[236:239], v[16:19]
    v_mfma_f32_16x16x32_bf16 v[20:23], v[92:95], v[236:239], v[20:23]
    v_mfma_f32_16x16x32_bf16 v[24:27], v[124:127], v[236:239], v[24:27]
    v_mfma_f32_16x16x32_bf16 v[28:31], v[156:159], v[236:239], v[28:31]
    s_waitcnt lgkmcnt(0)
    ds_read_b128 v[208:211], v12 offset:34320
    ds_read_b128 v[212:215], v12 offset:34384
    ds_read_b128 v[216:219], v12 offset:34448
    ds_read_b128 v[220:223], v12 offset:34512
    ds_read_b128 v[224:227], v12 offset:34576
    ds_read_b128 v[228:231], v12 offset:34640
    ds_read_b128 v[232:235], v12 offset:34704
    ds_read_b128 v[236:239], v12 offset:34768
    v_mfma_f32_16x16x32_bf16 v[192:195], v[32:35], v[160:163], 0
    v_mfma_f32_16x16x32_bf16 v[196:199], v[64:67], v[160:163], 0
    v_mfma_f32_16x16x32_bf16 v[200:203], v[96:99], v[160:163], 0
    v_mfma_f32_16x16x32_bf16 v[204:207], v[128:131], v[160:163], 0
    v_mfma_f32_16x16x32_bf16 v[192:195], v[36:39], v[164:167], v[192:195]
    v_pk_mul_f32 v[16:17], v[16:17], s[28:29]
    v_mfma_f32_16x16x32_bf16 v[196:199], v[68:71], v[164:167], v[196:199]
    v_pk_mul_f32 v[18:19], v[18:19], s[28:29]
    v_mfma_f32_16x16x32_bf16 v[200:203], v[100:103], v[164:167], v[200:203]
    v_pk_mul_f32 v[20:21], v[20:21], s[28:29]
    v_mfma_f32_16x16x32_bf16 v[204:207], v[132:135], v[164:167], v[204:207]
    v_pk_mul_f32 v[22:23], v[22:23], s[28:29]
    v_mfma_f32_16x16x32_bf16 v[192:195], v[40:43], v[168:171], v[192:195]
    v_pk_mul_f32 v[24:25], v[24:25], s[28:29]
    v_mfma_f32_16x16x32_bf16 v[196:199], v[72:75], v[168:171], v[196:199]
    v_pk_mul_f32 v[26:27], v[26:27], s[28:29]
    v_mfma_f32_16x16x32_bf16 v[200:203], v[104:107], v[168:171], v[200:203]
    v_pk_mul_f32 v[28:29], v[28:29], s[28:29]
    v_mfma_f32_16x16x32_bf16 v[204:207], v[136:139], v[168:171], v[204:207]
    v_pk_mul_f32 v[30:31], v[30:31], s[28:29]
    v_mfma_f32_16x16x32_bf16 v[192:195], v[44:47], v[172:175], v[192:195]
    v_cvt_pk_bf16_f32 v240, v16, v17
    v_mfma_f32_16x16x32_bf16 v[196:199], v[76:79], v[172:175], v[196:199]
    v_cvt_pk_bf16_f32 v241, v18, v19
    v_mfma_f32_16x16x32_bf16 v[200:203], v[108:111], v[172:175], v[200:203]
    v_cvt_pk_bf16_f32 v242, v20, v21
    v_mfma_f32_16x16x32_bf16 v[204:207], v[140:143], v[172:175], v[204:207]
    v_cvt_pk_bf16_f32 v243, v22, v23
    v_mfma_f32_16x16x32_bf16 v[192:195], v[48:51], v[176:179], v[192:195]
    v_cvt_pk_bf16_f32 v244, v24, v25
    v_mfma_f32_16x16x32_bf16 v[196:199], v[80:83], v[176:179], v[196:199]
    v_cvt_pk_bf16_f32 v245, v26, v27
    v_mfma_f32_16x16x32_bf16 v[200:203], v[112:115], v[176:179], v[200:203]
    v_cvt_pk_bf16_f32 v246, v28, v29
    v_mfma_f32_16x16x32_bf16 v[204:207], v[144:147], v[176:179], v[204:207]
    v_cvt_pk_bf16_f32 v247, v30, v31
    v_mfma_f32_16x16x32_bf16 v[192:195], v[52:55], v[180:183], v[192:195]
    global_store_dwordx4 v9, v[240:243], s[26:27]
    v_mfma_f32_16x16x32_bf16 v[196:199], v[84:87], v[180:183], v[196:199]
    global_store_dwordx4 v9, v[244:247], s[26:27] offset:1024
    v_mfma_f32_16x16x32_bf16 v[200:203], v[116:119], v[180:183], v[200:203]
    s_add_u32 s26, s26, s30
    v_mfma_f32_16x16x32_bf16 v[204:207], v[148:151], v[180:183], v[204:207]
    s_addc_u32 s27, s27, 0
    v_mfma_f32_16x16x32_bf16 v[192:195], v[56:59], v[184:187], v[192:195]
    v_mfma_f32_16x16x32_bf16 v[196:199], v[88:91], v[184:187], v[196:199]
    v_mfma_f32_16x16x32_bf16 v[200:203], v[120:123], v[184:187], v[200:203]
    v_mfma_f32_16x16x32_bf16 v[204:207], v[152:155], v[184:187], v[204:207]
    v_mfma_f32_16x16x32_bf16 v[192:195], v[60:63], v[188:191], v[192:195]
    v_mfma_f32_16x16x32_bf16 v[196:199], v[92:95], v[188:191], v[196:199]
    v_mfma_f32_16x16x32_bf16 v[200:203], v[124:127], v[188:191], v[200:203]
    v_mfma_f32_16x16x32_bf16 v[204:207], v[156:159], v[188:191], v[204:207]
    s_waitcnt lgkmcnt(0)
    ds_read_b128 v[160:163], v13 offset:0
    ds_read_b128 v[164:167], v13 offset:64
    ds_read_b128 v[168:171], v13 offset:128
    ds_read_b128 v[172:175], v13 offset:192
    ds_read_b128 v[176:179], v13 offset:256
    ds_read_b128 v[180:183], v13 offset:320
    ds_read_b128 v[184:187], v13 offset:384
    ds_read_b128 v[188:191], v13 offset:448
    v_mfma_f32_16x16x32_bf16 v[16:19], v[32:35], v[208:211], 0
    v_mfma_f32_16x16x32_bf16 v[20:23], v[64:67], v[208:211], 0
    v_mfma_f32_16x16x32_bf16 v[24:27], v[96:99], v[208:211], 0
    v_mfma_f32_16x16x32_bf16 v[28:31], v[128:131], v[208:211], 0
    v_mfma_f32_16x16x32_bf16 v[16:19], v[36:39], v[212:215], v[16:19]
    v_pk_mul_f32 v[192:193], v[192:193], s[28:29]
    v_mfma_f32_16x16x32_bf16 v[20:23], v[68:71], v[212:215], v[20:23]
    v_pk_mul_f32 v[194:195], v[194:195], s[28:29]
    v_mfma_f32_16x16x32_bf16 v[24:27], v[100:103], v[212:215], v[24:27]
    v_pk_mul_f32 v[196:197], v[196:197], s[28:29]
    v_mfma_f32_16x16x32_bf16 v[28:31], v[132:135], v[212:215], v[28:31]
    v_pk_mul_f32 v[198:199], v[198:199], s[28:29]
    v_mfma_f32_16x16x32_bf16 v[16:19], v[40:43], v[216:219], v[16:19]
    v_pk_mul_f32 v[200:201], v[200:201], s[28:29]
    v_mfma_f32_16x16x32_bf16 v[20:23], v[72:75], v[216:219], v[20:23]
    v_pk_mul_f32 v[202:203], v[202:203], s[28:29]
    v_mfma_f32_16x16x32_bf16 v[24:27], v[104:107], v[216:219], v[24:27]
    v_pk_mul_f32 v[204:205], v[204:205], s[28:29]
    v_mfma_f32_16x16x32_bf16 v[28:31], v[136:139], v[216:219], v[28:31]
    v_pk_mul_f32 v[206:207], v[206:207], s[28:29]
    v_mfma_f32_16x16x32_bf16 v[16:19], v[44:47], v[220:223], v[16:19]
    v_cvt_pk_bf16_f32 v240, v192, v193
    v_mfma_f32_16x16x32_bf16 v[20:23], v[76:79], v[220:223], v[20:23]
    v_cvt_pk_bf16_f32 v241, v194, v195
    v_mfma_f32_16x16x32_bf16 v[24:27], v[108:111], v[220:223], v[24:27]
    v_cvt_pk_bf16_f32 v242, v196, v197
    v_mfma_f32_16x16x32_bf16 v[28:31], v[140:143], v[220:223], v[28:31]
    v_cvt_pk_bf16_f32 v243, v198, v199
    v_mfma_f32_16x16x32_bf16 v[16:19], v[48:51], v[224:227], v[16:19]
    v_cvt_pk_bf16_f32 v244, v200, v201
    v_mfma_f32_16x16x32_bf16 v[20:23], v[80:83], v[224:227], v[20:23]
    v_cvt_pk_bf16_f32 v245, v202, v203
    v_mfma_f32_16x16x32_bf16 v[24:27], v[112:115], v[224:227], v[24:27]
    v_cvt_pk_bf16_f32 v246, v204, v205
    v_mfma_f32_16x16x32_bf16 v[28:31], v[144:147], v[224:227], v[28:31]
    v_cvt_pk_bf16_f32 v247, v206, v207
    v_mfma_f32_16x16x32_bf16 v[16:19], v[52:55], v[228:231], v[16:19]
    global_store_dwordx4 v9, v[240:243], s[26:27]
    v_mfma_f32_16x16x32_bf16 v[20:23], v[84:87], v[228:231], v[20:23]
    global_store_dwordx4 v9, v[244:247], s[26:27] offset:1024
    v_mfma_f32_16x16x32_bf16 v[24:27], v[116:119], v[228:231], v[24:27]
    s_add_u32 s26, s26, s30
    v_mfma_f32_16x16x32_bf16 v[28:31], v[148:151], v[228:231], v[28:31]
    s_addc_u32 s27, s27, 0
    v_mfma_f32_16x16x32_bf16 v[16:19], v[56:59], v[232:235], v[16:19]
    v_mfma_f32_16x16x32_bf16 v[20:23], v[88:91], v[232:235], v[20:23]
    v_mfma_f32_16x16x32_bf16 v[24:27], v[120:123], v[232:235], v[24:27]
    v_mfma_f32_16x16x32_bf16 v[28:31], v[152:155], v[232:235], v[28:31]
    v_mfma_f32_16x16x32_bf16 v[16:19], v[60:63], v[236:239], v[16:19]
    v_mfma_f32_16x16x32_bf16 v[20:23], v[92:95], v[236:239], v[20:23]
    v_mfma_f32_16x16x32_bf16 v[24:27], v[124:127], v[236:239], v[24:27]
    v_mfma_f32_16x16x32_bf16 v[28:31], v[156:159], v[236:239], v[28:31]
    s_waitcnt lgkmcnt(0)
    v_mfma_f32_16x16x32_bf16 v[192:195], v[32:35], v[160:163], 0
    v_mfma_f32_16x16x32_bf16 v[196:199], v[64:67], v[160:163], 0
    v_mfma_f32_16x16x32_bf16 v[200:203], v[96:99], v[160:163], 0
    v_mfma_f32_16x16x32_bf16 v[204:207], v[128:131], v[160:163], 0
    v_mfma_f32_16x16x32_bf16 v[192:195], v[36:39], v[164:167], v[192:195]
    v_pk_mul_f32 v[16:17], v[16:17], s[28:29]
    v_mfma_f32_16x16x32_bf16 v[196:199], v[68:71], v[164:167], v[196:199]
    v_pk_mul_f32 v[18:19], v[18:19], s[28:29]
    v_mfma_f32_16x16x32_bf16 v[200:203], v[100:103], v[164:167], v[200:203]
    v_pk_mul_f32 v[20:21], v[20:21], s[28:29]
    v_mfma_f32_16x16x32_bf16 v[204:207], v[132:135], v[164:167], v[204:207]
    v_pk_mul_f32 v[22:23], v[22:23], s[28:29]
    v_mfma_f32_16x16x32_bf16 v[192:195], v[40:43], v[168:171], v[192:195]
    v_pk_mul_f32 v[24:25], v[24:25], s[28:29]
    v_mfma_f32_16x16x32_bf16 v[196:199], v[72:75], v[168:171], v[196:199]
    v_pk_mul_f32 v[26:27], v[26:27], s[28:29]
    v_mfma_f32_16x16x32_bf16 v[200:203], v[104:107], v[168:171], v[200:203]
    v_pk_mul_f32 v[28:29], v[28:29], s[28:29]
    v_mfma_f32_16x16x32_bf16 v[204:207], v[136:139], v[168:171], v[204:207]
    v_pk_mul_f32 v[30:31], v[30:31], s[28:29]
    v_mfma_f32_16x16x32_bf16 v[192:195], v[44:47], v[172:175], v[192:195]
    v_cvt_pk_bf16_f32 v240, v16, v17
    v_mfma_f32_16x16x32_bf16 v[196:199], v[76:79], v[172:175], v[196:199]
    v_cvt_pk_bf16_f32 v241, v18, v19
    v_mfma_f32_16x16x32_bf16 v[200:203], v[108:111], v[172:175], v[200:203]
    v_cvt_pk_bf16_f32 v242, v20, v21
    v_mfma_f32_16x16x32_bf16 v[204:207], v[140:143], v[172:175], v[204:207]
    v_cvt_pk_bf16_f32 v243, v22, v23
    v_mfma_f32_16x16x32_bf16 v[192:195], v[48:51], v[176:179], v[192:195]
    v_cvt_pk_bf16_f32 v244, v24, v25
    v_mfma_f32_16x16x32_bf16 v[196:199], v[80:83], v[176:179], v[196:199]
    v_cvt_pk_bf16_f32 v245, v26, v27
    v_mfma_f32_16x16x32_bf16 v[200:203], v[112:115], v[176:179], v[200:203]
    v_cvt_pk_bf16_f32 v246, v28, v29
    v_mfma_f32_16x16x32_bf16 v[204:207], v[144:147], v[176:179], v[204:207]
    v_cvt_pk_bf16_f32 v247, v30, v31
    v_mfma_f32_16x16x32_bf16 v[192:195], v[52:55], v[180:183], v[192:195]
    global_store_dwordx4 v9, v[240:243], s[26:27]
    v_mfma_f32_16x16x32_bf16 v[196:199], v[84:87], v[180:183], v[196:199]
    global_store_dwordx4 v9, v[244:247], s[26:27] offset:1024
    v_mfma_f32_16x16x32_bf16 v[200:203], v[116:119], v[180:183], v[200:203]
    s_add_u32 s26, s26, s30
    v_mfma_f32_16x16x32_bf16 v[204:207], v[148:151], v[180:183], v[204:207]
    s_addc_u32 s27, s27, 0
    v_mfma_f32_16x16x32_bf16 v[192:195], v[56:59], v[184:187], v[192:195]
    v_mfma_f32_16x16x32_bf16 v[196:199], v[88:91], v[184:187], v[196:199]
    v_mfma_f32_16x16x32_bf16 v[200:203], v[120:123], v[184:187], v[200:203]
    v_mfma_f32_16x16x32_bf16 v[204:207], v[152:155], v[184:187], v[204:207]
    v_mfma_f32_16x16x32_bf16 v[192:195], v[60:63], v[188:191], v[192:195]
    v_mfma_f32_16x16x32_bf16 v[196:199], v[92:95], v[188:191], v[196:199]
    v_mfma_f32_16x16x32_bf16 v[200:203], v[124:127], v[188:191], v[200:203]
    v_mfma_f32_16x16x32_bf16 v[204:207], v[156:159], v[188:191], v[204:207]
    s_nop 7
    v_pk_mul_f32 v[192:193], v[192:193], s[28:29]
    v_pk_mul_f32 v[194:195], v[194:195], s[28:29]
    v_pk_mul_f32 v[196:197], v[196:197], s[28:29]
    v_pk_mul_f32 v[198:199], v[198:199], s[28:29]
    v_pk_mul_f32 v[200:201], v[200:201], s[28:29]
    v_pk_mul_f32 v[202:203], v[202:203], s[28:29]
    v_pk_mul_f32 v[204:205], v[204:205], s[28:29]
    v_pk_mul_f32 v[206:207], v[206:207], s[28:29]
    v_cvt_pk_bf16_f32 v240, v192, v193
    v_cvt_pk_bf16_f32 v241, v194, v195
    v_cvt_pk_bf16_f32 v242, v196, v197
    v_cvt_pk_bf16_f32 v243, v198, v199
    v_cvt_pk_bf16_f32 v244, v200, v201
    v_cvt_pk_bf16_f32 v245, v202, v203
    v_cvt_pk_bf16_f32 v246, v204, v205
    v_cvt_pk_bf16_f32 v247, v206, v207
    global_store_dwordx4 v9, v[240:243], s[26:27]
    global_store_dwordx4 v9, v[244:247], s[26:27] offset:1024
    s_add_u32 s26, s26, s30
    s_addc_u32 s27, s27, 0
    s_branch L_prep_done
L_pf_cB:
    s_mul_i32 s15, s14, 112
    s_add_u32 s15, s15, s11
    s_mul_i32 s15, s15, 7
    s_add_u32 s15, s15, s13
    s_lshl_b32 s15, s15, 11
    s_add_u32 s15, s15, 8519680
    s_add_u32 s26, s6, s15
    s_addc_u32 s27, s7, 0
    s_mov_b32 s30, 229376

    ds_read_b64_tr_b16 v[160:161], v14 offset:0
    ds_read_b64_tr_b16 v[162:163], v14 offset:960
    ds_read_b64_tr_b16 v[164:165], v14 offset:7680
    ds_read_b64_tr_b16 v[166:167], v14 offset:8640
    ds_read_b64_tr_b16 v[168:169], v14 offset:15360
    ds_read_b64_tr_b16 v[170:171], v14 offset:16320
    ds_read_b64_tr_b16 v[172:173], v14 offset:23040
    ds_read_b64_tr_b16 v[174:175], v14 offset:24000
    ds_read_b64_tr_b16 v[176:177], v14 offset:30720
    ds_read_b64_tr_b16 v[178:179], v14 offset:31680
    ds_read_b64_tr_b16 v[180:181], v14 offset:38400
    ds_read_b64_tr_b16 v[182:183], v14 offset:39360
    ds_read_b64_tr_b16 v[184:185], v14 offset:46080
    ds_read_b64_tr_b16 v[186:187], v14 offset:47040
    ds_read_b64_tr_b16 v[188:189], v14 offset:53760
    ds_read_b64_tr_b16 v[190:191], v14 offset:54720
    s_waitcnt lgkmcnt(0)
    ds_read_b64_tr_b16 v[208:209], v14 offset:32
    ds_read_b64_tr_b16 v[210:211], v14 offset:992
    ds_read_b64_tr_b16 v[212:213], v14 offset:7712
    ds_read_b64_tr_b16 v[214:215], v14 offset:8672
    ds_read_b64_tr_b16 v[216:217], v14 offset:15392
    ds_read_b64_tr_b16 v[218:219], v14 offset:16352
    ds_read_b64_tr_b16 v[220:221], v14 offset:23072
    ds_read_b64_tr_b16 v[222:223], v14 offset:24032
    ds_read_b64_tr_b16 v[224:225], v14 offset:30752
    ds_read_b64_tr_b16 v[226:227], v14 offset:31712
    ds_read_b64_tr_b16 v[228:229], v14 offset:38432
    ds_read_b64_tr_b16 v[230:231], v14 offset:39392
    ds_read_b64_tr_b16 v[232:233], v14 offset:46112
    ds_read_b64_tr_b16 v[234:235], v14 offset:47072
    ds_read_b64_tr_b16 v[236:237], v14 offset:53792
    ds_read_b64_tr_b16 v[238:239], v14 offset:54752
    v_mfma_f32_16x16x32_bf16 v[192:195], v[32:35], v[160:163], 0
    v_mfma_f32_16x16x32_bf16 v[196:199], v[64:67], v[160:163], 0
    v_mfma_f32_16x16x32_bf16 v[200:203], v[96:99], v[160:163], 0
    v_mfma_f32_16x16x32_bf16 v[204:207], v[128:131], v[160:163], 0
    v_mfma_f32_16x16x32_bf16 v[192:195], v[36:39], v[164:167], v[192:195]
    v_mfma_f32_16x16x32_bf16 v[196:199], v[68:71], v[164:167], v[196:199]
    v_mfma_f32_16x16x32_bf16 v[200:203], v[100:103], v[164:167], v[200:203]
    v_mfma_f32_16x16x32_bf16 v[204:207], v[132:135], v[164:167], v[204:207]
    v_mfma_f32_16x16x32_bf16 v[192:195], v[40:43], v[168:171], v[192:195]
    v_mfma_f32_16x16x32_bf16 v[196:199], v[72:75], v[168:171], v[196:199]
    v_mfma_f32_16x16x32_bf16 v[200:203], v[104:107], v[168:171], v[200:203]
    v_mfma_f32_16x16x32_bf16 v[204:207], v[136:139], v[168:171], v[204:207]
    v_mfma_f32_16x16x32_bf16 v[192:195], v[44:47], v[172:175], v[192:195]
    v_mfma_f32_16x16x32_bf16 v[196:199], v[76:79], v[172:175], v[196:199]
    v_mfma_f32_16x16x32_bf16 v[200:203], v[108:111], v[172:175], v[200:203]
    v_mfma_f32_16x16x32_bf16 v[204:207], v[140:143], v[172:175], v[204:207]
    v_mfma_f32_16x16x32_bf16 v[192:195], v[48:51], v[176:179], v[192:195]
    v_mfma_f32_16x16x32_bf16 v[196:199], v[80:83], v[176:179], v[196:199]
    v_mfma_f32_16x16x32_bf16 v[200:203], v[112:115], v[176:179], v[200:203]
    v_mfma_f32_16x16x32_bf16 v[204:207], v[144:147], v[176:179], v[204:207]
    v_mfma_f32_16x16x32_bf16 v[192:195], v[52:55], v[180:183], v[192:195]
    v_mfma_f32_16x16x32_bf16 v[196:199], v[84:87], v[180:183], v[196:199]
    v_mfma_f32_16x16x32_bf16 v[200:203], v[116:119], v[180:183], v[200:203]
    v_mfma_f32_16x16x32_bf16 v[204:207], v[148:151], v[180:183], v[204:207]
    v_mfma_f32_16x16x32_bf16 v[192:195], v[56:59], v[184:187], v[192:195]
    v_mfma_f32_16x16x32_bf16 v[196:199], v[88:91], v[184:187], v[196:199]
    v_mfma_f32_16x16x32_bf16 v[200:203], v[120:123], v[184:187], v[200:203]
    v_mfma_f32_16x16x32_bf16 v[204:207], v[152:155], v[184:187], v[204:207]
    v_mfma_f32_16x16x32_bf16 v[192:195], v[60:63], v[188:191], v[192:195]
    v_mfma_f32_16x16x32_bf16 v[196:199], v[92:95], v[188:191], v[196:199]
    v_mfma_f32_16x16x32_bf16 v[200:203], v[124:127], v[188:191], v[200:203]
    v_mfma_f32_16x16x32_bf16 v[204:207], v[156:159], v[188:191], v[204:207]
    s_waitcnt lgkmcnt(0)
    ds_read_b64_tr_b16 v[160:161], v14 offset:64
    ds_read_b64_tr_b16 v[162:163], v14 offset:1024
    ds_read_b64_tr_b16 v[164:165], v14 offset:7744
    ds_read_b64_tr_b16 v[166:167], v14 offset:8704
    ds_read_b64_tr_b16 v[168:169], v14 offset:15424
    ds_read_b64_tr_b16 v[170:171], v14 offset:16384
    ds_read_b64_tr_b16 v[172:173], v14 offset:23104
    ds_read_b64_tr_b16 v[174:175], v14 offset:24064
    ds_read_b64_tr_b16 v[176:177], v14 offset:30784
    ds_read_b64_tr_b16 v[178:179], v14 offset:31744
    ds_read_b64_tr_b16 v[180:181], v14 offset:38464
    ds_read_b64_tr_b16 v[182:183], v14 offset:39424
    ds_read_b64_tr_b16 v[184:185], v14 offset:46144
    ds_read_b64_tr_b16 v[186:187], v14 offset:47104
    ds_read_b64_tr_b16 v[188:189], v14 offset:53824
    ds_read_b64_tr_b16 v[190:191], v14 offset:54784
    v_mfma_f32_16x16x32_bf16 v[16:19], v[32:35], v[208:211], 0
    v_mfma_f32_16x16x32_bf16 v[20:23], v[64:67], v[208:211], 0
    v_mfma_f32_16x16x32_bf16 v[24:27], v[96:99], v[208:211], 0
    v_mfma_f32_16x16x32_bf16 v[28:31], v[128:131], v[208:211], 0
    v_mfma_f32_16x16x32_bf16 v[16:19], v[36:39], v[212:215], v[16:19]
    v_cvt_pk_bf16_f32 v240, v192, v193
    v_mfma_f32_16x16x32_bf16 v[20:23], v[68:71], v[212:215], v[20:23]
    v_cvt_pk_bf16_f32 v241, v194, v195
    v_mfma_f32_16x16x32_bf16 v[24:27], v[100:103], v[212:215], v[24:27]
    v_cvt_pk_bf16_f32 v242, v196, v197
    v_mfma_f32_16x16x32_bf16 v[28:31], v[132:135], v[212:215], v[28:31]
    v_cvt_pk_bf16_f32 v243, v198, v199
    v_mfma_f32_16x16x32_bf16 v[16:19], v[40:43], v[216:219], v[16:19]
    v_cvt_pk_bf16_f32 v244, v200, v201
    v_mfma_f32_16x16x32_bf16 v[20:23], v[72:75], v[216:219], v[20:23]
    v_cvt_pk_bf16_f32 v245, v202, v203
    v_mfma_f32_16x16x32_bf16 v[24:27], v[104:107], v[216:219], v[24:27]
    v_cvt_pk_bf16_f32 v246, v204, v205
    v_mfma_f32_16x16x32_bf16 v[28:31], v[136:139], v[216:219], v[28:31]
    v_cvt_pk_bf16_f32 v247, v206, v207
    v_mfma_f32_16x16x32_bf16 v[16:19], v[44:47], v[220:223], v[16:19]
    global_store_dwordx4 v9, v[240:243], s[26:27]
    v_mfma_f32_16x16x32_bf16 v[20:23], v[76:79], v[220:223], v[20:23]
    global_store_dwordx4 v9, v[244:247], s[26:27] offset:1024
    v_mfma_f32_16x16x32_bf16 v[24:27], v[108:111], v[220:223], v[24:27]
    s_add_u32 s26, s26, s30
    v_mfma_f32_16x16x32_bf16 v[28:31], v[140:143], v[220:223], v[28:31]
    s_addc_u32 s27, s27, 0
    v_mfma_f32_16x16x32_bf16 v[16:19], v[48:51], v[224:227], v[16:19]
    v_mfma_f32_16x16x32_bf16 v[20:23], v[80:83], v[224:227], v[20:23]
    v_mfma_f32_16x16x32_bf16 v[24:27], v[112:115], v[224:227], v[24:27]
    v_mfma_f32_16x16x32_bf16 v[28:31], v[144:147], v[224:227], v[28:31]
    v_mfma_f32_16x16x32_bf16 v[16:19], v[52:55], v[228:231], v[16:19]
    v_mfma_f32_16x16x32_bf16 v[20:23], v[84:87], v[228:231], v[20:23]
    v_mfma_f32_16x16x32_bf16 v[24:27], v[116:119], v[228:231], v[24:27]
    v_mfma_f32_16x16x32_bf16 v[28:31], v[148:151], v[228:231], v[28:31]
    v_mfma_f32_16x16x32_bf16 v[16:19], v[56:59], v[232:235], v[16:19]
    v_mfma_f32_16x16x32_bf16 v[20:23], v[88:91], v[232:235], v[20:23]
    v_mfma_f32_16x16x32_bf16 v[24:27], v[120:123], v[232:235], v[24:27]
    v_mfma_f32_16x16x32_bf16 v[28:31], v[152:155], v[232:235], v[28:31]
    v_mfma_f32_16x16x32_bf16 v[16:19], v[60:63], v[236:239], v[16:19]
    v_mfma_f32_16x16x32_bf16 v[20:23], v[92:95], v[236:239], v[20:23]
    v_mfma_f32_16x16x32_bf16 v[24:27], v[124:127], v[236:239], v[24:27]
    v_mfma_f32_16x16x32_bf16 v[28:31], v[156:159], v[236:239], v[28:31]
    s_waitcnt lgkmcnt(0)
    ds_read_b64_tr_b16 v[208:209], v14 offset:96
    ds_read_b64_tr_b16 v[210:211], v14 offset:1056
    ds_read_b64_tr_b16 v[212:213], v14 offset:7776
    ds_read_b64_tr_b16 v[214:215], v14 offset:8736
    ds_read_b64_tr_b16 v[216:217], v14 offset:15456
    ds_read_b64_tr_b16 v[218:219], v14 offset:16416
    ds_read_b64_tr_b16 v[220:221], v14 offset:23136
    ds_read_b64_tr_b16 v[222:223], v14 offset:24096
    ds_read_b64_tr_b16 v[224:225], v14 offset:30816
    ds_read_b64_tr_b16 v[226:227], v14 offset:31776
    ds_read_b64_tr_b16 v[228:229], v14 offset:38496
    ds_read_b64_tr_b16 v[230:231], v14 offset:39456
    ds_read_b64_tr_b16 v[232:233], v14 offset:46176
    ds_read_b64_tr_b16 v[234:235], v14 offset:47136
    ds_read_b64_tr_b16 v[236:237], v14 offset:53856
    ds_read_b64_tr_b16 v[238:239], v14 offset:54816
    v_mfma_f32_16x16x32_bf16 v[192:195], v[32:35], v[160:163], 0
    v_mfma_f32_16x16x32_bf16 v[196:199], v[64:67], v[160:163], 0
    v_mfma_f32_16x16x32_bf16 v[200:203], v[96:99], v[160:163], 0
    v_mfma_f32_16x16x32_bf16 v[204:207], v[128:131], v[160:163], 0
    v_mfma_f32_16x16x32_bf16 v[192:195], v[36:39], v[164:167], v[192:195]
    v_cvt_pk_bf16_f32 v240, v16, v17
    v_mfma_f32_16x16x32_bf16 v[196:199], v[68:71], v[164:167], v[196:199]
    v_cvt_pk_bf16_f32 v241, v18, v19
    v_mfma_f32_16x16x32_bf16 v[200:203], v[100:103], v[164:167], v[200:203]
    v_cvt_pk_bf16_f32 v242, v20, v21
    v_mfma_f32_16x16x32_bf16 v[204:207], v[132:135], v[164:167], v[204:207]
    v_cvt_pk_bf16_f32 v243, v22, v23
    v_mfma_f32_16x16x32_bf16 v[192:195], v[40:43], v[168:171], v[192:195]
    v_cvt_pk_bf16_f32 v244, v24, v25
    v_mfma_f32_16x16x32_bf16 v[196:199], v[72:75], v[168:171], v[196:199]
    v_cvt_pk_bf16_f32 v245, v26, v27
    v_mfma_f32_16x16x32_bf16 v[200:203], v[104:107], v[168:171], v[200:203]
    v_cvt_pk_bf16_f32 v246, v28, v29
    v_mfma_f32_16x16x32_bf16 v[204:207], v[136:139], v[168:171], v[204:207]
    v_cvt_pk_bf16_f32 v247, v30, v31
    v_mfma_f32_16x16x32_bf16 v[192:195], v[44:47], v[172:175], v[192:195]
    global_store_dwordx4 v9, v[240:243], s[26:27]
    v_mfma_f32_16x16x32_bf16 v[196:199], v[76:79], v[172:175], v[196:199]
    global_store_dwordx4 v9, v[244:247], s[26:27] offset:1024
    v_mfma_f32_16x16x32_bf16 v[200:203], v[108:111], v[172:175], v[200:203]
    s_add_u32 s26, s26, s30
    v_mfma_f32_16x16x32_bf16 v[204:207], v[140:143], v[172:175], v[204:207]
    s_addc_u32 s27, s27, 0
    v_mfma_f32_16x16x32_bf16 v[192:195], v[48:51], v[176:179], v[192:195]
    v_mfma_f32_16x16x32_bf16 v[196:199], v[80:83], v[176:179], v[196:199]
    v_mfma_f32_16x16x32_bf16 v[200:203], v[112:115], v[176:179], v[200:203]
    v_mfma_f32_16x16x32_bf16 v[204:207], v[144:147], v[176:179], v[204:207]
    v_mfma_f32_16x16x32_bf16 v[192:195], v[52:55], v[180:183], v[192:195]
    v_mfma_f32_16x16x32_bf16 v[196:199], v[84:87], v[180:183], v[196:199]
    v_mfma_f32_16x16x32_bf16 v[200:203], v[116:119], v[180:183], v[200:203]
    v_mfma_f32_16x16x32_bf16 v[204:207], v[148:151], v[180:183], v[204:207]
    v_mfma_f32_16x16x32_bf16 v[192:195], v[56:59], v[184:187], v[192:195]
    v_mfma_f32_16x16x32_bf16 v[196:199], v[88:91], v[184:187], v[196:199]
    v_mfma_f32_16x16x32_bf16 v[200:203], v[120:123], v[184:187], v[200:203]
    v_mfma_f32_16x16x32_bf16 v[204:207], v[152:155], v[184:187], v[204:207]
    v_mfma_f32_16x16x32_bf16 v[192:195], v[60:63], v[188:191], v[192:195]
    v_mfma_f32_16x16x32_bf16 v[196:199], v[92:95], v[188:191], v[196:199]
    v_mfma_f32_16x16x32_bf16 v[200:203], v[124:127], v[188:191], v[200:203]
    v_mfma_f32_16x16x32_bf16 v[204:207], v[156:159], v[188:191], v[204:207]
    s_waitcnt lgkmcnt(0)
    ds_read_b64_tr_b16 v[160:161], v14 offset:128
    ds_read_b64_tr_b16 v[162:163], v14 offset:1088
    ds_read_b64_tr_b16 v[164:165], v14 offset:7808
    ds_read_b64_tr_b16 v[166:167], v14 offset:8768
    ds_read_b64_tr_b16 v[168:169], v14 offset:15488
    ds_read_b64_tr_b16 v[170:171], v14 offset:16448
    ds_read_b64_tr_b16 v[172:173], v14 offset:23168
    ds_read_b64_tr_b16 v[174:175], v14 offset:24128
    ds_read_b64_tr_b16 v[176:177], v14 offset:30848
    ds_read_b64_tr_b16 v[178:179], v14 offset:31808
    ds_read_b64_tr_b16 v[180:181], v14 offset:38528
    ds_read_b64_tr_b16 v[182:183], v14 offset:39488
    ds_read_b64_tr_b16 v[184:185], v14 offset:46208
    ds_read_b64_tr_b16 v[186:187], v14 offset:47168
    ds_read_b64_tr_b16 v[188:189], v14 offset:53888
    ds_read_b64_tr_b16 v[190:191], v14 offset:54848
    v_mfma_f32_16x16x32_bf16 v[16:19], v[32:35], v[208:211], 0
    v_mfma_f32_16x16x32_bf16 v[20:23], v[64:67], v[208:211], 0
    v_mfma_f32_16x16x32_bf16 v[24:27], v[96:99], v[208:211], 0
    v_mfma_f32_16x16x32_bf16 v[28:31], v[128:131], v[208:211], 0
    v_mfma_f32_16x16x32_bf16 v[16:19], v[36:39], v[212:215], v[16:19]
    v_cvt_pk_bf16_f32 v240, v192, v193
    v_mfma_f32_16x16x32_bf16 v[20:23], v[68:71], v[212:215], v[20:23]
    v_cvt_pk_bf16_f32 v241, v194, v195
    v_mfma_f32_16x16x32_bf16 v[24:27], v[100:103], v[212:215], v[24:27]
    v_cvt_pk_bf16_f32 v242, v196, v197
    v_mfma_f32_16x16x32_bf16 v[28:31], v[132:135], v[212:215], v[28:31]
    v_cvt_pk_bf16_f32 v243, v198, v199
    v_mfma_f32_16x16x32_bf16 v[16:19], v[40:43], v[216:219], v[16:19]
    v_cvt_pk_bf16_f32 v244, v200, v201
    v_mfma_f32_16x16x32_bf16 v[20:23], v[72:75], v[216:219], v[20:23]
    v_cvt_pk_bf16_f32 v245, v202, v203
    v_mfma_f32_16x16x32_bf16 v[24:27], v[104:107], v[216:219], v[24:27]
    v_cvt_pk_bf16_f32 v246, v204, v205
    v_mfma_f32_16x16x32_bf16 v[28:31], v[136:139], v[216:219], v[28:31]
    v_cvt_pk_bf16_f32 v247, v206, v207
    v_mfma_f32_16x16x32_bf16 v[16:19], v[44:47], v[220:223], v[16:19]
    global_store_dwordx4 v9, v[240:243], s[26:27]
    v_mfma_f32_16x16x32_bf16 v[20:23], v[76:79], v[220:223], v[20:23]
    global_store_dwordx4 v9, v[244:247], s[26:27] offset:1024
    v_mfma_f32_16x16x32_bf16 v[24:27], v[108:111], v[220:223], v[24:27]
    s_add_u32 s26, s26, s30
    v_mfma_f32_16x16x32_bf16 v[28:31], v[140:143], v[220:223], v[28:31]
    s_addc_u32 s27, s27, 0
    v_mfma_f32_16x16x32_bf16 v[16:19], v[48:51], v[224:227], v[16:19]
    v_mfma_f32_16x16x32_bf16 v[20:23], v[80:83], v[224:227], v[20:23]
    v_mfma_f32_16x16x32_bf16 v[24:27], v[112:115], v[224:227], v[24:27]
    v_mfma_f32_16x16x32_bf16 v[28:31], v[144:147], v[224:227], v[28:31]
    v_mfma_f32_16x16x32_bf16 v[16:19], v[52:55], v[228:231], v[16:19]
    v_mfma_f32_16x16x32_bf16 v[20:23], v[84:87], v[228:231], v[20:23]
    v_mfma_f32_16x16x32_bf16 v[24:27], v[116:119], v[228:231], v[24:27]
    v_mfma_f32_16x16x32_bf16 v[28:31], v[148:151], v[228:231], v[28:31]
    v_mfma_f32_16x16x32_bf16 v[16:19], v[56:59], v[232:235], v[16:19]
    v_mfma_f32_16x16x32_bf16 v[20:23], v[88:91], v[232:235], v[20:23]
    v_mfma_f32_16x16x32_bf16 v[24:27], v[120:123], v[232:235], v[24:27]
    v_mfma_f32_16x16x32_bf16 v[28:31], v[152:155], v[232:235], v[28:31]
    v_mfma_f32_16x16x32_bf16 v[16:19], v[60:63], v[236:239], v[16:19]
    v_mfma_f32_16x16x32_bf16 v[20:23], v[92:95], v[236:239], v[20:23]
    v_mfma_f32_16x16x32_bf16 v[24:27], v[124:127], v[236:239], v[24:27]
    v_mfma_f32_16x16x32_bf16 v[28:31], v[156:159], v[236:239], v[28:31]
    s_waitcnt lgkmcnt(0)
    ds_read_b64_tr_b16 v[208:209], v14 offset:160
    ds_read_b64_tr_b16 v[210:211], v14 offset:1120
    ds_read_b64_tr_b16 v[212:213], v14 offset:7840
    ds_read_b64_tr_b16 v[214:215], v14 offset:8800
    ds_read_b64_tr_b16 v[216:217], v14 offset:15520
    ds_read_b64_tr_b16 v[218:219], v14 offset:16480
    ds_read_b64_tr_b16 v[220:221], v14 offset:23200
    ds_read_b64_tr_b16 v[222:223], v14 offset:24160
    ds_read_b64_tr_b16 v[224:225], v14 offset:30880
    ds_read_b64_tr_b16 v[226:227], v14 offset:31840
    ds_read_b64_tr_b16 v[228:229], v14 offset:38560
    ds_read_b64_tr_b16 v[230:231], v14 offset:39520
    ds_read_b64_tr_b16 v[232:233], v14 offset:46240
    ds_read_b64_tr_b16 v[234:235], v14 offset:47200
    ds_read_b64_tr_b16 v[236:237], v14 offset:53920
    ds_read_b64_tr_b16 v[238:239], v14 offset:54880
    v_mfma_f32_16x16x32_bf16 v[192:195], v[32:35], v[160:163], 0
    v_mfma_f32_16x16x32_bf16 v[196:199], v[64:67], v[160:163], 0
    v_mfma_f32_16x16x32_bf16 v[200:203], v[96:99], v[160:163], 0
    v_mfma_f32_16x16x32_bf16 v[204:207], v[128:131], v[160:163], 0
    v_mfma_f32_16x16x32_bf16 v[192:195], v[36:39], v[164:167], v[192:195]
    v_cvt_pk_bf16_f32 v240, v16, v17
    v_mfma_f32_16x16x32_bf16 v[196:199], v[68:71], v[164:167], v[196:199]
    v_cvt_pk_bf16_f32 v241, v18, v19
    v_mfma_f32_16x16x32_bf16 v[200:203], v[100:103], v[164:167], v[200:203]
    v_cvt_pk_bf16_f32 v242, v20, v21
    v_mfma_f32_16x16x32_bf16 v[204:207], v[132:135], v[164:167], v[204:207]
    v_cvt_pk_bf16_f32 v243, v22, v23
    v_mfma_f32_16x16x32_bf16 v[192:195], v[40:43], v[168:171], v[192:195]
    v_cvt_pk_bf16_f32 v244, v24, v25
    v_mfma_f32_16x16x32_bf16 v[196:199], v[72:75], v[168:171], v[196:199]
    v_cvt_pk_bf16_f32 v245, v26, v27
    v_mfma_f32_16x16x32_bf16 v[200:203], v[104:107], v[168:171], v[200:203]
    v_cvt_pk_bf16_f32 v246, v28, v29
    v_mfma_f32_16x16x32_bf16 v[204:207], v[136:139], v[168:171], v[204:207]
    v_cvt_pk_bf16_f32 v247, v30, v31
    v_mfma_f32_16x16x32_bf16 v[192:195], v[44:47], v[172:175], v[192:195]
    global_store_dwordx4 v9, v[240:243], s[26:27]
    v_mfma_f32_16x16x32_bf16 v[196:199], v[76:79], v[172:175], v[196:199]
    global_store_dwordx4 v9, v[244:247], s[26:27] offset:1024
    v_mfma_f32_16x16x32_bf16 v[200:203], v[108:111], v[172:175], v[200:203]
    s_add_u32 s26, s26, s30
    v_mfma_f32_16x16x32_bf16 v[204:207], v[140:143], v[172:175], v[204:207]
    s_addc_u32 s27, s27, 0
    v_mfma_f32_16x16x32_bf16 v[192:195], v[48:51], v[176:179], v[192:195]
    v_mfma_f32_16x16x32_bf16 v[196:199], v[80:83], v[176:179], v[196:199]
    v_mfma_f32_16x16x32_bf16 v[200:203], v[112:115], v[176:179], v[200:203]
    v_mfma_f32_16x16x32_bf16 v[204:207], v[144:147], v[176:179], v[204:207]
    v_mfma_f32_16x16x32_bf16 v[192:195], v[52:55], v[180:183], v[192:195]
    v_mfma_f32_16x16x32_bf16 v[196:199], v[84:87], v[180:183], v[196:199]
    v_mfma_f32_16x16x32_bf16 v[200:203], v[116:119], v[180:183], v[200:203]
    v_mfma_f32_16x16x32_bf16 v[204:207], v[148:151], v[180:183], v[204:207]
    v_mfma_f32_16x16x32_bf16 v[192:195], v[56:59], v[184:187], v[192:195]
    v_mfma_f32_16x16x32_bf16 v[196:199], v[88:91], v[184:187], v[196:199]
    v_mfma_f32_16x16x32_bf16 v[200:203], v[120:123], v[184:187], v[200:203]
    v_mfma_f32_16x16x32_bf16 v[204:207], v[152:155], v[184:187], v[204:207]
    v_mfma_f32_16x16x32_bf16 v[192:195], v[60:63], v[188:191], v[192:195]
    v_mfma_f32_16x16x32_bf16 v[196:199], v[92:95], v[188:191], v[196:199]
    v_mfma_f32_16x16x32_bf16 v[200:203], v[124:127], v[188:191], v[200:203]
    v_mfma_f32_16x16x32_bf16 v[204:207], v[156:159], v[188:191], v[204:207]
    s_waitcnt lgkmcnt(0)
    ds_read_b64_tr_b16 v[160:161], v14 offset:192
    ds_read_b64_tr_b16 v[162:163], v14 offset:1152
    ds_read_b64_tr_b16 v[164:165], v14 offset:7872
    ds_read_b64_tr_b16 v[166:167], v14 offset:8832
    ds_read_b64_tr_b16 v[168:169], v14 offset:15552
    ds_read_b64_tr_b16 v[170:171], v14 offset:16512
    ds_read_b64_tr_b16 v[172:173], v14 offset:23232
    ds_read_b64_tr_b16 v[174:175], v14 offset:24192
    ds_read_b64_tr_b16 v[176:177], v14 offset:30912
    ds_read_b64_tr_b16 v[178:179], v14 offset:31872
    ds_read_b64_tr_b16 v[180:181], v14 offset:38592
    ds_read_b64_tr_b16 v[182:183], v14 offset:39552
    ds_read_b64_tr_b16 v[184:185], v14 offset:46272
    ds_read_b64_tr_b16 v[186:187], v14 offset:47232
    ds_read_b64_tr_b16 v[188:189], v14 offset:53952
    ds_read_b64_tr_b16 v[190:191], v14 offset:54912
    v_mfma_f32_16x16x32_bf16 v[16:19], v[32:35], v[208:211], 0
    v_mfma_f32_16x16x32_bf16 v[20:23], v[64:67], v[208:211], 0
    v_mfma_f32_16x16x32_bf16 v[24:27], v[96:99], v[208:211], 0
    v_mfma_f32_16x16x32_bf16 v[28:31], v[128:131], v[208:211], 0
    v_mfma_f32_16x16x32_bf16 v[16:19], v[36:39], v[212:215], v[16:19]
    v_cvt_pk_bf16_f32 v240, v192, v193
    v_mfma_f32_16x16x32_bf16 v[20:23], v[68:71], v[212:215], v[20:23]
    v_cvt_pk_bf16_f32 v241, v194, v195
    v_mfma_f32_16x16x32_bf16 v[24:27], v[100:103], v[212:215], v[24:27]
    v_cvt_pk_bf16_f32 v242, v196, v197
    v_mfma_f32_16x16x32_bf16 v[28:31], v[132:135], v[212:215], v[28:31]
    v_cvt_pk_bf16_f32 v243, v198, v199
    v_mfma_f32_16x16x32_bf16 v[16:19], v[40:43], v[216:219], v[16:19]
    v_cvt_pk_bf16_f32 v244, v200, v201
    v_mfma_f32_16x16x32_bf16 v[20:23], v[72:75], v[216:219], v[20:23]
    v_cvt_pk_bf16_f32 v245, v202, v203
    v_mfma_f32_16x16x32_bf16 v[24:27], v[104:107], v[216:219], v[24:27]
    v_cvt_pk_bf16_f32 v246, v204, v205
    v_mfma_f32_16x16x32_bf16 v[28:31], v[136:139], v[216:219], v[28:31]
    v_cvt_pk_bf16_f32 v247, v206, v207
    v_mfma_f32_16x16x32_bf16 v[16:19], v[44:47], v[220:223], v[16:19]
    global_store_dwordx4 v9, v[240:243], s[26:27]
    v_mfma_f32_16x16x32_bf16 v[20:23], v[76:79], v[220:223], v[20:23]
    global_store_dwordx4 v9, v[244:247], s[26:27] offset:1024
    v_mfma_f32_16x16x32_bf16 v[24:27], v[108:111], v[220:223], v[24:27]
    s_add_u32 s26, s26, s30
    v_mfma_f32_16x16x32_bf16 v[28:31], v[140:143], v[220:223], v[28:31]
    s_addc_u32 s27, s27, 0
    v_mfma_f32_16x16x32_bf16 v[16:19], v[48:51], v[224:227], v[16:19]
    v_mfma_f32_16x16x32_bf16 v[20:23], v[80:83], v[224:227], v[20:23]
    v_mfma_f32_16x16x32_bf16 v[24:27], v[112:115], v[224:227], v[24:27]
    v_mfma_f32_16x16x32_bf16 v[28:31], v[144:147], v[224:227], v[28:31]
    v_mfma_f32_16x16x32_bf16 v[16:19], v[52:55], v[228:231], v[16:19]
    v_mfma_f32_16x16x32_bf16 v[20:23], v[84:87], v[228:231], v[20:23]
    v_mfma_f32_16x16x32_bf16 v[24:27], v[116:119], v[228:231], v[24:27]
    v_mfma_f32_16x16x32_bf16 v[28:31], v[148:151], v[228:231], v[28:31]
    v_mfma_f32_16x16x32_bf16 v[16:19], v[56:59], v[232:235], v[16:19]
    v_mfma_f32_16x16x32_bf16 v[20:23], v[88:91], v[232:235], v[20:23]
    v_mfma_f32_16x16x32_bf16 v[24:27], v[120:123], v[232:235], v[24:27]
    v_mfma_f32_16x16x32_bf16 v[28:31], v[152:155], v[232:235], v[28:31]
    v_mfma_f32_16x16x32_bf16 v[16:19], v[60:63], v[236:239], v[16:19]
    v_mfma_f32_16x16x32_bf16 v[20:23], v[92:95], v[236:239], v[20:23]
    v_mfma_f32_16x16x32_bf16 v[24:27], v[124:127], v[236:239], v[24:27]
    v_mfma_f32_16x16x32_bf16 v[28:31], v[156:159], v[236:239], v[28:31]
    s_waitcnt lgkmcnt(0)
    v_mfma_f32_16x16x32_bf16 v[192:195], v[32:35], v[160:163], 0
    v_mfma_f32_16x16x32_bf16 v[196:199], v[64:67], v[160:163], 0
    v_mfma_f32_16x16x32_bf16 v[200:203], v[96:99], v[160:163], 0
    v_mfma_f32_16x16x32_bf16 v[204:207], v[128:131], v[160:163], 0
    v_mfma_f32_16x16x32_bf16 v[192:195], v[36:39], v[164:167], v[192:195]
    v_cvt_pk_bf16_f32 v240, v16, v17
    v_mfma_f32_16x16x32_bf16 v[196:199], v[68:71], v[164:167], v[196:199]
    v_cvt_pk_bf16_f32 v241, v18, v19
    v_mfma_f32_16x16x32_bf16 v[200:203], v[100:103], v[164:167], v[200:203]
    v_cvt_pk_bf16_f32 v242, v20, v21
    v_mfma_f32_16x16x32_bf16 v[204:207], v[132:135], v[164:167], v[204:207]
    v_cvt_pk_bf16_f32 v243, v22, v23
    v_mfma_f32_16x16x32_bf16 v[192:195], v[40:43], v[168:171], v[192:195]
    v_cvt_pk_bf16_f32 v244, v24, v25
    v_mfma_f32_16x16x32_bf16 v[196:199], v[72:75], v[168:171], v[196:199]
    v_cvt_pk_bf16_f32 v245, v26, v27
    v_mfma_f32_16x16x32_bf16 v[200:203], v[104:107], v[168:171], v[200:203]
    v_cvt_pk_bf16_f32 v246, v28, v29
    v_mfma_f32_16x16x32_bf16 v[204:207], v[136:139], v[168:171], v[204:207]
    v_cvt_pk_bf16_f32 v247, v30, v31
    v_mfma_f32_16x16x32_bf16 v[192:195], v[44:47], v[172:175], v[192:195]
    global_store_dwordx4 v9, v[240:243], s[26:27]
    v_mfma_f32_16x16x32_bf16 v[196:199], v[76:79], v[172:175], v[196:199]
    global_store_dwordx4 v9, v[244:247], s[26:27] offset:1024
    v_mfma_f32_16x16x32_bf16 v[200:203], v[108:111], v[172:175], v[200:203]
    s_add_u32 s26, s26, s30
    v_mfma_f32_16x16x32_bf16 v[204:207], v[140:143], v[172:175], v[204:207]
    s_addc_u32 s27, s27, 0
    v_mfma_f32_16x16x32_bf16 v[192:195], v[48:51], v[176:179], v[192:195]
    v_mfma_f32_16x16x32_bf16 v[196:199], v[80:83], v[176:179], v[196:199]
    v_mfma_f32_16x16x32_bf16 v[200:203], v[112:115], v[176:179], v[200:203]
    v_mfma_f32_16x16x32_bf16 v[204:207], v[144:147], v[176:179], v[204:207]
    v_mfma_f32_16x16x32_bf16 v[192:195], v[52:55], v[180:183], v[192:195]
    v_mfma_f32_16x16x32_bf16 v[196:199], v[84:87], v[180:183], v[196:199]
    v_mfma_f32_16x16x32_bf16 v[200:203], v[116:119], v[180:183], v[200:203]
    v_mfma_f32_16x16x32_bf16 v[204:207], v[148:151], v[180:183], v[204:207]
    v_mfma_f32_16x16x32_bf16 v[192:195], v[56:59], v[184:187], v[192:195]
    v_mfma_f32_16x16x32_bf16 v[196:199], v[88:91], v[184:187], v[196:199]
    v_mfma_f32_16x16x32_bf16 v[200:203], v[120:123], v[184:187], v[200:203]
    v_mfma_f32_16x16x32_bf16 v[204:207], v[152:155], v[184:187], v[204:207]
    v_mfma_f32_16x16x32_bf16 v[192:195], v[60:63], v[188:191], v[192:195]
    v_mfma_f32_16x16x32_bf16 v[196:199], v[92:95], v[188:191], v[196:199]
    v_mfma_f32_16x16x32_bf16 v[200:203], v[124:127], v[188:191], v[200:203]
    v_mfma_f32_16x16x32_bf16 v[204:207], v[156:159], v[188:191], v[204:207]
    s_nop 7
    v_cvt_pk_bf16_f32 v240, v192, v193
    v_cvt_pk_bf16_f32 v241, v194, v195
    v_cvt_pk_bf16_f32 v242, v196, v197
    v_cvt_pk_bf16_f32 v243, v198, v199
    v_cvt_pk_bf16_f32 v244, v200, v201
    v_cvt_pk_bf16_f32 v245, v202, v203
    v_cvt_pk_bf16_f32 v246, v204, v205
    v_cvt_pk_bf16_f32 v247, v206, v207
    global_store_dwordx4 v9, v[240:243], s[26:27]
    global_store_dwordx4 v9, v[244:247], s[26:27] offset:1024
    s_add_u32 s26, s26, s30
    s_addc_u32 s27, s27, 0
    s_branch L_prep_done
L_prep_t2:
    s_cmp_ge_u32 s2, 320
    s_cbranch_scc1 L_prep_t3
    s_sub_u32 s9, s2, 256
    v_and_b32 v2, 15, v1
    v_lshrrev_b32 v3, 4, v1
    s_mul_i32 s10, s9, 28672
    s_mul_i32 s11, s8, 224
    s_add_u32 s11, s11, s10
    v_mul_u32_u24 v4, 896, v2
    v_add_u32 v4, s11, v4
    v_lshl_add_u32 v5, v3, 3, v4
    v_lshl_add_u32 v4, v3, 4, v4
    s_mul_i32 s11, s8, 7168
    s_add_u32 s11, s11, s10
    s_add_u32 s11, s11, 51642368
    v_lshlrev_b32 v6, 4, v1
    v_add_u32 v6, s11, v6
    v_lshlrev_b32 v7, 3, v1
    v_add_u32 v7, s11, v7
    v_add_u32 v8, 14336, v4
    v_add_u32 v9, 14336, v5
    v_add_u32 v10, 3584, v6
    v_add_u32 v11, 3584, v7
    v_mul_u32_u24 v12, 896, v2
    v_add_u32 v12, s10, v12
    v_lshrrev_b32 v13, 1, v3
    v_lshl_add_u32 v12, v13, 5, v12
    v_and_b32 v13, 1, v3
    v_lshl_add_u32 v12, v13, 3, v12
    s_lshl_b32 s11, s8, 6
    v_add_u32 v12, s11, v12
    v_add_u32 v13, 14336, v12
    s_lshl_b32 s11, s8, 10
    s_add_u32 s11, s11, s10
    s_add_u32 s11, s11, 92602368
    v_lshlrev_b32 v14, 4, v1
    v_add_u32 v14, s11, v14
    v_add_u32 v15, 14336, v14
    s_cmp_ge_u32 s8, 2
    s_cselect_b32 s12, 2, 3
    s_lshl_b32 s12, s12, 8

    global_load_dwordx4 v[16:19], v4, s[4:5] offset:0
    global_load_dwordx4 v[20:23], v4, s[4:5] offset:64
    global_load_dwordx4 v[24:27], v4, s[4:5] offset:128
    global_load_dwordx2 v[28:29], v5, s[4:5] offset:192
    global_load_dwordx4 v[32:35], v8, s[4:5] offset:0
    global_load_dwordx4 v[36:39], v8, s[4:5] offset:64
    global_load_dwordx4 v[40:43], v8, s[4:5] offset:128
    global_load_dwordx2 v[44:45], v9, s[4:5] offset:192
    global_load_dwordx2 v[48:49], v12, s[4:5] offset:0
    global_load_dwordx2 v[50:51], v12, s[4:5] offset:16
    global_load_dwordx2 v[52:53], v13, s[4:5] offset:0
    global_load_dwordx2 v[54:55], v13, s[4:5] offset:16
    global_load_dwordx2 v[56:57], v12, s[4:5] offset:256
    global_load_dwordx2 v[58:59], v12, s[4:5] offset:272
    global_load_dwordx2 v[60:61], v13, s[4:5] offset:256
    global_load_dwordx2 v[62:63], v13, s[4:5] offset:272
    global_load_dwordx2 v[64:65], v12, s[4:5] offset:512
    global_load_dwordx2 v[66:67], v12, s[4:5] offset:528
    global_load_dwordx2 v[68:69], v13, s[4:5] offset:512
    global_load_dwordx2 v[70:71], v13, s[4:5] offset:528
    v_add_u32 v12, s12, v12
    v_add_u32 v13, s12, v13
    global_load_dwordx2 v[72:73], v12, s[4:5] offset:0
    global_load_dwordx2 v[74:75], v12, s[4:5] offset:16
    global_load_dwordx2 v[76:77], v13, s[4:5] offset:0
    global_load_dwordx2 v[78:79], v13, s[4:5] offset:16
    s_waitcnt vmcnt(16)
    global_store_dwordx4 v6, v[16:19], s[6:7] offset:0
    global_store_dwordx4 v6, v[20:23], s[6:7] offset:1024
    global_store_dwordx4 v6, v[24:27], s[6:7] offset:2048
    global_store_dwordx2 v7, v[28:29], s[6:7] offset:3072
    global_store_dwordx4 v10, v[32:35], s[6:7] offset:0
    global_store_dwordx4 v10, v[36:39], s[6:7] offset:1024
    global_store_dwordx4 v10, v[40:43], s[6:7] offset:2048
    global_store_dwordx2 v11, v[44:45], s[6:7] offset:3072
    s_waitcnt vmcnt(8)
    v_swap_b32 v49, v50
    v_swap_b32 v53, v54
    v_swap_b32 v57, v58
    v_swap_b32 v61, v62
    v_swap_b32 v65, v66
    v_swap_b32 v69, v70
    v_swap_b32 v73, v74
    v_swap_b32 v77, v78
    global_store_dwordx4 v14, v[48:51], s[6:7]
    global_store_dwordx4 v15, v[52:55], s[6:7]
    v_add_u32 v14, 4096, v14
    v_add_u32 v15, 4096, v15
    global_store_dwordx4 v14, v[56:59], s[6:7]
    global_store_dwordx4 v15, v[60:63], s[6:7]
    v_add_u32 v14, 4096, v14
    v_add_u32 v15, 4096, v15
    global_store_dwordx4 v14, v[64:67], s[6:7]
    global_store_dwordx4 v15, v[68:71], s[6:7]
    v_add_u32 v14, 4096, v14
    v_add_u32 v15, 4096, v15
    s_cmp_ge_u32 s8, 2
    s_cbranch_scc1 L_prep_done
    global_store_dwordx4 v14, v[72:75], s[6:7]
    global_store_dwordx4 v15, v[76:79], s[6:7]
    v_add_u32 v14, 4096, v14
    v_add_u32 v15, 4096, v15
    s_branch L_prep_done
L_prep_t3:
    s_cmp_ge_u32 s2, 352
    s_cbranch_scc1 L_prep_t4
    s_sub_u32 s9, s2, 320
    s_lshl_b32 s9, s9, 8
    v_add_u32 v2, s9, v0
    v_mov_b32 v8, -1
    v_mov_b32 v9, -1
    v_mov_b32 v10, -1
    v_mov_b32 v11, -1
    v_lshlrev_b32 v3, 4, v2
    v_add_u32 v3, 39936, v3
    s_mov_b32 s10, 1277952

    v_cmp_gt_u32 vcc, s10, v3
    s_and_saveexec_b64 s[12:13], vcc
    global_store_dwordx4 v3, v[8:11], s[6:7]
    s_mov_b64 exec, s[12:13]
    v_add_u32 v3, 131072, v3
    v_cmp_gt_u32 vcc, s10, v3
    s_and_saveexec_b64 s[12:13], vcc
    global_store_dwordx4 v3, v[8:11], s[6:7]
    s_mov_b64 exec, s[12:13]
    v_add_u32 v3, 131072, v3
    v_cmp_gt_u32 vcc, s10, v3
    s_and_saveexec_b64 s[12:13], vcc
    global_store_dwordx4 v3, v[8:11], s[6:7]
    s_mov_b64 exec, s[12:13]
    v_add_u32 v3, 131072, v3
    v_cmp_gt_u32 vcc, s10, v3
    s_and_saveexec_b64 s[12:13], vcc
    global_store_dwordx4 v3, v[8:11], s[6:7]
    s_mov_b64 exec, s[12:13]
    v_add_u32 v3, 131072, v3
    v_cmp_gt_u32 vcc, s10, v3
    s_and_saveexec_b64 s[12:13], vcc
    global_store_dwordx4 v3, v[8:11], s[6:7]
    s_mov_b64 exec, s[12:13]
    v_add_u32 v3, 131072, v3
    v_cmp_gt_u32 vcc, s10, v3
    s_and_saveexec_b64 s[12:13], vcc
    global_store_dwordx4 v3, v[8:11], s[6:7]
    s_mov_b64 exec, s[12:13]
    v_add_u32 v3, 131072, v3
    v_cmp_gt_u32 vcc, s10, v3
    s_and_saveexec_b64 s[12:13], vcc
    global_store_dwordx4 v3, v[8:11], s[6:7]
    s_mov_b64 exec, s[12:13]
    v_add_u32 v3, 131072, v3
    v_cmp_gt_u32 vcc, s10, v3
    s_and_saveexec_b64 s[12:13], vcc
    global_store_dwordx4 v3, v[8:11], s[6:7]
    s_mov_b64 exec, s[12:13]
    v_add_u32 v3, 131072, v3
    v_cmp_gt_u32 vcc, s10, v3
    s_and_saveexec_b64 s[12:13], vcc
    global_store_dwordx4 v3, v[8:11], s[6:7]
    s_mov_b64 exec, s[12:13]
    v_add_u32 v3, 131072, v3
    v_cmp_gt_u32 vcc, s10, v3
    s_and_saveexec_b64 s[12:13], vcc
    global_store_dwordx4 v3, v[8:11], s[6:7]
    s_mov_b64 exec, s[12:13]
    v_add_u32 v3, 131072, v3
    v_lshlrev_b32 v3, 4, v2
    v_add_u32 v3, 92150784, v3
    s_mov_b32 s10, 92602368
    v_cmp_gt_u32 vcc, s10, v3
    s_and_saveexec_b64 s[12:13], vcc
    global_store_dwordx4 v3, v[8:11], s[6:7]
    s_mov_b64 exec, s[12:13]
    v_add_u32 v3, 131072, v3
    v_cmp_gt_u32 vcc, s10, v3
    s_and_saveexec_b64 s[12:13], vcc
    global_store_dwordx4 v3, v[8:11], s[6:7]
    s_mov_b64 exec, s[12:13]
    v_add_u32 v3, 131072, v3
    v_cmp_gt_u32 vcc, s10, v3
    s_and_saveexec_b64 s[12:13], vcc
    global_store_dwordx4 v3, v[8:11], s[6:7]
    s_mov_b64 exec, s[12:13]
    v_add_u32 v3, 131072, v3
    v_cmp_gt_u32 vcc, s10, v3
    s_and_saveexec_b64 s[12:13], vcc
    global_store_dwordx4 v3, v[8:11], s[6:7]
    s_mov_b64 exec, s[12:13]
    v_add_u32 v3, 131072, v3
    v_mov_b32 v8, 0
    v_mov_b32 v9, 0
    v_mov_b32 v10, 0
    v_mov_b32 v11, 0
    v_lshlrev_b32 v3, 4, v2
    v_add_u32 v4, 87359488, v3
    global_store_dwordx4 v4, v[8:11], s[6:7]
    s_cmp_ge_u32 s9, 2048
    s_cbranch_scc1 L_fill_1
    global_store_dwordx4 v3, v[8:11], s[6:7]
    s_branch L_prep_done

L_fill_1:
    s_cmp_gt_u32 s9, 2304
    s_cbranch_scc1 L_prep_done
    v_subrev_u32 v3, 32768, v3
    v_cmp_gt_u32 vcc, 7168, v3
    s_and_saveexec_b64 s[12:13], vcc
    s_cbranch_execz L_prep_done
    global_load_dwordx4 v[8:11], v3, s[24:25]
    v_add_u32 v4, 32768, v3
    v_add_u32 v5, 92143616, v3
    s_waitcnt vmcnt(0)
    global_store_dwordx4 v4, v[8:11], s[6:7]
    global_store_dwordx4 v5, v[8:11], s[6:7]
    s_branch L_prep_done

L_prep_t4:
L_prep_done:
    s_endpgm
.section .rodata,"a"
.p2align 6
.amdhsa_kernel prep_kernel
  .amdhsa_next_free_vgpr 256
  .amdhsa_next_free_sgpr 64
  .amdhsa_accum_offset 256
  .amdhsa_group_segment_fixed_size 0
  .amdhsa_kernarg_size 112
  .amdhsa_user_sgpr_count 2
  .amdhsa_user_sgpr_kernarg_segment_ptr 1
  .amdhsa_system_sgpr_workgroup_id_x 1
.end_amdhsa_kernel
.text
.globl main_kernel
.p2align 8
.type main_kernel,@function
main_kernel:
    s_cmp_ge_u32 s2, 256
    s_cbranch_scc1 L_main_done
    s_load_dwordx2 s[4:5], s[0:1], 0
    s_load_dwordx2 s[6:7], s[0:1], 104
    s_load_dwordx2 s[64:65], s[0:1], 0
    s_load_dwordx2 s[66:67], s[0:1], 56
    s_load_dwordx2 s[68:69], s[0:1], 88
    s_waitcnt lgkmcnt(0)

    v_lshrrev_b32 v1, 6, v0
    s_nop 0
    v_readfirstlane_b32 s8, v1
    v_and_b32 v1, 63, v0
    s_cmp_lg_u32 s8, 0
    s_cbranch_scc1 L_role_wait
    s_getreg_b32 s22, hwreg(HW_REG_XCC_ID)
    s_and_b32 s22, s22, 15
    s_mov_b64 s[24:25], exec
    s_mov_b64 exec, 1
    s_lshl_b32 s23, s22, 6
    v_mov_b32 v2, s23
    v_mov_b32 v3, 1
    global_atomic_add v4, v2, v3, s[6:7] sc0
    v_mov_b32 v5, 2048
    s_waitcnt vmcnt(0)
    v_readfirstlane_b32 s23, v4
    s_add_u32 s28, s22, 1
    s_cmp_lg_u32 s23, 31
    s_cbranch_scc1 L_ra_skip1
    v_mov_b32 v8, s28
    v_mov_b32 v9, 0
    global_atomic_cmpswap v5, v[8:9], s[6:7]

L_ra_skip1:
    s_mov_b32 s9, 255
    s_mov_b32 s26, 0

L_ra_poll:
    s_cmp_lg_u32 s26, 500
    s_cbranch_scc1 L_ra_nofb
    v_mov_b32 v8, 99
    v_mov_b32 v9, 0
    global_atomic_cmpswap v5, v[8:9], s[6:7]
    L_ra_nofb:
    global_load_dword v10, v5, s[6:7] sc1
    s_add_u32 s26, s26, 1
    s_cmp_ge_u32 s26, 4194304
    s_cbranch_scc1 L_ra_write
    s_waitcnt vmcnt(0)
    v_readfirstlane_b32 s29, v10
    s_cmp_eq_u32 s29, 0
    s_cbranch_scc1 L_ra_poll
    s_cmp_lg_u32 s29, s28
    s_cbranch_scc1 L_ra_notsame
    s_cmp_ge_u32 s23, 32
    s_cbranch_scc1 L_ra_write
    s_mov_b32 s9, s23
    s_branch L_ra_write

L_ra_notsame:
    s_cmp_lg_u32 s29, 99
    s_cbranch_scc1 L_ra_write
    v_mov_b32 v5, 1024
    global_atomic_add v6, v5, v3, s[6:7] sc0
    s_waitcnt vmcnt(0)
    v_readfirstlane_b32 s27, v6
    s_cmp_ge_u32 s27, 32
    s_cbranch_scc1 L_ra_write
    s_or_b32 s9, s27, 0x100

L_ra_write:
    v_mov_b32 v2, 0
    v_mov_b32 v3, s9
    ds_write_b32 v2, v3
    s_mov_b64 exec, s[24:25]

L_role_wait:
    s_waitcnt lgkmcnt(0)
    s_barrier
    v_mov_b32 v2, 0
    ds_read_b32 v3, v2
    s_waitcnt lgkmcnt(0)
    v_readfirstlane_b32 s9, v3
    s_lshr_b32 s10, s9, 8
    s_and_b32 s9, s9, 255

    s_cmp_ge_u32 s9, 32
    s_cbranch_scc1 L_bulk
    s_cmp_lt_u32 s9, 30
    s_cbranch_scc1 L_notwarm
    v_lshlrev_b32 v2, 4, v0
    v_mov_b32 v3, 0
    v_add_u32 v5, 256, v0
    v_min_u32 v5, 447, v5
    v_lshlrev_b32 v5, 4, v5
    s_mov_b32 s11, 0
    s_add_u32 s12, s6, 32768
    s_addc_u32 s13, s7, 0
    s_add_u32 s16, s6, 51642368
    s_addc_u32 s17, s7, 0
    s_add_u32 s14, s6, 32768
    s_addc_u32 s15, s7, 0
    s_add_u32 s18, s6, 491520
    s_addc_u32 s19, s7, 0
    s_sub_u32 s22, s9, 30
    s_mul_i32 s22, s22, 229376
    s_add_u32 s22, s22, 14942208
    s_add_u32 s20, s6, s22
    s_addc_u32 s21, s7, 0
    s_add_u32 s28, s6, 92143616
    s_addc_u32 s29, s7, 0

L_w_loop:
    s_cmp_ge_u32 s11, 64
    s_cbranch_scc1 L_w_notouch
    s_cmp_eq_u32 s9, 31
    s_cbranch_scc1 L_w_j
    global_load_dwordx4 v[8:11], v2, s[16:17]
    s_add_u32 s16, s16, 4096
    s_addc_u32 s17, s17, 0
    global_load_dwordx4 v[8:11], v2, s[16:17]
    s_add_u32 s16, s16, 4096
    s_addc_u32 s17, s17, 0
    global_load_dwordx4 v[8:11], v2, s[16:17]
    s_add_u32 s16, s16, 4096
    s_addc_u32 s17, s17, 0
    global_load_dwordx4 v[8:11], v2, s[16:17]
    s_add_u32 s16, s16, 4096
    s_addc_u32 s17, s17, 0
    global_load_dwordx4 v[8:11], v2, s[16:17]
    s_add_u32 s16, s16, 4096
    s_addc_u32 s17, s17, 0
    global_load_dwordx4 v[8:11], v2, s[16:17]
    s_add_u32 s16, s16, 4096
    s_addc_u32 s17, s17, 0
    global_load_dwordx4 v[8:11], v2, s[16:17]
    s_add_u32 s16, s16, 4096
    s_addc_u32 s17, s17, 0
    global_load_dwordx4 v[8:11], v2, s[14:15] sc1
    global_load_dwordx4 v[8:11], v2, s[14:15] offset:3072 sc1
    global_load_dwordx4 v[8:11], v2, s[18:19] sc1
    s_add_u32 s18, s18, 4096
    s_addc_u32 s19, s19, 0
    global_load_dwordx4 v[8:11], v2, s[18:19] sc1
    s_add_u32 s18, s18, 4096
    s_addc_u32 s19, s19, 0
    global_load_dwordx4 v[8:11], v2, s[18:19] sc1
    s_add_u32 s18, s18, 4096
    s_addc_u32 s19, s19, 0
    s_add_u32 s14, s14, 7168
    s_addc_u32 s15, s15, 0
L_w_j:
L_w_notouch:
    s_add_u32 s11, s11, 1
    s_cmp_ge_u32 s11, 66
    s_cbranch_scc1 L_main_done
    s_cmp_lt_u32 s11, 3
    s_cbranch_scc1 L_w_loop
    s_add_u32 s12, s12, 7168
    s_addc_u32 s13, s13, 0
    s_add_u32 s28, s28, 7168
    s_addc_u32 s29, s29, 0
    s_mov_b32 s26, 0
L_w_poll:
    s_sleep 2
    global_load_dwordx4 v[8:11], v2, s[12:13] sc1
    global_load_dwordx4 v[12:15], v5, s[12:13] sc1
    s_add_u32 s26, s26, 1
    s_cmp_ge_u32 s26, 4194304
    s_cbranch_scc1 L_main_done
    s_waitcnt vmcnt(0)
    v_max3_u32 v4, v8, v10, v12
    v_max_u32 v4, v4, v14
    v_cmp_eq_u32 vcc, -1, v4
    s_cbranch_vccnz L_w_poll

    s_cmp_eq_u32 s9, 31
    s_cbranch_scc1 L_w_copy
    s_cmp_lt_u32 s11, 4
    s_cbranch_scc1 L_w_loop
    s_sub_u32 s23, s11, 4

L_w_ymk:
    s_lshl_b32 s22, s23, 8
    s_add_u32 s22, s22, 8192
    v_and_b32 v6, 63, v0
    v_lshlrev_b32 v6, 2, v6
    v_add_u32 v6, s22, v6
    s_mov_b32 s26, 0
    s_mov_b32 s30, -1
    s_mov_b32 s31, 0x00ffffff

L_w_ymp:
    global_load_dword v7, v6, s[6:7] sc1
    s_add_u32 s26, s26, 1
    s_cmp_ge_u32 s26, 4194304
    s_cbranch_scc1 L_main_done
    s_waitcnt vmcnt(0)
    v_cmp_eq_u32 vcc, 1, v7
    s_cmp_eq_u64 vcc, s[30:31]
    s_cbranch_scc1 L_w_ymok
    s_sleep 2
    s_branch L_w_ymp

L_w_ymok:
    s_lshl_b32 s22, s23, 6
    s_add_u32 s22, s22, 28672
    v_mov_b32 v6, s22
    v_mov_b32 v7, 1
    s_mov_b64 exec, 1
    global_store_dword v6, v7, s[6:7] sc1
    s_mov_b64 exec, -1
    s_cmp_lt_u32 s11, 65
    s_cbranch_scc1 L_w_loop
    s_add_u32 s23, s23, 1
    s_cmp_lt_u32 s23, 64
    s_cbranch_scc1 L_w_ymk
    s_branch L_main_done

L_w_copy:
    global_store_dwordx4 v2, v[8:11], s[28:29] sc1
    global_store_dwordx4 v5, v[12:15], s[28:29] sc1
    s_nop 1

    s_branch L_w_loop
L_notwarm:
    v_lshlrev_b32 v2, 4, v0
    v_add_u32 v3, 256, v0
    v_min_u32 v3, 447, v3
    s_mov_b32 s22, 0x4924925
    v_mul_hi_u32 v8, v0, s22
    v_mul_hi_u32 v9, v3, s22

    v_mul_u32_u24 v10, 56, v8
    v_sub_u32 v10, v0, v10
    v_mul_u32_u24 v4, 1088, v8
    v_lshl_add_u32 v4, v10, 4, v4
    v_add_u32 v4, 64, v4
    v_mul_u32_u24 v10, 56, v9
    v_sub_u32 v10, v3, v10
    v_mul_u32_u24 v5, 1088, v9
    v_lshl_add_u32 v5, v10, 4, v5
    v_add_u32 v5, 64, v5
    v_lshlrev_b32 v3, 4, v3

    v_and_b32 v8, 15, v1
    v_lshrrev_b32 v9, 2, v8
    v_lshlrev_b32 v9, 1, v9
    v_and_b32 v10, 1, v8
    v_add_u32 v9, v9, v10
    v_bfe_u32 v10, v8, 1, 1
    v_lshrrev_b32 v11, 4, v1
    v_mul_u32_u24 v6, 1088, v9
    v_lshl_add_u32 v6, v11, 5, v6
    v_lshl_add_u32 v6, v10, 4, v6
    v_add_u32 v6, 64, v6
    v_mov_b32 v7, 0x4444
    v_mov_b32 v12, 0xeeee
    v_cmp_eq_u32 vcc, 1, v10
    s_nop 1
    v_cndmask_b32 v7, v7, v12, vcc

    s_cmp_ge_u32 s9, 16
    s_cbranch_scc1 L_bside
    v_and_b32 v44, 15, v1
    v_lshrrev_b32 v45, 4, v1
    v_and_b32 v46, 7, v1
    s_mul_i32 s22, s8, 1920
    s_add_u32 s22, s22, 8768
    v_mul_u32_u24 v8, 480, v45
    v_add_u32 v8, s22, v8
    v_lshl_add_u32 v0, v44, 1, v8
    v_lshl_add_u32 v8, v44, 2, v8
    v_mul_u32_u24 v9, 240, v46
    v_add_u32 v9, s22, v9
    v_lshl_add_u32 v10, v45, 3, v9
    v_add_u32 v10, 192, v10
    v_lshl_add_u32 v9, v45, 4, v9
    s_mul_i32 s22, s8, 224
    s_add_u32 s23, s22, 64
    v_mul_u32_u24 v11, 1088, v46
    v_add_u32 v11, s23, v11
    v_lshl_add_u32 v12, v45, 3, v11
    v_add_u32 v12, 192, v12
    v_lshl_add_u32 v11, v45, 4, v11
    s_mul_i32 s22, s8, 7168
    v_lshlrev_b32 v13, 4, v1
    v_add_u32 v13, s22, v13
    v_lshlrev_b32 v14, 3, v1
    v_add_u32 v14, s22, v14
    v_add_u32 v14, 3072, v14
    s_mul_i32 s22, s8, 3072
    s_add_u32 s22, s22, 16448
    v_mul_u32_u24 v114, 192, v44
    v_lshl_add_u32 v114, v45, 4, v114
    v_add_u32 v114, s22, v114

    v_and_b32 v46, 1, v1
    v_lshl_add_u32 v46, v45, 1, v46
    v_lshrrev_b32 v47, 1, v44
    v_mul_u32_u24 v115, 192, v46
    v_add_u32 v115, 16448, v115
    v_lshl_add_u32 v116, v47, 2, v115
    v_add_u32 v116, 128, v116
    v_lshl_add_u32 v115, v47, 4, v115
    s_and_b32 s22, s9, 1
    s_lshl_b32 s22, s22, 1
    v_lshrrev_b32 v48, 1, v46
    v_lshlrev_b32 v48, 2, v48
    v_and_b32 v49, 1, v46
    v_add_u32 v48, v48, v49
    v_add_u32 v48, s22, v48
    v_lshrrev_b32 v49, 1, v47
    v_lshl_add_u32 v117, v49, 4, v48
    v_lshlrev_b32 v117, 4, v117
    v_and_b32 v50, 1, v47
    v_lshl_add_u32 v117, v50, 3, v117
    s_lshr_b32 s22, s9, 1
    s_lshl_b32 s22, s22, 10
    v_add_u32 v117, s22, v117
    v_lshrrev_b32 v50, 2, v47
    s_bfe_u32 s22, s9, 0x10001
    s_lshl_b32 s22, s22, 1
    v_add_u32 v50, s22, v50
    v_lshl_add_u32 v118, v50, 4, v48
    v_lshlrev_b32 v118, 4, v118
    v_and_b32 v49, 1, v49
    v_lshl_add_u32 v118, v49, 3, v118
    s_lshr_b32 s22, s9, 2
    s_lshl_b32 s22, s22, 10
    s_add_u32 s22, s22, 8192
    v_add_u32 v118, s22, v118

    s_mul_i32 s22, s9, 28
    s_mul_i32 s23, s8, 7
    s_add_u32 s22, s22, s23
    s_mul_i32 s22, s22, 14336
    s_add_u32 s22, s22, 2097152
    s_add_u32 s20, s6, s22
    s_addc_u32 s21, s7, 0
    v_lshlrev_b32 v15, 4, v1

    global_load_dwordx4 a[0:3], v15, s[20:21] offset:0
    global_load_dwordx4 a[4:7], v15, s[20:21] offset:1024
    global_load_dwordx4 a[8:11], v15, s[20:21] offset:2048
    global_load_dwordx4 a[12:15], v15, s[20:21] offset:3072
    s_add_u32 s20, s20, 4096
    s_addc_u32 s21, s21, 0
    global_load_dwordx4 a[16:19], v15, s[20:21] offset:0
    global_load_dwordx4 a[20:23], v15, s[20:21] offset:1024
    global_load_dwordx4 a[24:27], v15, s[20:21] offset:2048
    global_load_dwordx4 a[28:31], v15, s[20:21] offset:3072
    s_add_u32 s20, s20, 4096
    s_addc_u32 s21, s21, 0
    global_load_dwordx4 a[32:35], v15, s[20:21] offset:0
    global_load_dwordx4 a[36:39], v15, s[20:21] offset:1024
    global_load_dwordx4 a[40:43], v15, s[20:21] offset:2048
    global_load_dwordx4 a[44:47], v15, s[20:21] offset:3072
    s_add_u32 s20, s20, 4096
    s_addc_u32 s21, s21, 0
    global_load_dwordx4 a[48:51], v15, s[20:21] offset:0
    global_load_dwordx4 a[52:55], v15, s[20:21] offset:1024
    global_load_dwordx4 a[56:59], v15, s[20:21] offset:2048
    global_load_dwordx4 a[60:63], v15, s[20:21] offset:3072
    s_add_u32 s20, s20, 4096
    s_addc_u32 s21, s21, 0
    global_load_dwordx4 a[64:67], v15, s[20:21] offset:0
    global_load_dwordx4 a[68:71], v15, s[20:21] offset:1024
    global_load_dwordx4 a[72:75], v15, s[20:21] offset:2048
    global_load_dwordx4 a[76:79], v15, s[20:21] offset:3072
    s_add_u32 s20, s20, 4096
    s_addc_u32 s21, s21, 0
    global_load_dwordx4 a[80:83], v15, s[20:21] offset:0
    global_load_dwordx4 a[84:87], v15, s[20:21] offset:1024
    global_load_dwordx4 a[88:91], v15, s[20:21] offset:2048
    global_load_dwordx4 a[92:95], v15, s[20:21] offset:3072
    s_add_u32 s20, s20, 4096
    s_addc_u32 s21, s21, 0
    global_load_dwordx4 a[96:99], v15, s[20:21] offset:0
    global_load_dwordx4 a[100:103], v15, s[20:21] offset:1024
    global_load_dwordx4 a[104:107], v15, s[20:21] offset:2048
    global_load_dwordx4 a[108:111], v15, s[20:21] offset:3072
    s_add_u32 s20, s20, 4096
    s_addc_u32 s21, s21, 0
    global_load_dwordx4 a[112:115], v15, s[20:21] offset:0
    global_load_dwordx4 a[116:119], v15, s[20:21] offset:1024
    global_load_dwordx4 a[120:123], v15, s[20:21] offset:2048
    global_load_dwordx4 a[124:127], v15, s[20:21] offset:3072
    s_add_u32 s20, s20, 4096
    s_addc_u32 s21, s21, 0
    global_load_dwordx4 a[128:131], v15, s[20:21] offset:0
    global_load_dwordx4 a[132:135], v15, s[20:21] offset:1024
    global_load_dwordx4 a[136:139], v15, s[20:21] offset:2048
    global_load_dwordx4 a[140:143], v15, s[20:21] offset:3072
    s_add_u32 s20, s20, 4096
    s_addc_u32 s21, s21, 0
    global_load_dwordx4 a[144:147], v15, s[20:21] offset:0
    global_load_dwordx4 a[148:151], v15, s[20:21] offset:1024
    global_load_dwordx4 a[152:155], v15, s[20:21] offset:2048
    global_load_dwordx4 a[156:159], v15, s[20:21] offset:3072
    s_add_u32 s20, s20, 4096
    s_addc_u32 s21, s21, 0
    global_load_dwordx4 a[160:163], v15, s[20:21] offset:0
    global_load_dwordx4 a[164:167], v15, s[20:21] offset:1024
    global_load_dwordx4 a[168:171], v15, s[20:21] offset:2048
    global_load_dwordx4 a[172:175], v15, s[20:21] offset:3072
    s_add_u32 s20, s20, 4096
    s_addc_u32 s21, s21, 0
    global_load_dwordx4 a[176:179], v15, s[20:21] offset:0
    global_load_dwordx4 a[180:183], v15, s[20:21] offset:1024
    global_load_dwordx4 a[184:187], v15, s[20:21] offset:2048
    global_load_dwordx4 a[188:191], v15, s[20:21] offset:3072
    s_add_u32 s20, s20, 4096
    s_addc_u32 s21, s21, 0
    global_load_dwordx4 a[192:195], v15, s[20:21] offset:0
    global_load_dwordx4 a[196:199], v15, s[20:21] offset:1024
    global_load_dwordx4 a[200:203], v15, s[20:21] offset:2048
    global_load_dwordx4 a[204:207], v15, s[20:21] offset:3072
    s_add_u32 s20, s20, 4096
    s_addc_u32 s21, s21, 0
    global_load_dwordx4 a[208:211], v15, s[20:21] offset:0
    global_load_dwordx4 a[212:215], v15, s[20:21] offset:1024
    global_load_dwordx4 a[216:219], v15, s[20:21] offset:2048
    global_load_dwordx4 a[220:223], v15, s[20:21] offset:3072
    s_add_u32 s20, s20, 4096
    s_addc_u32 s21, s21, 0
    global_load_dwordx4 a[224:227], v15, s[20:21] offset:0
    global_load_dwordx4 a[228:231], v15, s[20:21] offset:1024
    global_load_dwordx4 a[232:235], v15, s[20:21] offset:2048
    global_load_dwordx4 a[236:239], v15, s[20:21] offset:3072
    s_add_u32 s20, s20, 4096
    s_addc_u32 s21, s21, 0
    global_load_dwordx4 a[240:243], v15, s[20:21] offset:0
    global_load_dwordx4 a[244:247], v15, s[20:21] offset:1024
    global_load_dwordx4 a[248:251], v15, s[20:21] offset:2048
    global_load_dwordx4 a[252:255], v15, s[20:21] offset:3072
    s_add_u32 s20, s20, 4096
    s_addc_u32 s21, s21, 0
    global_load_dwordx4 v[120:123], v15, s[20:21] offset:0
    global_load_dwordx4 v[124:127], v15, s[20:21] offset:1024
    global_load_dwordx4 v[128:131], v15, s[20:21] offset:2048
    global_load_dwordx4 v[132:135], v15, s[20:21] offset:3072
    s_add_u32 s20, s20, 4096
    s_addc_u32 s21, s21, 0
    global_load_dwordx4 v[136:139], v15, s[20:21] offset:0
    global_load_dwordx4 v[140:143], v15, s[20:21] offset:1024
    global_load_dwordx4 v[144:147], v15, s[20:21] offset:2048
    global_load_dwordx4 v[148:151], v15, s[20:21] offset:3072
    s_add_u32 s20, s20, 4096
    s_addc_u32 s21, s21, 0
    global_load_dwordx4 v[152:155], v15, s[20:21] offset:0
    global_load_dwordx4 v[156:159], v15, s[20:21] offset:1024
    global_load_dwordx4 v[160:163], v15, s[20:21] offset:2048
    global_load_dwordx4 v[164:167], v15, s[20:21] offset:3072
    s_add_u32 s20, s20, 4096
    s_addc_u32 s21, s21, 0
    global_load_dwordx4 v[168:171], v15, s[20:21] offset:0
    global_load_dwordx4 v[172:175], v15, s[20:21] offset:1024
    global_load_dwordx4 v[176:179], v15, s[20:21] offset:2048
    global_load_dwordx4 v[180:183], v15, s[20:21] offset:3072
    s_add_u32 s20, s20, 4096
    s_addc_u32 s21, s21, 0
    global_load_dwordx4 v[184:187], v15, s[20:21] offset:0
    global_load_dwordx4 v[188:191], v15, s[20:21] offset:1024
    global_load_dwordx4 v[192:195], v15, s[20:21] offset:2048
    global_load_dwordx4 v[196:199], v15, s[20:21] offset:3072
    s_add_u32 s20, s20, 4096
    s_addc_u32 s21, s21, 0
    global_load_dwordx4 v[200:203], v15, s[20:21] offset:0
    global_load_dwordx4 v[204:207], v15, s[20:21] offset:1024
    global_load_dwordx4 v[208:211], v15, s[20:21] offset:2048
    global_load_dwordx4 v[212:215], v15, s[20:21] offset:3072
    s_add_u32 s20, s20, 4096
    s_addc_u32 s21, s21, 0
    global_load_dwordx4 v[216:219], v15, s[20:21] offset:0
    global_load_dwordx4 v[220:223], v15, s[20:21] offset:1024
    global_load_dwordx4 v[224:227], v15, s[20:21] offset:2048
    global_load_dwordx4 v[228:231], v15, s[20:21] offset:3072
    s_add_u32 s20, s20, 4096
    s_addc_u32 s21, s21, 0
    global_load_dwordx4 v[232:235], v15, s[20:21] offset:0
    global_load_dwordx4 v[236:239], v15, s[20:21] offset:1024
    global_load_dwordx4 v[240:243], v15, s[20:21] offset:2048
    global_load_dwordx4 v[244:247], v15, s[20:21] offset:3072
    s_add_u32 s20, s20, 4096
    s_addc_u32 s21, s21, 0
    global_load_dwordx4 v[248:251], v15, s[20:21] offset:0
    global_load_dwordx4 v[252:255], v15, s[20:21] offset:1024
    s_mov_b32 s11, 0
    s_add_u32 s12, s6, 32768
    s_addc_u32 s13, s7, 0
    s_add_u32 s14, s6, 491520
    s_addc_u32 s15, s7, 0
    s_add_u32 s16, s6, 51642368
    s_addc_u32 s17, s7, 0
    s_add_u32 s18, s6, 51645952
    s_addc_u32 s19, s7, 0
    s_mov_b32 s33, 0x3fb8aa3b
    s_mov_b32 s34, 0x33333333
    s_mov_b32 s35, 0x33333333
    s_mov_b32 s36, 0x00ff00ff
    s_mov_b32 s37, 0x00ff00ff

    s_cmp_lg_u32 s10, 0
    s_cbranch_scc1 L_sc_m1
    v_mov_b32 v44, 0
    v_mov_b32 v45, 0
    v_mov_b32 v46, 0
    v_mov_b32 v47, 0
    v_mov_b32 v48, 0
    v_mov_b32 v49, 0
    v_mov_b32 v50, 0
    v_mov_b32 v51, 0
    v_mov_b32 v52, 0
    v_mov_b32 v53, 0
    v_mov_b32 v54, 0
    v_mov_b32 v55, 0
L_loop_sc0:
    s_mov_b32 s26, 0
L_gp_sc0:
    global_load_dwordx4 v[72:75], v2, s[12:13] sc1
    global_load_dwordx4 v[76:79], v3, s[12:13] sc1
    s_waitcnt vmcnt(0)
    v_max3_u32 v15, v72, v74, v76
    v_max_u32 v15, v15, v78
    v_cmp_eq_u32 vcc, -1, v15
    s_cbranch_vccz L_gp_sc0_a
    s_add_u32 s26, s26, 1
    s_cmp_lt_u32 s26, 4194304
    s_cbranch_scc1 L_gp_sc0
    s_branch L_main_done
L_gp_sc0_b:
    ds_write_b128 v4, v[80:83]
    ds_write_b128 v5, v[84:87]
    s_branch L_gp_sc0_j
L_gp_sc0_a:
    ds_write_b128 v4, v[72:75]
    ds_write_b128 v5, v[76:79]
L_gp_sc0_j:
    s_waitcnt lgkmcnt(0)
    s_barrier
    ds_read_b128 v[16:19], v6 offset:0
    ds_read_b128 v[20:23], v6 offset:128
    ds_read_b128 v[24:27], v6 offset:256
    ds_read_b128 v[28:31], v6 offset:384
    ds_read_b128 v[32:35], v6 offset:512
    ds_read_b128 v[36:39], v6 offset:640
    ds_read_b128 v[40:43], v6 offset:768
    s_waitcnt lgkmcnt(6)
    v_smfmac_f32_16x16x64_bf16 v[44:47], v[16:19], v[200:207], v7
    global_load_dwordx2 v[84:85], v14, s[16:17]
    s_waitcnt lgkmcnt(5)
    v_smfmac_f32_16x16x64_bf16 v[44:47], v[20:23], v[208:215], v7
    s_waitcnt lgkmcnt(4)
    v_smfmac_f32_16x16x64_bf16 v[44:47], v[24:27], v[216:223], v7
    global_load_dwordx2 v[98:99], v14, s[18:19]
    s_waitcnt lgkmcnt(3)
    v_smfmac_f32_16x16x64_bf16 v[44:47], v[28:31], v[224:231], v7
    s_waitcnt lgkmcnt(2)
    v_smfmac_f32_16x16x64_bf16 v[44:47], v[32:35], v[232:239], v7
    global_load_dwordx4 v[72:75], v13, s[16:17] offset:0
    s_waitcnt lgkmcnt(1)
    v_smfmac_f32_16x16x64_bf16 v[44:47], v[36:39], v[240:247], v7
    s_waitcnt lgkmcnt(0)
    v_smfmac_f32_16x16x64_bf16 v[44:47], v[40:43], v[248:255], v7
    global_load_dwordx4 v[86:89], v13, s[18:19] offset:0
    v_smfmac_f32_16x16x64_bf16 v[48:51], v[16:19], a[0:7], v7
    ds_read_b64 v[112:113], v12
    ds_read_b128 v[100:103], v11 offset:0
    v_smfmac_f32_16x16x64_bf16 v[48:51], v[20:23], a[8:15], v7
    ds_read_b128 v[104:107], v11 offset:64
    ds_read_b128 v[108:111], v11 offset:128
    global_load_dwordx4 v[76:79], v13, s[16:17] offset:1024
    v_smfmac_f32_16x16x64_bf16 v[48:51], v[24:27], a[16:23], v7
    v_pk_add_f32 v[44:45], v[44:45], v[46:47]
    v_cvt_pk_bf16_f32 v119, v44, v45
    v_smfmac_f32_16x16x64_bf16 v[48:51], v[28:31], a[24:31], v7
    v_mov_b64 v[44:45], 0
    v_mov_b64 v[46:47], 0
    global_load_dwordx4 v[90:93], v13, s[18:19] offset:1024
    v_smfmac_f32_16x16x64_bf16 v[48:51], v[32:35], a[32:39], v7
    ds_write_b16 v0, v119 offset:192
    ds_write_b16_d16_hi v0, v119 offset:432
    v_smfmac_f32_16x16x64_bf16 v[48:51], v[36:39], a[40:47], v7
    ds_read_b64 v[56:57], v10
    global_load_dwordx4 v[80:83], v13, s[16:17] offset:2048
    v_smfmac_f32_16x16x64_bf16 v[48:51], v[40:43], a[48:55], v7
    v_smfmac_f32_16x16x64_bf16 v[52:55], v[16:19], a[56:63], v7
    global_load_dwordx4 v[94:97], v13, s[18:19] offset:2048
    v_smfmac_f32_16x16x64_bf16 v[52:55], v[20:23], a[64:71], v7
    v_smfmac_f32_16x16x64_bf16 v[52:55], v[24:27], a[72:79], v7
    v_smfmac_f32_16x16x64_bf16 v[52:55], v[28:31], a[80:87], v7
    v_smfmac_f32_16x16x64_bf16 v[52:55], v[32:35], a[88:95], v7
    v_smfmac_f32_16x16x64_bf16 v[52:55], v[36:39], a[96:103], v7
    v_smfmac_f32_16x16x64_bf16 v[52:55], v[40:43], a[104:111], v7
    s_waitcnt vmcnt(6) lgkmcnt(0)
    v_mfma_f32_16x16x16_bf16 v[60:63], v[112:113], v[56:57], 0
    v_mfma_f32_16x16x16_bf16 v[64:67], v[84:85], v[56:57], 0
    v_mfma_f32_16x16x16_bf16 v[68:71], v[98:99], v[56:57], 0
    v_smfmac_f32_16x16x64_bf16 v[44:47], v[16:19], a[112:119], v7
    v_smfmac_f32_16x16x64_bf16 v[44:47], v[20:23], a[120:127], v7
    v_pk_add_f32 v[48:49], v[48:49], v[50:51]
    v_pk_add_f32 v[52:53], v[52:53], v[54:55]
    v_smfmac_f32_16x16x64_bf16 v[44:47], v[24:27], a[128:135], v7
    v_cvt_pk_bf16_f32 v50, v48, v52
    v_cvt_pk_bf16_f32 v51, v49, v53
    v_smfmac_f32_16x16x64_bf16 v[44:47], v[28:31], a[136:143], v7
    ds_write2_b32 v8, v50, v51 offset0:0 offset1:60
    ds_read_b128 v[56:59], v9 offset:0
    v_smfmac_f32_16x16x64_bf16 v[44:47], v[32:35], a[144:151], v7
    v_mov_b64 v[52:53], 0
    v_mov_b64 v[54:55], 0
    v_smfmac_f32_16x16x64_bf16 v[44:47], v[36:39], a[152:159], v7
    v_mov_b64 v[48:49], 0
    v_mov_b64 v[50:51], 0
    v_smfmac_f32_16x16x64_bf16 v[44:47], v[40:43], a[160:167], v7
    v_smfmac_f32_16x16x64_bf16 v[48:51], v[16:19], a[168:175], v7
    v_smfmac_f32_16x16x64_bf16 v[48:51], v[20:23], a[176:183], v7
    v_smfmac_f32_16x16x64_bf16 v[48:51], v[24:27], a[184:191], v7
    v_smfmac_f32_16x16x64_bf16 v[48:51], v[28:31], a[192:199], v7
    v_smfmac_f32_16x16x64_bf16 v[48:51], v[32:35], a[200:207], v7
    v_smfmac_f32_16x16x64_bf16 v[48:51], v[36:39], a[208:215], v7
    v_smfmac_f32_16x16x64_bf16 v[48:51], v[40:43], a[216:223], v7
    s_waitcnt vmcnt(4) lgkmcnt(0)
    v_mfma_f32_16x16x32_bf16 v[60:63], v[100:103], v[56:59], v[60:63]
    v_mfma_f32_16x16x32_bf16 v[64:67], v[72:75], v[56:59], v[64:67]
    v_mfma_f32_16x16x32_bf16 v[68:71], v[86:89], v[56:59], v[68:71]
    v_smfmac_f32_16x16x64_bf16 v[52:55], v[16:19], a[224:231], v7
    v_smfmac_f32_16x16x64_bf16 v[52:55], v[20:23], a[232:239], v7
    v_pk_add_f32 v[44:45], v[44:45], v[46:47]
    v_pk_add_f32 v[48:49], v[48:49], v[50:51]
    v_smfmac_f32_16x16x64_bf16 v[52:55], v[24:27], a[240:247], v7
    v_cvt_pk_bf16_f32 v46, v44, v48
    v_cvt_pk_bf16_f32 v47, v45, v49
    v_smfmac_f32_16x16x64_bf16 v[52:55], v[28:31], a[248:255], v7
    ds_write2_b32 v8, v46, v47 offset0:16 offset1:76
    ds_read_b128 v[56:59], v9 offset:64
    v_smfmac_f32_16x16x64_bf16 v[52:55], v[32:35], v[120:127], v7
    v_mov_b64 v[48:49], 0
    v_mov_b64 v[50:51], 0
    v_smfmac_f32_16x16x64_bf16 v[52:55], v[36:39], v[128:135], v7
    v_mov_b64 v[44:45], 0
    v_mov_b64 v[46:47], 0
    v_smfmac_f32_16x16x64_bf16 v[52:55], v[40:43], v[136:143], v7
    v_smfmac_f32_16x16x64_bf16 v[44:47], v[16:19], v[144:151], v7
    v_smfmac_f32_16x16x64_bf16 v[44:47], v[20:23], v[152:159], v7
    v_smfmac_f32_16x16x64_bf16 v[44:47], v[24:27], v[160:167], v7
    s_waitcnt vmcnt(0) lgkmcnt(0)
    v_mfma_f32_16x16x32_bf16 v[60:63], v[104:107], v[56:59], v[60:63]
    v_mfma_f32_16x16x32_bf16 v[64:67], v[76:79], v[56:59], v[64:67]
    v_mfma_f32_16x16x32_bf16 v[68:71], v[90:93], v[56:59], v[68:71]
    v_smfmac_f32_16x16x64_bf16 v[44:47], v[28:31], v[168:175], v7
    v_smfmac_f32_16x16x64_bf16 v[44:47], v[32:35], v[176:183], v7
    v_smfmac_f32_16x16x64_bf16 v[44:47], v[36:39], v[184:191], v7
    v_smfmac_f32_16x16x64_bf16 v[44:47], v[40:43], v[192:199], v7
    s_add_u32 s16, s16, 28672
    s_addc_u32 s17, s17, 0
    s_add_u32 s18, s18, 28672
    s_addc_u32 s19, s19, 0
    s_nop 3
    v_pk_add_f32 v[52:53], v[52:53], v[54:55]
    v_pk_add_f32 v[44:45], v[44:45], v[46:47]
    v_cvt_pk_bf16_f32 v54, v52, v44
    v_cvt_pk_bf16_f32 v55, v53, v45
    ds_write2_b32 v8, v54, v55 offset0:32 offset1:92
    ds_read_b128 v[56:59], v9 offset:128
    v_mov_b64 v[44:45], 0
    v_mov_b64 v[46:47], 0
    v_mov_b64 v[52:53], 0
    v_mov_b64 v[54:55], 0
    s_waitcnt lgkmcnt(0)
    v_mfma_f32_16x16x32_bf16 v[60:63], v[108:111], v[56:59], v[60:63]
    v_mfma_f32_16x16x32_bf16 v[64:67], v[80:83], v[56:59], v[64:67]
    v_mfma_f32_16x16x32_bf16 v[68:71], v[94:97], v[56:59], v[68:71]
    s_mov_b64 exec, s[36:37]
    s_nop 4
    ds_write_b128 v114, v[60:63] offset:128
    s_nop 0
    ds_write_b128 v114, v[64:67]
    s_nop 0
    ds_write_b128 v114, v[68:71] offset:64
    s_mov_b64 exec, -1
    s_waitcnt lgkmcnt(0)
    s_barrier
    s_cmp_lg_u32 s8, 0
    s_cbranch_scc1 L_next_sc0
    ds_read_b128 v[16:19], v115 offset:0
    ds_read_b32 v32, v116 offset:0
    ds_read_b128 v[20:23], v115 offset:3072
    ds_read_b32 v33, v116 offset:3072
    ds_read_b128 v[24:27], v115 offset:6144
    ds_read_b32 v34, v116 offset:6144
    ds_read_b128 v[28:31], v115 offset:9216
    ds_read_b32 v35, v116 offset:9216
    s_waitcnt lgkmcnt(0)
    v_pk_add_f32 v[16:17], v[16:17], v[20:21]
    v_pk_add_f32 v[18:19], v[18:19], v[22:23]
    v_pk_add_f32 v[24:25], v[24:25], v[28:29]
    v_pk_add_f32 v[26:27], v[26:27], v[30:31]
    v_pk_add_f32 v[32:33], v[32:33], v[34:35]
    v_pk_add_f32 v[16:17], v[16:17], v[24:25]
    v_pk_add_f32 v[18:19], v[18:19], v[26:27]
    v_add_f32 v20, v32, v33
    v_max3_f32 v21, v16, v17, v18
    v_max3_f32 v21, v21, v19, v20
    s_nop 1
    v_max_f32_dpp v21, v21, v21 row_ror:2 row_mask:0xf bank_mask:0xf
    s_nop 1
    v_max_f32_dpp v21, v21, v21 row_ror:4 row_mask:0xf bank_mask:0xf
    s_nop 1
    v_max_f32_dpp v21, v21, v21 row_ror:8 row_mask:0xf bank_mask:0xf
    v_mul_f32 v21, s33, v21
    v_fma_f32 v16, v16, s33, -v21
    v_fma_f32 v17, v17, s33, -v21
    v_exp_f32 v16, v16
    v_fma_f32 v18, v18, s33, -v21
    v_exp_f32 v17, v17
    v_fma_f32 v19, v19, s33, -v21
    v_exp_f32 v18, v18
    v_fma_f32 v20, v20, s33, -v21
    v_exp_f32 v19, v19
    v_add_f32 v22, v16, v17
    v_exp_f32 v20, v20
    v_add_f32 v22, v22, v18
    v_add_f32 v22, v22, v19
    v_add_f32 v22, v22, v20
    s_nop 1
    v_add_f32_dpp v22, v22, v22 row_ror:2 row_mask:0xf bank_mask:0xf
    s_nop 1
    v_add_f32_dpp v22, v22, v22 row_ror:4 row_mask:0xf bank_mask:0xf
    s_nop 1
    v_add_f32_dpp v22, v22, v22 row_ror:8 row_mask:0xf bank_mask:0xf
    v_rcp_f32 v22, v22
    s_nop 0
    v_mul_f32 v20, v20, v22
    v_mul_f32 v16, v16, v22
    v_mul_f32 v17, v17, v22
    v_mul_f32 v18, v18, v22
    v_mul_f32 v19, v19, v22
    v_mov_b32_dpp v21, v20 row_shl:2 row_mask:0xf bank_mask:0xf
    v_cvt_pk_bf16_f32 v24, v16, v17
    v_cvt_pk_bf16_f32 v25, v18, v19
    v_cvt_pk_bf16_f32 v26, v20, v21
    v_min_u32 v24, -2, v24
    v_min_u32 v25, -2, v25
    v_min_u32 v26, -2, v26
    global_store_dwordx2 v117, v[24:25], s[14:15]
    v_mov_b32 v27, v26
    s_mov_b64 exec, s[34:35]
    global_store_dwordx2 v118, v[26:27], s[14:15]
    s_mov_b64 exec, -1

L_next_sc0:
    s_add_u32 s12, s12, 7168
    s_addc_u32 s13, s13, 0
    s_add_u32 s14, s14, 12288
    s_addc_u32 s15, s15, 0
    s_add_u32 s11, s11, 1
    s_cmp_lt_u32 s11, 63
    s_cbranch_scc1 L_loop_sc0
    s_branch L_main_done

L_sc_m1:
    v_mov_b32 v44, 0
    v_mov_b32 v45, 0
    v_mov_b32 v46, 0
    v_mov_b32 v47, 0
    v_mov_b32 v48, 0
    v_mov_b32 v49, 0
    v_mov_b32 v50, 0
    v_mov_b32 v51, 0
    v_mov_b32 v52, 0
    v_mov_b32 v53, 0
    v_mov_b32 v54, 0
    v_mov_b32 v55, 0
L_loop_sc1:
    s_mov_b32 s26, 0
L_gp_sc1:
    global_load_dwordx4 v[72:75], v2, s[12:13] sc1
    global_load_dwordx4 v[76:79], v3, s[12:13] sc1
    s_waitcnt vmcnt(0)
    v_max3_u32 v15, v72, v74, v76
    v_max_u32 v15, v15, v78
    v_cmp_eq_u32 vcc, -1, v15
    s_cbranch_vccz L_gp_sc1_a
    s_add_u32 s26, s26, 1
    s_cmp_lt_u32 s26, 4194304
    s_cbranch_scc1 L_gp_sc1
    s_branch L_main_done
L_gp_sc1_b:
    ds_write_b128 v4, v[80:83]
    ds_write_b128 v5, v[84:87]
    s_branch L_gp_sc1_j
L_gp_sc1_a:
    ds_write_b128 v4, v[72:75]
    ds_write_b128 v5, v[76:79]
L_gp_sc1_j:
    s_waitcnt lgkmcnt(0)
    s_barrier
    ds_read_b128 v[16:19], v6 offset:0
    ds_read_b128 v[20:23], v6 offset:128
    ds_read_b128 v[24:27], v6 offset:256
    ds_read_b128 v[28:31], v6 offset:384
    ds_read_b128 v[32:35], v6 offset:512
    ds_read_b128 v[36:39], v6 offset:640
    ds_read_b128 v[40:43], v6 offset:768
    s_waitcnt lgkmcnt(6)
    v_smfmac_f32_16x16x64_bf16 v[44:47], v[16:19], v[200:207], v7
    global_load_dwordx2 v[84:85], v14, s[16:17]
    s_waitcnt lgkmcnt(5)
    v_smfmac_f32_16x16x64_bf16 v[44:47], v[20:23], v[208:215], v7
    s_waitcnt lgkmcnt(4)
    v_smfmac_f32_16x16x64_bf16 v[44:47], v[24:27], v[216:223], v7
    global_load_dwordx2 v[98:99], v14, s[18:19]
    s_waitcnt lgkmcnt(3)
    v_smfmac_f32_16x16x64_bf16 v[44:47], v[28:31], v[224:231], v7
    s_waitcnt lgkmcnt(2)
    v_smfmac_f32_16x16x64_bf16 v[44:47], v[32:35], v[232:239], v7
    global_load_dwordx4 v[72:75], v13, s[16:17] offset:0
    s_waitcnt lgkmcnt(1)
    v_smfmac_f32_16x16x64_bf16 v[44:47], v[36:39], v[240:247], v7
    s_waitcnt lgkmcnt(0)
    v_smfmac_f32_16x16x64_bf16 v[44:47], v[40:43], v[248:255], v7
    global_load_dwordx4 v[86:89], v13, s[18:19] offset:0
    v_smfmac_f32_16x16x64_bf16 v[48:51], v[16:19], a[0:7], v7
    ds_read_b64 v[112:113], v12
    ds_read_b128 v[100:103], v11 offset:0
    v_smfmac_f32_16x16x64_bf16 v[48:51], v[20:23], a[8:15], v7
    ds_read_b128 v[104:107], v11 offset:64
    ds_read_b128 v[108:111], v11 offset:128
    global_load_dwordx4 v[76:79], v13, s[16:17] offset:1024
    v_smfmac_f32_16x16x64_bf16 v[48:51], v[24:27], a[16:23], v7
    v_pk_add_f32 v[44:45], v[44:45], v[46:47]
    v_cvt_pk_bf16_f32 v119, v44, v45
    v_smfmac_f32_16x16x64_bf16 v[48:51], v[28:31], a[24:31], v7
    v_mov_b64 v[44:45], 0
    v_mov_b64 v[46:47], 0
    global_load_dwordx4 v[90:93], v13, s[18:19] offset:1024
    v_smfmac_f32_16x16x64_bf16 v[48:51], v[32:35], a[32:39], v7
    ds_write_b16 v0, v119 offset:192
    ds_write_b16_d16_hi v0, v119 offset:432
    v_smfmac_f32_16x16x64_bf16 v[48:51], v[36:39], a[40:47], v7
    ds_read_b64 v[56:57], v10
    global_load_dwordx4 v[80:83], v13, s[16:17] offset:2048
    v_smfmac_f32_16x16x64_bf16 v[48:51], v[40:43], a[48:55], v7
    v_smfmac_f32_16x16x64_bf16 v[52:55], v[16:19], a[56:63], v7
    global_load_dwordx4 v[94:97], v13, s[18:19] offset:2048
    v_smfmac_f32_16x16x64_bf16 v[52:55], v[20:23], a[64:71], v7
    v_smfmac_f32_16x16x64_bf16 v[52:55], v[24:27], a[72:79], v7
    v_smfmac_f32_16x16x64_bf16 v[52:55], v[28:31], a[80:87], v7
    v_smfmac_f32_16x16x64_bf16 v[52:55], v[32:35], a[88:95], v7
    v_smfmac_f32_16x16x64_bf16 v[52:55], v[36:39], a[96:103], v7
    v_smfmac_f32_16x16x64_bf16 v[52:55], v[40:43], a[104:111], v7
    s_waitcnt vmcnt(6) lgkmcnt(0)
    v_mfma_f32_16x16x16_bf16 v[60:63], v[112:113], v[56:57], 0
    v_mfma_f32_16x16x16_bf16 v[64:67], v[84:85], v[56:57], 0
    v_mfma_f32_16x16x16_bf16 v[68:71], v[98:99], v[56:57], 0
    v_smfmac_f32_16x16x64_bf16 v[44:47], v[16:19], a[112:119], v7
    v_smfmac_f32_16x16x64_bf16 v[44:47], v[20:23], a[120:127], v7
    v_pk_add_f32 v[48:49], v[48:49], v[50:51]
    v_pk_add_f32 v[52:53], v[52:53], v[54:55]
    v_smfmac_f32_16x16x64_bf16 v[44:47], v[24:27], a[128:135], v7
    v_cvt_pk_bf16_f32 v50, v48, v52
    v_cvt_pk_bf16_f32 v51, v49, v53
    v_smfmac_f32_16x16x64_bf16 v[44:47], v[28:31], a[136:143], v7
    ds_write2_b32 v8, v50, v51 offset0:0 offset1:60
    ds_read_b128 v[56:59], v9 offset:0
    v_smfmac_f32_16x16x64_bf16 v[44:47], v[32:35], a[144:151], v7
    v_mov_b64 v[52:53], 0
    v_mov_b64 v[54:55], 0
    v_smfmac_f32_16x16x64_bf16 v[44:47], v[36:39], a[152:159], v7
    v_mov_b64 v[48:49], 0
    v_mov_b64 v[50:51], 0
    v_smfmac_f32_16x16x64_bf16 v[44:47], v[40:43], a[160:167], v7
    v_smfmac_f32_16x16x64_bf16 v[48:51], v[16:19], a[168:175], v7
    v_smfmac_f32_16x16x64_bf16 v[48:51], v[20:23], a[176:183], v7
    v_smfmac_f32_16x16x64_bf16 v[48:51], v[24:27], a[184:191], v7
    v_smfmac_f32_16x16x64_bf16 v[48:51], v[28:31], a[192:199], v7
    v_smfmac_f32_16x16x64_bf16 v[48:51], v[32:35], a[200:207], v7
    v_smfmac_f32_16x16x64_bf16 v[48:51], v[36:39], a[208:215], v7
    v_smfmac_f32_16x16x64_bf16 v[48:51], v[40:43], a[216:223], v7
    s_waitcnt vmcnt(4) lgkmcnt(0)
    v_mfma_f32_16x16x32_bf16 v[60:63], v[100:103], v[56:59], v[60:63]
    v_mfma_f32_16x16x32_bf16 v[64:67], v[72:75], v[56:59], v[64:67]
    v_mfma_f32_16x16x32_bf16 v[68:71], v[86:89], v[56:59], v[68:71]
    v_smfmac_f32_16x16x64_bf16 v[52:55], v[16:19], a[224:231], v7
    v_smfmac_f32_16x16x64_bf16 v[52:55], v[20:23], a[232:239], v7
    v_pk_add_f32 v[44:45], v[44:45], v[46:47]
    v_pk_add_f32 v[48:49], v[48:49], v[50:51]
    v_smfmac_f32_16x16x64_bf16 v[52:55], v[24:27], a[240:247], v7
    v_cvt_pk_bf16_f32 v46, v44, v48
    v_cvt_pk_bf16_f32 v47, v45, v49
    v_smfmac_f32_16x16x64_bf16 v[52:55], v[28:31], a[248:255], v7
    ds_write2_b32 v8, v46, v47 offset0:16 offset1:76
    ds_read_b128 v[56:59], v9 offset:64
    v_smfmac_f32_16x16x64_bf16 v[52:55], v[32:35], v[120:127], v7
    v_mov_b64 v[48:49], 0
    v_mov_b64 v[50:51], 0
    v_smfmac_f32_16x16x64_bf16 v[52:55], v[36:39], v[128:135], v7
    v_mov_b64 v[44:45], 0
    v_mov_b64 v[46:47], 0
    v_smfmac_f32_16x16x64_bf16 v[52:55], v[40:43], v[136:143], v7
    v_smfmac_f32_16x16x64_bf16 v[44:47], v[16:19], v[144:151], v7
    v_smfmac_f32_16x16x64_bf16 v[44:47], v[20:23], v[152:159], v7
    v_smfmac_f32_16x16x64_bf16 v[44:47], v[24:27], v[160:167], v7
    s_waitcnt vmcnt(0) lgkmcnt(0)
    v_mfma_f32_16x16x32_bf16 v[60:63], v[104:107], v[56:59], v[60:63]
    v_mfma_f32_16x16x32_bf16 v[64:67], v[76:79], v[56:59], v[64:67]
    v_mfma_f32_16x16x32_bf16 v[68:71], v[90:93], v[56:59], v[68:71]
    v_smfmac_f32_16x16x64_bf16 v[44:47], v[28:31], v[168:175], v7
    v_smfmac_f32_16x16x64_bf16 v[44:47], v[32:35], v[176:183], v7
    v_smfmac_f32_16x16x64_bf16 v[44:47], v[36:39], v[184:191], v7
    v_smfmac_f32_16x16x64_bf16 v[44:47], v[40:43], v[192:199], v7
    s_add_u32 s16, s16, 28672
    s_addc_u32 s17, s17, 0
    s_add_u32 s18, s18, 28672
    s_addc_u32 s19, s19, 0
    s_nop 3
    v_pk_add_f32 v[52:53], v[52:53], v[54:55]
    v_pk_add_f32 v[44:45], v[44:45], v[46:47]
    v_cvt_pk_bf16_f32 v54, v52, v44
    v_cvt_pk_bf16_f32 v55, v53, v45
    ds_write2_b32 v8, v54, v55 offset0:32 offset1:92
    ds_read_b128 v[56:59], v9 offset:128
    v_mov_b64 v[44:45], 0
    v_mov_b64 v[46:47], 0
    v_mov_b64 v[52:53], 0
    v_mov_b64 v[54:55], 0
    s_waitcnt lgkmcnt(0)
    v_mfma_f32_16x16x32_bf16 v[60:63], v[108:111], v[56:59], v[60:63]
    v_mfma_f32_16x16x32_bf16 v[64:67], v[80:83], v[56:59], v[64:67]
    v_mfma_f32_16x16x32_bf16 v[68:71], v[94:97], v[56:59], v[68:71]
    s_mov_b64 exec, s[36:37]
    s_nop 4
    ds_write_b128 v114, v[60:63] offset:128
    s_nop 0
    ds_write_b128 v114, v[64:67]
    s_nop 0
    ds_write_b128 v114, v[68:71] offset:64
    s_mov_b64 exec, -1
    s_waitcnt lgkmcnt(0)
    s_barrier
    s_cmp_lg_u32 s8, 0
    s_cbranch_scc1 L_next_sc1
    ds_read_b128 v[16:19], v115 offset:0
    ds_read_b32 v32, v116 offset:0
    ds_read_b128 v[20:23], v115 offset:3072
    ds_read_b32 v33, v116 offset:3072
    ds_read_b128 v[24:27], v115 offset:6144
    ds_read_b32 v34, v116 offset:6144
    ds_read_b128 v[28:31], v115 offset:9216
    ds_read_b32 v35, v116 offset:9216
    s_waitcnt lgkmcnt(0)
    v_pk_add_f32 v[16:17], v[16:17], v[20:21]
    v_pk_add_f32 v[18:19], v[18:19], v[22:23]
    v_pk_add_f32 v[24:25], v[24:25], v[28:29]
    v_pk_add_f32 v[26:27], v[26:27], v[30:31]
    v_pk_add_f32 v[32:33], v[32:33], v[34:35]
    v_pk_add_f32 v[16:17], v[16:17], v[24:25]
    v_pk_add_f32 v[18:19], v[18:19], v[26:27]
    v_add_f32 v20, v32, v33
    v_max3_f32 v21, v16, v17, v18
    v_max3_f32 v21, v21, v19, v20
    s_nop 1
    v_max_f32_dpp v21, v21, v21 row_ror:2 row_mask:0xf bank_mask:0xf
    s_nop 1
    v_max_f32_dpp v21, v21, v21 row_ror:4 row_mask:0xf bank_mask:0xf
    s_nop 1
    v_max_f32_dpp v21, v21, v21 row_ror:8 row_mask:0xf bank_mask:0xf
    v_mul_f32 v21, s33, v21
    v_fma_f32 v16, v16, s33, -v21
    v_fma_f32 v17, v17, s33, -v21
    v_exp_f32 v16, v16
    v_fma_f32 v18, v18, s33, -v21
    v_exp_f32 v17, v17
    v_fma_f32 v19, v19, s33, -v21
    v_exp_f32 v18, v18
    v_fma_f32 v20, v20, s33, -v21
    v_exp_f32 v19, v19
    v_add_f32 v22, v16, v17
    v_exp_f32 v20, v20
    v_add_f32 v22, v22, v18
    v_add_f32 v22, v22, v19
    v_add_f32 v22, v22, v20
    s_nop 1
    v_add_f32_dpp v22, v22, v22 row_ror:2 row_mask:0xf bank_mask:0xf
    s_nop 1
    v_add_f32_dpp v22, v22, v22 row_ror:4 row_mask:0xf bank_mask:0xf
    s_nop 1
    v_add_f32_dpp v22, v22, v22 row_ror:8 row_mask:0xf bank_mask:0xf
    v_rcp_f32 v22, v22
    s_nop 0
    v_mul_f32 v20, v20, v22
    v_mul_f32 v16, v16, v22
    v_mul_f32 v17, v17, v22
    v_mul_f32 v18, v18, v22
    v_mul_f32 v19, v19, v22
    v_mov_b32_dpp v21, v20 row_shl:2 row_mask:0xf bank_mask:0xf
    v_cvt_pk_bf16_f32 v24, v16, v17
    v_cvt_pk_bf16_f32 v25, v18, v19
    v_cvt_pk_bf16_f32 v26, v20, v21
    v_min_u32 v24, -2, v24
    v_min_u32 v25, -2, v25
    v_min_u32 v26, -2, v26
    global_store_dwordx2 v117, v[24:25], s[14:15] sc1
    v_mov_b32 v27, v26
    s_mov_b64 exec, s[34:35]
    global_store_dwordx2 v118, v[26:27], s[14:15] sc1
    s_mov_b64 exec, -1

L_next_sc1:
    s_add_u32 s12, s12, 7168
    s_addc_u32 s13, s13, 0
    s_add_u32 s14, s14, 12288
    s_addc_u32 s15, s15, 0
    s_add_u32 s11, s11, 1
    s_cmp_lt_u32 s11, 63
    s_cbranch_scc1 L_loop_sc1
    s_branch L_main_done

L_bside:
    s_sub_u32 s30, s9, 16
    s_lshl_b32 s31, s30, 1
    s_lshl_b32 s38, s30, 2
    s_add_u32 s38, s38, s8
    s_lshl_b32 s38, s38, 2
    s_add_u32 s38, s38, 7680
    s_lshl_b32 s22, s8, 11
    v_lshlrev_b32 v8, 4, v1
    v_add_u32 v8, s22, v8
    s_lshl_b32 s22, s8, 10
    s_add_u32 s22, s22, 8192
    v_lshlrev_b32 v12, 4, v1
    v_add_u32 v12, s22, v12
    v_lshlrev_b32 v156, 4, v1
    v_and_b32 v44, 15, v1
    s_lshl_b32 s22, s8, 10
    s_add_u32 s22, s22, 8768
    v_lshlrev_b32 v13, 7, v11
    v_lshl_add_u32 v13, v44, 2, v13
    v_add_u32 v13, s22, v13
    v_lshrrev_b32 v44, 3, v1
    v_and_b32 v45, 7, v1
    v_lshrrev_b32 v46, 2, v45
    v_and_b32 v47, 3, v45
    v_lshlrev_b32 v14, 9, v46
    v_lshl_add_u32 v14, v44, 6, v14
    v_lshl_add_u32 v14, v47, 4, v14
    v_add_u32 v14, 8768, v14
    s_lshl_b32 s22, s30, 6
    v_mul_u32_u24 v152, 896, v44
    v_lshl_add_u32 v152, v45, 3, v152
    v_add_u32 v152, s22, v152
    v_add_u32 v152, 7168, v152
    v_lshlrev_b32 v153, 4, v1
    v_add_u32 v157, 16384, v156
    s_mul_i32 s22, s8, 28672
    s_add_u32 s22, s22, 20480
    v_lshlrev_b32 v154, 4, v1
    v_add_u32 v154, s22, v154
    v_lshlrev_b32 v155, 4, v1
    v_add_u32 v151, 4096, v155

    s_lshl_b32 s22, s31, 4
    s_lshl_b32 s23, s8, 2
    s_add_u32 s22, s22, s23
    s_mul_i32 s22, s22, 14336
    s_add_u32 s22, s22, 8519680
    s_add_u32 s20, s6, s22
    s_addc_u32 s21, s7, 0

    global_load_dwordx4 a[0:3], v153, s[20:21] offset:0
    global_load_dwordx4 a[4:7], v153, s[20:21] offset:1024
    global_load_dwordx4 a[8:11], v153, s[20:21] offset:2048
    global_load_dwordx4 a[12:15], v153, s[20:21] offset:3072
    s_add_u32 s20, s20, 4096
    s_addc_u32 s21, s21, 0
    global_load_dwordx4 a[16:19], v153, s[20:21] offset:0
    global_load_dwordx4 a[20:23], v153, s[20:21] offset:1024
    global_load_dwordx4 a[24:27], v153, s[20:21] offset:2048
    global_load_dwordx4 a[28:31], v153, s[20:21] offset:3072
    s_add_u32 s20, s20, 4096
    s_addc_u32 s21, s21, 0
    global_load_dwordx4 a[32:35], v153, s[20:21] offset:0
    global_load_dwordx4 a[36:39], v153, s[20:21] offset:1024
    global_load_dwordx4 a[40:43], v153, s[20:21] offset:2048
    global_load_dwordx4 a[44:47], v153, s[20:21] offset:3072
    s_add_u32 s20, s20, 4096
    s_addc_u32 s21, s21, 0
    global_load_dwordx4 a[48:51], v153, s[20:21] offset:0
    global_load_dwordx4 a[52:55], v153, s[20:21] offset:1024
    global_load_dwordx4 a[56:59], v153, s[20:21] offset:2048
    global_load_dwordx4 a[60:63], v153, s[20:21] offset:3072
    s_add_u32 s20, s20, 4096
    s_addc_u32 s21, s21, 0
    global_load_dwordx4 a[64:67], v153, s[20:21] offset:0
    global_load_dwordx4 a[68:71], v153, s[20:21] offset:1024
    global_load_dwordx4 a[72:75], v153, s[20:21] offset:2048
    global_load_dwordx4 a[76:79], v153, s[20:21] offset:3072
    s_add_u32 s20, s20, 4096
    s_addc_u32 s21, s21, 0
    global_load_dwordx4 a[80:83], v153, s[20:21] offset:0
    global_load_dwordx4 a[84:87], v153, s[20:21] offset:1024
    global_load_dwordx4 a[88:91], v153, s[20:21] offset:2048
    global_load_dwordx4 a[92:95], v153, s[20:21] offset:3072
    s_add_u32 s20, s20, 4096
    s_addc_u32 s21, s21, 0
    global_load_dwordx4 a[96:99], v153, s[20:21] offset:0
    global_load_dwordx4 a[100:103], v153, s[20:21] offset:1024
    global_load_dwordx4 a[104:107], v153, s[20:21] offset:2048
    global_load_dwordx4 a[108:111], v153, s[20:21] offset:3072
    s_add_u32 s20, s20, 4096
    s_addc_u32 s21, s21, 0
    global_load_dwordx4 a[112:115], v153, s[20:21] offset:0
    global_load_dwordx4 a[116:119], v153, s[20:21] offset:1024
    global_load_dwordx4 a[120:123], v153, s[20:21] offset:2048
    global_load_dwordx4 a[124:127], v153, s[20:21] offset:3072
    s_add_u32 s20, s20, 4096
    s_addc_u32 s21, s21, 0
    global_load_dwordx4 a[128:131], v153, s[20:21] offset:0
    global_load_dwordx4 a[132:135], v153, s[20:21] offset:1024
    global_load_dwordx4 a[136:139], v153, s[20:21] offset:2048
    global_load_dwordx4 a[140:143], v153, s[20:21] offset:3072
    s_add_u32 s20, s20, 4096
    s_addc_u32 s21, s21, 0
    global_load_dwordx4 a[144:147], v153, s[20:21] offset:0
    global_load_dwordx4 a[148:151], v153, s[20:21] offset:1024
    global_load_dwordx4 a[152:155], v153, s[20:21] offset:2048
    global_load_dwordx4 a[156:159], v153, s[20:21] offset:3072
    s_add_u32 s20, s20, 4096
    s_addc_u32 s21, s21, 0
    global_load_dwordx4 a[160:163], v153, s[20:21] offset:0
    global_load_dwordx4 a[164:167], v153, s[20:21] offset:1024
    global_load_dwordx4 a[168:171], v153, s[20:21] offset:2048
    global_load_dwordx4 a[172:175], v153, s[20:21] offset:3072
    s_add_u32 s20, s20, 4096
    s_addc_u32 s21, s21, 0
    global_load_dwordx4 a[176:179], v153, s[20:21] offset:0
    global_load_dwordx4 a[180:183], v153, s[20:21] offset:1024
    global_load_dwordx4 a[184:187], v153, s[20:21] offset:2048
    global_load_dwordx4 a[188:191], v153, s[20:21] offset:3072
    s_add_u32 s20, s20, 4096
    s_addc_u32 s21, s21, 0
    global_load_dwordx4 a[192:195], v153, s[20:21] offset:0
    global_load_dwordx4 a[196:199], v153, s[20:21] offset:1024
    global_load_dwordx4 a[200:203], v153, s[20:21] offset:2048
    global_load_dwordx4 a[204:207], v153, s[20:21] offset:3072
    s_add_u32 s20, s20, 4096
    s_addc_u32 s21, s21, 0
    global_load_dwordx4 a[208:211], v153, s[20:21] offset:0
    global_load_dwordx4 a[212:215], v153, s[20:21] offset:1024
    global_load_dwordx4 a[216:219], v153, s[20:21] offset:2048
    global_load_dwordx4 a[220:223], v153, s[20:21] offset:3072
    s_add_u32 s20, s20, 176128
    s_addc_u32 s21, s21, 0
    global_load_dwordx4 a[224:227], v153, s[20:21] offset:0
    global_load_dwordx4 a[228:231], v153, s[20:21] offset:1024
    global_load_dwordx4 a[232:235], v153, s[20:21] offset:2048
    global_load_dwordx4 a[236:239], v153, s[20:21] offset:3072
    s_add_u32 s20, s20, 4096
    s_addc_u32 s21, s21, 0
    global_load_dwordx4 a[240:243], v153, s[20:21] offset:0
    global_load_dwordx4 a[244:247], v153, s[20:21] offset:1024
    global_load_dwordx4 a[248:251], v153, s[20:21] offset:2048
    global_load_dwordx4 a[252:255], v153, s[20:21] offset:3072
    s_add_u32 s20, s20, 4096
    s_addc_u32 s21, s21, 0
    global_load_dwordx4 v[176:179], v153, s[20:21] offset:0
    global_load_dwordx4 v[180:183], v153, s[20:21] offset:1024
    global_load_dwordx4 v[184:187], v153, s[20:21] offset:2048
    global_load_dwordx4 v[188:191], v153, s[20:21] offset:3072
    s_add_u32 s20, s20, 4096
    s_addc_u32 s21, s21, 0
    global_load_dwordx4 v[192:195], v153, s[20:21] offset:0
    global_load_dwordx4 v[196:199], v153, s[20:21] offset:1024
    global_load_dwordx4 v[200:203], v153, s[20:21] offset:2048
    global_load_dwordx4 v[204:207], v153, s[20:21] offset:3072
    s_add_u32 s20, s20, 4096
    s_addc_u32 s21, s21, 0
    global_load_dwordx4 v[208:211], v153, s[20:21] offset:0
    global_load_dwordx4 v[212:215], v153, s[20:21] offset:1024
    global_load_dwordx4 v[216:219], v153, s[20:21] offset:2048
    global_load_dwordx4 v[220:223], v153, s[20:21] offset:3072
    s_add_u32 s20, s20, 4096
    s_addc_u32 s21, s21, 0
    global_load_dwordx4 v[224:227], v153, s[20:21] offset:0
    global_load_dwordx4 v[228:231], v153, s[20:21] offset:1024
    global_load_dwordx4 v[232:235], v153, s[20:21] offset:2048
    global_load_dwordx4 v[236:239], v153, s[20:21] offset:3072
    s_add_u32 s20, s20, 4096
    s_addc_u32 s21, s21, 0
    global_load_dwordx4 v[240:243], v153, s[20:21] offset:0
    global_load_dwordx4 v[244:247], v153, s[20:21] offset:1024
    global_load_dwordx4 v[248:251], v153, s[20:21] offset:2048
    global_load_dwordx4 v[252:255], v153, s[20:21] offset:3072
    s_add_u32 s20, s20, 4096
    s_addc_u32 s21, s21, 0
    global_load_dwordx4 v[16:19], v153, s[20:21] offset:0
    global_load_dwordx4 v[20:23], v153, s[20:21] offset:1024
    global_load_dwordx4 v[24:27], v153, s[20:21] offset:2048
    global_load_dwordx4 v[28:31], v153, s[20:21] offset:3072
    s_add_u32 s20, s20, 4096
    s_addc_u32 s21, s21, 0
    global_load_dwordx4 v[32:35], v153, s[20:21] offset:0
    global_load_dwordx4 v[36:39], v153, s[20:21] offset:1024
    global_load_dwordx4 v[40:43], v153, s[20:21] offset:2048
    global_load_dwordx4 v[44:47], v153, s[20:21] offset:3072
    s_add_u32 s20, s20, 4096
    s_addc_u32 s21, s21, 0
    global_load_dwordx4 v[48:51], v153, s[20:21] offset:0
    global_load_dwordx4 v[52:55], v153, s[20:21] offset:1024
    global_load_dwordx4 v[56:59], v153, s[20:21] offset:2048
    global_load_dwordx4 v[60:63], v153, s[20:21] offset:3072
    s_add_u32 s20, s20, 4096
    s_addc_u32 s21, s21, 0
    global_load_dwordx4 v[64:67], v153, s[20:21] offset:0
    global_load_dwordx4 v[68:71], v153, s[20:21] offset:1024
    global_load_dwordx4 v[72:75], v153, s[20:21] offset:2048
    global_load_dwordx4 v[76:79], v153, s[20:21] offset:3072
    s_add_u32 s20, s20, 4096
    s_addc_u32 s21, s21, 0
    global_load_dwordx4 v[80:83], v153, s[20:21] offset:0
    global_load_dwordx4 v[84:87], v153, s[20:21] offset:1024
    global_load_dwordx4 v[88:91], v153, s[20:21] offset:2048
    global_load_dwordx4 v[92:95], v153, s[20:21] offset:3072
    s_add_u32 s20, s20, 4096
    s_addc_u32 s21, s21, 0
    global_load_dwordx4 v[96:99], v153, s[20:21] offset:0
    global_load_dwordx4 v[100:103], v153, s[20:21] offset:1024
    global_load_dwordx4 v[104:107], v153, s[20:21] offset:2048
    global_load_dwordx4 v[108:111], v153, s[20:21] offset:3072
    s_add_u32 s20, s20, 4096
    s_addc_u32 s21, s21, 0
    global_load_dwordx4 v[112:115], v153, s[20:21] offset:0
    global_load_dwordx4 v[116:119], v153, s[20:21] offset:1024
    global_load_dwordx4 v[120:123], v153, s[20:21] offset:2048
    global_load_dwordx4 v[124:127], v153, s[20:21] offset:3072
    s_add_u32 s20, s20, 4096
    s_addc_u32 s21, s21, 0
    s_waitcnt vmcnt(0)
    ds_write_b128 v154, v[16:19] offset:0
    ds_write_b128 v154, v[20:23] offset:1024
    ds_write_b128 v154, v[24:27] offset:2048
    ds_write_b128 v154, v[28:31] offset:3072
    ds_write_b128 v154, v[32:35] offset:4096
    ds_write_b128 v154, v[36:39] offset:5120
    ds_write_b128 v154, v[40:43] offset:6144
    ds_write_b128 v154, v[44:47] offset:7168
    ds_write_b128 v154, v[48:51] offset:8192
    ds_write_b128 v154, v[52:55] offset:9216
    ds_write_b128 v154, v[56:59] offset:10240
    ds_write_b128 v154, v[60:63] offset:11264
    ds_write_b128 v154, v[64:67] offset:12288
    ds_write_b128 v154, v[68:71] offset:13312
    ds_write_b128 v154, v[72:75] offset:14336
    ds_write_b128 v154, v[76:79] offset:15360
    ds_write_b128 v154, v[80:83] offset:16384
    ds_write_b128 v154, v[84:87] offset:17408
    ds_write_b128 v154, v[88:91] offset:18432
    ds_write_b128 v154, v[92:95] offset:19456
    ds_write_b128 v154, v[96:99] offset:20480
    ds_write_b128 v154, v[100:103] offset:21504
    ds_write_b128 v154, v[104:107] offset:22528
    ds_write_b128 v154, v[108:111] offset:23552
    ds_write_b128 v154, v[112:115] offset:24576
    ds_write_b128 v154, v[116:119] offset:25600
    ds_write_b128 v154, v[120:123] offset:26624
    ds_write_b128 v154, v[124:127] offset:27648
    s_waitcnt lgkmcnt(0)
    s_mov_b32 s11, 0
    s_add_u32 s12, s6, 32768
    s_addc_u32 s13, s7, 0
    s_add_u32 s14, s6, 491520
    s_addc_u32 s15, s7, 0
    s_lshl_b32 s22, s31, 3
    s_lshl_b32 s23, s8, 1
    s_add_u32 s22, s22, s23
    s_lshl_b32 s22, s22, 11
    s_add_u32 s22, s22, 14942208
    s_add_u32 s16, s6, s22
    s_addc_u32 s17, s7, 0
    s_lshl_b32 s22, s31, 2
    s_add_u32 s22, s22, s8
    s_lshl_b32 s22, s22, 10
    s_add_u32 s22, s22, 44187648
    s_add_u32 s18, s6, s22
    s_addc_u32 s19, s7, 0

    s_cmp_lg_u32 s10, 0
    s_cbranch_scc1 L_b_m1
    v_mov_b32 v44, 0
    v_mov_b32 v160, 0
    v_mov_b32 v45, 0
    v_mov_b32 v161, 0
    v_mov_b32 v46, 0
    v_mov_b32 v162, 0
    v_mov_b32 v47, 0
    v_mov_b32 v163, 0
    v_mov_b32 v48, 0
    v_mov_b32 v164, 0
    v_mov_b32 v49, 0
    v_mov_b32 v165, 0
    v_mov_b32 v50, 0
    v_mov_b32 v166, 0
    v_mov_b32 v51, 0
    v_mov_b32 v167, 0
L_loop_b0:
    s_mov_b32 s26, 0
L_gp_b0:
    global_load_dwordx4 v[68:71], v2, s[12:13] sc1
    global_load_dwordx4 v[72:75], v3, s[12:13] sc1
    s_waitcnt vmcnt(0)
    v_max3_u32 v15, v68, v70, v72
    v_max_u32 v15, v15, v74
    v_cmp_eq_u32 vcc, -1, v15
    s_cbranch_vccz L_gp_b0_a
    s_add_u32 s26, s26, 1
    s_cmp_lt_u32 s26, 4194304
    s_cbranch_scc1 L_gp_b0
    s_branch L_main_done
L_gp_b0_b:
    ds_write_b128 v4, v[76:79]
    ds_write_b128 v5, v[80:83]
    s_branch L_gp_b0_j
L_gp_b0_a:
    ds_write_b128 v4, v[68:71]
    ds_write_b128 v5, v[72:75]
L_gp_b0_j:
    s_waitcnt lgkmcnt(0)
    s_barrier
    ds_read_b128 v[16:19], v6 offset:0
    ds_read_b128 v[20:23], v6 offset:128
    ds_read_b128 v[24:27], v6 offset:256
    ds_read_b128 v[28:31], v6 offset:384
    ds_read_b128 v[32:35], v6 offset:512
    ds_read_b128 v[36:39], v6 offset:640
    ds_read_b128 v[40:43], v6 offset:768
    s_and_b32 s22, s11, 7
    s_cmp_lg_u32 s22, 0
    s_cbranch_scc1 L_yxok_b0
    s_lshr_b32 s22, s11, 3
    s_lshl_b32 s22, s22, 2
    s_add_u32 s22, s22, 2304
    v_mov_b32 v159, s22
    s_cmp_eq_u32 s11, 0
    s_cselect_b32 s23, 64, 32
    s_mov_b32 s26, 0
L_yxw_b0:
    global_load_dword v158, v159, s[6:7] sc1
    s_add_u32 s26, s26, 1
    s_cmp_ge_u32 s26, 4194304
    s_cbranch_scc1 L_main_done
    s_waitcnt vmcnt(0)
    v_cmp_gt_u32 vcc, s23, v158
    s_cbranch_vccnz L_yxw_b0
L_yxok_b0:
    s_cmp_lt_u32 s11, 2
    s_cbranch_scc1 L_nosig_b0
    s_lshl_b32 s22, s11, 8
    s_add_u32 s22, s22, s38
    v_mov_b32 v159, s22
    v_mov_b32 v158, 1
    s_mov_b64 exec, 1
    global_store_dword v159, v158, s[6:7]
    s_mov_b64 exec, -1
L_nosig_b0:
    s_cmp_eq_u32 s11, 0
    s_cbranch_scc1 L_noyst_b0
    global_store_dwordx4 v155, v[168:171], s[18:19] sc1
    global_store_dwordx4 v151, v[172:175], s[18:19] sc1
L_noyst_b0:
    s_waitcnt lgkmcnt(6)
    v_smfmac_f32_16x16x64_bf16 v[44:47], v[16:19], a[0:7], v7
    global_load_dwordx4 v[68:71], v156, s[16:17] offset:0 sc1
    s_waitcnt lgkmcnt(5)
    v_smfmac_f32_16x16x64_bf16 v[44:47], v[20:23], a[8:15], v7
    s_waitcnt lgkmcnt(4)
    v_smfmac_f32_16x16x64_bf16 v[44:47], v[24:27], a[16:23], v7
    s_waitcnt lgkmcnt(3)
    v_smfmac_f32_16x16x64_bf16 v[44:47], v[28:31], a[24:31], v7
    global_load_dwordx4 v[72:75], v156, s[16:17] offset:1024 sc1
    s_waitcnt lgkmcnt(2)
    v_smfmac_f32_16x16x64_bf16 v[44:47], v[32:35], a[32:39], v7
    s_waitcnt lgkmcnt(1)
    v_smfmac_f32_16x16x64_bf16 v[44:47], v[36:39], a[40:47], v7
    s_waitcnt lgkmcnt(0)
    v_smfmac_f32_16x16x64_bf16 v[44:47], v[40:43], a[48:55], v7
    v_smfmac_f32_16x16x64_bf16 v[48:51], v[16:19], a[56:63], v7
    global_load_dwordx4 v[76:79], v156, s[16:17] offset:2048 sc1
    v_smfmac_f32_16x16x64_bf16 v[48:51], v[20:23], a[64:71], v7
    v_smfmac_f32_16x16x64_bf16 v[48:51], v[24:27], a[72:79], v7
    v_cvt_pk_bf16_f32 v52, v44, v45
    v_cvt_pk_bf16_f32 v54, v46, v47
    v_smfmac_f32_16x16x64_bf16 v[48:51], v[28:31], a[80:87], v7
    v_pk_add_f32 v[144:145], v[44:45], v[46:47]
    v_mov_b64 v[44:45], 0
    global_load_dwordx4 v[80:83], v156, s[16:17] offset:3072 sc1
    v_smfmac_f32_16x16x64_bf16 v[48:51], v[32:35], a[88:95], v7
    v_mov_b64 v[46:47], 0
    v_cvt_pk_bf16_f32 v168, v144, v145
    v_smfmac_f32_16x16x64_bf16 v[48:51], v[36:39], a[96:103], v7
    v_smfmac_f32_16x16x64_bf16 v[48:51], v[40:43], a[104:111], v7
    v_smfmac_f32_16x16x64_bf16 v[160:163], v[16:19], a[112:119], v7
    global_load_dwordx4 v[84:87], v157, s[16:17] offset:0 sc1
    v_smfmac_f32_16x16x64_bf16 v[160:163], v[20:23], a[120:127], v7
    v_smfmac_f32_16x16x64_bf16 v[160:163], v[24:27], a[128:135], v7
    v_cvt_pk_bf16_f32 v53, v48, v49
    v_cvt_pk_bf16_f32 v55, v50, v51
    v_smfmac_f32_16x16x64_bf16 v[160:163], v[28:31], a[136:143], v7
    v_pk_add_f32 v[144:145], v[48:49], v[50:51]
    v_mov_b64 v[48:49], 0
    global_load_dwordx4 v[88:91], v157, s[16:17] offset:1024 sc1
    v_smfmac_f32_16x16x64_bf16 v[160:163], v[32:35], a[144:151], v7
    v_mov_b64 v[50:51], 0
    v_cvt_pk_bf16_f32 v169, v144, v145
    v_smfmac_f32_16x16x64_bf16 v[160:163], v[36:39], a[152:159], v7
    v_smfmac_f32_16x16x64_bf16 v[160:163], v[40:43], a[160:167], v7
    v_smfmac_f32_16x16x64_bf16 v[164:167], v[16:19], a[168:175], v7
    global_load_dwordx4 v[92:95], v157, s[16:17] offset:2048 sc1
    v_smfmac_f32_16x16x64_bf16 v[164:167], v[20:23], a[176:183], v7
    v_smfmac_f32_16x16x64_bf16 v[164:167], v[24:27], a[184:191], v7
    v_cvt_pk_bf16_f32 v56, v160, v161
    v_cvt_pk_bf16_f32 v58, v162, v163
    v_smfmac_f32_16x16x64_bf16 v[164:167], v[28:31], a[192:199], v7
    v_pk_add_f32 v[144:145], v[160:161], v[162:163]
    v_mov_b64 v[160:161], 0
    global_load_dwordx4 v[96:99], v157, s[16:17] offset:3072 sc1
    v_smfmac_f32_16x16x64_bf16 v[164:167], v[32:35], a[200:207], v7
    v_mov_b64 v[162:163], 0
    v_cvt_pk_bf16_f32 v170, v144, v145
    v_smfmac_f32_16x16x64_bf16 v[164:167], v[36:39], a[208:215], v7
    ds_read_b128 v[124:127], v154 offset:0
    ds_read_b128 v[128:131], v154 offset:1024
    v_smfmac_f32_16x16x64_bf16 v[164:167], v[40:43], a[216:223], v7
    ds_read_b128 v[132:135], v154 offset:2048
    ds_read_b128 v[136:139], v154 offset:3072
    ds_read_b128 v[100:103], v154 offset:4096
    ds_read_b128 v[104:107], v154 offset:5120
    v_smfmac_f32_16x16x64_bf16 v[44:47], v[16:19], a[224:231], v7
    s_waitcnt lgkmcnt(4)
    v_smfmac_f32_16x16x64_bf16 v[48:51], v[16:19], v[124:131], v7
    ds_read_b128 v[108:111], v154 offset:6144
    ds_read_b128 v[112:115], v154 offset:7168
    v_smfmac_f32_16x16x64_bf16 v[44:47], v[20:23], a[232:239], v7
    v_cvt_pk_bf16_f32 v57, v164, v165
    v_cvt_pk_bf16_f32 v59, v166, v167
    s_waitcnt lgkmcnt(4)
    v_smfmac_f32_16x16x64_bf16 v[48:51], v[20:23], v[132:139], v7
    ds_read_b128 v[124:127], v154 offset:8192
    ds_read_b128 v[128:131], v154 offset:9216
    v_smfmac_f32_16x16x64_bf16 v[44:47], v[24:27], a[240:247], v7
    v_pk_add_f32 v[144:145], v[164:165], v[166:167]
    v_mov_b64 v[164:165], 0
    s_waitcnt lgkmcnt(4)
    v_smfmac_f32_16x16x64_bf16 v[48:51], v[24:27], v[100:107], v7
    ds_read_b128 v[132:135], v154 offset:10240
    ds_read_b128 v[136:139], v154 offset:11264
    v_smfmac_f32_16x16x64_bf16 v[44:47], v[28:31], a[248:255], v7
    v_mov_b64 v[166:167], 0
    v_cvt_pk_bf16_f32 v171, v144, v145
    s_waitcnt lgkmcnt(4)
    v_smfmac_f32_16x16x64_bf16 v[48:51], v[28:31], v[108:115], v7
    ds_read_b128 v[100:103], v154 offset:12288
    ds_read_b128 v[104:107], v154 offset:13312
    v_smfmac_f32_16x16x64_bf16 v[44:47], v[32:35], v[176:183], v7
    s_waitcnt lgkmcnt(4)
    v_smfmac_f32_16x16x64_bf16 v[48:51], v[32:35], v[124:131], v7
    ds_read_b128 v[108:111], v154 offset:14336
    ds_read_b128 v[112:115], v154 offset:15360
    v_smfmac_f32_16x16x64_bf16 v[44:47], v[36:39], v[184:191], v7
    s_waitcnt lgkmcnt(4)
    v_smfmac_f32_16x16x64_bf16 v[48:51], v[36:39], v[132:139], v7
    ds_read_b128 v[124:127], v154 offset:16384
    ds_read_b128 v[128:131], v154 offset:17408
    v_smfmac_f32_16x16x64_bf16 v[44:47], v[40:43], v[192:199], v7
    s_waitcnt lgkmcnt(4)
    v_smfmac_f32_16x16x64_bf16 v[48:51], v[40:43], v[100:107], v7
    ds_read_b128 v[132:135], v154 offset:18432
    ds_read_b128 v[136:139], v154 offset:19456
    v_smfmac_f32_16x16x64_bf16 v[160:163], v[16:19], v[200:207], v7
    s_waitcnt lgkmcnt(4)
    v_smfmac_f32_16x16x64_bf16 v[164:167], v[16:19], v[108:115], v7
    ds_read_b128 v[100:103], v154 offset:20480
    ds_read_b128 v[104:107], v154 offset:21504
    v_smfmac_f32_16x16x64_bf16 v[160:163], v[20:23], v[208:215], v7
    v_cvt_pk_bf16_f32 v60, v44, v45
    v_cvt_pk_bf16_f32 v62, v46, v47
    s_waitcnt lgkmcnt(4)
    v_smfmac_f32_16x16x64_bf16 v[164:167], v[20:23], v[124:131], v7
    ds_read_b128 v[108:111], v154 offset:22528
    ds_read_b128 v[112:115], v154 offset:23552
    v_smfmac_f32_16x16x64_bf16 v[160:163], v[24:27], v[216:223], v7
    v_pk_add_f32 v[144:145], v[44:45], v[46:47]
    v_mov_b64 v[44:45], 0
    s_waitcnt lgkmcnt(4)
    v_smfmac_f32_16x16x64_bf16 v[164:167], v[24:27], v[132:139], v7
    ds_read_b128 v[124:127], v154 offset:24576
    ds_read_b128 v[128:131], v154 offset:25600
    v_smfmac_f32_16x16x64_bf16 v[160:163], v[28:31], v[224:231], v7
    v_mov_b64 v[46:47], 0
    v_cvt_pk_bf16_f32 v172, v144, v145
    s_waitcnt lgkmcnt(4)
    v_smfmac_f32_16x16x64_bf16 v[164:167], v[28:31], v[100:107], v7
    ds_read_b128 v[132:135], v154 offset:26624
    ds_read_b128 v[136:139], v154 offset:27648
    v_smfmac_f32_16x16x64_bf16 v[160:163], v[32:35], v[232:239], v7
    v_cvt_pk_bf16_f32 v64, v48, v49
    v_cvt_pk_bf16_f32 v66, v50, v51
    s_waitcnt lgkmcnt(4)
    v_smfmac_f32_16x16x64_bf16 v[164:167], v[32:35], v[108:115], v7
    v_smfmac_f32_16x16x64_bf16 v[160:163], v[36:39], v[240:247], v7
    v_pk_add_f32 v[144:145], v[48:49], v[50:51]
    v_mov_b64 v[48:49], 0
    s_waitcnt lgkmcnt(2)
    v_smfmac_f32_16x16x64_bf16 v[164:167], v[36:39], v[124:131], v7
    v_smfmac_f32_16x16x64_bf16 v[160:163], v[40:43], v[248:255], v7
    v_mov_b64 v[50:51], 0
    v_cvt_pk_bf16_f32 v174, v144, v145
    s_waitcnt lgkmcnt(0)
    v_smfmac_f32_16x16x64_bf16 v[164:167], v[40:43], v[132:139], v7
    s_nop 3
    v_cvt_pk_bf16_f32 v61, v160, v161
    v_cvt_pk_bf16_f32 v63, v162, v163
    v_pk_add_f32 v[144:145], v[160:161], v[162:163]
    v_mov_b64 v[160:161], 0
    v_mov_b64 v[162:163], 0
    v_cvt_pk_bf16_f32 v173, v144, v145
    v_mov_b64 v[140:141], 0
    v_mov_b64 v[142:143], 0
    v_mov_b64 v[120:121], 0
    v_mov_b64 v[122:123], 0
    s_nop 3
    v_cvt_pk_bf16_f32 v65, v164, v165
    v_cvt_pk_bf16_f32 v67, v166, v167
    v_pk_add_f32 v[144:145], v[164:165], v[166:167]
    v_mov_b64 v[164:165], 0
    v_mov_b64 v[166:167], 0
    v_cvt_pk_bf16_f32 v175, v144, v145
    s_cmp_lt_u32 s11, 63
    s_cbranch_scc1 L_notlast_b0
    s_add_u32 s18, s18, 114688
    s_addc_u32 s19, s19, 0
    global_store_dwordx4 v155, v[168:171], s[18:19] sc1
    global_store_dwordx4 v151, v[172:175], s[18:19] sc1
    s_add_u32 s22, s38, 16384
    v_mov_b32 v159, s22
    v_mov_b32 v158, 1
    s_waitcnt vmcnt(0)
    s_mov_b64 exec, 1
    global_store_dword v159, v158, s[6:7]
    global_store_dword v159, v158, s[6:7] offset:256
    s_branch L_main_done
L_notlast_b0:
    s_mov_b32 s26, 0
L_ppoll_b0:
    global_load_dwordx4 v[100:103], v8, s[14:15] offset:0 sc1
    global_load_dwordx4 v[104:107], v8, s[14:15] offset:1024 sc1
    global_load_dwordx4 v[116:119], v12, s[14:15] sc1
    s_waitcnt vmcnt(0)
    v_max3_u32 v15, v100, v102, v104
    v_max3_u32 v158, v106, v116, v118
    v_max_u32 v15, v15, v158
    v_cmp_eq_u32 vcc, -1, v15
    s_cbranch_vccz L_pa_b0
    s_add_u32 s26, s26, 1
    s_cmp_lt_u32 s26, 4194304
    s_cbranch_scc1 L_ppoll_b0
    s_branch L_main_done
L_pb_b0:
    v_smfmac_f32_16x16x64_bf16 v[140:143], v[124:127], v[68:75], v7
    v_smfmac_f32_16x16x64_bf16 v[120:123], v[124:127], v[84:91], v7
    v_smfmac_f32_16x16x64_bf16 v[140:143], v[128:131], v[76:83], v7
    v_smfmac_f32_16x16x64_bf16 v[120:123], v[128:131], v[92:99], v7
    v_smfmac_f32_16x16x64_bf16 v[140:143], v[132:135], v[52:59], v7
    v_smfmac_f32_16x16x64_bf16 v[120:123], v[132:135], v[60:67], v7
    s_branch L_pj_b0
L_pa_b0:
    v_smfmac_f32_16x16x64_bf16 v[140:143], v[100:103], v[68:75], v7
    v_smfmac_f32_16x16x64_bf16 v[120:123], v[100:103], v[84:91], v7
    v_smfmac_f32_16x16x64_bf16 v[140:143], v[104:107], v[76:83], v7
    v_smfmac_f32_16x16x64_bf16 v[120:123], v[104:107], v[92:99], v7
    v_smfmac_f32_16x16x64_bf16 v[140:143], v[116:119], v[52:59], v7
    v_smfmac_f32_16x16x64_bf16 v[120:123], v[116:119], v[60:67], v7
L_pj_b0:
    s_add_u32 s16, s16, 458752
    s_addc_u32 s17, s17, 0
    s_add_u32 s18, s18, 114688
    s_addc_u32 s19, s19, 0
    s_nop 1

    v_pk_add_f32 v[144:145], v[140:141], v[142:143]
    s_nop 0
    v_pk_add_f32 v[146:147], v[120:121], v[122:123]
    ds_write2_b32 v13, v144, v145 offset0:0 offset1:16
    ds_write2_b32 v13, v146, v147 offset0:128 offset1:144
    s_waitcnt lgkmcnt(0)
    s_barrier
    s_cmp_lg_u32 s8, 0
    s_cbranch_scc1 L_next_b0
    ds_read_b128 v[16:19], v14 offset:0
    ds_read_b128 v[20:23], v14 offset:1024
    ds_read_b128 v[24:27], v14 offset:2048
    ds_read_b128 v[28:31], v14 offset:3072
    s_waitcnt lgkmcnt(2)
    v_pk_add_f32 v[16:17], v[16:17], v[20:21]
    v_pk_add_f32 v[18:19], v[18:19], v[22:23]
    s_waitcnt lgkmcnt(0)
    v_pk_add_f32 v[24:25], v[24:25], v[28:29]
    v_pk_add_f32 v[26:27], v[26:27], v[30:31]
    v_pk_add_f32 v[16:17], v[16:17], v[24:25]
    v_pk_add_f32 v[18:19], v[18:19], v[26:27]
    v_cvt_pk_bf16_f32 v24, v16, v17
    v_cvt_pk_bf16_f32 v25, v18, v19
    v_min_u32 v24, -2, v24
    v_min_u32 v25, -2, v25
    global_store_dwordx2 v152, v[24:25], s[12:13]
    s_cmp_lt_u32 s11, 62
    s_cbranch_scc1 L_nom2_b0
    v_add_u32 v159, 92110848, v152
    global_store_dwordx2 v159, v[24:25], s[12:13] sc1
L_nom2_b0:
L_next_b0:
    s_add_u32 s12, s12, 7168
    s_addc_u32 s13, s13, 0
    s_add_u32 s14, s14, 12288
    s_addc_u32 s15, s15, 0
    s_add_u32 s11, s11, 1
    s_branch L_loop_b0

L_b_m1:
    v_mov_b32 v44, 0
    v_mov_b32 v160, 0
    v_mov_b32 v45, 0
    v_mov_b32 v161, 0
    v_mov_b32 v46, 0
    v_mov_b32 v162, 0
    v_mov_b32 v47, 0
    v_mov_b32 v163, 0
    v_mov_b32 v48, 0
    v_mov_b32 v164, 0
    v_mov_b32 v49, 0
    v_mov_b32 v165, 0
    v_mov_b32 v50, 0
    v_mov_b32 v166, 0
    v_mov_b32 v51, 0
    v_mov_b32 v167, 0
L_loop_b1:
    s_mov_b32 s26, 0
L_gp_b1:
    global_load_dwordx4 v[68:71], v2, s[12:13] sc1
    global_load_dwordx4 v[72:75], v3, s[12:13] sc1
    s_waitcnt vmcnt(0)
    v_max3_u32 v15, v68, v70, v72
    v_max_u32 v15, v15, v74
    v_cmp_eq_u32 vcc, -1, v15
    s_cbranch_vccz L_gp_b1_a
    s_add_u32 s26, s26, 1
    s_cmp_lt_u32 s26, 4194304
    s_cbranch_scc1 L_gp_b1
    s_branch L_main_done
L_gp_b1_b:
    ds_write_b128 v4, v[76:79]
    ds_write_b128 v5, v[80:83]
    s_branch L_gp_b1_j
L_gp_b1_a:
    ds_write_b128 v4, v[68:71]
    ds_write_b128 v5, v[72:75]
L_gp_b1_j:
    s_waitcnt lgkmcnt(0)
    s_barrier
    ds_read_b128 v[16:19], v6 offset:0
    ds_read_b128 v[20:23], v6 offset:128
    ds_read_b128 v[24:27], v6 offset:256
    ds_read_b128 v[28:31], v6 offset:384
    ds_read_b128 v[32:35], v6 offset:512
    ds_read_b128 v[36:39], v6 offset:640
    ds_read_b128 v[40:43], v6 offset:768
    s_and_b32 s22, s11, 7
    s_cmp_lg_u32 s22, 0
    s_cbranch_scc1 L_yxok_b1
    s_lshr_b32 s22, s11, 3
    s_lshl_b32 s22, s22, 2
    s_add_u32 s22, s22, 2304
    v_mov_b32 v159, s22
    s_cmp_eq_u32 s11, 0
    s_cselect_b32 s23, 64, 32
    s_mov_b32 s26, 0
L_yxw_b1:
    global_load_dword v158, v159, s[6:7] sc1
    s_add_u32 s26, s26, 1
    s_cmp_ge_u32 s26, 4194304
    s_cbranch_scc1 L_main_done
    s_waitcnt vmcnt(0)
    v_cmp_gt_u32 vcc, s23, v158
    s_cbranch_vccnz L_yxw_b1
L_yxok_b1:
    s_cmp_lt_u32 s11, 2
    s_cbranch_scc1 L_nosig_b1
    s_lshl_b32 s22, s11, 8
    s_add_u32 s22, s22, s38
    v_mov_b32 v159, s22
    v_mov_b32 v158, 1
    s_mov_b64 exec, 1
    global_store_dword v159, v158, s[6:7] sc1
    s_mov_b64 exec, -1
L_nosig_b1:
    s_cmp_eq_u32 s11, 0
    s_cbranch_scc1 L_noyst_b1
    global_store_dwordx4 v155, v[168:171], s[18:19] sc1
    global_store_dwordx4 v151, v[172:175], s[18:19] sc1
L_noyst_b1:
    s_waitcnt lgkmcnt(6)
    v_smfmac_f32_16x16x64_bf16 v[44:47], v[16:19], a[0:7], v7
    global_load_dwordx4 v[68:71], v156, s[16:17] offset:0 sc1
    s_waitcnt lgkmcnt(5)
    v_smfmac_f32_16x16x64_bf16 v[44:47], v[20:23], a[8:15], v7
    s_waitcnt lgkmcnt(4)
    v_smfmac_f32_16x16x64_bf16 v[44:47], v[24:27], a[16:23], v7
    s_waitcnt lgkmcnt(3)
    v_smfmac_f32_16x16x64_bf16 v[44:47], v[28:31], a[24:31], v7
    global_load_dwordx4 v[72:75], v156, s[16:17] offset:1024 sc1
    s_waitcnt lgkmcnt(2)
    v_smfmac_f32_16x16x64_bf16 v[44:47], v[32:35], a[32:39], v7
    s_waitcnt lgkmcnt(1)
    v_smfmac_f32_16x16x64_bf16 v[44:47], v[36:39], a[40:47], v7
    s_waitcnt lgkmcnt(0)
    v_smfmac_f32_16x16x64_bf16 v[44:47], v[40:43], a[48:55], v7
    v_smfmac_f32_16x16x64_bf16 v[48:51], v[16:19], a[56:63], v7
    global_load_dwordx4 v[76:79], v156, s[16:17] offset:2048 sc1
    v_smfmac_f32_16x16x64_bf16 v[48:51], v[20:23], a[64:71], v7
    v_smfmac_f32_16x16x64_bf16 v[48:51], v[24:27], a[72:79], v7
    v_cvt_pk_bf16_f32 v52, v44, v45
    v_cvt_pk_bf16_f32 v54, v46, v47
    v_smfmac_f32_16x16x64_bf16 v[48:51], v[28:31], a[80:87], v7
    v_pk_add_f32 v[144:145], v[44:45], v[46:47]
    v_mov_b64 v[44:45], 0
    global_load_dwordx4 v[80:83], v156, s[16:17] offset:3072 sc1
    v_smfmac_f32_16x16x64_bf16 v[48:51], v[32:35], a[88:95], v7
    v_mov_b64 v[46:47], 0
    v_cvt_pk_bf16_f32 v168, v144, v145
    v_smfmac_f32_16x16x64_bf16 v[48:51], v[36:39], a[96:103], v7
    v_smfmac_f32_16x16x64_bf16 v[48:51], v[40:43], a[104:111], v7
    v_smfmac_f32_16x16x64_bf16 v[160:163], v[16:19], a[112:119], v7
    global_load_dwordx4 v[84:87], v157, s[16:17] offset:0 sc1
    v_smfmac_f32_16x16x64_bf16 v[160:163], v[20:23], a[120:127], v7
    v_smfmac_f32_16x16x64_bf16 v[160:163], v[24:27], a[128:135], v7
    v_cvt_pk_bf16_f32 v53, v48, v49
    v_cvt_pk_bf16_f32 v55, v50, v51
    v_smfmac_f32_16x16x64_bf16 v[160:163], v[28:31], a[136:143], v7
    v_pk_add_f32 v[144:145], v[48:49], v[50:51]
    v_mov_b64 v[48:49], 0
    global_load_dwordx4 v[88:91], v157, s[16:17] offset:1024 sc1
    v_smfmac_f32_16x16x64_bf16 v[160:163], v[32:35], a[144:151], v7
    v_mov_b64 v[50:51], 0
    v_cvt_pk_bf16_f32 v169, v144, v145
    v_smfmac_f32_16x16x64_bf16 v[160:163], v[36:39], a[152:159], v7
    v_smfmac_f32_16x16x64_bf16 v[160:163], v[40:43], a[160:167], v7
    v_smfmac_f32_16x16x64_bf16 v[164:167], v[16:19], a[168:175], v7
    global_load_dwordx4 v[92:95], v157, s[16:17] offset:2048 sc1
    v_smfmac_f32_16x16x64_bf16 v[164:167], v[20:23], a[176:183], v7
    v_smfmac_f32_16x16x64_bf16 v[164:167], v[24:27], a[184:191], v7
    v_cvt_pk_bf16_f32 v56, v160, v161
    v_cvt_pk_bf16_f32 v58, v162, v163
    v_smfmac_f32_16x16x64_bf16 v[164:167], v[28:31], a[192:199], v7
    v_pk_add_f32 v[144:145], v[160:161], v[162:163]
    v_mov_b64 v[160:161], 0
    global_load_dwordx4 v[96:99], v157, s[16:17] offset:3072 sc1
    v_smfmac_f32_16x16x64_bf16 v[164:167], v[32:35], a[200:207], v7
    v_mov_b64 v[162:163], 0
    v_cvt_pk_bf16_f32 v170, v144, v145
    v_smfmac_f32_16x16x64_bf16 v[164:167], v[36:39], a[208:215], v7
    ds_read_b128 v[124:127], v154 offset:0
    ds_read_b128 v[128:131], v154 offset:1024
    v_smfmac_f32_16x16x64_bf16 v[164:167], v[40:43], a[216:223], v7
    ds_read_b128 v[132:135], v154 offset:2048
    ds_read_b128 v[136:139], v154 offset:3072
    ds_read_b128 v[100:103], v154 offset:4096
    ds_read_b128 v[104:107], v154 offset:5120
    v_smfmac_f32_16x16x64_bf16 v[44:47], v[16:19], a[224:231], v7
    s_waitcnt lgkmcnt(4)
    v_smfmac_f32_16x16x64_bf16 v[48:51], v[16:19], v[124:131], v7
    ds_read_b128 v[108:111], v154 offset:6144
    ds_read_b128 v[112:115], v154 offset:7168
    v_smfmac_f32_16x16x64_bf16 v[44:47], v[20:23], a[232:239], v7
    v_cvt_pk_bf16_f32 v57, v164, v165
    v_cvt_pk_bf16_f32 v59, v166, v167
    s_waitcnt lgkmcnt(4)
    v_smfmac_f32_16x16x64_bf16 v[48:51], v[20:23], v[132:139], v7
    ds_read_b128 v[124:127], v154 offset:8192
    ds_read_b128 v[128:131], v154 offset:9216
    v_smfmac_f32_16x16x64_bf16 v[44:47], v[24:27], a[240:247], v7
    v_pk_add_f32 v[144:145], v[164:165], v[166:167]
    v_mov_b64 v[164:165], 0
    s_waitcnt lgkmcnt(4)
    v_smfmac_f32_16x16x64_bf16 v[48:51], v[24:27], v[100:107], v7
    ds_read_b128 v[132:135], v154 offset:10240
    ds_read_b128 v[136:139], v154 offset:11264
    v_smfmac_f32_16x16x64_bf16 v[44:47], v[28:31], a[248:255], v7
    v_mov_b64 v[166:167], 0
    v_cvt_pk_bf16_f32 v171, v144, v145
    s_waitcnt lgkmcnt(4)
    v_smfmac_f32_16x16x64_bf16 v[48:51], v[28:31], v[108:115], v7
    ds_read_b128 v[100:103], v154 offset:12288
    ds_read_b128 v[104:107], v154 offset:13312
    v_smfmac_f32_16x16x64_bf16 v[44:47], v[32:35], v[176:183], v7
    s_waitcnt lgkmcnt(4)
    v_smfmac_f32_16x16x64_bf16 v[48:51], v[32:35], v[124:131], v7
    ds_read_b128 v[108:111], v154 offset:14336
    ds_read_b128 v[112:115], v154 offset:15360
    v_smfmac_f32_16x16x64_bf16 v[44:47], v[36:39], v[184:191], v7
    s_waitcnt lgkmcnt(4)
    v_smfmac_f32_16x16x64_bf16 v[48:51], v[36:39], v[132:139], v7
    ds_read_b128 v[124:127], v154 offset:16384
    ds_read_b128 v[128:131], v154 offset:17408
    v_smfmac_f32_16x16x64_bf16 v[44:47], v[40:43], v[192:199], v7
    s_waitcnt lgkmcnt(4)
    v_smfmac_f32_16x16x64_bf16 v[48:51], v[40:43], v[100:107], v7
    ds_read_b128 v[132:135], v154 offset:18432
    ds_read_b128 v[136:139], v154 offset:19456
    v_smfmac_f32_16x16x64_bf16 v[160:163], v[16:19], v[200:207], v7
    s_waitcnt lgkmcnt(4)
    v_smfmac_f32_16x16x64_bf16 v[164:167], v[16:19], v[108:115], v7
    ds_read_b128 v[100:103], v154 offset:20480
    ds_read_b128 v[104:107], v154 offset:21504
    v_smfmac_f32_16x16x64_bf16 v[160:163], v[20:23], v[208:215], v7
    v_cvt_pk_bf16_f32 v60, v44, v45
    v_cvt_pk_bf16_f32 v62, v46, v47
    s_waitcnt lgkmcnt(4)
    v_smfmac_f32_16x16x64_bf16 v[164:167], v[20:23], v[124:131], v7
    ds_read_b128 v[108:111], v154 offset:22528
    ds_read_b128 v[112:115], v154 offset:23552
    v_smfmac_f32_16x16x64_bf16 v[160:163], v[24:27], v[216:223], v7
    v_pk_add_f32 v[144:145], v[44:45], v[46:47]
    v_mov_b64 v[44:45], 0
    s_waitcnt lgkmcnt(4)
    v_smfmac_f32_16x16x64_bf16 v[164:167], v[24:27], v[132:139], v7
    ds_read_b128 v[124:127], v154 offset:24576
    ds_read_b128 v[128:131], v154 offset:25600
    v_smfmac_f32_16x16x64_bf16 v[160:163], v[28:31], v[224:231], v7
    v_mov_b64 v[46:47], 0
    v_cvt_pk_bf16_f32 v172, v144, v145
    s_waitcnt lgkmcnt(4)
    v_smfmac_f32_16x16x64_bf16 v[164:167], v[28:31], v[100:107], v7
    ds_read_b128 v[132:135], v154 offset:26624
    ds_read_b128 v[136:139], v154 offset:27648
    v_smfmac_f32_16x16x64_bf16 v[160:163], v[32:35], v[232:239], v7
    v_cvt_pk_bf16_f32 v64, v48, v49
    v_cvt_pk_bf16_f32 v66, v50, v51
    s_waitcnt lgkmcnt(4)
    v_smfmac_f32_16x16x64_bf16 v[164:167], v[32:35], v[108:115], v7
    v_smfmac_f32_16x16x64_bf16 v[160:163], v[36:39], v[240:247], v7
    v_pk_add_f32 v[144:145], v[48:49], v[50:51]
    v_mov_b64 v[48:49], 0
    s_waitcnt lgkmcnt(2)
    v_smfmac_f32_16x16x64_bf16 v[164:167], v[36:39], v[124:131], v7
    v_smfmac_f32_16x16x64_bf16 v[160:163], v[40:43], v[248:255], v7
    v_mov_b64 v[50:51], 0
    v_cvt_pk_bf16_f32 v174, v144, v145
    s_waitcnt lgkmcnt(0)
    v_smfmac_f32_16x16x64_bf16 v[164:167], v[40:43], v[132:139], v7
    s_nop 3
    v_cvt_pk_bf16_f32 v61, v160, v161
    v_cvt_pk_bf16_f32 v63, v162, v163
    v_pk_add_f32 v[144:145], v[160:161], v[162:163]
    v_mov_b64 v[160:161], 0
    v_mov_b64 v[162:163], 0
    v_cvt_pk_bf16_f32 v173, v144, v145
    v_mov_b64 v[140:141], 0
    v_mov_b64 v[142:143], 0
    v_mov_b64 v[120:121], 0
    v_mov_b64 v[122:123], 0
    s_nop 3
    v_cvt_pk_bf16_f32 v65, v164, v165
    v_cvt_pk_bf16_f32 v67, v166, v167
    v_pk_add_f32 v[144:145], v[164:165], v[166:167]
    v_mov_b64 v[164:165], 0
    v_mov_b64 v[166:167], 0
    v_cvt_pk_bf16_f32 v175, v144, v145
    s_cmp_lt_u32 s11, 63
    s_cbranch_scc1 L_notlast_b1
    s_add_u32 s18, s18, 114688
    s_addc_u32 s19, s19, 0
    global_store_dwordx4 v155, v[168:171], s[18:19] sc1
    global_store_dwordx4 v151, v[172:175], s[18:19] sc1
    s_add_u32 s22, s38, 16384
    v_mov_b32 v159, s22
    v_mov_b32 v158, 1
    s_waitcnt vmcnt(0)
    s_mov_b64 exec, 1
    global_store_dword v159, v158, s[6:7] sc1
    global_store_dword v159, v158, s[6:7] offset:256 sc1
    s_branch L_main_done
L_notlast_b1:
    s_mov_b32 s26, 0
L_ppoll_b1:
    global_load_dwordx4 v[100:103], v8, s[14:15] offset:0 sc1
    global_load_dwordx4 v[104:107], v8, s[14:15] offset:1024 sc1
    global_load_dwordx4 v[116:119], v12, s[14:15] sc1
    s_waitcnt vmcnt(0)
    v_max3_u32 v15, v100, v102, v104
    v_max3_u32 v158, v106, v116, v118
    v_max_u32 v15, v15, v158
    v_cmp_eq_u32 vcc, -1, v15
    s_cbranch_vccz L_pa_b1
    s_add_u32 s26, s26, 1
    s_cmp_lt_u32 s26, 4194304
    s_cbranch_scc1 L_ppoll_b1
    s_branch L_main_done
L_pb_b1:
    v_smfmac_f32_16x16x64_bf16 v[140:143], v[124:127], v[68:75], v7
    v_smfmac_f32_16x16x64_bf16 v[120:123], v[124:127], v[84:91], v7
    v_smfmac_f32_16x16x64_bf16 v[140:143], v[128:131], v[76:83], v7
    v_smfmac_f32_16x16x64_bf16 v[120:123], v[128:131], v[92:99], v7
    v_smfmac_f32_16x16x64_bf16 v[140:143], v[132:135], v[52:59], v7
    v_smfmac_f32_16x16x64_bf16 v[120:123], v[132:135], v[60:67], v7
    s_branch L_pj_b1
L_pa_b1:
    v_smfmac_f32_16x16x64_bf16 v[140:143], v[100:103], v[68:75], v7
    v_smfmac_f32_16x16x64_bf16 v[120:123], v[100:103], v[84:91], v7
    v_smfmac_f32_16x16x64_bf16 v[140:143], v[104:107], v[76:83], v7
    v_smfmac_f32_16x16x64_bf16 v[120:123], v[104:107], v[92:99], v7
    v_smfmac_f32_16x16x64_bf16 v[140:143], v[116:119], v[52:59], v7
    v_smfmac_f32_16x16x64_bf16 v[120:123], v[116:119], v[60:67], v7
L_pj_b1:
    s_add_u32 s16, s16, 458752
    s_addc_u32 s17, s17, 0
    s_add_u32 s18, s18, 114688
    s_addc_u32 s19, s19, 0
    s_nop 1

    v_pk_add_f32 v[144:145], v[140:141], v[142:143]
    s_nop 0
    v_pk_add_f32 v[146:147], v[120:121], v[122:123]
    ds_write2_b32 v13, v144, v145 offset0:0 offset1:16
    ds_write2_b32 v13, v146, v147 offset0:128 offset1:144
    s_waitcnt lgkmcnt(0)
    s_barrier
    s_cmp_lg_u32 s8, 0
    s_cbranch_scc1 L_next_b1
    ds_read_b128 v[16:19], v14 offset:0
    ds_read_b128 v[20:23], v14 offset:1024
    ds_read_b128 v[24:27], v14 offset:2048
    ds_read_b128 v[28:31], v14 offset:3072
    s_waitcnt lgkmcnt(2)
    v_pk_add_f32 v[16:17], v[16:17], v[20:21]
    v_pk_add_f32 v[18:19], v[18:19], v[22:23]
    s_waitcnt lgkmcnt(0)
    v_pk_add_f32 v[24:25], v[24:25], v[28:29]
    v_pk_add_f32 v[26:27], v[26:27], v[30:31]
    v_pk_add_f32 v[16:17], v[16:17], v[24:25]
    v_pk_add_f32 v[18:19], v[18:19], v[26:27]
    v_cvt_pk_bf16_f32 v24, v16, v17
    v_cvt_pk_bf16_f32 v25, v18, v19
    v_min_u32 v24, -2, v24
    v_min_u32 v25, -2, v25
    global_store_dwordx2 v152, v[24:25], s[12:13] sc1
    s_cmp_lt_u32 s11, 62
    s_cbranch_scc1 L_nom2_b1
    v_add_u32 v159, 92110848, v152
    global_store_dwordx2 v159, v[24:25], s[12:13] sc1
L_nom2_b1:
L_next_b1:
    s_add_u32 s12, s12, 7168
    s_addc_u32 s13, s13, 0
    s_add_u32 s14, s14, 12288
    s_addc_u32 s15, s15, 0
    s_add_u32 s11, s11, 1
    s_branch L_loop_b1

L_bulk:
    s_mov_b32 s70, 0
L_task_done:
    s_waitcnt vmcnt(0) lgkmcnt(0)
    s_barrier
    s_cmp_lg_u32 s8, 0
    s_cbranch_scc1 L_task_wait
    s_mov_b64 exec, 1
    v_mov_b32 v3, 1
    s_cmp_eq_u32 s70, 0
    s_cbranch_scc1 L_task_nosig
    v_mov_b32 v2, s70
    global_atomic_add v2, v3, s[6:7]

L_task_nosig:
    v_mov_b32 v2, 1088
    global_atomic_add v4, v2, v3, s[6:7] sc0
    v_mov_b32 v2, 135000
    s_waitcnt vmcnt(0)
    ds_write_b32 v2, v4
    s_mov_b64 exec, -1

L_task_wait:
    s_waitcnt lgkmcnt(0)
    s_barrier
    v_mov_b32 v2, 135000
    ds_read_b32 v3, v2
    s_waitcnt lgkmcnt(0)
    v_readfirstlane_b32 s41, v3
    s_barrier
    s_cmp_ge_u32 s41, 563
    s_cbranch_scc1 L_remap_done
    s_cmp_lt_u32 s41, 19
    s_cbranch_scc1 L_remap_pb
    s_sub_u32 s41, s41, 19
    s_branch L_remap_done
    L_remap_pb:
    s_add_u32 s41, s41, 544
    L_remap_done:
    v_and_b32 v1, 63, v0

    s_cmp_ge_u32 s41, 1523
    s_cbranch_scc1 L_main_done
    s_cmp_ge_u32 s41, 544
    s_cbranch_scc1 L_t_pb

    s_cmp_ge_u32 s41, 64
    s_cbranch_scc1 L_t_yxn
    s_mov_b32 s40, 0
    s_mov_b32 s42, 1
    s_lshr_b32 s43, s41, 3
    s_lshl_b32 s43, s43, 2
    s_bfe_u32 s46, s41, 0x20001
    s_mul_i32 s46, s46, 7
    s_and_b32 s47, s41, 1
    s_lshl_b32 s44, s47, 2
    s_add_u32 s46, s46, s44
    s_sub_u32 s47, 4, s47
    s_mov_b32 s70, 2304
    s_branch L_t_gemm

L_t_yxn:
    s_sub_u32 s44, s41, 32
    s_bfe_u32 s40, s44, 0x30005
    s_and_b32 s43, s44, 31
    s_lshr_b32 s42, s44, 8
    s_xor_b32 s42, s42, 1
    s_and_b32 s46, s43, 3
    s_mul_i32 s46, s46, 7
    s_mov_b32 s47, 7
    s_lshl_b32 s70, s40, 2
    s_cmp_ge_u32 s44, 256
    s_cbranch_scc1 L_t_gx
    s_add_u32 s70, s70, 2304
    s_branch L_t_gemm

L_t_gx:
    s_add_u32 s70, s70, 2432
L_t_gemm:
    s_mov_b32 s4, s64
    s_mov_b32 s5, s65
    s_lshl_b32 s11, s40, 3
    s_lshl_b32 s12, s8, 1
    s_add_u32 s11, s11, s12
    v_lshlrev_b32 v6, 4, v1
    v_lshlrev_b32 v8, 4, v1
    v_lshlrev_b32 v9, 3, v1
    s_cmp_lg_u32 s42, 0
    s_cbranch_scc1 L_g_Bsetup

    s_mul_i32 s12, s43, 200704
    s_add_u32 s12, s12, 2097152
    s_mov_b32 s13, 28672
    s_mul_i32 s14, s11, 458752
    s_mul_i32 s15, s43, 14336
    s_add_u32 s14, s14, s15
    s_add_u32 s14, s14, 53477376
    s_branch L_g_common

L_g_Bsetup:
    s_lshr_b32 s15, s43, 2
    s_lshl_b32 s12, s46, 4
    s_lshl_b32 s23, s15, 1
    s_add_u32 s12, s12, s23
    s_mul_i32 s12, s12, 14336
    s_add_u32 s12, s12, 8519680
    s_mov_b32 s13, 229376
    s_mul_i32 s14, s11, 458752
    s_lshl_b32 s22, s46, 3
    s_add_u32 s22, s22, s15
    s_lshl_b32 s22, s22, 11
    s_add_u32 s14, s14, s22
    s_add_u32 s14, s14, 14942208

L_g_common:
    s_lshl_b32 s22, s8, 10
    s_add_u32 s12, s12, s22
    s_add_u32 s16, s6, s12
    s_addc_u32 s17, s7, 0
    s_add_u32 s18, s6, s14
    s_addc_u32 s19, s7, 0
    s_lshl_b32 s24, s8, 10

    s_add_u32 m0, s24, 0
    s_add_u32 s20, s16, 0
    s_addc_u32 s21, s17, 0
    global_load_lds_dwordx4 v6, s[20:21]
    s_add_u32 m0, s24, 4096
    s_add_u32 s20, s16, 4096
    s_addc_u32 s21, s17, 0
    global_load_lds_dwordx4 v6, s[20:21]
    s_add_u32 m0, s24, 8192
    s_add_u32 s20, s16, 8192
    s_addc_u32 s21, s17, 0
    global_load_lds_dwordx4 v6, s[20:21]
    s_add_u32 m0, s24, 12288
    s_add_u32 s20, s16, 12288
    s_addc_u32 s21, s17, 0
    global_load_lds_dwordx4 v6, s[20:21]
    s_add_u32 m0, s24, 16384
    s_add_u32 s20, s16, 16384
    s_addc_u32 s21, s17, 0
    global_load_lds_dwordx4 v6, s[20:21]
    s_add_u32 m0, s24, 20480
    s_add_u32 s20, s16, 20480
    s_addc_u32 s21, s17, 0
    global_load_lds_dwordx4 v6, s[20:21]
    s_add_u32 m0, s24, 24576
    s_add_u32 s20, s16, 24576
    s_addc_u32 s21, s17, 0
    global_load_lds_dwordx4 v6, s[20:21]
    s_add_u32 s16, s16, s13
    s_addc_u32 s17, s17, 0
    s_add_u32 m0, s24, 28672
    s_add_u32 s20, s16, 0
    s_addc_u32 s21, s17, 0
    global_load_lds_dwordx4 v6, s[20:21]
    s_add_u32 m0, s24, 32768
    s_add_u32 s20, s16, 4096
    s_addc_u32 s21, s17, 0
    global_load_lds_dwordx4 v6, s[20:21]
    s_add_u32 m0, s24, 36864
    s_add_u32 s20, s16, 8192
    s_addc_u32 s21, s17, 0
    global_load_lds_dwordx4 v6, s[20:21]
    s_add_u32 m0, s24, 40960
    s_add_u32 s20, s16, 12288
    s_addc_u32 s21, s17, 0
    global_load_lds_dwordx4 v6, s[20:21]
    s_add_u32 m0, s24, 45056
    s_add_u32 s20, s16, 16384
    s_addc_u32 s21, s17, 0
    global_load_lds_dwordx4 v6, s[20:21]
    s_add_u32 m0, s24, 49152
    s_add_u32 s20, s16, 20480
    s_addc_u32 s21, s17, 0
    global_load_lds_dwordx4 v6, s[20:21]
    s_add_u32 m0, s24, 53248
    s_add_u32 s20, s16, 24576
    s_addc_u32 s21, s17, 0
    global_load_lds_dwordx4 v6, s[20:21]
    s_add_u32 s16, s16, s13
    s_addc_u32 s17, s17, 0
    s_mul_i32 s12, s11, 28672
    s_add_u32 s12, s12, 92602368
    s_add_u32 s22, s6, s12
    s_addc_u32 s23, s7, 0
    v_add_u32 v10, 14336, v8
    v_add_u32 v11, 28672, v8
    v_add_u32 v12, 43008, v8
    v_add_u32 v13, 57344, v8

    global_load_dwordx4 a[0:3], v8, s[22:23] offset:0
    global_load_dwordx4 a[4:7], v10, s[22:23] offset:0
    global_load_dwordx4 a[8:11], v11, s[22:23] offset:0
    global_load_dwordx4 a[12:15], v12, s[22:23] offset:0
    global_load_dwordx4 a[16:19], v8, s[22:23] offset:1024
    global_load_dwordx4 a[20:23], v10, s[22:23] offset:1024
    global_load_dwordx4 a[24:27], v11, s[22:23] offset:1024
    global_load_dwordx4 a[28:31], v12, s[22:23] offset:1024
    global_load_dwordx4 a[32:35], v8, s[22:23] offset:2048
    global_load_dwordx4 a[36:39], v10, s[22:23] offset:2048
    global_load_dwordx4 a[40:43], v11, s[22:23] offset:2048
    global_load_dwordx4 a[44:47], v12, s[22:23] offset:2048
    global_load_dwordx4 a[48:51], v8, s[22:23] offset:3072
    global_load_dwordx4 a[52:55], v10, s[22:23] offset:3072
    global_load_dwordx4 a[56:59], v11, s[22:23] offset:3072
    global_load_dwordx4 a[60:63], v12, s[22:23] offset:3072
    s_add_u32 s22, s22, 4096
    s_addc_u32 s23, s23, 0
    global_load_dwordx4 a[64:67], v8, s[22:23] offset:0
    global_load_dwordx4 a[68:71], v10, s[22:23] offset:0
    global_load_dwordx4 a[72:75], v11, s[22:23] offset:0
    global_load_dwordx4 a[76:79], v12, s[22:23] offset:0
    global_load_dwordx4 a[80:83], v8, s[22:23] offset:1024
    global_load_dwordx4 a[84:87], v10, s[22:23] offset:1024
    global_load_dwordx4 a[88:91], v11, s[22:23] offset:1024
    global_load_dwordx4 a[92:95], v12, s[22:23] offset:1024
    global_load_dwordx4 a[96:99], v8, s[22:23] offset:2048
    global_load_dwordx4 a[100:103], v10, s[22:23] offset:2048
    global_load_dwordx4 a[104:107], v11, s[22:23] offset:2048
    global_load_dwordx4 a[108:111], v12, s[22:23] offset:2048
    global_load_dwordx4 a[112:115], v8, s[22:23] offset:3072
    global_load_dwordx4 a[116:119], v10, s[22:23] offset:3072
    global_load_dwordx4 a[120:123], v11, s[22:23] offset:3072
    global_load_dwordx4 a[124:127], v12, s[22:23] offset:3072
    s_add_u32 s22, s22, 4096
    s_addc_u32 s23, s23, 0
    global_load_dwordx4 a[128:131], v8, s[22:23] offset:0
    global_load_dwordx4 a[132:135], v10, s[22:23] offset:0
    global_load_dwordx4 a[136:139], v11, s[22:23] offset:0
    global_load_dwordx4 a[140:143], v12, s[22:23] offset:0
    global_load_dwordx4 a[144:147], v8, s[22:23] offset:1024
    global_load_dwordx4 a[148:151], v10, s[22:23] offset:1024
    global_load_dwordx4 a[152:155], v11, s[22:23] offset:1024
    global_load_dwordx4 a[156:159], v12, s[22:23] offset:1024
    global_load_dwordx4 a[160:163], v8, s[22:23] offset:2048
    global_load_dwordx4 a[164:167], v10, s[22:23] offset:2048
    global_load_dwordx4 a[168:171], v11, s[22:23] offset:2048
    global_load_dwordx4 a[172:175], v12, s[22:23] offset:2048
    global_load_dwordx4 a[176:179], v8, s[22:23] offset:3072
    global_load_dwordx4 a[180:183], v10, s[22:23] offset:3072
    global_load_dwordx4 a[184:187], v11, s[22:23] offset:3072
    global_load_dwordx4 a[188:191], v12, s[22:23] offset:3072
    s_add_u32 s22, s22, 4096
    s_addc_u32 s23, s23, 0
    global_load_dwordx4 a[192:195], v8, s[22:23] offset:0
    global_load_dwordx4 a[196:199], v10, s[22:23] offset:0
    global_load_dwordx4 a[200:203], v11, s[22:23] offset:0
    global_load_dwordx4 a[204:207], v12, s[22:23] offset:0
    global_load_dwordx4 a[208:211], v8, s[22:23] offset:1024
    global_load_dwordx4 a[212:215], v10, s[22:23] offset:1024
    global_load_dwordx4 a[216:219], v11, s[22:23] offset:1024
    global_load_dwordx4 a[220:223], v12, s[22:23] offset:1024
    s_waitcnt vmcnt(63)
    s_barrier
    s_cmp_lg_u32 s42, 0
    s_cbranch_scc1 L_g_Bloop
    ds_read_b128 v[16:19], v8 offset:0
    ds_read_b128 v[20:23], v8 offset:1024
    ds_read_b128 v[24:27], v8 offset:2048
    ds_read_b128 v[28:31], v8 offset:3072
    ds_read_b128 v[32:35], v8 offset:4096
    ds_read_b128 v[36:39], v8 offset:5120
    ds_read_b128 v[40:43], v8 offset:6144
    ds_read_b128 v[44:47], v8 offset:7168
    s_waitcnt lgkmcnt(7)
    s_waitcnt vmcnt(52)
    v_mfma_f32_16x16x32_bf16 v[48:51], v[16:19], a[0:3], 0
    v_mfma_f32_16x16x32_bf16 v[52:55], v[16:19], a[4:7], 0
    v_mfma_f32_16x16x32_bf16 v[56:59], v[16:19], a[8:11], 0
    v_mfma_f32_16x16x32_bf16 v[60:63], v[16:19], a[12:15], 0
    ds_read_b128 v[16:19], v8 offset:8192
    s_waitcnt lgkmcnt(7)
    s_waitcnt vmcnt(48)
    v_mfma_f32_16x16x32_bf16 v[48:51], v[20:23], a[16:19], v[48:51]
    v_mfma_f32_16x16x32_bf16 v[52:55], v[20:23], a[20:23], v[52:55]
    v_mfma_f32_16x16x32_bf16 v[56:59], v[20:23], a[24:27], v[56:59]
    v_mfma_f32_16x16x32_bf16 v[60:63], v[20:23], a[28:31], v[60:63]
    s_add_u32 m0, s24, 57344
    s_add_u32 s20, s16, 0
    s_addc_u32 s21, s17, 0
    global_load_lds_dwordx4 v6, s[20:21]
    ds_read_b128 v[20:23], v8 offset:9216
    s_waitcnt lgkmcnt(7)
    s_waitcnt vmcnt(45)
    v_mfma_f32_16x16x32_bf16 v[48:51], v[24:27], a[32:35], v[48:51]
    v_mfma_f32_16x16x32_bf16 v[52:55], v[24:27], a[36:39], v[52:55]
    v_mfma_f32_16x16x32_bf16 v[56:59], v[24:27], a[40:43], v[56:59]
    v_mfma_f32_16x16x32_bf16 v[60:63], v[24:27], a[44:47], v[60:63]
    ds_read_b128 v[24:27], v8 offset:10240
    s_waitcnt lgkmcnt(7)
    s_waitcnt vmcnt(41)
    v_mfma_f32_16x16x32_bf16 v[48:51], v[28:31], a[48:51], v[48:51]
    v_mfma_f32_16x16x32_bf16 v[52:55], v[28:31], a[52:55], v[52:55]
    v_mfma_f32_16x16x32_bf16 v[56:59], v[28:31], a[56:59], v[56:59]
    v_mfma_f32_16x16x32_bf16 v[60:63], v[28:31], a[60:63], v[60:63]
    ds_read_b128 v[28:31], v8 offset:11264
    s_waitcnt lgkmcnt(7)
    s_waitcnt vmcnt(37)
    v_mfma_f32_16x16x32_bf16 v[48:51], v[32:35], a[64:67], v[48:51]
    v_mfma_f32_16x16x32_bf16 v[52:55], v[32:35], a[68:71], v[52:55]
    v_mfma_f32_16x16x32_bf16 v[56:59], v[32:35], a[72:75], v[56:59]
    v_mfma_f32_16x16x32_bf16 v[60:63], v[32:35], a[76:79], v[60:63]
    s_add_u32 m0, s24, 61440
    s_add_u32 s20, s16, 4096
    s_addc_u32 s21, s17, 0
    global_load_lds_dwordx4 v6, s[20:21]
    ds_read_b128 v[32:35], v8 offset:12288
    s_waitcnt lgkmcnt(7)
    s_waitcnt vmcnt(34)
    v_mfma_f32_16x16x32_bf16 v[48:51], v[36:39], a[80:83], v[48:51]
    v_mfma_f32_16x16x32_bf16 v[52:55], v[36:39], a[84:87], v[52:55]
    v_mfma_f32_16x16x32_bf16 v[56:59], v[36:39], a[88:91], v[56:59]
    v_mfma_f32_16x16x32_bf16 v[60:63], v[36:39], a[92:95], v[60:63]
    ds_read_b128 v[36:39], v8 offset:13312
    s_waitcnt lgkmcnt(7)
    s_waitcnt vmcnt(30)
    v_mfma_f32_16x16x32_bf16 v[48:51], v[40:43], a[96:99], v[48:51]
    v_mfma_f32_16x16x32_bf16 v[52:55], v[40:43], a[100:103], v[52:55]
    v_mfma_f32_16x16x32_bf16 v[56:59], v[40:43], a[104:107], v[56:59]
    v_mfma_f32_16x16x32_bf16 v[60:63], v[40:43], a[108:111], v[60:63]
    ds_read_b128 v[40:43], v8 offset:14336
    s_waitcnt lgkmcnt(7)
    s_waitcnt vmcnt(26)
    v_mfma_f32_16x16x32_bf16 v[48:51], v[44:47], a[112:115], v[48:51]
    v_mfma_f32_16x16x32_bf16 v[52:55], v[44:47], a[116:119], v[52:55]
    v_mfma_f32_16x16x32_bf16 v[56:59], v[44:47], a[120:123], v[56:59]
    v_mfma_f32_16x16x32_bf16 v[60:63], v[44:47], a[124:127], v[60:63]
    s_add_u32 m0, s24, 65536
    s_add_u32 s20, s16, 8192
    s_addc_u32 s21, s17, 0
    global_load_lds_dwordx4 v6, s[20:21]
    ds_read_b128 v[44:47], v8 offset:15360
    s_waitcnt lgkmcnt(7)
    s_waitcnt vmcnt(23)
    v_mfma_f32_16x16x32_bf16 v[48:51], v[16:19], a[128:131], v[48:51]
    v_mfma_f32_16x16x32_bf16 v[52:55], v[16:19], a[132:135], v[52:55]
    v_mfma_f32_16x16x32_bf16 v[56:59], v[16:19], a[136:139], v[56:59]
    v_mfma_f32_16x16x32_bf16 v[60:63], v[16:19], a[140:143], v[60:63]
    ds_read_b128 v[16:19], v8 offset:16384
    s_waitcnt lgkmcnt(7)
    s_waitcnt vmcnt(19)
    v_mfma_f32_16x16x32_bf16 v[48:51], v[20:23], a[144:147], v[48:51]
    v_mfma_f32_16x16x32_bf16 v[52:55], v[20:23], a[148:151], v[52:55]
    v_mfma_f32_16x16x32_bf16 v[56:59], v[20:23], a[152:155], v[56:59]
    v_mfma_f32_16x16x32_bf16 v[60:63], v[20:23], a[156:159], v[60:63]
    ds_read_b128 v[20:23], v8 offset:17408
    s_waitcnt lgkmcnt(7)
    s_waitcnt vmcnt(15)
    v_mfma_f32_16x16x32_bf16 v[48:51], v[24:27], a[160:163], v[48:51]
    v_mfma_f32_16x16x32_bf16 v[52:55], v[24:27], a[164:167], v[52:55]
    v_mfma_f32_16x16x32_bf16 v[56:59], v[24:27], a[168:171], v[56:59]
    v_mfma_f32_16x16x32_bf16 v[60:63], v[24:27], a[172:175], v[60:63]
    s_add_u32 m0, s24, 69632
    s_add_u32 s20, s16, 12288
    s_addc_u32 s21, s17, 0
    global_load_lds_dwordx4 v6, s[20:21]
    ds_read_b128 v[24:27], v8 offset:18432
    s_waitcnt lgkmcnt(7)
    s_waitcnt vmcnt(12)
    v_mfma_f32_16x16x32_bf16 v[48:51], v[28:31], a[176:179], v[48:51]
    v_mfma_f32_16x16x32_bf16 v[52:55], v[28:31], a[180:183], v[52:55]
    v_mfma_f32_16x16x32_bf16 v[56:59], v[28:31], a[184:187], v[56:59]
    v_mfma_f32_16x16x32_bf16 v[60:63], v[28:31], a[188:191], v[60:63]
    ds_read_b128 v[28:31], v8 offset:19456
    s_waitcnt lgkmcnt(7)
    s_waitcnt vmcnt(8)
    v_mfma_f32_16x16x32_bf16 v[48:51], v[32:35], a[192:195], v[48:51]
    v_mfma_f32_16x16x32_bf16 v[52:55], v[32:35], a[196:199], v[52:55]
    v_mfma_f32_16x16x32_bf16 v[56:59], v[32:35], a[200:203], v[56:59]
    v_mfma_f32_16x16x32_bf16 v[60:63], v[32:35], a[204:207], v[60:63]
    ds_read_b128 v[32:35], v8 offset:20480
    s_waitcnt lgkmcnt(7)
    s_waitcnt vmcnt(4)
    v_mfma_f32_16x16x32_bf16 v[48:51], v[36:39], a[208:211], v[48:51]
    v_mfma_f32_16x16x32_bf16 v[52:55], v[36:39], a[212:215], v[52:55]
    v_mfma_f32_16x16x32_bf16 v[56:59], v[36:39], a[216:219], v[56:59]
    v_mfma_f32_16x16x32_bf16 v[60:63], v[36:39], a[220:223], v[60:63]
    s_add_u32 m0, s24, 73728
    s_add_u32 s20, s16, 16384
    s_addc_u32 s21, s17, 0
    global_load_lds_dwordx4 v6, s[20:21]
    ds_read_b128 v[36:39], v8 offset:21504
    s_waitcnt lgkmcnt(7)
    v_mfma_f32_16x16x32_bf16 v[64:67], v[40:43], a[0:3], 0
    v_mfma_f32_16x16x32_bf16 v[68:71], v[40:43], a[4:7], 0
    v_mfma_f32_16x16x32_bf16 v[72:75], v[40:43], a[8:11], 0
    v_mfma_f32_16x16x32_bf16 v[76:79], v[40:43], a[12:15], 0
    ds_read_b128 v[40:43], v8 offset:22528
    s_waitcnt lgkmcnt(7)
    v_mfma_f32_16x16x32_bf16 v[64:67], v[44:47], a[16:19], v[64:67]
    v_mfma_f32_16x16x32_bf16 v[68:71], v[44:47], a[20:23], v[68:71]
    v_mfma_f32_16x16x32_bf16 v[72:75], v[44:47], a[24:27], v[72:75]
    v_mfma_f32_16x16x32_bf16 v[76:79], v[44:47], a[28:31], v[76:79]
    ds_read_b128 v[44:47], v8 offset:23552
    s_waitcnt lgkmcnt(7)
    v_mfma_f32_16x16x32_bf16 v[64:67], v[16:19], a[32:35], v[64:67]
    v_mfma_f32_16x16x32_bf16 v[68:71], v[16:19], a[36:39], v[68:71]
    v_mfma_f32_16x16x32_bf16 v[72:75], v[16:19], a[40:43], v[72:75]
    v_mfma_f32_16x16x32_bf16 v[76:79], v[16:19], a[44:47], v[76:79]
    s_add_u32 m0, s24, 77824
    s_add_u32 s20, s16, 20480
    s_addc_u32 s21, s17, 0
    global_load_lds_dwordx4 v6, s[20:21]
    ds_read_b128 v[16:19], v8 offset:24576
    s_waitcnt lgkmcnt(7)
    v_mfma_f32_16x16x32_bf16 v[64:67], v[20:23], a[48:51], v[64:67]
    v_mfma_f32_16x16x32_bf16 v[68:71], v[20:23], a[52:55], v[68:71]
    v_mfma_f32_16x16x32_bf16 v[72:75], v[20:23], a[56:59], v[72:75]
    v_mfma_f32_16x16x32_bf16 v[76:79], v[20:23], a[60:63], v[76:79]
    ds_read_b128 v[20:23], v8 offset:25600
    s_waitcnt lgkmcnt(7)
    v_mfma_f32_16x16x32_bf16 v[64:67], v[24:27], a[64:67], v[64:67]
    v_mfma_f32_16x16x32_bf16 v[68:71], v[24:27], a[68:71], v[68:71]
    v_mfma_f32_16x16x32_bf16 v[72:75], v[24:27], a[72:75], v[72:75]
    v_mfma_f32_16x16x32_bf16 v[76:79], v[24:27], a[76:79], v[76:79]
    ds_read_b128 v[24:27], v8 offset:26624
    s_waitcnt lgkmcnt(7)
    v_mfma_f32_16x16x32_bf16 v[64:67], v[28:31], a[80:83], v[64:67]
    v_mfma_f32_16x16x32_bf16 v[68:71], v[28:31], a[84:87], v[68:71]
    v_mfma_f32_16x16x32_bf16 v[72:75], v[28:31], a[88:91], v[72:75]
    v_mfma_f32_16x16x32_bf16 v[76:79], v[28:31], a[92:95], v[76:79]
    s_add_u32 m0, s24, 81920
    s_add_u32 s20, s16, 24576
    s_addc_u32 s21, s17, 0
    global_load_lds_dwordx4 v6, s[20:21]
    s_add_u32 s16, s16, s13
    s_addc_u32 s17, s17, 0
    ds_read_b128 v[28:31], v8 offset:27648
    s_waitcnt lgkmcnt(7)
    v_mfma_f32_16x16x32_bf16 v[64:67], v[32:35], a[96:99], v[64:67]
    v_mfma_f32_16x16x32_bf16 v[68:71], v[32:35], a[100:103], v[68:71]
    v_mfma_f32_16x16x32_bf16 v[72:75], v[32:35], a[104:107], v[72:75]
    v_mfma_f32_16x16x32_bf16 v[76:79], v[32:35], a[108:111], v[76:79]
    s_waitcnt lgkmcnt(6)
    v_mfma_f32_16x16x32_bf16 v[64:67], v[36:39], a[112:115], v[64:67]
    v_mfma_f32_16x16x32_bf16 v[68:71], v[36:39], a[116:119], v[68:71]
    v_mfma_f32_16x16x32_bf16 v[72:75], v[36:39], a[120:123], v[72:75]
    v_mfma_f32_16x16x32_bf16 v[76:79], v[36:39], a[124:127], v[76:79]
    s_waitcnt lgkmcnt(5)
    v_mfma_f32_16x16x32_bf16 v[64:67], v[40:43], a[128:131], v[64:67]
    v_mfma_f32_16x16x32_bf16 v[68:71], v[40:43], a[132:135], v[68:71]
    v_mfma_f32_16x16x32_bf16 v[72:75], v[40:43], a[136:139], v[72:75]
    v_mfma_f32_16x16x32_bf16 v[76:79], v[40:43], a[140:143], v[76:79]
    s_waitcnt lgkmcnt(4)
    v_mfma_f32_16x16x32_bf16 v[64:67], v[44:47], a[144:147], v[64:67]
    v_mfma_f32_16x16x32_bf16 v[68:71], v[44:47], a[148:151], v[68:71]
    v_mfma_f32_16x16x32_bf16 v[72:75], v[44:47], a[152:155], v[72:75]
    v_mfma_f32_16x16x32_bf16 v[76:79], v[44:47], a[156:159], v[76:79]
    s_waitcnt lgkmcnt(3)
    v_mfma_f32_16x16x32_bf16 v[64:67], v[16:19], a[160:163], v[64:67]
    v_mfma_f32_16x16x32_bf16 v[68:71], v[16:19], a[164:167], v[68:71]
    v_mfma_f32_16x16x32_bf16 v[72:75], v[16:19], a[168:171], v[72:75]
    v_mfma_f32_16x16x32_bf16 v[76:79], v[16:19], a[172:175], v[76:79]
    s_waitcnt lgkmcnt(2)
    v_mfma_f32_16x16x32_bf16 v[64:67], v[20:23], a[176:179], v[64:67]
    v_mfma_f32_16x16x32_bf16 v[68:71], v[20:23], a[180:183], v[68:71]
    v_mfma_f32_16x16x32_bf16 v[72:75], v[20:23], a[184:187], v[72:75]
    v_mfma_f32_16x16x32_bf16 v[76:79], v[20:23], a[188:191], v[76:79]
    s_waitcnt lgkmcnt(1)
    v_mfma_f32_16x16x32_bf16 v[64:67], v[24:27], a[192:195], v[64:67]
    v_mfma_f32_16x16x32_bf16 v[68:71], v[24:27], a[196:199], v[68:71]
    v_mfma_f32_16x16x32_bf16 v[72:75], v[24:27], a[200:203], v[72:75]
    v_mfma_f32_16x16x32_bf16 v[76:79], v[24:27], a[204:207], v[76:79]
    s_waitcnt lgkmcnt(0)
    v_mfma_f32_16x16x32_bf16 v[64:67], v[28:31], a[208:211], v[64:67]
    v_mfma_f32_16x16x32_bf16 v[68:71], v[28:31], a[212:215], v[68:71]
    v_mfma_f32_16x16x32_bf16 v[72:75], v[28:31], a[216:219], v[72:75]
    v_mfma_f32_16x16x32_bf16 v[76:79], v[28:31], a[220:223], v[76:79]
    s_nop 7
    v_cvt_pk_bf16_f32 v80, v48, v64
    v_cvt_pk_bf16_f32 v81, v49, v65
    v_cvt_pk_bf16_f32 v82, v50, v66
    v_cvt_pk_bf16_f32 v83, v51, v67
    s_add_u32 s22, s18, 0
    s_addc_u32 s23, s19, 0
    global_store_dwordx4 v8, v[80:83], s[22:23] sc1
    v_cvt_pk_bf16_f32 v84, v52, v68
    v_cvt_pk_bf16_f32 v85, v53, v69
    v_cvt_pk_bf16_f32 v86, v54, v70
    v_cvt_pk_bf16_f32 v87, v55, v71
    s_add_u32 s22, s18, 3584
    s_addc_u32 s23, s19, 0
    global_store_dwordx4 v8, v[84:87], s[22:23] sc1
    v_cvt_pk_bf16_f32 v88, v56, v72
    v_cvt_pk_bf16_f32 v89, v57, v73
    v_cvt_pk_bf16_f32 v90, v58, v74
    v_cvt_pk_bf16_f32 v91, v59, v75
    s_add_u32 s22, s18, 458752
    s_addc_u32 s23, s19, 0
    global_store_dwordx4 v8, v[88:91], s[22:23] sc1
    v_cvt_pk_bf16_f32 v92, v60, v76
    v_cvt_pk_bf16_f32 v93, v61, v77
    v_cvt_pk_bf16_f32 v94, v62, v78
    v_cvt_pk_bf16_f32 v95, v63, v79
    s_add_u32 s22, s18, 462336
    s_addc_u32 s23, s19, 0
    global_store_dwordx4 v8, v[92:95], s[22:23] sc1
    s_waitcnt vmcnt(11)
    s_barrier
    ds_read_b128 v[16:19], v8 offset:28672
    ds_read_b128 v[20:23], v8 offset:29696
    ds_read_b128 v[24:27], v8 offset:30720
    ds_read_b128 v[28:31], v8 offset:31744
    ds_read_b128 v[32:35], v8 offset:32768
    ds_read_b128 v[36:39], v8 offset:33792
    ds_read_b128 v[40:43], v8 offset:34816
    ds_read_b128 v[44:47], v8 offset:35840
    s_waitcnt lgkmcnt(7)
    v_mfma_f32_16x16x32_bf16 v[48:51], v[16:19], a[0:3], 0
    v_mfma_f32_16x16x32_bf16 v[52:55], v[16:19], a[4:7], 0
    v_mfma_f32_16x16x32_bf16 v[56:59], v[16:19], a[8:11], 0
    v_mfma_f32_16x16x32_bf16 v[60:63], v[16:19], a[12:15], 0
    ds_read_b128 v[16:19], v8 offset:36864
    s_waitcnt lgkmcnt(7)
    v_mfma_f32_16x16x32_bf16 v[48:51], v[20:23], a[16:19], v[48:51]
    v_mfma_f32_16x16x32_bf16 v[52:55], v[20:23], a[20:23], v[52:55]
    v_mfma_f32_16x16x32_bf16 v[56:59], v[20:23], a[24:27], v[56:59]
    v_mfma_f32_16x16x32_bf16 v[60:63], v[20:23], a[28:31], v[60:63]
    s_add_u32 m0, s24, 0
    s_add_u32 s20, s16, 0
    s_addc_u32 s21, s17, 0
    global_load_lds_dwordx4 v6, s[20:21]
    ds_read_b128 v[20:23], v8 offset:37888
    s_waitcnt lgkmcnt(7)
    v_mfma_f32_16x16x32_bf16 v[48:51], v[24:27], a[32:35], v[48:51]
    v_mfma_f32_16x16x32_bf16 v[52:55], v[24:27], a[36:39], v[52:55]
    v_mfma_f32_16x16x32_bf16 v[56:59], v[24:27], a[40:43], v[56:59]
    v_mfma_f32_16x16x32_bf16 v[60:63], v[24:27], a[44:47], v[60:63]
    ds_read_b128 v[24:27], v8 offset:38912
    s_waitcnt lgkmcnt(7)
    v_mfma_f32_16x16x32_bf16 v[48:51], v[28:31], a[48:51], v[48:51]
    v_mfma_f32_16x16x32_bf16 v[52:55], v[28:31], a[52:55], v[52:55]
    v_mfma_f32_16x16x32_bf16 v[56:59], v[28:31], a[56:59], v[56:59]
    v_mfma_f32_16x16x32_bf16 v[60:63], v[28:31], a[60:63], v[60:63]
    ds_read_b128 v[28:31], v8 offset:39936
    s_waitcnt lgkmcnt(7)
    v_mfma_f32_16x16x32_bf16 v[48:51], v[32:35], a[64:67], v[48:51]
    v_mfma_f32_16x16x32_bf16 v[52:55], v[32:35], a[68:71], v[52:55]
    v_mfma_f32_16x16x32_bf16 v[56:59], v[32:35], a[72:75], v[56:59]
    v_mfma_f32_16x16x32_bf16 v[60:63], v[32:35], a[76:79], v[60:63]
    s_add_u32 m0, s24, 4096
    s_add_u32 s20, s16, 4096
    s_addc_u32 s21, s17, 0
    global_load_lds_dwordx4 v6, s[20:21]
    ds_read_b128 v[32:35], v8 offset:40960
    s_waitcnt lgkmcnt(7)
    v_mfma_f32_16x16x32_bf16 v[48:51], v[36:39], a[80:83], v[48:51]
    v_mfma_f32_16x16x32_bf16 v[52:55], v[36:39], a[84:87], v[52:55]
    v_mfma_f32_16x16x32_bf16 v[56:59], v[36:39], a[88:91], v[56:59]
    v_mfma_f32_16x16x32_bf16 v[60:63], v[36:39], a[92:95], v[60:63]
    ds_read_b128 v[36:39], v8 offset:41984
    s_waitcnt lgkmcnt(7)
    v_mfma_f32_16x16x32_bf16 v[48:51], v[40:43], a[96:99], v[48:51]
    v_mfma_f32_16x16x32_bf16 v[52:55], v[40:43], a[100:103], v[52:55]
    v_mfma_f32_16x16x32_bf16 v[56:59], v[40:43], a[104:107], v[56:59]
    v_mfma_f32_16x16x32_bf16 v[60:63], v[40:43], a[108:111], v[60:63]
    ds_read_b128 v[40:43], v8 offset:43008
    s_waitcnt lgkmcnt(7)
    v_mfma_f32_16x16x32_bf16 v[48:51], v[44:47], a[112:115], v[48:51]
    v_mfma_f32_16x16x32_bf16 v[52:55], v[44:47], a[116:119], v[52:55]
    v_mfma_f32_16x16x32_bf16 v[56:59], v[44:47], a[120:123], v[56:59]
    v_mfma_f32_16x16x32_bf16 v[60:63], v[44:47], a[124:127], v[60:63]
    s_add_u32 m0, s24, 8192
    s_add_u32 s20, s16, 8192
    s_addc_u32 s21, s17, 0
    global_load_lds_dwordx4 v6, s[20:21]
    ds_read_b128 v[44:47], v8 offset:44032
    s_waitcnt lgkmcnt(7)
    v_mfma_f32_16x16x32_bf16 v[48:51], v[16:19], a[128:131], v[48:51]
    v_mfma_f32_16x16x32_bf16 v[52:55], v[16:19], a[132:135], v[52:55]
    v_mfma_f32_16x16x32_bf16 v[56:59], v[16:19], a[136:139], v[56:59]
    v_mfma_f32_16x16x32_bf16 v[60:63], v[16:19], a[140:143], v[60:63]
    ds_read_b128 v[16:19], v8 offset:45056
    s_waitcnt lgkmcnt(7)
    v_mfma_f32_16x16x32_bf16 v[48:51], v[20:23], a[144:147], v[48:51]
    v_mfma_f32_16x16x32_bf16 v[52:55], v[20:23], a[148:151], v[52:55]
    v_mfma_f32_16x16x32_bf16 v[56:59], v[20:23], a[152:155], v[56:59]
    v_mfma_f32_16x16x32_bf16 v[60:63], v[20:23], a[156:159], v[60:63]
    ds_read_b128 v[20:23], v8 offset:46080
    s_waitcnt lgkmcnt(7)
    v_mfma_f32_16x16x32_bf16 v[48:51], v[24:27], a[160:163], v[48:51]
    v_mfma_f32_16x16x32_bf16 v[52:55], v[24:27], a[164:167], v[52:55]
    v_mfma_f32_16x16x32_bf16 v[56:59], v[24:27], a[168:171], v[56:59]
    v_mfma_f32_16x16x32_bf16 v[60:63], v[24:27], a[172:175], v[60:63]
    s_add_u32 m0, s24, 12288
    s_add_u32 s20, s16, 12288
    s_addc_u32 s21, s17, 0
    global_load_lds_dwordx4 v6, s[20:21]
    ds_read_b128 v[24:27], v8 offset:47104
    s_waitcnt lgkmcnt(7)
    v_mfma_f32_16x16x32_bf16 v[48:51], v[28:31], a[176:179], v[48:51]
    v_mfma_f32_16x16x32_bf16 v[52:55], v[28:31], a[180:183], v[52:55]
    v_mfma_f32_16x16x32_bf16 v[56:59], v[28:31], a[184:187], v[56:59]
    v_mfma_f32_16x16x32_bf16 v[60:63], v[28:31], a[188:191], v[60:63]
    ds_read_b128 v[28:31], v8 offset:48128
    s_waitcnt lgkmcnt(7)
    v_mfma_f32_16x16x32_bf16 v[48:51], v[32:35], a[192:195], v[48:51]
    v_mfma_f32_16x16x32_bf16 v[52:55], v[32:35], a[196:199], v[52:55]
    v_mfma_f32_16x16x32_bf16 v[56:59], v[32:35], a[200:203], v[56:59]
    v_mfma_f32_16x16x32_bf16 v[60:63], v[32:35], a[204:207], v[60:63]
    ds_read_b128 v[32:35], v8 offset:49152
    s_waitcnt lgkmcnt(7)
    v_mfma_f32_16x16x32_bf16 v[48:51], v[36:39], a[208:211], v[48:51]
    v_mfma_f32_16x16x32_bf16 v[52:55], v[36:39], a[212:215], v[52:55]
    v_mfma_f32_16x16x32_bf16 v[56:59], v[36:39], a[216:219], v[56:59]
    v_mfma_f32_16x16x32_bf16 v[60:63], v[36:39], a[220:223], v[60:63]
    s_add_u32 m0, s24, 16384
    s_add_u32 s20, s16, 16384
    s_addc_u32 s21, s17, 0
    global_load_lds_dwordx4 v6, s[20:21]
    ds_read_b128 v[36:39], v8 offset:50176
    s_waitcnt lgkmcnt(7)
    v_mfma_f32_16x16x32_bf16 v[64:67], v[40:43], a[0:3], 0
    v_mfma_f32_16x16x32_bf16 v[68:71], v[40:43], a[4:7], 0
    v_mfma_f32_16x16x32_bf16 v[72:75], v[40:43], a[8:11], 0
    v_mfma_f32_16x16x32_bf16 v[76:79], v[40:43], a[12:15], 0
    ds_read_b128 v[40:43], v8 offset:51200
    s_waitcnt lgkmcnt(7)
    v_mfma_f32_16x16x32_bf16 v[64:67], v[44:47], a[16:19], v[64:67]
    v_mfma_f32_16x16x32_bf16 v[68:71], v[44:47], a[20:23], v[68:71]
    v_mfma_f32_16x16x32_bf16 v[72:75], v[44:47], a[24:27], v[72:75]
    v_mfma_f32_16x16x32_bf16 v[76:79], v[44:47], a[28:31], v[76:79]
    ds_read_b128 v[44:47], v8 offset:52224
    s_waitcnt lgkmcnt(7)
    v_mfma_f32_16x16x32_bf16 v[64:67], v[16:19], a[32:35], v[64:67]
    v_mfma_f32_16x16x32_bf16 v[68:71], v[16:19], a[36:39], v[68:71]
    v_mfma_f32_16x16x32_bf16 v[72:75], v[16:19], a[40:43], v[72:75]
    v_mfma_f32_16x16x32_bf16 v[76:79], v[16:19], a[44:47], v[76:79]
    s_add_u32 m0, s24, 20480
    s_add_u32 s20, s16, 20480
    s_addc_u32 s21, s17, 0
    global_load_lds_dwordx4 v6, s[20:21]
    ds_read_b128 v[16:19], v8 offset:53248
    s_waitcnt lgkmcnt(7)
    v_mfma_f32_16x16x32_bf16 v[64:67], v[20:23], a[48:51], v[64:67]
    v_mfma_f32_16x16x32_bf16 v[68:71], v[20:23], a[52:55], v[68:71]
    v_mfma_f32_16x16x32_bf16 v[72:75], v[20:23], a[56:59], v[72:75]
    v_mfma_f32_16x16x32_bf16 v[76:79], v[20:23], a[60:63], v[76:79]
    ds_read_b128 v[20:23], v8 offset:54272
    s_waitcnt lgkmcnt(7)
    v_mfma_f32_16x16x32_bf16 v[64:67], v[24:27], a[64:67], v[64:67]
    v_mfma_f32_16x16x32_bf16 v[68:71], v[24:27], a[68:71], v[68:71]
    v_mfma_f32_16x16x32_bf16 v[72:75], v[24:27], a[72:75], v[72:75]
    v_mfma_f32_16x16x32_bf16 v[76:79], v[24:27], a[76:79], v[76:79]
    ds_read_b128 v[24:27], v8 offset:55296
    s_waitcnt lgkmcnt(7)
    v_mfma_f32_16x16x32_bf16 v[64:67], v[28:31], a[80:83], v[64:67]
    v_mfma_f32_16x16x32_bf16 v[68:71], v[28:31], a[84:87], v[68:71]
    v_mfma_f32_16x16x32_bf16 v[72:75], v[28:31], a[88:91], v[72:75]
    v_mfma_f32_16x16x32_bf16 v[76:79], v[28:31], a[92:95], v[76:79]
    s_add_u32 m0, s24, 24576
    s_add_u32 s20, s16, 24576
    s_addc_u32 s21, s17, 0
    global_load_lds_dwordx4 v6, s[20:21]
    s_add_u32 s16, s16, s13
    s_addc_u32 s17, s17, 0
    ds_read_b128 v[28:31], v8 offset:56320
    s_waitcnt lgkmcnt(7)
    v_mfma_f32_16x16x32_bf16 v[64:67], v[32:35], a[96:99], v[64:67]
    v_mfma_f32_16x16x32_bf16 v[68:71], v[32:35], a[100:103], v[68:71]
    v_mfma_f32_16x16x32_bf16 v[72:75], v[32:35], a[104:107], v[72:75]
    v_mfma_f32_16x16x32_bf16 v[76:79], v[32:35], a[108:111], v[76:79]
    s_waitcnt lgkmcnt(6)
    v_mfma_f32_16x16x32_bf16 v[64:67], v[36:39], a[112:115], v[64:67]
    v_mfma_f32_16x16x32_bf16 v[68:71], v[36:39], a[116:119], v[68:71]
    v_mfma_f32_16x16x32_bf16 v[72:75], v[36:39], a[120:123], v[72:75]
    v_mfma_f32_16x16x32_bf16 v[76:79], v[36:39], a[124:127], v[76:79]
    s_waitcnt lgkmcnt(5)
    v_mfma_f32_16x16x32_bf16 v[64:67], v[40:43], a[128:131], v[64:67]
    v_mfma_f32_16x16x32_bf16 v[68:71], v[40:43], a[132:135], v[68:71]
    v_mfma_f32_16x16x32_bf16 v[72:75], v[40:43], a[136:139], v[72:75]
    v_mfma_f32_16x16x32_bf16 v[76:79], v[40:43], a[140:143], v[76:79]
    s_waitcnt lgkmcnt(4)
    v_mfma_f32_16x16x32_bf16 v[64:67], v[44:47], a[144:147], v[64:67]
    v_mfma_f32_16x16x32_bf16 v[68:71], v[44:47], a[148:151], v[68:71]
    v_mfma_f32_16x16x32_bf16 v[72:75], v[44:47], a[152:155], v[72:75]
    v_mfma_f32_16x16x32_bf16 v[76:79], v[44:47], a[156:159], v[76:79]
    s_waitcnt lgkmcnt(3)
    v_mfma_f32_16x16x32_bf16 v[64:67], v[16:19], a[160:163], v[64:67]
    v_mfma_f32_16x16x32_bf16 v[68:71], v[16:19], a[164:167], v[68:71]
    v_mfma_f32_16x16x32_bf16 v[72:75], v[16:19], a[168:171], v[72:75]
    v_mfma_f32_16x16x32_bf16 v[76:79], v[16:19], a[172:175], v[76:79]
    s_waitcnt lgkmcnt(2)
    v_mfma_f32_16x16x32_bf16 v[64:67], v[20:23], a[176:179], v[64:67]
    v_mfma_f32_16x16x32_bf16 v[68:71], v[20:23], a[180:183], v[68:71]
    v_mfma_f32_16x16x32_bf16 v[72:75], v[20:23], a[184:187], v[72:75]
    v_mfma_f32_16x16x32_bf16 v[76:79], v[20:23], a[188:191], v[76:79]
    s_waitcnt lgkmcnt(1)
    v_mfma_f32_16x16x32_bf16 v[64:67], v[24:27], a[192:195], v[64:67]
    v_mfma_f32_16x16x32_bf16 v[68:71], v[24:27], a[196:199], v[68:71]
    v_mfma_f32_16x16x32_bf16 v[72:75], v[24:27], a[200:203], v[72:75]
    v_mfma_f32_16x16x32_bf16 v[76:79], v[24:27], a[204:207], v[76:79]
    s_waitcnt lgkmcnt(0)
    v_mfma_f32_16x16x32_bf16 v[64:67], v[28:31], a[208:211], v[64:67]
    v_mfma_f32_16x16x32_bf16 v[68:71], v[28:31], a[212:215], v[68:71]
    v_mfma_f32_16x16x32_bf16 v[72:75], v[28:31], a[216:219], v[72:75]
    v_mfma_f32_16x16x32_bf16 v[76:79], v[28:31], a[220:223], v[76:79]
    s_nop 7
    v_cvt_pk_bf16_f32 v80, v48, v64
    v_cvt_pk_bf16_f32 v81, v49, v65
    v_cvt_pk_bf16_f32 v82, v50, v66
    v_cvt_pk_bf16_f32 v83, v51, v67
    s_add_u32 s22, s18, 1024
    s_addc_u32 s23, s19, 0
    global_store_dwordx4 v8, v[80:83], s[22:23] sc1
    v_cvt_pk_bf16_f32 v84, v52, v68
    v_cvt_pk_bf16_f32 v85, v53, v69
    v_cvt_pk_bf16_f32 v86, v54, v70
    v_cvt_pk_bf16_f32 v87, v55, v71
    s_add_u32 s22, s18, 4608
    s_addc_u32 s23, s19, 0
    global_store_dwordx4 v8, v[84:87], s[22:23] sc1
    v_cvt_pk_bf16_f32 v88, v56, v72
    v_cvt_pk_bf16_f32 v89, v57, v73
    v_cvt_pk_bf16_f32 v90, v58, v74
    v_cvt_pk_bf16_f32 v91, v59, v75
    s_add_u32 s22, s18, 459776
    s_addc_u32 s23, s19, 0
    global_store_dwordx4 v8, v[88:91], s[22:23] sc1
    v_cvt_pk_bf16_f32 v92, v60, v76
    v_cvt_pk_bf16_f32 v93, v61, v77
    v_cvt_pk_bf16_f32 v94, v62, v78
    v_cvt_pk_bf16_f32 v95, v63, v79
    s_add_u32 s22, s18, 463360
    s_addc_u32 s23, s19, 0
    global_store_dwordx4 v8, v[92:95], s[22:23] sc1
    s_waitcnt vmcnt(11)
    s_barrier
    ds_read_b128 v[16:19], v13 offset:0
    ds_read_b128 v[20:23], v13 offset:1024
    ds_read_b128 v[24:27], v13 offset:2048
    ds_read_b128 v[28:31], v13 offset:3072
    ds_read_b128 v[32:35], v13 offset:4096
    ds_read_b128 v[36:39], v13 offset:5120
    ds_read_b128 v[40:43], v13 offset:6144
    ds_read_b128 v[44:47], v13 offset:7168
    s_waitcnt lgkmcnt(7)
    v_mfma_f32_16x16x32_bf16 v[48:51], v[16:19], a[0:3], 0
    v_mfma_f32_16x16x32_bf16 v[52:55], v[16:19], a[4:7], 0
    v_mfma_f32_16x16x32_bf16 v[56:59], v[16:19], a[8:11], 0
    v_mfma_f32_16x16x32_bf16 v[60:63], v[16:19], a[12:15], 0
    ds_read_b128 v[16:19], v13 offset:8192
    s_waitcnt lgkmcnt(7)
    v_mfma_f32_16x16x32_bf16 v[48:51], v[20:23], a[16:19], v[48:51]
    v_mfma_f32_16x16x32_bf16 v[52:55], v[20:23], a[20:23], v[52:55]
    v_mfma_f32_16x16x32_bf16 v[56:59], v[20:23], a[24:27], v[56:59]
    v_mfma_f32_16x16x32_bf16 v[60:63], v[20:23], a[28:31], v[60:63]
    s_add_u32 m0, s24, 28672
    s_add_u32 s20, s16, 0
    s_addc_u32 s21, s17, 0
    global_load_lds_dwordx4 v6, s[20:21]
    ds_read_b128 v[20:23], v13 offset:9216
    s_waitcnt lgkmcnt(7)
    v_mfma_f32_16x16x32_bf16 v[48:51], v[24:27], a[32:35], v[48:51]
    v_mfma_f32_16x16x32_bf16 v[52:55], v[24:27], a[36:39], v[52:55]
    v_mfma_f32_16x16x32_bf16 v[56:59], v[24:27], a[40:43], v[56:59]
    v_mfma_f32_16x16x32_bf16 v[60:63], v[24:27], a[44:47], v[60:63]
    ds_read_b128 v[24:27], v13 offset:10240
    s_waitcnt lgkmcnt(7)
    v_mfma_f32_16x16x32_bf16 v[48:51], v[28:31], a[48:51], v[48:51]
    v_mfma_f32_16x16x32_bf16 v[52:55], v[28:31], a[52:55], v[52:55]
    v_mfma_f32_16x16x32_bf16 v[56:59], v[28:31], a[56:59], v[56:59]
    v_mfma_f32_16x16x32_bf16 v[60:63], v[28:31], a[60:63], v[60:63]
    ds_read_b128 v[28:31], v13 offset:11264
    s_waitcnt lgkmcnt(7)
    v_mfma_f32_16x16x32_bf16 v[48:51], v[32:35], a[64:67], v[48:51]
    v_mfma_f32_16x16x32_bf16 v[52:55], v[32:35], a[68:71], v[52:55]
    v_mfma_f32_16x16x32_bf16 v[56:59], v[32:35], a[72:75], v[56:59]
    v_mfma_f32_16x16x32_bf16 v[60:63], v[32:35], a[76:79], v[60:63]
    s_add_u32 m0, s24, 32768
    s_add_u32 s20, s16, 4096
    s_addc_u32 s21, s17, 0
    global_load_lds_dwordx4 v6, s[20:21]
    ds_read_b128 v[32:35], v13 offset:12288
    s_waitcnt lgkmcnt(7)
    v_mfma_f32_16x16x32_bf16 v[48:51], v[36:39], a[80:83], v[48:51]
    v_mfma_f32_16x16x32_bf16 v[52:55], v[36:39], a[84:87], v[52:55]
    v_mfma_f32_16x16x32_bf16 v[56:59], v[36:39], a[88:91], v[56:59]
    v_mfma_f32_16x16x32_bf16 v[60:63], v[36:39], a[92:95], v[60:63]
    ds_read_b128 v[36:39], v13 offset:13312
    s_waitcnt lgkmcnt(7)
    v_mfma_f32_16x16x32_bf16 v[48:51], v[40:43], a[96:99], v[48:51]
    v_mfma_f32_16x16x32_bf16 v[52:55], v[40:43], a[100:103], v[52:55]
    v_mfma_f32_16x16x32_bf16 v[56:59], v[40:43], a[104:107], v[56:59]
    v_mfma_f32_16x16x32_bf16 v[60:63], v[40:43], a[108:111], v[60:63]
    ds_read_b128 v[40:43], v13 offset:14336
    s_waitcnt lgkmcnt(7)
    v_mfma_f32_16x16x32_bf16 v[48:51], v[44:47], a[112:115], v[48:51]
    v_mfma_f32_16x16x32_bf16 v[52:55], v[44:47], a[116:119], v[52:55]
    v_mfma_f32_16x16x32_bf16 v[56:59], v[44:47], a[120:123], v[56:59]
    v_mfma_f32_16x16x32_bf16 v[60:63], v[44:47], a[124:127], v[60:63]
    s_add_u32 m0, s24, 36864
    s_add_u32 s20, s16, 8192
    s_addc_u32 s21, s17, 0
    global_load_lds_dwordx4 v6, s[20:21]
    ds_read_b128 v[44:47], v13 offset:15360
    s_waitcnt lgkmcnt(7)
    v_mfma_f32_16x16x32_bf16 v[48:51], v[16:19], a[128:131], v[48:51]
    v_mfma_f32_16x16x32_bf16 v[52:55], v[16:19], a[132:135], v[52:55]
    v_mfma_f32_16x16x32_bf16 v[56:59], v[16:19], a[136:139], v[56:59]
    v_mfma_f32_16x16x32_bf16 v[60:63], v[16:19], a[140:143], v[60:63]
    ds_read_b128 v[16:19], v13 offset:16384
    s_waitcnt lgkmcnt(7)
    v_mfma_f32_16x16x32_bf16 v[48:51], v[20:23], a[144:147], v[48:51]
    v_mfma_f32_16x16x32_bf16 v[52:55], v[20:23], a[148:151], v[52:55]
    v_mfma_f32_16x16x32_bf16 v[56:59], v[20:23], a[152:155], v[56:59]
    v_mfma_f32_16x16x32_bf16 v[60:63], v[20:23], a[156:159], v[60:63]
    ds_read_b128 v[20:23], v13 offset:17408
    s_waitcnt lgkmcnt(7)
    v_mfma_f32_16x16x32_bf16 v[48:51], v[24:27], a[160:163], v[48:51]
    v_mfma_f32_16x16x32_bf16 v[52:55], v[24:27], a[164:167], v[52:55]
    v_mfma_f32_16x16x32_bf16 v[56:59], v[24:27], a[168:171], v[56:59]
    v_mfma_f32_16x16x32_bf16 v[60:63], v[24:27], a[172:175], v[60:63]
    s_add_u32 m0, s24, 40960
    s_add_u32 s20, s16, 12288
    s_addc_u32 s21, s17, 0
    global_load_lds_dwordx4 v6, s[20:21]
    ds_read_b128 v[24:27], v13 offset:18432
    s_waitcnt lgkmcnt(7)
    v_mfma_f32_16x16x32_bf16 v[48:51], v[28:31], a[176:179], v[48:51]
    v_mfma_f32_16x16x32_bf16 v[52:55], v[28:31], a[180:183], v[52:55]
    v_mfma_f32_16x16x32_bf16 v[56:59], v[28:31], a[184:187], v[56:59]
    v_mfma_f32_16x16x32_bf16 v[60:63], v[28:31], a[188:191], v[60:63]
    ds_read_b128 v[28:31], v13 offset:19456
    s_waitcnt lgkmcnt(7)
    v_mfma_f32_16x16x32_bf16 v[48:51], v[32:35], a[192:195], v[48:51]
    v_mfma_f32_16x16x32_bf16 v[52:55], v[32:35], a[196:199], v[52:55]
    v_mfma_f32_16x16x32_bf16 v[56:59], v[32:35], a[200:203], v[56:59]
    v_mfma_f32_16x16x32_bf16 v[60:63], v[32:35], a[204:207], v[60:63]
    ds_read_b128 v[32:35], v13 offset:20480
    s_waitcnt lgkmcnt(7)
    v_mfma_f32_16x16x32_bf16 v[48:51], v[36:39], a[208:211], v[48:51]
    v_mfma_f32_16x16x32_bf16 v[52:55], v[36:39], a[212:215], v[52:55]
    v_mfma_f32_16x16x32_bf16 v[56:59], v[36:39], a[216:219], v[56:59]
    v_mfma_f32_16x16x32_bf16 v[60:63], v[36:39], a[220:223], v[60:63]
    s_add_u32 m0, s24, 45056
    s_add_u32 s20, s16, 16384
    s_addc_u32 s21, s17, 0
    global_load_lds_dwordx4 v6, s[20:21]
    ds_read_b128 v[36:39], v13 offset:21504
    s_waitcnt lgkmcnt(7)
    v_mfma_f32_16x16x32_bf16 v[64:67], v[40:43], a[0:3], 0
    v_mfma_f32_16x16x32_bf16 v[68:71], v[40:43], a[4:7], 0
    v_mfma_f32_16x16x32_bf16 v[72:75], v[40:43], a[8:11], 0
    v_mfma_f32_16x16x32_bf16 v[76:79], v[40:43], a[12:15], 0
    ds_read_b128 v[40:43], v13 offset:22528
    s_waitcnt lgkmcnt(7)
    v_mfma_f32_16x16x32_bf16 v[64:67], v[44:47], a[16:19], v[64:67]
    v_mfma_f32_16x16x32_bf16 v[68:71], v[44:47], a[20:23], v[68:71]
    v_mfma_f32_16x16x32_bf16 v[72:75], v[44:47], a[24:27], v[72:75]
    v_mfma_f32_16x16x32_bf16 v[76:79], v[44:47], a[28:31], v[76:79]
    ds_read_b128 v[44:47], v13 offset:23552
    s_waitcnt lgkmcnt(7)
    v_mfma_f32_16x16x32_bf16 v[64:67], v[16:19], a[32:35], v[64:67]
    v_mfma_f32_16x16x32_bf16 v[68:71], v[16:19], a[36:39], v[68:71]
    v_mfma_f32_16x16x32_bf16 v[72:75], v[16:19], a[40:43], v[72:75]
    v_mfma_f32_16x16x32_bf16 v[76:79], v[16:19], a[44:47], v[76:79]
    s_add_u32 m0, s24, 49152
    s_add_u32 s20, s16, 20480
    s_addc_u32 s21, s17, 0
    global_load_lds_dwordx4 v6, s[20:21]
    ds_read_b128 v[16:19], v13 offset:24576
    s_waitcnt lgkmcnt(7)
    v_mfma_f32_16x16x32_bf16 v[64:67], v[20:23], a[48:51], v[64:67]
    v_mfma_f32_16x16x32_bf16 v[68:71], v[20:23], a[52:55], v[68:71]
    v_mfma_f32_16x16x32_bf16 v[72:75], v[20:23], a[56:59], v[72:75]
    v_mfma_f32_16x16x32_bf16 v[76:79], v[20:23], a[60:63], v[76:79]
    ds_read_b128 v[20:23], v13 offset:25600
    s_waitcnt lgkmcnt(7)
    v_mfma_f32_16x16x32_bf16 v[64:67], v[24:27], a[64:67], v[64:67]
    v_mfma_f32_16x16x32_bf16 v[68:71], v[24:27], a[68:71], v[68:71]
    v_mfma_f32_16x16x32_bf16 v[72:75], v[24:27], a[72:75], v[72:75]
    v_mfma_f32_16x16x32_bf16 v[76:79], v[24:27], a[76:79], v[76:79]
    ds_read_b128 v[24:27], v13 offset:26624
    s_waitcnt lgkmcnt(7)
    v_mfma_f32_16x16x32_bf16 v[64:67], v[28:31], a[80:83], v[64:67]
    v_mfma_f32_16x16x32_bf16 v[68:71], v[28:31], a[84:87], v[68:71]
    v_mfma_f32_16x16x32_bf16 v[72:75], v[28:31], a[88:91], v[72:75]
    v_mfma_f32_16x16x32_bf16 v[76:79], v[28:31], a[92:95], v[76:79]
    s_add_u32 m0, s24, 53248
    s_add_u32 s20, s16, 24576
    s_addc_u32 s21, s17, 0
    global_load_lds_dwordx4 v6, s[20:21]
    s_add_u32 s16, s16, s13
    s_addc_u32 s17, s17, 0
    ds_read_b128 v[28:31], v13 offset:27648
    s_waitcnt lgkmcnt(7)
    v_mfma_f32_16x16x32_bf16 v[64:67], v[32:35], a[96:99], v[64:67]
    v_mfma_f32_16x16x32_bf16 v[68:71], v[32:35], a[100:103], v[68:71]
    v_mfma_f32_16x16x32_bf16 v[72:75], v[32:35], a[104:107], v[72:75]
    v_mfma_f32_16x16x32_bf16 v[76:79], v[32:35], a[108:111], v[76:79]
    s_waitcnt lgkmcnt(6)
    v_mfma_f32_16x16x32_bf16 v[64:67], v[36:39], a[112:115], v[64:67]
    v_mfma_f32_16x16x32_bf16 v[68:71], v[36:39], a[116:119], v[68:71]
    v_mfma_f32_16x16x32_bf16 v[72:75], v[36:39], a[120:123], v[72:75]
    v_mfma_f32_16x16x32_bf16 v[76:79], v[36:39], a[124:127], v[76:79]
    s_waitcnt lgkmcnt(5)
    v_mfma_f32_16x16x32_bf16 v[64:67], v[40:43], a[128:131], v[64:67]
    v_mfma_f32_16x16x32_bf16 v[68:71], v[40:43], a[132:135], v[68:71]
    v_mfma_f32_16x16x32_bf16 v[72:75], v[40:43], a[136:139], v[72:75]
    v_mfma_f32_16x16x32_bf16 v[76:79], v[40:43], a[140:143], v[76:79]
    s_waitcnt lgkmcnt(4)
    v_mfma_f32_16x16x32_bf16 v[64:67], v[44:47], a[144:147], v[64:67]
    v_mfma_f32_16x16x32_bf16 v[68:71], v[44:47], a[148:151], v[68:71]
    v_mfma_f32_16x16x32_bf16 v[72:75], v[44:47], a[152:155], v[72:75]
    v_mfma_f32_16x16x32_bf16 v[76:79], v[44:47], a[156:159], v[76:79]
    s_waitcnt lgkmcnt(3)
    v_mfma_f32_16x16x32_bf16 v[64:67], v[16:19], a[160:163], v[64:67]
    v_mfma_f32_16x16x32_bf16 v[68:71], v[16:19], a[164:167], v[68:71]
    v_mfma_f32_16x16x32_bf16 v[72:75], v[16:19], a[168:171], v[72:75]
    v_mfma_f32_16x16x32_bf16 v[76:79], v[16:19], a[172:175], v[76:79]
    s_waitcnt lgkmcnt(2)
    v_mfma_f32_16x16x32_bf16 v[64:67], v[20:23], a[176:179], v[64:67]
    v_mfma_f32_16x16x32_bf16 v[68:71], v[20:23], a[180:183], v[68:71]
    v_mfma_f32_16x16x32_bf16 v[72:75], v[20:23], a[184:187], v[72:75]
    v_mfma_f32_16x16x32_bf16 v[76:79], v[20:23], a[188:191], v[76:79]
    s_waitcnt lgkmcnt(1)
    v_mfma_f32_16x16x32_bf16 v[64:67], v[24:27], a[192:195], v[64:67]
    v_mfma_f32_16x16x32_bf16 v[68:71], v[24:27], a[196:199], v[68:71]
    v_mfma_f32_16x16x32_bf16 v[72:75], v[24:27], a[200:203], v[72:75]
    v_mfma_f32_16x16x32_bf16 v[76:79], v[24:27], a[204:207], v[76:79]
    s_waitcnt lgkmcnt(0)
    v_mfma_f32_16x16x32_bf16 v[64:67], v[28:31], a[208:211], v[64:67]
    v_mfma_f32_16x16x32_bf16 v[68:71], v[28:31], a[212:215], v[68:71]
    v_mfma_f32_16x16x32_bf16 v[72:75], v[28:31], a[216:219], v[72:75]
    v_mfma_f32_16x16x32_bf16 v[76:79], v[28:31], a[220:223], v[76:79]
    s_nop 7
    v_cvt_pk_bf16_f32 v80, v48, v64
    v_cvt_pk_bf16_f32 v81, v49, v65
    v_cvt_pk_bf16_f32 v82, v50, v66
    v_cvt_pk_bf16_f32 v83, v51, v67
    s_add_u32 s22, s18, 2048
    s_addc_u32 s23, s19, 0
    global_store_dwordx4 v8, v[80:83], s[22:23] sc1
    v_cvt_pk_bf16_f32 v84, v52, v68
    v_cvt_pk_bf16_f32 v85, v53, v69
    v_cvt_pk_bf16_f32 v86, v54, v70
    v_cvt_pk_bf16_f32 v87, v55, v71
    s_add_u32 s22, s18, 5632
    s_addc_u32 s23, s19, 0
    global_store_dwordx4 v8, v[84:87], s[22:23] sc1
    v_cvt_pk_bf16_f32 v88, v56, v72
    v_cvt_pk_bf16_f32 v89, v57, v73
    v_cvt_pk_bf16_f32 v90, v58, v74
    v_cvt_pk_bf16_f32 v91, v59, v75
    s_add_u32 s22, s18, 460800
    s_addc_u32 s23, s19, 0
    global_store_dwordx4 v8, v[88:91], s[22:23] sc1
    v_cvt_pk_bf16_f32 v92, v60, v76
    v_cvt_pk_bf16_f32 v93, v61, v77
    v_cvt_pk_bf16_f32 v94, v62, v78
    v_cvt_pk_bf16_f32 v95, v63, v79
    s_add_u32 s22, s18, 464384
    s_addc_u32 s23, s19, 0
    global_store_dwordx4 v8, v[92:95], s[22:23] sc1
    s_waitcnt vmcnt(11)
    s_barrier
    ds_read_b128 v[16:19], v8 offset:0
    ds_read_b128 v[20:23], v8 offset:1024
    ds_read_b128 v[24:27], v8 offset:2048
    ds_read_b128 v[28:31], v8 offset:3072
    ds_read_b128 v[32:35], v8 offset:4096
    ds_read_b128 v[36:39], v8 offset:5120
    ds_read_b128 v[40:43], v8 offset:6144
    ds_read_b128 v[44:47], v8 offset:7168
    s_waitcnt lgkmcnt(7)
    v_mfma_f32_16x16x32_bf16 v[48:51], v[16:19], a[0:3], 0
    v_mfma_f32_16x16x32_bf16 v[52:55], v[16:19], a[4:7], 0
    v_mfma_f32_16x16x32_bf16 v[56:59], v[16:19], a[8:11], 0
    v_mfma_f32_16x16x32_bf16 v[60:63], v[16:19], a[12:15], 0
    ds_read_b128 v[16:19], v8 offset:8192
    s_waitcnt lgkmcnt(7)
    v_mfma_f32_16x16x32_bf16 v[48:51], v[20:23], a[16:19], v[48:51]
    v_mfma_f32_16x16x32_bf16 v[52:55], v[20:23], a[20:23], v[52:55]
    v_mfma_f32_16x16x32_bf16 v[56:59], v[20:23], a[24:27], v[56:59]
    v_mfma_f32_16x16x32_bf16 v[60:63], v[20:23], a[28:31], v[60:63]
    s_add_u32 m0, s24, 57344
    s_add_u32 s20, s16, 0
    s_addc_u32 s21, s17, 0
    global_load_lds_dwordx4 v6, s[20:21]
    ds_read_b128 v[20:23], v8 offset:9216
    s_waitcnt lgkmcnt(7)
    v_mfma_f32_16x16x32_bf16 v[48:51], v[24:27], a[32:35], v[48:51]
    v_mfma_f32_16x16x32_bf16 v[52:55], v[24:27], a[36:39], v[52:55]
    v_mfma_f32_16x16x32_bf16 v[56:59], v[24:27], a[40:43], v[56:59]
    v_mfma_f32_16x16x32_bf16 v[60:63], v[24:27], a[44:47], v[60:63]
    ds_read_b128 v[24:27], v8 offset:10240
    s_waitcnt lgkmcnt(7)
    v_mfma_f32_16x16x32_bf16 v[48:51], v[28:31], a[48:51], v[48:51]
    v_mfma_f32_16x16x32_bf16 v[52:55], v[28:31], a[52:55], v[52:55]
    v_mfma_f32_16x16x32_bf16 v[56:59], v[28:31], a[56:59], v[56:59]
    v_mfma_f32_16x16x32_bf16 v[60:63], v[28:31], a[60:63], v[60:63]
    ds_read_b128 v[28:31], v8 offset:11264
    s_waitcnt lgkmcnt(7)
    v_mfma_f32_16x16x32_bf16 v[48:51], v[32:35], a[64:67], v[48:51]
    v_mfma_f32_16x16x32_bf16 v[52:55], v[32:35], a[68:71], v[52:55]
    v_mfma_f32_16x16x32_bf16 v[56:59], v[32:35], a[72:75], v[56:59]
    v_mfma_f32_16x16x32_bf16 v[60:63], v[32:35], a[76:79], v[60:63]
    s_add_u32 m0, s24, 61440
    s_add_u32 s20, s16, 4096
    s_addc_u32 s21, s17, 0
    global_load_lds_dwordx4 v6, s[20:21]
    ds_read_b128 v[32:35], v8 offset:12288
    s_waitcnt lgkmcnt(7)
    v_mfma_f32_16x16x32_bf16 v[48:51], v[36:39], a[80:83], v[48:51]
    v_mfma_f32_16x16x32_bf16 v[52:55], v[36:39], a[84:87], v[52:55]
    v_mfma_f32_16x16x32_bf16 v[56:59], v[36:39], a[88:91], v[56:59]
    v_mfma_f32_16x16x32_bf16 v[60:63], v[36:39], a[92:95], v[60:63]
    ds_read_b128 v[36:39], v8 offset:13312
    s_waitcnt lgkmcnt(7)
    v_mfma_f32_16x16x32_bf16 v[48:51], v[40:43], a[96:99], v[48:51]
    v_mfma_f32_16x16x32_bf16 v[52:55], v[40:43], a[100:103], v[52:55]
    v_mfma_f32_16x16x32_bf16 v[56:59], v[40:43], a[104:107], v[56:59]
    v_mfma_f32_16x16x32_bf16 v[60:63], v[40:43], a[108:111], v[60:63]
    ds_read_b128 v[40:43], v8 offset:14336
    s_waitcnt lgkmcnt(7)
    v_mfma_f32_16x16x32_bf16 v[48:51], v[44:47], a[112:115], v[48:51]
    v_mfma_f32_16x16x32_bf16 v[52:55], v[44:47], a[116:119], v[52:55]
    v_mfma_f32_16x16x32_bf16 v[56:59], v[44:47], a[120:123], v[56:59]
    v_mfma_f32_16x16x32_bf16 v[60:63], v[44:47], a[124:127], v[60:63]
    s_add_u32 m0, s24, 65536
    s_add_u32 s20, s16, 8192
    s_addc_u32 s21, s17, 0
    global_load_lds_dwordx4 v6, s[20:21]
    ds_read_b128 v[44:47], v8 offset:15360
    s_waitcnt lgkmcnt(7)
    v_mfma_f32_16x16x32_bf16 v[48:51], v[16:19], a[128:131], v[48:51]
    v_mfma_f32_16x16x32_bf16 v[52:55], v[16:19], a[132:135], v[52:55]
    v_mfma_f32_16x16x32_bf16 v[56:59], v[16:19], a[136:139], v[56:59]
    v_mfma_f32_16x16x32_bf16 v[60:63], v[16:19], a[140:143], v[60:63]
    ds_read_b128 v[16:19], v8 offset:16384
    s_waitcnt lgkmcnt(7)
    v_mfma_f32_16x16x32_bf16 v[48:51], v[20:23], a[144:147], v[48:51]
    v_mfma_f32_16x16x32_bf16 v[52:55], v[20:23], a[148:151], v[52:55]
    v_mfma_f32_16x16x32_bf16 v[56:59], v[20:23], a[152:155], v[56:59]
    v_mfma_f32_16x16x32_bf16 v[60:63], v[20:23], a[156:159], v[60:63]
    ds_read_b128 v[20:23], v8 offset:17408
    s_waitcnt lgkmcnt(7)
    v_mfma_f32_16x16x32_bf16 v[48:51], v[24:27], a[160:163], v[48:51]
    v_mfma_f32_16x16x32_bf16 v[52:55], v[24:27], a[164:167], v[52:55]
    v_mfma_f32_16x16x32_bf16 v[56:59], v[24:27], a[168:171], v[56:59]
    v_mfma_f32_16x16x32_bf16 v[60:63], v[24:27], a[172:175], v[60:63]
    s_add_u32 m0, s24, 69632
    s_add_u32 s20, s16, 12288
    s_addc_u32 s21, s17, 0
    global_load_lds_dwordx4 v6, s[20:21]
    ds_read_b128 v[24:27], v8 offset:18432
    s_waitcnt lgkmcnt(7)
    v_mfma_f32_16x16x32_bf16 v[48:51], v[28:31], a[176:179], v[48:51]
    v_mfma_f32_16x16x32_bf16 v[52:55], v[28:31], a[180:183], v[52:55]
    v_mfma_f32_16x16x32_bf16 v[56:59], v[28:31], a[184:187], v[56:59]
    v_mfma_f32_16x16x32_bf16 v[60:63], v[28:31], a[188:191], v[60:63]
    ds_read_b128 v[28:31], v8 offset:19456
    s_waitcnt lgkmcnt(7)
    v_mfma_f32_16x16x32_bf16 v[48:51], v[32:35], a[192:195], v[48:51]
    v_mfma_f32_16x16x32_bf16 v[52:55], v[32:35], a[196:199], v[52:55]
    v_mfma_f32_16x16x32_bf16 v[56:59], v[32:35], a[200:203], v[56:59]
    v_mfma_f32_16x16x32_bf16 v[60:63], v[32:35], a[204:207], v[60:63]
    ds_read_b128 v[32:35], v8 offset:20480
    s_waitcnt lgkmcnt(7)
    v_mfma_f32_16x16x32_bf16 v[48:51], v[36:39], a[208:211], v[48:51]
    v_mfma_f32_16x16x32_bf16 v[52:55], v[36:39], a[212:215], v[52:55]
    v_mfma_f32_16x16x32_bf16 v[56:59], v[36:39], a[216:219], v[56:59]
    v_mfma_f32_16x16x32_bf16 v[60:63], v[36:39], a[220:223], v[60:63]
    s_add_u32 m0, s24, 73728
    s_add_u32 s20, s16, 16384
    s_addc_u32 s21, s17, 0
    global_load_lds_dwordx4 v6, s[20:21]
    s_nop 7
    v_cvt_pk_bf16_f32 v80, v48, v49
    v_cvt_pk_bf16_f32 v81, v50, v51
    s_add_u32 s22, s18, 3072
    s_addc_u32 s23, s19, 0
    global_store_dwordx2 v9, v[80:81], s[22:23] sc1
    v_cvt_pk_bf16_f32 v84, v52, v53
    v_cvt_pk_bf16_f32 v85, v54, v55
    s_add_u32 s22, s18, 6656
    s_addc_u32 s23, s19, 0
    global_store_dwordx2 v9, v[84:85], s[22:23] sc1
    v_cvt_pk_bf16_f32 v88, v56, v57
    v_cvt_pk_bf16_f32 v89, v58, v59
    s_add_u32 s22, s18, 461824
    s_addc_u32 s23, s19, 0
    global_store_dwordx2 v9, v[88:89], s[22:23] sc1
    v_cvt_pk_bf16_f32 v92, v60, v61
    v_cvt_pk_bf16_f32 v93, v62, v63
    s_add_u32 s22, s18, 465408
    s_addc_u32 s23, s19, 0
    global_store_dwordx2 v9, v[92:93], s[22:23] sc1
    ds_read_b128 v[36:39], v8 offset:21504
    s_waitcnt lgkmcnt(7)
    v_mfma_f32_16x16x32_bf16 v[48:51], v[40:43], a[0:3], 0
    v_mfma_f32_16x16x32_bf16 v[52:55], v[40:43], a[4:7], 0
    v_mfma_f32_16x16x32_bf16 v[56:59], v[40:43], a[8:11], 0
    v_mfma_f32_16x16x32_bf16 v[60:63], v[40:43], a[12:15], 0
    ds_read_b128 v[40:43], v8 offset:22528
    s_waitcnt lgkmcnt(7)
    v_mfma_f32_16x16x32_bf16 v[48:51], v[44:47], a[16:19], v[48:51]
    v_mfma_f32_16x16x32_bf16 v[52:55], v[44:47], a[20:23], v[52:55]
    v_mfma_f32_16x16x32_bf16 v[56:59], v[44:47], a[24:27], v[56:59]
    v_mfma_f32_16x16x32_bf16 v[60:63], v[44:47], a[28:31], v[60:63]
    ds_read_b128 v[44:47], v8 offset:23552
    s_waitcnt lgkmcnt(7)
    v_mfma_f32_16x16x32_bf16 v[48:51], v[16:19], a[32:35], v[48:51]
    v_mfma_f32_16x16x32_bf16 v[52:55], v[16:19], a[36:39], v[52:55]
    v_mfma_f32_16x16x32_bf16 v[56:59], v[16:19], a[40:43], v[56:59]
    v_mfma_f32_16x16x32_bf16 v[60:63], v[16:19], a[44:47], v[60:63]
    s_add_u32 m0, s24, 77824
    s_add_u32 s20, s16, 20480
    s_addc_u32 s21, s17, 0
    global_load_lds_dwordx4 v6, s[20:21]
    ds_read_b128 v[16:19], v8 offset:24576
    s_waitcnt lgkmcnt(7)
    v_mfma_f32_16x16x32_bf16 v[48:51], v[20:23], a[48:51], v[48:51]
    v_mfma_f32_16x16x32_bf16 v[52:55], v[20:23], a[52:55], v[52:55]
    v_mfma_f32_16x16x32_bf16 v[56:59], v[20:23], a[56:59], v[56:59]
    v_mfma_f32_16x16x32_bf16 v[60:63], v[20:23], a[60:63], v[60:63]
    ds_read_b128 v[20:23], v8 offset:25600
    s_waitcnt lgkmcnt(7)
    v_mfma_f32_16x16x32_bf16 v[48:51], v[24:27], a[64:67], v[48:51]
    v_mfma_f32_16x16x32_bf16 v[52:55], v[24:27], a[68:71], v[52:55]
    v_mfma_f32_16x16x32_bf16 v[56:59], v[24:27], a[72:75], v[56:59]
    v_mfma_f32_16x16x32_bf16 v[60:63], v[24:27], a[76:79], v[60:63]
    ds_read_b128 v[24:27], v8 offset:26624
    s_waitcnt lgkmcnt(7)
    v_mfma_f32_16x16x32_bf16 v[48:51], v[28:31], a[80:83], v[48:51]
    v_mfma_f32_16x16x32_bf16 v[52:55], v[28:31], a[84:87], v[52:55]
    v_mfma_f32_16x16x32_bf16 v[56:59], v[28:31], a[88:91], v[56:59]
    v_mfma_f32_16x16x32_bf16 v[60:63], v[28:31], a[92:95], v[60:63]
    s_add_u32 m0, s24, 81920
    s_add_u32 s20, s16, 24576
    s_addc_u32 s21, s17, 0
    global_load_lds_dwordx4 v6, s[20:21]
    s_add_u32 s16, s16, s13
    s_addc_u32 s17, s17, 0
    ds_read_b128 v[28:31], v8 offset:27648
    s_waitcnt lgkmcnt(7)
    v_mfma_f32_16x16x32_bf16 v[48:51], v[32:35], a[96:99], v[48:51]
    v_mfma_f32_16x16x32_bf16 v[52:55], v[32:35], a[100:103], v[52:55]
    v_mfma_f32_16x16x32_bf16 v[56:59], v[32:35], a[104:107], v[56:59]
    v_mfma_f32_16x16x32_bf16 v[60:63], v[32:35], a[108:111], v[60:63]
    s_waitcnt lgkmcnt(6)
    v_mfma_f32_16x16x32_bf16 v[48:51], v[36:39], a[112:115], v[48:51]
    v_mfma_f32_16x16x32_bf16 v[52:55], v[36:39], a[116:119], v[52:55]
    v_mfma_f32_16x16x32_bf16 v[56:59], v[36:39], a[120:123], v[56:59]
    v_mfma_f32_16x16x32_bf16 v[60:63], v[36:39], a[124:127], v[60:63]
    s_waitcnt lgkmcnt(5)
    v_mfma_f32_16x16x32_bf16 v[48:51], v[40:43], a[128:131], v[48:51]
    v_mfma_f32_16x16x32_bf16 v[52:55], v[40:43], a[132:135], v[52:55]
    v_mfma_f32_16x16x32_bf16 v[56:59], v[40:43], a[136:139], v[56:59]
    v_mfma_f32_16x16x32_bf16 v[60:63], v[40:43], a[140:143], v[60:63]
    s_waitcnt lgkmcnt(4)
    v_mfma_f32_16x16x32_bf16 v[48:51], v[44:47], a[144:147], v[48:51]
    v_mfma_f32_16x16x32_bf16 v[52:55], v[44:47], a[148:151], v[52:55]
    v_mfma_f32_16x16x32_bf16 v[56:59], v[44:47], a[152:155], v[56:59]
    v_mfma_f32_16x16x32_bf16 v[60:63], v[44:47], a[156:159], v[60:63]
    s_waitcnt lgkmcnt(3)
    v_mfma_f32_16x16x32_bf16 v[48:51], v[16:19], a[160:163], v[48:51]
    v_mfma_f32_16x16x32_bf16 v[52:55], v[16:19], a[164:167], v[52:55]
    v_mfma_f32_16x16x32_bf16 v[56:59], v[16:19], a[168:171], v[56:59]
    v_mfma_f32_16x16x32_bf16 v[60:63], v[16:19], a[172:175], v[60:63]
    s_waitcnt lgkmcnt(2)
    v_mfma_f32_16x16x32_bf16 v[48:51], v[20:23], a[176:179], v[48:51]
    v_mfma_f32_16x16x32_bf16 v[52:55], v[20:23], a[180:183], v[52:55]
    v_mfma_f32_16x16x32_bf16 v[56:59], v[20:23], a[184:187], v[56:59]
    v_mfma_f32_16x16x32_bf16 v[60:63], v[20:23], a[188:191], v[60:63]
    s_waitcnt lgkmcnt(1)
    v_mfma_f32_16x16x32_bf16 v[48:51], v[24:27], a[192:195], v[48:51]
    v_mfma_f32_16x16x32_bf16 v[52:55], v[24:27], a[196:199], v[52:55]
    v_mfma_f32_16x16x32_bf16 v[56:59], v[24:27], a[200:203], v[56:59]
    v_mfma_f32_16x16x32_bf16 v[60:63], v[24:27], a[204:207], v[60:63]
    s_waitcnt lgkmcnt(0)
    v_mfma_f32_16x16x32_bf16 v[48:51], v[28:31], a[208:211], v[48:51]
    v_mfma_f32_16x16x32_bf16 v[52:55], v[28:31], a[212:215], v[52:55]
    v_mfma_f32_16x16x32_bf16 v[56:59], v[28:31], a[216:219], v[56:59]
    v_mfma_f32_16x16x32_bf16 v[60:63], v[28:31], a[220:223], v[60:63]
    s_waitcnt vmcnt(11)
    s_barrier
    ds_read_b128 v[16:19], v8 offset:28672
    ds_read_b128 v[20:23], v8 offset:29696
    ds_read_b128 v[24:27], v8 offset:30720
    ds_read_b128 v[28:31], v8 offset:31744
    ds_read_b128 v[32:35], v8 offset:32768
    ds_read_b128 v[36:39], v8 offset:33792
    ds_read_b128 v[40:43], v8 offset:34816
    ds_read_b128 v[44:47], v8 offset:35840
    s_waitcnt lgkmcnt(7)
    v_mfma_f32_16x16x32_bf16 v[64:67], v[16:19], a[0:3], 0
    v_mfma_f32_16x16x32_bf16 v[68:71], v[16:19], a[4:7], 0
    v_mfma_f32_16x16x32_bf16 v[72:75], v[16:19], a[8:11], 0
    v_mfma_f32_16x16x32_bf16 v[76:79], v[16:19], a[12:15], 0
    ds_read_b128 v[16:19], v8 offset:36864
    s_waitcnt lgkmcnt(7)
    v_mfma_f32_16x16x32_bf16 v[64:67], v[20:23], a[16:19], v[64:67]
    v_mfma_f32_16x16x32_bf16 v[68:71], v[20:23], a[20:23], v[68:71]
    v_mfma_f32_16x16x32_bf16 v[72:75], v[20:23], a[24:27], v[72:75]
    v_mfma_f32_16x16x32_bf16 v[76:79], v[20:23], a[28:31], v[76:79]
    s_add_u32 m0, s24, 0
    s_add_u32 s20, s16, 0
    s_addc_u32 s21, s17, 0
    global_load_lds_dwordx4 v6, s[20:21]
    ds_read_b128 v[20:23], v8 offset:37888
    s_waitcnt lgkmcnt(7)
    v_mfma_f32_16x16x32_bf16 v[64:67], v[24:27], a[32:35], v[64:67]
    v_mfma_f32_16x16x32_bf16 v[68:71], v[24:27], a[36:39], v[68:71]
    v_mfma_f32_16x16x32_bf16 v[72:75], v[24:27], a[40:43], v[72:75]
    v_mfma_f32_16x16x32_bf16 v[76:79], v[24:27], a[44:47], v[76:79]
    ds_read_b128 v[24:27], v8 offset:38912
    s_waitcnt lgkmcnt(7)
    v_mfma_f32_16x16x32_bf16 v[64:67], v[28:31], a[48:51], v[64:67]
    v_mfma_f32_16x16x32_bf16 v[68:71], v[28:31], a[52:55], v[68:71]
    v_mfma_f32_16x16x32_bf16 v[72:75], v[28:31], a[56:59], v[72:75]
    v_mfma_f32_16x16x32_bf16 v[76:79], v[28:31], a[60:63], v[76:79]
    ds_read_b128 v[28:31], v8 offset:39936
    s_waitcnt lgkmcnt(7)
    v_mfma_f32_16x16x32_bf16 v[64:67], v[32:35], a[64:67], v[64:67]
    v_mfma_f32_16x16x32_bf16 v[68:71], v[32:35], a[68:71], v[68:71]
    v_mfma_f32_16x16x32_bf16 v[72:75], v[32:35], a[72:75], v[72:75]
    v_mfma_f32_16x16x32_bf16 v[76:79], v[32:35], a[76:79], v[76:79]
    s_add_u32 m0, s24, 4096
    s_add_u32 s20, s16, 4096
    s_addc_u32 s21, s17, 0
    global_load_lds_dwordx4 v6, s[20:21]
    ds_read_b128 v[32:35], v8 offset:40960
    s_waitcnt lgkmcnt(7)
    v_mfma_f32_16x16x32_bf16 v[64:67], v[36:39], a[80:83], v[64:67]
    v_mfma_f32_16x16x32_bf16 v[68:71], v[36:39], a[84:87], v[68:71]
    v_mfma_f32_16x16x32_bf16 v[72:75], v[36:39], a[88:91], v[72:75]
    v_mfma_f32_16x16x32_bf16 v[76:79], v[36:39], a[92:95], v[76:79]
    ds_read_b128 v[36:39], v8 offset:41984
    s_waitcnt lgkmcnt(7)
    v_mfma_f32_16x16x32_bf16 v[64:67], v[40:43], a[96:99], v[64:67]
    v_mfma_f32_16x16x32_bf16 v[68:71], v[40:43], a[100:103], v[68:71]
    v_mfma_f32_16x16x32_bf16 v[72:75], v[40:43], a[104:107], v[72:75]
    v_mfma_f32_16x16x32_bf16 v[76:79], v[40:43], a[108:111], v[76:79]
    ds_read_b128 v[40:43], v8 offset:43008
    s_waitcnt lgkmcnt(7)
    v_mfma_f32_16x16x32_bf16 v[64:67], v[44:47], a[112:115], v[64:67]
    v_mfma_f32_16x16x32_bf16 v[68:71], v[44:47], a[116:119], v[68:71]
    v_mfma_f32_16x16x32_bf16 v[72:75], v[44:47], a[120:123], v[72:75]
    v_mfma_f32_16x16x32_bf16 v[76:79], v[44:47], a[124:127], v[76:79]
    s_add_u32 m0, s24, 8192
    s_add_u32 s20, s16, 8192
    s_addc_u32 s21, s17, 0
    global_load_lds_dwordx4 v6, s[20:21]
    ds_read_b128 v[44:47], v8 offset:44032
    s_waitcnt lgkmcnt(7)
    v_mfma_f32_16x16x32_bf16 v[64:67], v[16:19], a[128:131], v[64:67]
    v_mfma_f32_16x16x32_bf16 v[68:71], v[16:19], a[132:135], v[68:71]
    v_mfma_f32_16x16x32_bf16 v[72:75], v[16:19], a[136:139], v[72:75]
    v_mfma_f32_16x16x32_bf16 v[76:79], v[16:19], a[140:143], v[76:79]
    ds_read_b128 v[16:19], v8 offset:45056
    s_waitcnt lgkmcnt(7)
    v_mfma_f32_16x16x32_bf16 v[64:67], v[20:23], a[144:147], v[64:67]
    v_mfma_f32_16x16x32_bf16 v[68:71], v[20:23], a[148:151], v[68:71]
    v_mfma_f32_16x16x32_bf16 v[72:75], v[20:23], a[152:155], v[72:75]
    v_mfma_f32_16x16x32_bf16 v[76:79], v[20:23], a[156:159], v[76:79]
    ds_read_b128 v[20:23], v8 offset:46080
    s_waitcnt lgkmcnt(7)
    v_mfma_f32_16x16x32_bf16 v[64:67], v[24:27], a[160:163], v[64:67]
    v_mfma_f32_16x16x32_bf16 v[68:71], v[24:27], a[164:167], v[68:71]
    v_mfma_f32_16x16x32_bf16 v[72:75], v[24:27], a[168:171], v[72:75]
    v_mfma_f32_16x16x32_bf16 v[76:79], v[24:27], a[172:175], v[76:79]
    s_add_u32 m0, s24, 12288
    s_add_u32 s20, s16, 12288
    s_addc_u32 s21, s17, 0
    global_load_lds_dwordx4 v6, s[20:21]
    ds_read_b128 v[24:27], v8 offset:47104
    s_waitcnt lgkmcnt(7)
    v_mfma_f32_16x16x32_bf16 v[64:67], v[28:31], a[176:179], v[64:67]
    v_mfma_f32_16x16x32_bf16 v[68:71], v[28:31], a[180:183], v[68:71]
    v_mfma_f32_16x16x32_bf16 v[72:75], v[28:31], a[184:187], v[72:75]
    v_mfma_f32_16x16x32_bf16 v[76:79], v[28:31], a[188:191], v[76:79]
    ds_read_b128 v[28:31], v8 offset:48128
    s_waitcnt lgkmcnt(7)
    v_mfma_f32_16x16x32_bf16 v[64:67], v[32:35], a[192:195], v[64:67]
    v_mfma_f32_16x16x32_bf16 v[68:71], v[32:35], a[196:199], v[68:71]
    v_mfma_f32_16x16x32_bf16 v[72:75], v[32:35], a[200:203], v[72:75]
    v_mfma_f32_16x16x32_bf16 v[76:79], v[32:35], a[204:207], v[76:79]
    ds_read_b128 v[32:35], v8 offset:49152
    s_waitcnt lgkmcnt(7)
    v_mfma_f32_16x16x32_bf16 v[64:67], v[36:39], a[208:211], v[64:67]
    v_mfma_f32_16x16x32_bf16 v[68:71], v[36:39], a[212:215], v[68:71]
    v_mfma_f32_16x16x32_bf16 v[72:75], v[36:39], a[216:219], v[72:75]
    v_mfma_f32_16x16x32_bf16 v[76:79], v[36:39], a[220:223], v[76:79]
    s_add_u32 m0, s24, 16384
    s_add_u32 s20, s16, 16384
    s_addc_u32 s21, s17, 0
    global_load_lds_dwordx4 v6, s[20:21]
    s_nop 7
    v_cvt_pk_bf16_f32 v80, v48, v64
    v_cvt_pk_bf16_f32 v81, v49, v65
    v_cvt_pk_bf16_f32 v82, v50, v66
    v_cvt_pk_bf16_f32 v83, v51, v67
    s_add_u32 s22, s18, 7168
    s_addc_u32 s23, s19, 0
    global_store_dwordx4 v8, v[80:83], s[22:23] sc1
    v_cvt_pk_bf16_f32 v84, v52, v68
    v_cvt_pk_bf16_f32 v85, v53, v69
    v_cvt_pk_bf16_f32 v86, v54, v70
    v_cvt_pk_bf16_f32 v87, v55, v71
    s_add_u32 s22, s18, 10752
    s_addc_u32 s23, s19, 0
    global_store_dwordx4 v8, v[84:87], s[22:23] sc1
    v_cvt_pk_bf16_f32 v88, v56, v72
    v_cvt_pk_bf16_f32 v89, v57, v73
    v_cvt_pk_bf16_f32 v90, v58, v74
    v_cvt_pk_bf16_f32 v91, v59, v75
    s_add_u32 s22, s18, 465920
    s_addc_u32 s23, s19, 0
    global_store_dwordx4 v8, v[88:91], s[22:23] sc1
    v_cvt_pk_bf16_f32 v92, v60, v76
    v_cvt_pk_bf16_f32 v93, v61, v77
    v_cvt_pk_bf16_f32 v94, v62, v78
    v_cvt_pk_bf16_f32 v95, v63, v79
    s_add_u32 s22, s18, 469504
    s_addc_u32 s23, s19, 0
    global_store_dwordx4 v8, v[92:95], s[22:23] sc1
    ds_read_b128 v[36:39], v8 offset:50176
    s_waitcnt lgkmcnt(7)
    v_mfma_f32_16x16x32_bf16 v[48:51], v[40:43], a[0:3], 0
    v_mfma_f32_16x16x32_bf16 v[52:55], v[40:43], a[4:7], 0
    v_mfma_f32_16x16x32_bf16 v[56:59], v[40:43], a[8:11], 0
    v_mfma_f32_16x16x32_bf16 v[60:63], v[40:43], a[12:15], 0
    ds_read_b128 v[40:43], v8 offset:51200
    s_waitcnt lgkmcnt(7)
    v_mfma_f32_16x16x32_bf16 v[48:51], v[44:47], a[16:19], v[48:51]
    v_mfma_f32_16x16x32_bf16 v[52:55], v[44:47], a[20:23], v[52:55]
    v_mfma_f32_16x16x32_bf16 v[56:59], v[44:47], a[24:27], v[56:59]
    v_mfma_f32_16x16x32_bf16 v[60:63], v[44:47], a[28:31], v[60:63]
    ds_read_b128 v[44:47], v8 offset:52224
    s_waitcnt lgkmcnt(7)
    v_mfma_f32_16x16x32_bf16 v[48:51], v[16:19], a[32:35], v[48:51]
    v_mfma_f32_16x16x32_bf16 v[52:55], v[16:19], a[36:39], v[52:55]
    v_mfma_f32_16x16x32_bf16 v[56:59], v[16:19], a[40:43], v[56:59]
    v_mfma_f32_16x16x32_bf16 v[60:63], v[16:19], a[44:47], v[60:63]
    s_add_u32 m0, s24, 20480
    s_add_u32 s20, s16, 20480
    s_addc_u32 s21, s17, 0
    global_load_lds_dwordx4 v6, s[20:21]
    ds_read_b128 v[16:19], v8 offset:53248
    s_waitcnt lgkmcnt(7)
    v_mfma_f32_16x16x32_bf16 v[48:51], v[20:23], a[48:51], v[48:51]
    v_mfma_f32_16x16x32_bf16 v[52:55], v[20:23], a[52:55], v[52:55]
    v_mfma_f32_16x16x32_bf16 v[56:59], v[20:23], a[56:59], v[56:59]
    v_mfma_f32_16x16x32_bf16 v[60:63], v[20:23], a[60:63], v[60:63]
    ds_read_b128 v[20:23], v8 offset:54272
    s_waitcnt lgkmcnt(7)
    v_mfma_f32_16x16x32_bf16 v[48:51], v[24:27], a[64:67], v[48:51]
    v_mfma_f32_16x16x32_bf16 v[52:55], v[24:27], a[68:71], v[52:55]
    v_mfma_f32_16x16x32_bf16 v[56:59], v[24:27], a[72:75], v[56:59]
    v_mfma_f32_16x16x32_bf16 v[60:63], v[24:27], a[76:79], v[60:63]
    ds_read_b128 v[24:27], v8 offset:55296
    s_waitcnt lgkmcnt(7)
    v_mfma_f32_16x16x32_bf16 v[48:51], v[28:31], a[80:83], v[48:51]
    v_mfma_f32_16x16x32_bf16 v[52:55], v[28:31], a[84:87], v[52:55]
    v_mfma_f32_16x16x32_bf16 v[56:59], v[28:31], a[88:91], v[56:59]
    v_mfma_f32_16x16x32_bf16 v[60:63], v[28:31], a[92:95], v[60:63]
    s_add_u32 m0, s24, 24576
    s_add_u32 s20, s16, 24576
    s_addc_u32 s21, s17, 0
    global_load_lds_dwordx4 v6, s[20:21]
    s_add_u32 s16, s16, s13
    s_addc_u32 s17, s17, 0
    ds_read_b128 v[28:31], v8 offset:56320
    s_waitcnt lgkmcnt(7)
    v_mfma_f32_16x16x32_bf16 v[48:51], v[32:35], a[96:99], v[48:51]
    v_mfma_f32_16x16x32_bf16 v[52:55], v[32:35], a[100:103], v[52:55]
    v_mfma_f32_16x16x32_bf16 v[56:59], v[32:35], a[104:107], v[56:59]
    v_mfma_f32_16x16x32_bf16 v[60:63], v[32:35], a[108:111], v[60:63]
    s_waitcnt lgkmcnt(6)
    v_mfma_f32_16x16x32_bf16 v[48:51], v[36:39], a[112:115], v[48:51]
    v_mfma_f32_16x16x32_bf16 v[52:55], v[36:39], a[116:119], v[52:55]
    v_mfma_f32_16x16x32_bf16 v[56:59], v[36:39], a[120:123], v[56:59]
    v_mfma_f32_16x16x32_bf16 v[60:63], v[36:39], a[124:127], v[60:63]
    s_waitcnt lgkmcnt(5)
    v_mfma_f32_16x16x32_bf16 v[48:51], v[40:43], a[128:131], v[48:51]
    v_mfma_f32_16x16x32_bf16 v[52:55], v[40:43], a[132:135], v[52:55]
    v_mfma_f32_16x16x32_bf16 v[56:59], v[40:43], a[136:139], v[56:59]
    v_mfma_f32_16x16x32_bf16 v[60:63], v[40:43], a[140:143], v[60:63]
    s_waitcnt lgkmcnt(4)
    v_mfma_f32_16x16x32_bf16 v[48:51], v[44:47], a[144:147], v[48:51]
    v_mfma_f32_16x16x32_bf16 v[52:55], v[44:47], a[148:151], v[52:55]
    v_mfma_f32_16x16x32_bf16 v[56:59], v[44:47], a[152:155], v[56:59]
    v_mfma_f32_16x16x32_bf16 v[60:63], v[44:47], a[156:159], v[60:63]
    s_waitcnt lgkmcnt(3)
    v_mfma_f32_16x16x32_bf16 v[48:51], v[16:19], a[160:163], v[48:51]
    v_mfma_f32_16x16x32_bf16 v[52:55], v[16:19], a[164:167], v[52:55]
    v_mfma_f32_16x16x32_bf16 v[56:59], v[16:19], a[168:171], v[56:59]
    v_mfma_f32_16x16x32_bf16 v[60:63], v[16:19], a[172:175], v[60:63]
    s_waitcnt lgkmcnt(2)
    v_mfma_f32_16x16x32_bf16 v[48:51], v[20:23], a[176:179], v[48:51]
    v_mfma_f32_16x16x32_bf16 v[52:55], v[20:23], a[180:183], v[52:55]
    v_mfma_f32_16x16x32_bf16 v[56:59], v[20:23], a[184:187], v[56:59]
    v_mfma_f32_16x16x32_bf16 v[60:63], v[20:23], a[188:191], v[60:63]
    s_waitcnt lgkmcnt(1)
    v_mfma_f32_16x16x32_bf16 v[48:51], v[24:27], a[192:195], v[48:51]
    v_mfma_f32_16x16x32_bf16 v[52:55], v[24:27], a[196:199], v[52:55]
    v_mfma_f32_16x16x32_bf16 v[56:59], v[24:27], a[200:203], v[56:59]
    v_mfma_f32_16x16x32_bf16 v[60:63], v[24:27], a[204:207], v[60:63]
    s_waitcnt lgkmcnt(0)
    v_mfma_f32_16x16x32_bf16 v[48:51], v[28:31], a[208:211], v[48:51]
    v_mfma_f32_16x16x32_bf16 v[52:55], v[28:31], a[212:215], v[52:55]
    v_mfma_f32_16x16x32_bf16 v[56:59], v[28:31], a[216:219], v[56:59]
    v_mfma_f32_16x16x32_bf16 v[60:63], v[28:31], a[220:223], v[60:63]
    s_waitcnt vmcnt(11)
    s_barrier
    ds_read_b128 v[16:19], v13 offset:0
    ds_read_b128 v[20:23], v13 offset:1024
    ds_read_b128 v[24:27], v13 offset:2048
    ds_read_b128 v[28:31], v13 offset:3072
    ds_read_b128 v[32:35], v13 offset:4096
    ds_read_b128 v[36:39], v13 offset:5120
    ds_read_b128 v[40:43], v13 offset:6144
    ds_read_b128 v[44:47], v13 offset:7168
    s_waitcnt lgkmcnt(7)
    v_mfma_f32_16x16x32_bf16 v[64:67], v[16:19], a[0:3], 0
    v_mfma_f32_16x16x32_bf16 v[68:71], v[16:19], a[4:7], 0
    v_mfma_f32_16x16x32_bf16 v[72:75], v[16:19], a[8:11], 0
    v_mfma_f32_16x16x32_bf16 v[76:79], v[16:19], a[12:15], 0
    ds_read_b128 v[16:19], v13 offset:8192
    s_waitcnt lgkmcnt(7)
    v_mfma_f32_16x16x32_bf16 v[64:67], v[20:23], a[16:19], v[64:67]
    v_mfma_f32_16x16x32_bf16 v[68:71], v[20:23], a[20:23], v[68:71]
    v_mfma_f32_16x16x32_bf16 v[72:75], v[20:23], a[24:27], v[72:75]
    v_mfma_f32_16x16x32_bf16 v[76:79], v[20:23], a[28:31], v[76:79]
    ds_read_b128 v[20:23], v13 offset:9216
    s_waitcnt lgkmcnt(7)
    v_mfma_f32_16x16x32_bf16 v[64:67], v[24:27], a[32:35], v[64:67]
    v_mfma_f32_16x16x32_bf16 v[68:71], v[24:27], a[36:39], v[68:71]
    v_mfma_f32_16x16x32_bf16 v[72:75], v[24:27], a[40:43], v[72:75]
    v_mfma_f32_16x16x32_bf16 v[76:79], v[24:27], a[44:47], v[76:79]
    ds_read_b128 v[24:27], v13 offset:10240
    s_waitcnt lgkmcnt(7)
    v_mfma_f32_16x16x32_bf16 v[64:67], v[28:31], a[48:51], v[64:67]
    v_mfma_f32_16x16x32_bf16 v[68:71], v[28:31], a[52:55], v[68:71]
    v_mfma_f32_16x16x32_bf16 v[72:75], v[28:31], a[56:59], v[72:75]
    v_mfma_f32_16x16x32_bf16 v[76:79], v[28:31], a[60:63], v[76:79]
    ds_read_b128 v[28:31], v13 offset:11264
    s_waitcnt lgkmcnt(7)
    v_mfma_f32_16x16x32_bf16 v[64:67], v[32:35], a[64:67], v[64:67]
    v_mfma_f32_16x16x32_bf16 v[68:71], v[32:35], a[68:71], v[68:71]
    v_mfma_f32_16x16x32_bf16 v[72:75], v[32:35], a[72:75], v[72:75]
    v_mfma_f32_16x16x32_bf16 v[76:79], v[32:35], a[76:79], v[76:79]
    ds_read_b128 v[32:35], v13 offset:12288
    s_waitcnt lgkmcnt(7)
    v_mfma_f32_16x16x32_bf16 v[64:67], v[36:39], a[80:83], v[64:67]
    v_mfma_f32_16x16x32_bf16 v[68:71], v[36:39], a[84:87], v[68:71]
    v_mfma_f32_16x16x32_bf16 v[72:75], v[36:39], a[88:91], v[72:75]
    v_mfma_f32_16x16x32_bf16 v[76:79], v[36:39], a[92:95], v[76:79]
    ds_read_b128 v[36:39], v13 offset:13312
    s_waitcnt lgkmcnt(7)
    v_mfma_f32_16x16x32_bf16 v[64:67], v[40:43], a[96:99], v[64:67]
    v_mfma_f32_16x16x32_bf16 v[68:71], v[40:43], a[100:103], v[68:71]
    v_mfma_f32_16x16x32_bf16 v[72:75], v[40:43], a[104:107], v[72:75]
    v_mfma_f32_16x16x32_bf16 v[76:79], v[40:43], a[108:111], v[76:79]
    ds_read_b128 v[40:43], v13 offset:14336
    s_waitcnt lgkmcnt(7)
    v_mfma_f32_16x16x32_bf16 v[64:67], v[44:47], a[112:115], v[64:67]
    v_mfma_f32_16x16x32_bf16 v[68:71], v[44:47], a[116:119], v[68:71]
    v_mfma_f32_16x16x32_bf16 v[72:75], v[44:47], a[120:123], v[72:75]
    v_mfma_f32_16x16x32_bf16 v[76:79], v[44:47], a[124:127], v[76:79]
    ds_read_b128 v[44:47], v13 offset:15360
    s_waitcnt lgkmcnt(7)
    v_mfma_f32_16x16x32_bf16 v[64:67], v[16:19], a[128:131], v[64:67]
    v_mfma_f32_16x16x32_bf16 v[68:71], v[16:19], a[132:135], v[68:71]
    v_mfma_f32_16x16x32_bf16 v[72:75], v[16:19], a[136:139], v[72:75]
    v_mfma_f32_16x16x32_bf16 v[76:79], v[16:19], a[140:143], v[76:79]
    ds_read_b128 v[16:19], v13 offset:16384
    s_waitcnt lgkmcnt(7)
    v_mfma_f32_16x16x32_bf16 v[64:67], v[20:23], a[144:147], v[64:67]
    v_mfma_f32_16x16x32_bf16 v[68:71], v[20:23], a[148:151], v[68:71]
    v_mfma_f32_16x16x32_bf16 v[72:75], v[20:23], a[152:155], v[72:75]
    v_mfma_f32_16x16x32_bf16 v[76:79], v[20:23], a[156:159], v[76:79]
    ds_read_b128 v[20:23], v13 offset:17408
    s_waitcnt lgkmcnt(7)
    v_mfma_f32_16x16x32_bf16 v[64:67], v[24:27], a[160:163], v[64:67]
    v_mfma_f32_16x16x32_bf16 v[68:71], v[24:27], a[164:167], v[68:71]
    v_mfma_f32_16x16x32_bf16 v[72:75], v[24:27], a[168:171], v[72:75]
    v_mfma_f32_16x16x32_bf16 v[76:79], v[24:27], a[172:175], v[76:79]
    ds_read_b128 v[24:27], v13 offset:18432
    s_waitcnt lgkmcnt(7)
    v_mfma_f32_16x16x32_bf16 v[64:67], v[28:31], a[176:179], v[64:67]
    v_mfma_f32_16x16x32_bf16 v[68:71], v[28:31], a[180:183], v[68:71]
    v_mfma_f32_16x16x32_bf16 v[72:75], v[28:31], a[184:187], v[72:75]
    v_mfma_f32_16x16x32_bf16 v[76:79], v[28:31], a[188:191], v[76:79]
    ds_read_b128 v[28:31], v13 offset:19456
    s_waitcnt lgkmcnt(7)
    v_mfma_f32_16x16x32_bf16 v[64:67], v[32:35], a[192:195], v[64:67]
    v_mfma_f32_16x16x32_bf16 v[68:71], v[32:35], a[196:199], v[68:71]
    v_mfma_f32_16x16x32_bf16 v[72:75], v[32:35], a[200:203], v[72:75]
    v_mfma_f32_16x16x32_bf16 v[76:79], v[32:35], a[204:207], v[76:79]
    ds_read_b128 v[32:35], v13 offset:20480
    s_waitcnt lgkmcnt(7)
    v_mfma_f32_16x16x32_bf16 v[64:67], v[36:39], a[208:211], v[64:67]
    v_mfma_f32_16x16x32_bf16 v[68:71], v[36:39], a[212:215], v[68:71]
    v_mfma_f32_16x16x32_bf16 v[72:75], v[36:39], a[216:219], v[72:75]
    v_mfma_f32_16x16x32_bf16 v[76:79], v[36:39], a[220:223], v[76:79]
    s_nop 7
    v_cvt_pk_bf16_f32 v80, v48, v64
    v_cvt_pk_bf16_f32 v81, v49, v65
    v_cvt_pk_bf16_f32 v82, v50, v66
    v_cvt_pk_bf16_f32 v83, v51, v67
    s_add_u32 s22, s18, 8192
    s_addc_u32 s23, s19, 0
    global_store_dwordx4 v8, v[80:83], s[22:23] sc1
    v_cvt_pk_bf16_f32 v84, v52, v68
    v_cvt_pk_bf16_f32 v85, v53, v69
    v_cvt_pk_bf16_f32 v86, v54, v70
    v_cvt_pk_bf16_f32 v87, v55, v71
    s_add_u32 s22, s18, 11776
    s_addc_u32 s23, s19, 0
    global_store_dwordx4 v8, v[84:87], s[22:23] sc1
    v_cvt_pk_bf16_f32 v88, v56, v72
    v_cvt_pk_bf16_f32 v89, v57, v73
    v_cvt_pk_bf16_f32 v90, v58, v74
    v_cvt_pk_bf16_f32 v91, v59, v75
    s_add_u32 s22, s18, 466944
    s_addc_u32 s23, s19, 0
    global_store_dwordx4 v8, v[88:91], s[22:23] sc1
    v_cvt_pk_bf16_f32 v92, v60, v76
    v_cvt_pk_bf16_f32 v93, v61, v77
    v_cvt_pk_bf16_f32 v94, v62, v78
    v_cvt_pk_bf16_f32 v95, v63, v79
    s_add_u32 s22, s18, 470528
    s_addc_u32 s23, s19, 0
    global_store_dwordx4 v8, v[92:95], s[22:23] sc1
    ds_read_b128 v[36:39], v13 offset:21504
    s_waitcnt lgkmcnt(7)
    v_mfma_f32_16x16x32_bf16 v[48:51], v[40:43], a[0:3], 0
    v_mfma_f32_16x16x32_bf16 v[52:55], v[40:43], a[4:7], 0
    v_mfma_f32_16x16x32_bf16 v[56:59], v[40:43], a[8:11], 0
    v_mfma_f32_16x16x32_bf16 v[60:63], v[40:43], a[12:15], 0
    ds_read_b128 v[40:43], v13 offset:22528
    s_waitcnt lgkmcnt(7)
    v_mfma_f32_16x16x32_bf16 v[48:51], v[44:47], a[16:19], v[48:51]
    v_mfma_f32_16x16x32_bf16 v[52:55], v[44:47], a[20:23], v[52:55]
    v_mfma_f32_16x16x32_bf16 v[56:59], v[44:47], a[24:27], v[56:59]
    v_mfma_f32_16x16x32_bf16 v[60:63], v[44:47], a[28:31], v[60:63]
    ds_read_b128 v[44:47], v13 offset:23552
    s_waitcnt lgkmcnt(7)
    v_mfma_f32_16x16x32_bf16 v[48:51], v[16:19], a[32:35], v[48:51]
    v_mfma_f32_16x16x32_bf16 v[52:55], v[16:19], a[36:39], v[52:55]
    v_mfma_f32_16x16x32_bf16 v[56:59], v[16:19], a[40:43], v[56:59]
    v_mfma_f32_16x16x32_bf16 v[60:63], v[16:19], a[44:47], v[60:63]
    ds_read_b128 v[16:19], v13 offset:24576
    s_waitcnt lgkmcnt(7)
    v_mfma_f32_16x16x32_bf16 v[48:51], v[20:23], a[48:51], v[48:51]
    v_mfma_f32_16x16x32_bf16 v[52:55], v[20:23], a[52:55], v[52:55]
    v_mfma_f32_16x16x32_bf16 v[56:59], v[20:23], a[56:59], v[56:59]
    v_mfma_f32_16x16x32_bf16 v[60:63], v[20:23], a[60:63], v[60:63]
    ds_read_b128 v[20:23], v13 offset:25600
    s_waitcnt lgkmcnt(7)
    v_mfma_f32_16x16x32_bf16 v[48:51], v[24:27], a[64:67], v[48:51]
    v_mfma_f32_16x16x32_bf16 v[52:55], v[24:27], a[68:71], v[52:55]
    v_mfma_f32_16x16x32_bf16 v[56:59], v[24:27], a[72:75], v[56:59]
    v_mfma_f32_16x16x32_bf16 v[60:63], v[24:27], a[76:79], v[60:63]
    ds_read_b128 v[24:27], v13 offset:26624
    s_waitcnt lgkmcnt(7)
    v_mfma_f32_16x16x32_bf16 v[48:51], v[28:31], a[80:83], v[48:51]
    v_mfma_f32_16x16x32_bf16 v[52:55], v[28:31], a[84:87], v[52:55]
    v_mfma_f32_16x16x32_bf16 v[56:59], v[28:31], a[88:91], v[56:59]
    v_mfma_f32_16x16x32_bf16 v[60:63], v[28:31], a[92:95], v[60:63]
    ds_read_b128 v[28:31], v13 offset:27648
    s_waitcnt lgkmcnt(7)
    v_mfma_f32_16x16x32_bf16 v[48:51], v[32:35], a[96:99], v[48:51]
    v_mfma_f32_16x16x32_bf16 v[52:55], v[32:35], a[100:103], v[52:55]
    v_mfma_f32_16x16x32_bf16 v[56:59], v[32:35], a[104:107], v[56:59]
    v_mfma_f32_16x16x32_bf16 v[60:63], v[32:35], a[108:111], v[60:63]
    s_waitcnt lgkmcnt(6)
    v_mfma_f32_16x16x32_bf16 v[48:51], v[36:39], a[112:115], v[48:51]
    v_mfma_f32_16x16x32_bf16 v[52:55], v[36:39], a[116:119], v[52:55]
    v_mfma_f32_16x16x32_bf16 v[56:59], v[36:39], a[120:123], v[56:59]
    v_mfma_f32_16x16x32_bf16 v[60:63], v[36:39], a[124:127], v[60:63]
    s_waitcnt lgkmcnt(5)
    v_mfma_f32_16x16x32_bf16 v[48:51], v[40:43], a[128:131], v[48:51]
    v_mfma_f32_16x16x32_bf16 v[52:55], v[40:43], a[132:135], v[52:55]
    v_mfma_f32_16x16x32_bf16 v[56:59], v[40:43], a[136:139], v[56:59]
    v_mfma_f32_16x16x32_bf16 v[60:63], v[40:43], a[140:143], v[60:63]
    s_waitcnt lgkmcnt(4)
    v_mfma_f32_16x16x32_bf16 v[48:51], v[44:47], a[144:147], v[48:51]
    v_mfma_f32_16x16x32_bf16 v[52:55], v[44:47], a[148:151], v[52:55]
    v_mfma_f32_16x16x32_bf16 v[56:59], v[44:47], a[152:155], v[56:59]
    v_mfma_f32_16x16x32_bf16 v[60:63], v[44:47], a[156:159], v[60:63]
    s_waitcnt lgkmcnt(3)
    v_mfma_f32_16x16x32_bf16 v[48:51], v[16:19], a[160:163], v[48:51]
    v_mfma_f32_16x16x32_bf16 v[52:55], v[16:19], a[164:167], v[52:55]
    v_mfma_f32_16x16x32_bf16 v[56:59], v[16:19], a[168:171], v[56:59]
    v_mfma_f32_16x16x32_bf16 v[60:63], v[16:19], a[172:175], v[60:63]
    s_waitcnt lgkmcnt(2)
    v_mfma_f32_16x16x32_bf16 v[48:51], v[20:23], a[176:179], v[48:51]
    v_mfma_f32_16x16x32_bf16 v[52:55], v[20:23], a[180:183], v[52:55]
    v_mfma_f32_16x16x32_bf16 v[56:59], v[20:23], a[184:187], v[56:59]
    v_mfma_f32_16x16x32_bf16 v[60:63], v[20:23], a[188:191], v[60:63]
    s_waitcnt lgkmcnt(1)
    v_mfma_f32_16x16x32_bf16 v[48:51], v[24:27], a[192:195], v[48:51]
    v_mfma_f32_16x16x32_bf16 v[52:55], v[24:27], a[196:199], v[52:55]
    v_mfma_f32_16x16x32_bf16 v[56:59], v[24:27], a[200:203], v[56:59]
    v_mfma_f32_16x16x32_bf16 v[60:63], v[24:27], a[204:207], v[60:63]
    s_waitcnt lgkmcnt(0)
    v_mfma_f32_16x16x32_bf16 v[48:51], v[28:31], a[208:211], v[48:51]
    v_mfma_f32_16x16x32_bf16 v[52:55], v[28:31], a[212:215], v[52:55]
    v_mfma_f32_16x16x32_bf16 v[56:59], v[28:31], a[216:219], v[56:59]
    v_mfma_f32_16x16x32_bf16 v[60:63], v[28:31], a[220:223], v[60:63]
    s_waitcnt vmcnt(4)
    s_barrier
    ds_read_b128 v[16:19], v8 offset:0
    ds_read_b128 v[20:23], v8 offset:1024
    ds_read_b128 v[24:27], v8 offset:2048
    ds_read_b128 v[28:31], v8 offset:3072
    ds_read_b128 v[32:35], v8 offset:4096
    ds_read_b128 v[36:39], v8 offset:5120
    ds_read_b128 v[40:43], v8 offset:6144
    ds_read_b128 v[44:47], v8 offset:7168
    s_waitcnt lgkmcnt(7)
    v_mfma_f32_16x16x32_bf16 v[64:67], v[16:19], a[0:3], 0
    v_mfma_f32_16x16x32_bf16 v[68:71], v[16:19], a[4:7], 0
    v_mfma_f32_16x16x32_bf16 v[72:75], v[16:19], a[8:11], 0
    v_mfma_f32_16x16x32_bf16 v[76:79], v[16:19], a[12:15], 0
    ds_read_b128 v[16:19], v8 offset:8192
    s_waitcnt lgkmcnt(7)
    v_mfma_f32_16x16x32_bf16 v[64:67], v[20:23], a[16:19], v[64:67]
    v_mfma_f32_16x16x32_bf16 v[68:71], v[20:23], a[20:23], v[68:71]
    v_mfma_f32_16x16x32_bf16 v[72:75], v[20:23], a[24:27], v[72:75]
    v_mfma_f32_16x16x32_bf16 v[76:79], v[20:23], a[28:31], v[76:79]
    ds_read_b128 v[20:23], v8 offset:9216
    s_waitcnt lgkmcnt(7)
    v_mfma_f32_16x16x32_bf16 v[64:67], v[24:27], a[32:35], v[64:67]
    v_mfma_f32_16x16x32_bf16 v[68:71], v[24:27], a[36:39], v[68:71]
    v_mfma_f32_16x16x32_bf16 v[72:75], v[24:27], a[40:43], v[72:75]
    v_mfma_f32_16x16x32_bf16 v[76:79], v[24:27], a[44:47], v[76:79]
    ds_read_b128 v[24:27], v8 offset:10240
    s_waitcnt lgkmcnt(7)
    v_mfma_f32_16x16x32_bf16 v[64:67], v[28:31], a[48:51], v[64:67]
    v_mfma_f32_16x16x32_bf16 v[68:71], v[28:31], a[52:55], v[68:71]
    v_mfma_f32_16x16x32_bf16 v[72:75], v[28:31], a[56:59], v[72:75]
    v_mfma_f32_16x16x32_bf16 v[76:79], v[28:31], a[60:63], v[76:79]
    ds_read_b128 v[28:31], v8 offset:11264
    s_waitcnt lgkmcnt(7)
    v_mfma_f32_16x16x32_bf16 v[64:67], v[32:35], a[64:67], v[64:67]
    v_mfma_f32_16x16x32_bf16 v[68:71], v[32:35], a[68:71], v[68:71]
    v_mfma_f32_16x16x32_bf16 v[72:75], v[32:35], a[72:75], v[72:75]
    v_mfma_f32_16x16x32_bf16 v[76:79], v[32:35], a[76:79], v[76:79]
    ds_read_b128 v[32:35], v8 offset:12288
    s_waitcnt lgkmcnt(7)
    v_mfma_f32_16x16x32_bf16 v[64:67], v[36:39], a[80:83], v[64:67]
    v_mfma_f32_16x16x32_bf16 v[68:71], v[36:39], a[84:87], v[68:71]
    v_mfma_f32_16x16x32_bf16 v[72:75], v[36:39], a[88:91], v[72:75]
    v_mfma_f32_16x16x32_bf16 v[76:79], v[36:39], a[92:95], v[76:79]
    ds_read_b128 v[36:39], v8 offset:13312
    s_waitcnt lgkmcnt(7)
    v_mfma_f32_16x16x32_bf16 v[64:67], v[40:43], a[96:99], v[64:67]
    v_mfma_f32_16x16x32_bf16 v[68:71], v[40:43], a[100:103], v[68:71]
    v_mfma_f32_16x16x32_bf16 v[72:75], v[40:43], a[104:107], v[72:75]
    v_mfma_f32_16x16x32_bf16 v[76:79], v[40:43], a[108:111], v[76:79]
    ds_read_b128 v[40:43], v8 offset:14336
    s_waitcnt lgkmcnt(7)
    v_mfma_f32_16x16x32_bf16 v[64:67], v[44:47], a[112:115], v[64:67]
    v_mfma_f32_16x16x32_bf16 v[68:71], v[44:47], a[116:119], v[68:71]
    v_mfma_f32_16x16x32_bf16 v[72:75], v[44:47], a[120:123], v[72:75]
    v_mfma_f32_16x16x32_bf16 v[76:79], v[44:47], a[124:127], v[76:79]
    ds_read_b128 v[44:47], v8 offset:15360
    s_waitcnt lgkmcnt(7)
    v_mfma_f32_16x16x32_bf16 v[64:67], v[16:19], a[128:131], v[64:67]
    v_mfma_f32_16x16x32_bf16 v[68:71], v[16:19], a[132:135], v[68:71]
    v_mfma_f32_16x16x32_bf16 v[72:75], v[16:19], a[136:139], v[72:75]
    v_mfma_f32_16x16x32_bf16 v[76:79], v[16:19], a[140:143], v[76:79]
    ds_read_b128 v[16:19], v8 offset:16384
    s_waitcnt lgkmcnt(7)
    v_mfma_f32_16x16x32_bf16 v[64:67], v[20:23], a[144:147], v[64:67]
    v_mfma_f32_16x16x32_bf16 v[68:71], v[20:23], a[148:151], v[68:71]
    v_mfma_f32_16x16x32_bf16 v[72:75], v[20:23], a[152:155], v[72:75]
    v_mfma_f32_16x16x32_bf16 v[76:79], v[20:23], a[156:159], v[76:79]
    ds_read_b128 v[20:23], v8 offset:17408
    s_waitcnt lgkmcnt(7)
    v_mfma_f32_16x16x32_bf16 v[64:67], v[24:27], a[160:163], v[64:67]
    v_mfma_f32_16x16x32_bf16 v[68:71], v[24:27], a[164:167], v[68:71]
    v_mfma_f32_16x16x32_bf16 v[72:75], v[24:27], a[168:171], v[72:75]
    v_mfma_f32_16x16x32_bf16 v[76:79], v[24:27], a[172:175], v[76:79]
    ds_read_b128 v[24:27], v8 offset:18432
    s_waitcnt lgkmcnt(7)
    v_mfma_f32_16x16x32_bf16 v[64:67], v[28:31], a[176:179], v[64:67]
    v_mfma_f32_16x16x32_bf16 v[68:71], v[28:31], a[180:183], v[68:71]
    v_mfma_f32_16x16x32_bf16 v[72:75], v[28:31], a[184:187], v[72:75]
    v_mfma_f32_16x16x32_bf16 v[76:79], v[28:31], a[188:191], v[76:79]
    ds_read_b128 v[28:31], v8 offset:19456
    s_waitcnt lgkmcnt(7)
    v_mfma_f32_16x16x32_bf16 v[64:67], v[32:35], a[192:195], v[64:67]
    v_mfma_f32_16x16x32_bf16 v[68:71], v[32:35], a[196:199], v[68:71]
    v_mfma_f32_16x16x32_bf16 v[72:75], v[32:35], a[200:203], v[72:75]
    v_mfma_f32_16x16x32_bf16 v[76:79], v[32:35], a[204:207], v[76:79]
    ds_read_b128 v[32:35], v8 offset:20480
    s_waitcnt lgkmcnt(7)
    v_mfma_f32_16x16x32_bf16 v[64:67], v[36:39], a[208:211], v[64:67]
    v_mfma_f32_16x16x32_bf16 v[68:71], v[36:39], a[212:215], v[68:71]
    v_mfma_f32_16x16x32_bf16 v[72:75], v[36:39], a[216:219], v[72:75]
    v_mfma_f32_16x16x32_bf16 v[76:79], v[36:39], a[220:223], v[76:79]
    s_nop 7
    v_cvt_pk_bf16_f32 v80, v48, v64
    v_cvt_pk_bf16_f32 v81, v49, v65
    v_cvt_pk_bf16_f32 v82, v50, v66
    v_cvt_pk_bf16_f32 v83, v51, v67
    s_add_u32 s22, s18, 9216
    s_addc_u32 s23, s19, 0
    global_store_dwordx4 v8, v[80:83], s[22:23] sc1
    v_cvt_pk_bf16_f32 v84, v52, v68
    v_cvt_pk_bf16_f32 v85, v53, v69
    v_cvt_pk_bf16_f32 v86, v54, v70
    v_cvt_pk_bf16_f32 v87, v55, v71
    s_add_u32 s22, s18, 12800
    s_addc_u32 s23, s19, 0
    global_store_dwordx4 v8, v[84:87], s[22:23] sc1
    v_cvt_pk_bf16_f32 v88, v56, v72
    v_cvt_pk_bf16_f32 v89, v57, v73
    v_cvt_pk_bf16_f32 v90, v58, v74
    v_cvt_pk_bf16_f32 v91, v59, v75
    s_add_u32 s22, s18, 467968
    s_addc_u32 s23, s19, 0
    global_store_dwordx4 v8, v[88:91], s[22:23] sc1
    v_cvt_pk_bf16_f32 v92, v60, v76
    v_cvt_pk_bf16_f32 v93, v61, v77
    v_cvt_pk_bf16_f32 v94, v62, v78
    v_cvt_pk_bf16_f32 v95, v63, v79
    s_add_u32 s22, s18, 471552
    s_addc_u32 s23, s19, 0
    global_store_dwordx4 v8, v[92:95], s[22:23] sc1
    ds_read_b128 v[36:39], v8 offset:21504
    s_waitcnt lgkmcnt(7)
    v_mfma_f32_16x16x32_bf16 v[48:51], v[40:43], a[0:3], 0
    v_mfma_f32_16x16x32_bf16 v[52:55], v[40:43], a[4:7], 0
    v_mfma_f32_16x16x32_bf16 v[56:59], v[40:43], a[8:11], 0
    v_mfma_f32_16x16x32_bf16 v[60:63], v[40:43], a[12:15], 0
    ds_read_b128 v[40:43], v8 offset:22528
    s_waitcnt lgkmcnt(7)
    v_mfma_f32_16x16x32_bf16 v[48:51], v[44:47], a[16:19], v[48:51]
    v_mfma_f32_16x16x32_bf16 v[52:55], v[44:47], a[20:23], v[52:55]
    v_mfma_f32_16x16x32_bf16 v[56:59], v[44:47], a[24:27], v[56:59]
    v_mfma_f32_16x16x32_bf16 v[60:63], v[44:47], a[28:31], v[60:63]
    ds_read_b128 v[44:47], v8 offset:23552
    s_waitcnt lgkmcnt(7)
    v_mfma_f32_16x16x32_bf16 v[48:51], v[16:19], a[32:35], v[48:51]
    v_mfma_f32_16x16x32_bf16 v[52:55], v[16:19], a[36:39], v[52:55]
    v_mfma_f32_16x16x32_bf16 v[56:59], v[16:19], a[40:43], v[56:59]
    v_mfma_f32_16x16x32_bf16 v[60:63], v[16:19], a[44:47], v[60:63]
    ds_read_b128 v[16:19], v8 offset:24576
    s_waitcnt lgkmcnt(7)
    v_mfma_f32_16x16x32_bf16 v[48:51], v[20:23], a[48:51], v[48:51]
    v_mfma_f32_16x16x32_bf16 v[52:55], v[20:23], a[52:55], v[52:55]
    v_mfma_f32_16x16x32_bf16 v[56:59], v[20:23], a[56:59], v[56:59]
    v_mfma_f32_16x16x32_bf16 v[60:63], v[20:23], a[60:63], v[60:63]
    ds_read_b128 v[20:23], v8 offset:25600
    s_waitcnt lgkmcnt(7)
    v_mfma_f32_16x16x32_bf16 v[48:51], v[24:27], a[64:67], v[48:51]
    v_mfma_f32_16x16x32_bf16 v[52:55], v[24:27], a[68:71], v[52:55]
    v_mfma_f32_16x16x32_bf16 v[56:59], v[24:27], a[72:75], v[56:59]
    v_mfma_f32_16x16x32_bf16 v[60:63], v[24:27], a[76:79], v[60:63]
    ds_read_b128 v[24:27], v8 offset:26624
    s_waitcnt lgkmcnt(7)
    v_mfma_f32_16x16x32_bf16 v[48:51], v[28:31], a[80:83], v[48:51]
    v_mfma_f32_16x16x32_bf16 v[52:55], v[28:31], a[84:87], v[52:55]
    v_mfma_f32_16x16x32_bf16 v[56:59], v[28:31], a[88:91], v[56:59]
    v_mfma_f32_16x16x32_bf16 v[60:63], v[28:31], a[92:95], v[60:63]
    ds_read_b128 v[28:31], v8 offset:27648
    s_waitcnt lgkmcnt(7)
    v_mfma_f32_16x16x32_bf16 v[48:51], v[32:35], a[96:99], v[48:51]
    v_mfma_f32_16x16x32_bf16 v[52:55], v[32:35], a[100:103], v[52:55]
    v_mfma_f32_16x16x32_bf16 v[56:59], v[32:35], a[104:107], v[56:59]
    v_mfma_f32_16x16x32_bf16 v[60:63], v[32:35], a[108:111], v[60:63]
    s_waitcnt lgkmcnt(6)
    v_mfma_f32_16x16x32_bf16 v[48:51], v[36:39], a[112:115], v[48:51]
    v_mfma_f32_16x16x32_bf16 v[52:55], v[36:39], a[116:119], v[52:55]
    v_mfma_f32_16x16x32_bf16 v[56:59], v[36:39], a[120:123], v[56:59]
    v_mfma_f32_16x16x32_bf16 v[60:63], v[36:39], a[124:127], v[60:63]
    s_waitcnt lgkmcnt(5)
    v_mfma_f32_16x16x32_bf16 v[48:51], v[40:43], a[128:131], v[48:51]
    v_mfma_f32_16x16x32_bf16 v[52:55], v[40:43], a[132:135], v[52:55]
    v_mfma_f32_16x16x32_bf16 v[56:59], v[40:43], a[136:139], v[56:59]
    v_mfma_f32_16x16x32_bf16 v[60:63], v[40:43], a[140:143], v[60:63]
    s_waitcnt lgkmcnt(4)
    v_mfma_f32_16x16x32_bf16 v[48:51], v[44:47], a[144:147], v[48:51]
    v_mfma_f32_16x16x32_bf16 v[52:55], v[44:47], a[148:151], v[52:55]
    v_mfma_f32_16x16x32_bf16 v[56:59], v[44:47], a[152:155], v[56:59]
    v_mfma_f32_16x16x32_bf16 v[60:63], v[44:47], a[156:159], v[60:63]
    s_waitcnt lgkmcnt(3)
    v_mfma_f32_16x16x32_bf16 v[48:51], v[16:19], a[160:163], v[48:51]
    v_mfma_f32_16x16x32_bf16 v[52:55], v[16:19], a[164:167], v[52:55]
    v_mfma_f32_16x16x32_bf16 v[56:59], v[16:19], a[168:171], v[56:59]
    v_mfma_f32_16x16x32_bf16 v[60:63], v[16:19], a[172:175], v[60:63]
    s_waitcnt lgkmcnt(2)
    v_mfma_f32_16x16x32_bf16 v[48:51], v[20:23], a[176:179], v[48:51]
    v_mfma_f32_16x16x32_bf16 v[52:55], v[20:23], a[180:183], v[52:55]
    v_mfma_f32_16x16x32_bf16 v[56:59], v[20:23], a[184:187], v[56:59]
    v_mfma_f32_16x16x32_bf16 v[60:63], v[20:23], a[188:191], v[60:63]
    s_waitcnt lgkmcnt(1)
    v_mfma_f32_16x16x32_bf16 v[48:51], v[24:27], a[192:195], v[48:51]
    v_mfma_f32_16x16x32_bf16 v[52:55], v[24:27], a[196:199], v[52:55]
    v_mfma_f32_16x16x32_bf16 v[56:59], v[24:27], a[200:203], v[56:59]
    v_mfma_f32_16x16x32_bf16 v[60:63], v[24:27], a[204:207], v[60:63]
    s_waitcnt lgkmcnt(0)
    v_mfma_f32_16x16x32_bf16 v[48:51], v[28:31], a[208:211], v[48:51]
    v_mfma_f32_16x16x32_bf16 v[52:55], v[28:31], a[212:215], v[52:55]
    v_mfma_f32_16x16x32_bf16 v[56:59], v[28:31], a[216:219], v[56:59]
    v_mfma_f32_16x16x32_bf16 v[60:63], v[28:31], a[220:223], v[60:63]
    s_nop 7
    v_cvt_pk_bf16_f32 v80, v48, v49
    v_cvt_pk_bf16_f32 v81, v50, v51
    s_add_u32 s22, s18, 10240
    s_addc_u32 s23, s19, 0
    global_store_dwordx2 v9, v[80:81], s[22:23] sc1
    v_cvt_pk_bf16_f32 v84, v52, v53
    v_cvt_pk_bf16_f32 v85, v54, v55
    s_add_u32 s22, s18, 13824
    s_addc_u32 s23, s19, 0
    global_store_dwordx2 v9, v[84:85], s[22:23] sc1
    v_cvt_pk_bf16_f32 v88, v56, v57
    v_cvt_pk_bf16_f32 v89, v58, v59
    s_add_u32 s22, s18, 468992
    s_addc_u32 s23, s19, 0
    global_store_dwordx2 v9, v[88:89], s[22:23] sc1
    v_cvt_pk_bf16_f32 v92, v60, v61
    v_cvt_pk_bf16_f32 v93, v62, v63
    s_add_u32 s22, s18, 472576
    s_addc_u32 s23, s19, 0
    global_store_dwordx2 v9, v[92:93], s[22:23] sc1
    s_branch L_task_done
L_g_Bloop:
    ds_read_b128 v[16:19], v8 offset:0
    ds_read_b128 v[20:23], v8 offset:1024
    ds_read_b128 v[24:27], v8 offset:2048
    ds_read_b128 v[28:31], v8 offset:3072
    ds_read_b128 v[32:35], v8 offset:4096
    ds_read_b128 v[36:39], v8 offset:5120
    ds_read_b128 v[40:43], v8 offset:6144
    ds_read_b128 v[44:47], v8 offset:7168
    s_waitcnt lgkmcnt(7)
    s_waitcnt vmcnt(52)
    v_mfma_f32_16x16x32_bf16 v[48:51], a[0:3], v[16:19], 0
    v_mfma_f32_16x16x32_bf16 v[52:55], a[4:7], v[16:19], 0
    v_mfma_f32_16x16x32_bf16 v[56:59], a[8:11], v[16:19], 0
    v_mfma_f32_16x16x32_bf16 v[60:63], a[12:15], v[16:19], 0
    ds_read_b128 v[16:19], v8 offset:8192
    s_waitcnt lgkmcnt(7)
    s_waitcnt vmcnt(48)
    v_mfma_f32_16x16x32_bf16 v[48:51], a[16:19], v[20:23], v[48:51]
    v_mfma_f32_16x16x32_bf16 v[52:55], a[20:23], v[20:23], v[52:55]
    v_mfma_f32_16x16x32_bf16 v[56:59], a[24:27], v[20:23], v[56:59]
    v_mfma_f32_16x16x32_bf16 v[60:63], a[28:31], v[20:23], v[60:63]
    s_add_u32 m0, s24, 57344
    s_add_u32 s20, s16, 0
    s_addc_u32 s21, s17, 0
    global_load_lds_dwordx4 v6, s[20:21]
    ds_read_b128 v[20:23], v8 offset:9216
    s_waitcnt lgkmcnt(7)
    s_waitcnt vmcnt(45)
    v_mfma_f32_16x16x32_bf16 v[48:51], a[32:35], v[24:27], v[48:51]
    v_mfma_f32_16x16x32_bf16 v[52:55], a[36:39], v[24:27], v[52:55]
    v_mfma_f32_16x16x32_bf16 v[56:59], a[40:43], v[24:27], v[56:59]
    v_mfma_f32_16x16x32_bf16 v[60:63], a[44:47], v[24:27], v[60:63]
    ds_read_b128 v[24:27], v8 offset:10240
    s_waitcnt lgkmcnt(7)
    s_waitcnt vmcnt(41)
    v_mfma_f32_16x16x32_bf16 v[48:51], a[48:51], v[28:31], v[48:51]
    v_mfma_f32_16x16x32_bf16 v[52:55], a[52:55], v[28:31], v[52:55]
    v_mfma_f32_16x16x32_bf16 v[56:59], a[56:59], v[28:31], v[56:59]
    v_mfma_f32_16x16x32_bf16 v[60:63], a[60:63], v[28:31], v[60:63]
    ds_read_b128 v[28:31], v8 offset:11264
    s_waitcnt lgkmcnt(7)
    s_waitcnt vmcnt(37)
    v_mfma_f32_16x16x32_bf16 v[48:51], a[64:67], v[32:35], v[48:51]
    v_mfma_f32_16x16x32_bf16 v[52:55], a[68:71], v[32:35], v[52:55]
    v_mfma_f32_16x16x32_bf16 v[56:59], a[72:75], v[32:35], v[56:59]
    v_mfma_f32_16x16x32_bf16 v[60:63], a[76:79], v[32:35], v[60:63]
    s_add_u32 m0, s24, 61440
    s_add_u32 s20, s16, 4096
    s_addc_u32 s21, s17, 0
    global_load_lds_dwordx4 v6, s[20:21]
    ds_read_b128 v[32:35], v8 offset:12288
    s_waitcnt lgkmcnt(7)
    s_waitcnt vmcnt(34)
    v_mfma_f32_16x16x32_bf16 v[48:51], a[80:83], v[36:39], v[48:51]
    v_mfma_f32_16x16x32_bf16 v[52:55], a[84:87], v[36:39], v[52:55]
    v_mfma_f32_16x16x32_bf16 v[56:59], a[88:91], v[36:39], v[56:59]
    v_mfma_f32_16x16x32_bf16 v[60:63], a[92:95], v[36:39], v[60:63]
    ds_read_b128 v[36:39], v8 offset:13312
    s_waitcnt lgkmcnt(7)
    s_waitcnt vmcnt(30)
    v_mfma_f32_16x16x32_bf16 v[48:51], a[96:99], v[40:43], v[48:51]
    v_mfma_f32_16x16x32_bf16 v[52:55], a[100:103], v[40:43], v[52:55]
    v_mfma_f32_16x16x32_bf16 v[56:59], a[104:107], v[40:43], v[56:59]
    v_mfma_f32_16x16x32_bf16 v[60:63], a[108:111], v[40:43], v[60:63]
    ds_read_b128 v[40:43], v8 offset:14336
    s_waitcnt lgkmcnt(7)
    s_waitcnt vmcnt(26)
    v_mfma_f32_16x16x32_bf16 v[48:51], a[112:115], v[44:47], v[48:51]
    v_mfma_f32_16x16x32_bf16 v[52:55], a[116:119], v[44:47], v[52:55]
    v_mfma_f32_16x16x32_bf16 v[56:59], a[120:123], v[44:47], v[56:59]
    v_mfma_f32_16x16x32_bf16 v[60:63], a[124:127], v[44:47], v[60:63]
    s_add_u32 m0, s24, 65536
    s_add_u32 s20, s16, 8192
    s_addc_u32 s21, s17, 0
    global_load_lds_dwordx4 v6, s[20:21]
    ds_read_b128 v[44:47], v8 offset:15360
    s_waitcnt lgkmcnt(7)
    s_waitcnt vmcnt(23)
    v_mfma_f32_16x16x32_bf16 v[48:51], a[128:131], v[16:19], v[48:51]
    v_mfma_f32_16x16x32_bf16 v[52:55], a[132:135], v[16:19], v[52:55]
    v_mfma_f32_16x16x32_bf16 v[56:59], a[136:139], v[16:19], v[56:59]
    v_mfma_f32_16x16x32_bf16 v[60:63], a[140:143], v[16:19], v[60:63]
    ds_read_b128 v[16:19], v8 offset:16384
    s_waitcnt lgkmcnt(7)
    s_waitcnt vmcnt(19)
    v_mfma_f32_16x16x32_bf16 v[48:51], a[144:147], v[20:23], v[48:51]
    v_mfma_f32_16x16x32_bf16 v[52:55], a[148:151], v[20:23], v[52:55]
    v_mfma_f32_16x16x32_bf16 v[56:59], a[152:155], v[20:23], v[56:59]
    v_mfma_f32_16x16x32_bf16 v[60:63], a[156:159], v[20:23], v[60:63]
    ds_read_b128 v[20:23], v8 offset:17408
    s_waitcnt lgkmcnt(7)
    s_waitcnt vmcnt(15)
    v_mfma_f32_16x16x32_bf16 v[48:51], a[160:163], v[24:27], v[48:51]
    v_mfma_f32_16x16x32_bf16 v[52:55], a[164:167], v[24:27], v[52:55]
    v_mfma_f32_16x16x32_bf16 v[56:59], a[168:171], v[24:27], v[56:59]
    v_mfma_f32_16x16x32_bf16 v[60:63], a[172:175], v[24:27], v[60:63]
    s_add_u32 m0, s24, 69632
    s_add_u32 s20, s16, 12288
    s_addc_u32 s21, s17, 0
    global_load_lds_dwordx4 v6, s[20:21]
    ds_read_b128 v[24:27], v8 offset:18432
    s_waitcnt lgkmcnt(7)
    s_waitcnt vmcnt(12)
    v_mfma_f32_16x16x32_bf16 v[48:51], a[176:179], v[28:31], v[48:51]
    v_mfma_f32_16x16x32_bf16 v[52:55], a[180:183], v[28:31], v[52:55]
    v_mfma_f32_16x16x32_bf16 v[56:59], a[184:187], v[28:31], v[56:59]
    v_mfma_f32_16x16x32_bf16 v[60:63], a[188:191], v[28:31], v[60:63]
    ds_read_b128 v[28:31], v8 offset:19456
    s_waitcnt lgkmcnt(7)
    s_waitcnt vmcnt(8)
    v_mfma_f32_16x16x32_bf16 v[48:51], a[192:195], v[32:35], v[48:51]
    v_mfma_f32_16x16x32_bf16 v[52:55], a[196:199], v[32:35], v[52:55]
    v_mfma_f32_16x16x32_bf16 v[56:59], a[200:203], v[32:35], v[56:59]
    v_mfma_f32_16x16x32_bf16 v[60:63], a[204:207], v[32:35], v[60:63]
    ds_read_b128 v[32:35], v8 offset:20480
    s_waitcnt lgkmcnt(7)
    s_waitcnt vmcnt(4)
    v_mfma_f32_16x16x32_bf16 v[48:51], a[208:211], v[36:39], v[48:51]
    v_mfma_f32_16x16x32_bf16 v[52:55], a[212:215], v[36:39], v[52:55]
    v_mfma_f32_16x16x32_bf16 v[56:59], a[216:219], v[36:39], v[56:59]
    v_mfma_f32_16x16x32_bf16 v[60:63], a[220:223], v[36:39], v[60:63]
    s_add_u32 m0, s24, 73728
    s_add_u32 s20, s16, 16384
    s_addc_u32 s21, s17, 0
    global_load_lds_dwordx4 v6, s[20:21]
    ds_read_b128 v[36:39], v8 offset:21504
    s_waitcnt lgkmcnt(7)
    v_mfma_f32_16x16x32_bf16 v[64:67], a[0:3], v[40:43], 0
    v_mfma_f32_16x16x32_bf16 v[68:71], a[4:7], v[40:43], 0
    v_mfma_f32_16x16x32_bf16 v[72:75], a[8:11], v[40:43], 0
    v_mfma_f32_16x16x32_bf16 v[76:79], a[12:15], v[40:43], 0
    ds_read_b128 v[40:43], v8 offset:22528
    s_waitcnt lgkmcnt(7)
    v_mfma_f32_16x16x32_bf16 v[64:67], a[16:19], v[44:47], v[64:67]
    v_mfma_f32_16x16x32_bf16 v[68:71], a[20:23], v[44:47], v[68:71]
    v_mfma_f32_16x16x32_bf16 v[72:75], a[24:27], v[44:47], v[72:75]
    v_mfma_f32_16x16x32_bf16 v[76:79], a[28:31], v[44:47], v[76:79]
    ds_read_b128 v[44:47], v8 offset:23552
    s_waitcnt lgkmcnt(7)
    v_mfma_f32_16x16x32_bf16 v[64:67], a[32:35], v[16:19], v[64:67]
    v_mfma_f32_16x16x32_bf16 v[68:71], a[36:39], v[16:19], v[68:71]
    v_mfma_f32_16x16x32_bf16 v[72:75], a[40:43], v[16:19], v[72:75]
    v_mfma_f32_16x16x32_bf16 v[76:79], a[44:47], v[16:19], v[76:79]
    s_add_u32 m0, s24, 77824
    s_add_u32 s20, s16, 20480
    s_addc_u32 s21, s17, 0
    global_load_lds_dwordx4 v6, s[20:21]
    ds_read_b128 v[16:19], v8 offset:24576
    s_waitcnt lgkmcnt(7)
    v_mfma_f32_16x16x32_bf16 v[64:67], a[48:51], v[20:23], v[64:67]
    v_mfma_f32_16x16x32_bf16 v[68:71], a[52:55], v[20:23], v[68:71]
    v_mfma_f32_16x16x32_bf16 v[72:75], a[56:59], v[20:23], v[72:75]
    v_mfma_f32_16x16x32_bf16 v[76:79], a[60:63], v[20:23], v[76:79]
    ds_read_b128 v[20:23], v8 offset:25600
    s_waitcnt lgkmcnt(7)
    v_mfma_f32_16x16x32_bf16 v[64:67], a[64:67], v[24:27], v[64:67]
    v_mfma_f32_16x16x32_bf16 v[68:71], a[68:71], v[24:27], v[68:71]
    v_mfma_f32_16x16x32_bf16 v[72:75], a[72:75], v[24:27], v[72:75]
    v_mfma_f32_16x16x32_bf16 v[76:79], a[76:79], v[24:27], v[76:79]
    ds_read_b128 v[24:27], v8 offset:26624
    s_waitcnt lgkmcnt(7)
    v_mfma_f32_16x16x32_bf16 v[64:67], a[80:83], v[28:31], v[64:67]
    v_mfma_f32_16x16x32_bf16 v[68:71], a[84:87], v[28:31], v[68:71]
    v_mfma_f32_16x16x32_bf16 v[72:75], a[88:91], v[28:31], v[72:75]
    v_mfma_f32_16x16x32_bf16 v[76:79], a[92:95], v[28:31], v[76:79]
    s_add_u32 m0, s24, 81920
    s_add_u32 s20, s16, 24576
    s_addc_u32 s21, s17, 0
    global_load_lds_dwordx4 v6, s[20:21]
    s_add_u32 s16, s16, s13
    s_addc_u32 s17, s17, 0
    ds_read_b128 v[28:31], v8 offset:27648
    s_waitcnt lgkmcnt(7)
    v_mfma_f32_16x16x32_bf16 v[64:67], a[96:99], v[32:35], v[64:67]
    v_mfma_f32_16x16x32_bf16 v[68:71], a[100:103], v[32:35], v[68:71]
    v_mfma_f32_16x16x32_bf16 v[72:75], a[104:107], v[32:35], v[72:75]
    v_mfma_f32_16x16x32_bf16 v[76:79], a[108:111], v[32:35], v[76:79]
    s_waitcnt lgkmcnt(6)
    v_mfma_f32_16x16x32_bf16 v[64:67], a[112:115], v[36:39], v[64:67]
    v_mfma_f32_16x16x32_bf16 v[68:71], a[116:119], v[36:39], v[68:71]
    v_mfma_f32_16x16x32_bf16 v[72:75], a[120:123], v[36:39], v[72:75]
    v_mfma_f32_16x16x32_bf16 v[76:79], a[124:127], v[36:39], v[76:79]
    s_waitcnt lgkmcnt(5)
    v_mfma_f32_16x16x32_bf16 v[64:67], a[128:131], v[40:43], v[64:67]
    v_mfma_f32_16x16x32_bf16 v[68:71], a[132:135], v[40:43], v[68:71]
    v_mfma_f32_16x16x32_bf16 v[72:75], a[136:139], v[40:43], v[72:75]
    v_mfma_f32_16x16x32_bf16 v[76:79], a[140:143], v[40:43], v[76:79]
    s_waitcnt lgkmcnt(4)
    v_mfma_f32_16x16x32_bf16 v[64:67], a[144:147], v[44:47], v[64:67]
    v_mfma_f32_16x16x32_bf16 v[68:71], a[148:151], v[44:47], v[68:71]
    v_mfma_f32_16x16x32_bf16 v[72:75], a[152:155], v[44:47], v[72:75]
    v_mfma_f32_16x16x32_bf16 v[76:79], a[156:159], v[44:47], v[76:79]
    s_waitcnt lgkmcnt(3)
    v_mfma_f32_16x16x32_bf16 v[64:67], a[160:163], v[16:19], v[64:67]
    v_mfma_f32_16x16x32_bf16 v[68:71], a[164:167], v[16:19], v[68:71]
    v_mfma_f32_16x16x32_bf16 v[72:75], a[168:171], v[16:19], v[72:75]
    v_mfma_f32_16x16x32_bf16 v[76:79], a[172:175], v[16:19], v[76:79]
    s_waitcnt lgkmcnt(2)
    v_mfma_f32_16x16x32_bf16 v[64:67], a[176:179], v[20:23], v[64:67]
    v_mfma_f32_16x16x32_bf16 v[68:71], a[180:183], v[20:23], v[68:71]
    v_mfma_f32_16x16x32_bf16 v[72:75], a[184:187], v[20:23], v[72:75]
    v_mfma_f32_16x16x32_bf16 v[76:79], a[188:191], v[20:23], v[76:79]
    s_waitcnt lgkmcnt(1)
    v_mfma_f32_16x16x32_bf16 v[64:67], a[192:195], v[24:27], v[64:67]
    v_mfma_f32_16x16x32_bf16 v[68:71], a[196:199], v[24:27], v[68:71]
    v_mfma_f32_16x16x32_bf16 v[72:75], a[200:203], v[24:27], v[72:75]
    v_mfma_f32_16x16x32_bf16 v[76:79], a[204:207], v[24:27], v[76:79]
    s_waitcnt lgkmcnt(0)
    v_mfma_f32_16x16x32_bf16 v[64:67], a[208:211], v[28:31], v[64:67]
    v_mfma_f32_16x16x32_bf16 v[68:71], a[212:215], v[28:31], v[68:71]
    v_mfma_f32_16x16x32_bf16 v[72:75], a[216:219], v[28:31], v[72:75]
    v_mfma_f32_16x16x32_bf16 v[76:79], a[220:223], v[28:31], v[76:79]
    s_nop 7
    v_cvt_pk_bf16_f32 v80, v48, v49
    v_cvt_pk_bf16_f32 v81, v64, v65
    v_cvt_pk_bf16_f32 v82, v50, v51
    v_cvt_pk_bf16_f32 v83, v66, v67
    v_cvt_pk_bf16_f32 v84, v52, v53
    v_cvt_pk_bf16_f32 v85, v68, v69
    v_cvt_pk_bf16_f32 v86, v54, v55
    v_cvt_pk_bf16_f32 v87, v70, v71
    s_add_u32 s22, s18, 0
    s_addc_u32 s23, s19, 0
    global_store_dwordx4 v8, v[80:83], s[22:23] sc1
    global_store_dwordx4 v8, v[84:87], s[22:23] offset:1024 sc1
    v_cvt_pk_bf16_f32 v88, v56, v57
    v_cvt_pk_bf16_f32 v89, v72, v73
    v_cvt_pk_bf16_f32 v90, v58, v59
    v_cvt_pk_bf16_f32 v91, v74, v75
    v_cvt_pk_bf16_f32 v92, v60, v61
    v_cvt_pk_bf16_f32 v93, v76, v77
    v_cvt_pk_bf16_f32 v94, v62, v63
    v_cvt_pk_bf16_f32 v95, v78, v79
    s_add_u32 s22, s18, 458752
    s_addc_u32 s23, s19, 0
    global_store_dwordx4 v8, v[88:91], s[22:23] sc1
    global_store_dwordx4 v8, v[92:95], s[22:23] offset:1024 sc1
    s_waitcnt vmcnt(11)
    s_barrier
    ds_read_b128 v[16:19], v8 offset:28672
    ds_read_b128 v[20:23], v8 offset:29696
    ds_read_b128 v[24:27], v8 offset:30720
    ds_read_b128 v[28:31], v8 offset:31744
    ds_read_b128 v[32:35], v8 offset:32768
    ds_read_b128 v[36:39], v8 offset:33792
    ds_read_b128 v[40:43], v8 offset:34816
    ds_read_b128 v[44:47], v8 offset:35840
    s_waitcnt lgkmcnt(7)
    v_mfma_f32_16x16x32_bf16 v[48:51], a[0:3], v[16:19], 0
    v_mfma_f32_16x16x32_bf16 v[52:55], a[4:7], v[16:19], 0
    v_mfma_f32_16x16x32_bf16 v[56:59], a[8:11], v[16:19], 0
    v_mfma_f32_16x16x32_bf16 v[60:63], a[12:15], v[16:19], 0
    ds_read_b128 v[16:19], v8 offset:36864
    s_waitcnt lgkmcnt(7)
    v_mfma_f32_16x16x32_bf16 v[48:51], a[16:19], v[20:23], v[48:51]
    v_mfma_f32_16x16x32_bf16 v[52:55], a[20:23], v[20:23], v[52:55]
    v_mfma_f32_16x16x32_bf16 v[56:59], a[24:27], v[20:23], v[56:59]
    v_mfma_f32_16x16x32_bf16 v[60:63], a[28:31], v[20:23], v[60:63]
    s_add_u32 m0, s24, 0
    s_add_u32 s20, s16, 0
    s_addc_u32 s21, s17, 0
    global_load_lds_dwordx4 v6, s[20:21]
    ds_read_b128 v[20:23], v8 offset:37888
    s_waitcnt lgkmcnt(7)
    v_mfma_f32_16x16x32_bf16 v[48:51], a[32:35], v[24:27], v[48:51]
    v_mfma_f32_16x16x32_bf16 v[52:55], a[36:39], v[24:27], v[52:55]
    v_mfma_f32_16x16x32_bf16 v[56:59], a[40:43], v[24:27], v[56:59]
    v_mfma_f32_16x16x32_bf16 v[60:63], a[44:47], v[24:27], v[60:63]
    ds_read_b128 v[24:27], v8 offset:38912
    s_waitcnt lgkmcnt(7)
    v_mfma_f32_16x16x32_bf16 v[48:51], a[48:51], v[28:31], v[48:51]
    v_mfma_f32_16x16x32_bf16 v[52:55], a[52:55], v[28:31], v[52:55]
    v_mfma_f32_16x16x32_bf16 v[56:59], a[56:59], v[28:31], v[56:59]
    v_mfma_f32_16x16x32_bf16 v[60:63], a[60:63], v[28:31], v[60:63]
    ds_read_b128 v[28:31], v8 offset:39936
    s_waitcnt lgkmcnt(7)
    v_mfma_f32_16x16x32_bf16 v[48:51], a[64:67], v[32:35], v[48:51]
    v_mfma_f32_16x16x32_bf16 v[52:55], a[68:71], v[32:35], v[52:55]
    v_mfma_f32_16x16x32_bf16 v[56:59], a[72:75], v[32:35], v[56:59]
    v_mfma_f32_16x16x32_bf16 v[60:63], a[76:79], v[32:35], v[60:63]
    s_add_u32 m0, s24, 4096
    s_add_u32 s20, s16, 4096
    s_addc_u32 s21, s17, 0
    global_load_lds_dwordx4 v6, s[20:21]
    ds_read_b128 v[32:35], v8 offset:40960
    s_waitcnt lgkmcnt(7)
    v_mfma_f32_16x16x32_bf16 v[48:51], a[80:83], v[36:39], v[48:51]
    v_mfma_f32_16x16x32_bf16 v[52:55], a[84:87], v[36:39], v[52:55]
    v_mfma_f32_16x16x32_bf16 v[56:59], a[88:91], v[36:39], v[56:59]
    v_mfma_f32_16x16x32_bf16 v[60:63], a[92:95], v[36:39], v[60:63]
    ds_read_b128 v[36:39], v8 offset:41984
    s_waitcnt lgkmcnt(7)
    v_mfma_f32_16x16x32_bf16 v[48:51], a[96:99], v[40:43], v[48:51]
    v_mfma_f32_16x16x32_bf16 v[52:55], a[100:103], v[40:43], v[52:55]
    v_mfma_f32_16x16x32_bf16 v[56:59], a[104:107], v[40:43], v[56:59]
    v_mfma_f32_16x16x32_bf16 v[60:63], a[108:111], v[40:43], v[60:63]
    ds_read_b128 v[40:43], v8 offset:43008
    s_waitcnt lgkmcnt(7)
    v_mfma_f32_16x16x32_bf16 v[48:51], a[112:115], v[44:47], v[48:51]
    v_mfma_f32_16x16x32_bf16 v[52:55], a[116:119], v[44:47], v[52:55]
    v_mfma_f32_16x16x32_bf16 v[56:59], a[120:123], v[44:47], v[56:59]
    v_mfma_f32_16x16x32_bf16 v[60:63], a[124:127], v[44:47], v[60:63]
    s_add_u32 m0, s24, 8192
    s_add_u32 s20, s16, 8192
    s_addc_u32 s21, s17, 0
    global_load_lds_dwordx4 v6, s[20:21]
    ds_read_b128 v[44:47], v8 offset:44032
    s_waitcnt lgkmcnt(7)
    v_mfma_f32_16x16x32_bf16 v[48:51], a[128:131], v[16:19], v[48:51]
    v_mfma_f32_16x16x32_bf16 v[52:55], a[132:135], v[16:19], v[52:55]
    v_mfma_f32_16x16x32_bf16 v[56:59], a[136:139], v[16:19], v[56:59]
    v_mfma_f32_16x16x32_bf16 v[60:63], a[140:143], v[16:19], v[60:63]
    ds_read_b128 v[16:19], v8 offset:45056
    s_waitcnt lgkmcnt(7)
    v_mfma_f32_16x16x32_bf16 v[48:51], a[144:147], v[20:23], v[48:51]
    v_mfma_f32_16x16x32_bf16 v[52:55], a[148:151], v[20:23], v[52:55]
    v_mfma_f32_16x16x32_bf16 v[56:59], a[152:155], v[20:23], v[56:59]
    v_mfma_f32_16x16x32_bf16 v[60:63], a[156:159], v[20:23], v[60:63]
    ds_read_b128 v[20:23], v8 offset:46080
    s_waitcnt lgkmcnt(7)
    v_mfma_f32_16x16x32_bf16 v[48:51], a[160:163], v[24:27], v[48:51]
    v_mfma_f32_16x16x32_bf16 v[52:55], a[164:167], v[24:27], v[52:55]
    v_mfma_f32_16x16x32_bf16 v[56:59], a[168:171], v[24:27], v[56:59]
    v_mfma_f32_16x16x32_bf16 v[60:63], a[172:175], v[24:27], v[60:63]
    s_add_u32 m0, s24, 12288
    s_add_u32 s20, s16, 12288
    s_addc_u32 s21, s17, 0
    global_load_lds_dwordx4 v6, s[20:21]
    ds_read_b128 v[24:27], v8 offset:47104
    s_waitcnt lgkmcnt(7)
    v_mfma_f32_16x16x32_bf16 v[48:51], a[176:179], v[28:31], v[48:51]
    v_mfma_f32_16x16x32_bf16 v[52:55], a[180:183], v[28:31], v[52:55]
    v_mfma_f32_16x16x32_bf16 v[56:59], a[184:187], v[28:31], v[56:59]
    v_mfma_f32_16x16x32_bf16 v[60:63], a[188:191], v[28:31], v[60:63]
    ds_read_b128 v[28:31], v8 offset:48128
    s_waitcnt lgkmcnt(7)
    v_mfma_f32_16x16x32_bf16 v[48:51], a[192:195], v[32:35], v[48:51]
    v_mfma_f32_16x16x32_bf16 v[52:55], a[196:199], v[32:35], v[52:55]
    v_mfma_f32_16x16x32_bf16 v[56:59], a[200:203], v[32:35], v[56:59]
    v_mfma_f32_16x16x32_bf16 v[60:63], a[204:207], v[32:35], v[60:63]
    ds_read_b128 v[32:35], v8 offset:49152
    s_waitcnt lgkmcnt(7)
    v_mfma_f32_16x16x32_bf16 v[48:51], a[208:211], v[36:39], v[48:51]
    v_mfma_f32_16x16x32_bf16 v[52:55], a[212:215], v[36:39], v[52:55]
    v_mfma_f32_16x16x32_bf16 v[56:59], a[216:219], v[36:39], v[56:59]
    v_mfma_f32_16x16x32_bf16 v[60:63], a[220:223], v[36:39], v[60:63]
    s_add_u32 m0, s24, 16384
    s_add_u32 s20, s16, 16384
    s_addc_u32 s21, s17, 0
    global_load_lds_dwordx4 v6, s[20:21]
    ds_read_b128 v[36:39], v8 offset:50176
    s_waitcnt lgkmcnt(7)
    v_mfma_f32_16x16x32_bf16 v[64:67], a[0:3], v[40:43], 0
    v_mfma_f32_16x16x32_bf16 v[68:71], a[4:7], v[40:43], 0
    v_mfma_f32_16x16x32_bf16 v[72:75], a[8:11], v[40:43], 0
    v_mfma_f32_16x16x32_bf16 v[76:79], a[12:15], v[40:43], 0
    ds_read_b128 v[40:43], v8 offset:51200
    s_waitcnt lgkmcnt(7)
    v_mfma_f32_16x16x32_bf16 v[64:67], a[16:19], v[44:47], v[64:67]
    v_mfma_f32_16x16x32_bf16 v[68:71], a[20:23], v[44:47], v[68:71]
    v_mfma_f32_16x16x32_bf16 v[72:75], a[24:27], v[44:47], v[72:75]
    v_mfma_f32_16x16x32_bf16 v[76:79], a[28:31], v[44:47], v[76:79]
    ds_read_b128 v[44:47], v8 offset:52224
    s_waitcnt lgkmcnt(7)
    v_mfma_f32_16x16x32_bf16 v[64:67], a[32:35], v[16:19], v[64:67]
    v_mfma_f32_16x16x32_bf16 v[68:71], a[36:39], v[16:19], v[68:71]
    v_mfma_f32_16x16x32_bf16 v[72:75], a[40:43], v[16:19], v[72:75]
    v_mfma_f32_16x16x32_bf16 v[76:79], a[44:47], v[16:19], v[76:79]
    s_add_u32 m0, s24, 20480
    s_add_u32 s20, s16, 20480
    s_addc_u32 s21, s17, 0
    global_load_lds_dwordx4 v6, s[20:21]
    ds_read_b128 v[16:19], v8 offset:53248
    s_waitcnt lgkmcnt(7)
    v_mfma_f32_16x16x32_bf16 v[64:67], a[48:51], v[20:23], v[64:67]
    v_mfma_f32_16x16x32_bf16 v[68:71], a[52:55], v[20:23], v[68:71]
    v_mfma_f32_16x16x32_bf16 v[72:75], a[56:59], v[20:23], v[72:75]
    v_mfma_f32_16x16x32_bf16 v[76:79], a[60:63], v[20:23], v[76:79]
    ds_read_b128 v[20:23], v8 offset:54272
    s_waitcnt lgkmcnt(7)
    v_mfma_f32_16x16x32_bf16 v[64:67], a[64:67], v[24:27], v[64:67]
    v_mfma_f32_16x16x32_bf16 v[68:71], a[68:71], v[24:27], v[68:71]
    v_mfma_f32_16x16x32_bf16 v[72:75], a[72:75], v[24:27], v[72:75]
    v_mfma_f32_16x16x32_bf16 v[76:79], a[76:79], v[24:27], v[76:79]
    ds_read_b128 v[24:27], v8 offset:55296
    s_waitcnt lgkmcnt(7)
    v_mfma_f32_16x16x32_bf16 v[64:67], a[80:83], v[28:31], v[64:67]
    v_mfma_f32_16x16x32_bf16 v[68:71], a[84:87], v[28:31], v[68:71]
    v_mfma_f32_16x16x32_bf16 v[72:75], a[88:91], v[28:31], v[72:75]
    v_mfma_f32_16x16x32_bf16 v[76:79], a[92:95], v[28:31], v[76:79]
    s_add_u32 m0, s24, 24576
    s_add_u32 s20, s16, 24576
    s_addc_u32 s21, s17, 0
    global_load_lds_dwordx4 v6, s[20:21]
    s_add_u32 s16, s16, s13
    s_addc_u32 s17, s17, 0
    ds_read_b128 v[28:31], v8 offset:56320
    s_waitcnt lgkmcnt(7)
    v_mfma_f32_16x16x32_bf16 v[64:67], a[96:99], v[32:35], v[64:67]
    v_mfma_f32_16x16x32_bf16 v[68:71], a[100:103], v[32:35], v[68:71]
    v_mfma_f32_16x16x32_bf16 v[72:75], a[104:107], v[32:35], v[72:75]
    v_mfma_f32_16x16x32_bf16 v[76:79], a[108:111], v[32:35], v[76:79]
    s_waitcnt lgkmcnt(6)
    v_mfma_f32_16x16x32_bf16 v[64:67], a[112:115], v[36:39], v[64:67]
    v_mfma_f32_16x16x32_bf16 v[68:71], a[116:119], v[36:39], v[68:71]
    v_mfma_f32_16x16x32_bf16 v[72:75], a[120:123], v[36:39], v[72:75]
    v_mfma_f32_16x16x32_bf16 v[76:79], a[124:127], v[36:39], v[76:79]
    s_waitcnt lgkmcnt(5)
    v_mfma_f32_16x16x32_bf16 v[64:67], a[128:131], v[40:43], v[64:67]
    v_mfma_f32_16x16x32_bf16 v[68:71], a[132:135], v[40:43], v[68:71]
    v_mfma_f32_16x16x32_bf16 v[72:75], a[136:139], v[40:43], v[72:75]
    v_mfma_f32_16x16x32_bf16 v[76:79], a[140:143], v[40:43], v[76:79]
    s_waitcnt lgkmcnt(4)
    v_mfma_f32_16x16x32_bf16 v[64:67], a[144:147], v[44:47], v[64:67]
    v_mfma_f32_16x16x32_bf16 v[68:71], a[148:151], v[44:47], v[68:71]
    v_mfma_f32_16x16x32_bf16 v[72:75], a[152:155], v[44:47], v[72:75]
    v_mfma_f32_16x16x32_bf16 v[76:79], a[156:159], v[44:47], v[76:79]
    s_waitcnt lgkmcnt(3)
    v_mfma_f32_16x16x32_bf16 v[64:67], a[160:163], v[16:19], v[64:67]
    v_mfma_f32_16x16x32_bf16 v[68:71], a[164:167], v[16:19], v[68:71]
    v_mfma_f32_16x16x32_bf16 v[72:75], a[168:171], v[16:19], v[72:75]
    v_mfma_f32_16x16x32_bf16 v[76:79], a[172:175], v[16:19], v[76:79]
    s_waitcnt lgkmcnt(2)
    v_mfma_f32_16x16x32_bf16 v[64:67], a[176:179], v[20:23], v[64:67]
    v_mfma_f32_16x16x32_bf16 v[68:71], a[180:183], v[20:23], v[68:71]
    v_mfma_f32_16x16x32_bf16 v[72:75], a[184:187], v[20:23], v[72:75]
    v_mfma_f32_16x16x32_bf16 v[76:79], a[188:191], v[20:23], v[76:79]
    s_waitcnt lgkmcnt(1)
    v_mfma_f32_16x16x32_bf16 v[64:67], a[192:195], v[24:27], v[64:67]
    v_mfma_f32_16x16x32_bf16 v[68:71], a[196:199], v[24:27], v[68:71]
    v_mfma_f32_16x16x32_bf16 v[72:75], a[200:203], v[24:27], v[72:75]
    v_mfma_f32_16x16x32_bf16 v[76:79], a[204:207], v[24:27], v[76:79]
    s_waitcnt lgkmcnt(0)
    v_mfma_f32_16x16x32_bf16 v[64:67], a[208:211], v[28:31], v[64:67]
    v_mfma_f32_16x16x32_bf16 v[68:71], a[212:215], v[28:31], v[68:71]
    v_mfma_f32_16x16x32_bf16 v[72:75], a[216:219], v[28:31], v[72:75]
    v_mfma_f32_16x16x32_bf16 v[76:79], a[220:223], v[28:31], v[76:79]
    s_nop 7
    v_cvt_pk_bf16_f32 v80, v48, v49
    v_cvt_pk_bf16_f32 v81, v64, v65
    v_cvt_pk_bf16_f32 v82, v50, v51
    v_cvt_pk_bf16_f32 v83, v66, v67
    v_cvt_pk_bf16_f32 v84, v52, v53
    v_cvt_pk_bf16_f32 v85, v68, v69
    v_cvt_pk_bf16_f32 v86, v54, v55
    v_cvt_pk_bf16_f32 v87, v70, v71
    s_add_u32 s22, s18, 16384
    s_addc_u32 s23, s19, 0
    global_store_dwordx4 v8, v[80:83], s[22:23] sc1
    global_store_dwordx4 v8, v[84:87], s[22:23] offset:1024 sc1
    v_cvt_pk_bf16_f32 v88, v56, v57
    v_cvt_pk_bf16_f32 v89, v72, v73
    v_cvt_pk_bf16_f32 v90, v58, v59
    v_cvt_pk_bf16_f32 v91, v74, v75
    v_cvt_pk_bf16_f32 v92, v60, v61
    v_cvt_pk_bf16_f32 v93, v76, v77
    v_cvt_pk_bf16_f32 v94, v62, v63
    v_cvt_pk_bf16_f32 v95, v78, v79
    s_add_u32 s22, s18, 475136
    s_addc_u32 s23, s19, 0
    global_store_dwordx4 v8, v[88:91], s[22:23] sc1
    global_store_dwordx4 v8, v[92:95], s[22:23] offset:1024 sc1
    s_waitcnt vmcnt(11)
    s_barrier
    ds_read_b128 v[16:19], v13 offset:0
    ds_read_b128 v[20:23], v13 offset:1024
    ds_read_b128 v[24:27], v13 offset:2048
    ds_read_b128 v[28:31], v13 offset:3072
    ds_read_b128 v[32:35], v13 offset:4096
    ds_read_b128 v[36:39], v13 offset:5120
    ds_read_b128 v[40:43], v13 offset:6144
    ds_read_b128 v[44:47], v13 offset:7168
    s_waitcnt lgkmcnt(7)
    v_mfma_f32_16x16x32_bf16 v[48:51], a[0:3], v[16:19], 0
    v_mfma_f32_16x16x32_bf16 v[52:55], a[4:7], v[16:19], 0
    v_mfma_f32_16x16x32_bf16 v[56:59], a[8:11], v[16:19], 0
    v_mfma_f32_16x16x32_bf16 v[60:63], a[12:15], v[16:19], 0
    ds_read_b128 v[16:19], v13 offset:8192
    s_waitcnt lgkmcnt(7)
    v_mfma_f32_16x16x32_bf16 v[48:51], a[16:19], v[20:23], v[48:51]
    v_mfma_f32_16x16x32_bf16 v[52:55], a[20:23], v[20:23], v[52:55]
    v_mfma_f32_16x16x32_bf16 v[56:59], a[24:27], v[20:23], v[56:59]
    v_mfma_f32_16x16x32_bf16 v[60:63], a[28:31], v[20:23], v[60:63]
    s_add_u32 m0, s24, 28672
    s_add_u32 s20, s16, 0
    s_addc_u32 s21, s17, 0
    global_load_lds_dwordx4 v6, s[20:21]
    ds_read_b128 v[20:23], v13 offset:9216
    s_waitcnt lgkmcnt(7)
    v_mfma_f32_16x16x32_bf16 v[48:51], a[32:35], v[24:27], v[48:51]
    v_mfma_f32_16x16x32_bf16 v[52:55], a[36:39], v[24:27], v[52:55]
    v_mfma_f32_16x16x32_bf16 v[56:59], a[40:43], v[24:27], v[56:59]
    v_mfma_f32_16x16x32_bf16 v[60:63], a[44:47], v[24:27], v[60:63]
    ds_read_b128 v[24:27], v13 offset:10240
    s_waitcnt lgkmcnt(7)
    v_mfma_f32_16x16x32_bf16 v[48:51], a[48:51], v[28:31], v[48:51]
    v_mfma_f32_16x16x32_bf16 v[52:55], a[52:55], v[28:31], v[52:55]
    v_mfma_f32_16x16x32_bf16 v[56:59], a[56:59], v[28:31], v[56:59]
    v_mfma_f32_16x16x32_bf16 v[60:63], a[60:63], v[28:31], v[60:63]
    ds_read_b128 v[28:31], v13 offset:11264
    s_waitcnt lgkmcnt(7)
    v_mfma_f32_16x16x32_bf16 v[48:51], a[64:67], v[32:35], v[48:51]
    v_mfma_f32_16x16x32_bf16 v[52:55], a[68:71], v[32:35], v[52:55]
    v_mfma_f32_16x16x32_bf16 v[56:59], a[72:75], v[32:35], v[56:59]
    v_mfma_f32_16x16x32_bf16 v[60:63], a[76:79], v[32:35], v[60:63]
    s_add_u32 m0, s24, 32768
    s_add_u32 s20, s16, 4096
    s_addc_u32 s21, s17, 0
    global_load_lds_dwordx4 v6, s[20:21]
    ds_read_b128 v[32:35], v13 offset:12288
    s_waitcnt lgkmcnt(7)
    v_mfma_f32_16x16x32_bf16 v[48:51], a[80:83], v[36:39], v[48:51]
    v_mfma_f32_16x16x32_bf16 v[52:55], a[84:87], v[36:39], v[52:55]
    v_mfma_f32_16x16x32_bf16 v[56:59], a[88:91], v[36:39], v[56:59]
    v_mfma_f32_16x16x32_bf16 v[60:63], a[92:95], v[36:39], v[60:63]
    ds_read_b128 v[36:39], v13 offset:13312
    s_waitcnt lgkmcnt(7)
    v_mfma_f32_16x16x32_bf16 v[48:51], a[96:99], v[40:43], v[48:51]
    v_mfma_f32_16x16x32_bf16 v[52:55], a[100:103], v[40:43], v[52:55]
    v_mfma_f32_16x16x32_bf16 v[56:59], a[104:107], v[40:43], v[56:59]
    v_mfma_f32_16x16x32_bf16 v[60:63], a[108:111], v[40:43], v[60:63]
    ds_read_b128 v[40:43], v13 offset:14336
    s_waitcnt lgkmcnt(7)
    v_mfma_f32_16x16x32_bf16 v[48:51], a[112:115], v[44:47], v[48:51]
    v_mfma_f32_16x16x32_bf16 v[52:55], a[116:119], v[44:47], v[52:55]
    v_mfma_f32_16x16x32_bf16 v[56:59], a[120:123], v[44:47], v[56:59]
    v_mfma_f32_16x16x32_bf16 v[60:63], a[124:127], v[44:47], v[60:63]
    s_add_u32 m0, s24, 36864
    s_add_u32 s20, s16, 8192
    s_addc_u32 s21, s17, 0
    global_load_lds_dwordx4 v6, s[20:21]
    ds_read_b128 v[44:47], v13 offset:15360
    s_waitcnt lgkmcnt(7)
    v_mfma_f32_16x16x32_bf16 v[48:51], a[128:131], v[16:19], v[48:51]
    v_mfma_f32_16x16x32_bf16 v[52:55], a[132:135], v[16:19], v[52:55]
    v_mfma_f32_16x16x32_bf16 v[56:59], a[136:139], v[16:19], v[56:59]
    v_mfma_f32_16x16x32_bf16 v[60:63], a[140:143], v[16:19], v[60:63]
    ds_read_b128 v[16:19], v13 offset:16384
    s_waitcnt lgkmcnt(7)
    v_mfma_f32_16x16x32_bf16 v[48:51], a[144:147], v[20:23], v[48:51]
    v_mfma_f32_16x16x32_bf16 v[52:55], a[148:151], v[20:23], v[52:55]
    v_mfma_f32_16x16x32_bf16 v[56:59], a[152:155], v[20:23], v[56:59]
    v_mfma_f32_16x16x32_bf16 v[60:63], a[156:159], v[20:23], v[60:63]
    ds_read_b128 v[20:23], v13 offset:17408
    s_waitcnt lgkmcnt(7)
    v_mfma_f32_16x16x32_bf16 v[48:51], a[160:163], v[24:27], v[48:51]
    v_mfma_f32_16x16x32_bf16 v[52:55], a[164:167], v[24:27], v[52:55]
    v_mfma_f32_16x16x32_bf16 v[56:59], a[168:171], v[24:27], v[56:59]
    v_mfma_f32_16x16x32_bf16 v[60:63], a[172:175], v[24:27], v[60:63]
    s_add_u32 m0, s24, 40960
    s_add_u32 s20, s16, 12288
    s_addc_u32 s21, s17, 0
    global_load_lds_dwordx4 v6, s[20:21]
    ds_read_b128 v[24:27], v13 offset:18432
    s_waitcnt lgkmcnt(7)
    v_mfma_f32_16x16x32_bf16 v[48:51], a[176:179], v[28:31], v[48:51]
    v_mfma_f32_16x16x32_bf16 v[52:55], a[180:183], v[28:31], v[52:55]
    v_mfma_f32_16x16x32_bf16 v[56:59], a[184:187], v[28:31], v[56:59]
    v_mfma_f32_16x16x32_bf16 v[60:63], a[188:191], v[28:31], v[60:63]
    ds_read_b128 v[28:31], v13 offset:19456
    s_waitcnt lgkmcnt(7)
    v_mfma_f32_16x16x32_bf16 v[48:51], a[192:195], v[32:35], v[48:51]
    v_mfma_f32_16x16x32_bf16 v[52:55], a[196:199], v[32:35], v[52:55]
    v_mfma_f32_16x16x32_bf16 v[56:59], a[200:203], v[32:35], v[56:59]
    v_mfma_f32_16x16x32_bf16 v[60:63], a[204:207], v[32:35], v[60:63]
    ds_read_b128 v[32:35], v13 offset:20480
    s_waitcnt lgkmcnt(7)
    v_mfma_f32_16x16x32_bf16 v[48:51], a[208:211], v[36:39], v[48:51]
    v_mfma_f32_16x16x32_bf16 v[52:55], a[212:215], v[36:39], v[52:55]
    v_mfma_f32_16x16x32_bf16 v[56:59], a[216:219], v[36:39], v[56:59]
    v_mfma_f32_16x16x32_bf16 v[60:63], a[220:223], v[36:39], v[60:63]
    s_add_u32 m0, s24, 45056
    s_add_u32 s20, s16, 16384
    s_addc_u32 s21, s17, 0
    global_load_lds_dwordx4 v6, s[20:21]
    ds_read_b128 v[36:39], v13 offset:21504
    s_waitcnt lgkmcnt(7)
    v_mfma_f32_16x16x32_bf16 v[64:67], a[0:3], v[40:43], 0
    v_mfma_f32_16x16x32_bf16 v[68:71], a[4:7], v[40:43], 0
    v_mfma_f32_16x16x32_bf16 v[72:75], a[8:11], v[40:43], 0
    v_mfma_f32_16x16x32_bf16 v[76:79], a[12:15], v[40:43], 0
    ds_read_b128 v[40:43], v13 offset:22528
    s_waitcnt lgkmcnt(7)
    v_mfma_f32_16x16x32_bf16 v[64:67], a[16:19], v[44:47], v[64:67]
    v_mfma_f32_16x16x32_bf16 v[68:71], a[20:23], v[44:47], v[68:71]
    v_mfma_f32_16x16x32_bf16 v[72:75], a[24:27], v[44:47], v[72:75]
    v_mfma_f32_16x16x32_bf16 v[76:79], a[28:31], v[44:47], v[76:79]
    ds_read_b128 v[44:47], v13 offset:23552
    s_waitcnt lgkmcnt(7)
    v_mfma_f32_16x16x32_bf16 v[64:67], a[32:35], v[16:19], v[64:67]
    v_mfma_f32_16x16x32_bf16 v[68:71], a[36:39], v[16:19], v[68:71]
    v_mfma_f32_16x16x32_bf16 v[72:75], a[40:43], v[16:19], v[72:75]
    v_mfma_f32_16x16x32_bf16 v[76:79], a[44:47], v[16:19], v[76:79]
    s_add_u32 m0, s24, 49152
    s_add_u32 s20, s16, 20480
    s_addc_u32 s21, s17, 0
    global_load_lds_dwordx4 v6, s[20:21]
    ds_read_b128 v[16:19], v13 offset:24576
    s_waitcnt lgkmcnt(7)
    v_mfma_f32_16x16x32_bf16 v[64:67], a[48:51], v[20:23], v[64:67]
    v_mfma_f32_16x16x32_bf16 v[68:71], a[52:55], v[20:23], v[68:71]
    v_mfma_f32_16x16x32_bf16 v[72:75], a[56:59], v[20:23], v[72:75]
    v_mfma_f32_16x16x32_bf16 v[76:79], a[60:63], v[20:23], v[76:79]
    ds_read_b128 v[20:23], v13 offset:25600
    s_waitcnt lgkmcnt(7)
    v_mfma_f32_16x16x32_bf16 v[64:67], a[64:67], v[24:27], v[64:67]
    v_mfma_f32_16x16x32_bf16 v[68:71], a[68:71], v[24:27], v[68:71]
    v_mfma_f32_16x16x32_bf16 v[72:75], a[72:75], v[24:27], v[72:75]
    v_mfma_f32_16x16x32_bf16 v[76:79], a[76:79], v[24:27], v[76:79]
    ds_read_b128 v[24:27], v13 offset:26624
    s_waitcnt lgkmcnt(7)
    v_mfma_f32_16x16x32_bf16 v[64:67], a[80:83], v[28:31], v[64:67]
    v_mfma_f32_16x16x32_bf16 v[68:71], a[84:87], v[28:31], v[68:71]
    v_mfma_f32_16x16x32_bf16 v[72:75], a[88:91], v[28:31], v[72:75]
    v_mfma_f32_16x16x32_bf16 v[76:79], a[92:95], v[28:31], v[76:79]
    s_add_u32 m0, s24, 53248
    s_add_u32 s20, s16, 24576
    s_addc_u32 s21, s17, 0
    global_load_lds_dwordx4 v6, s[20:21]
    s_add_u32 s16, s16, s13
    s_addc_u32 s17, s17, 0
    ds_read_b128 v[28:31], v13 offset:27648
    s_waitcnt lgkmcnt(7)
    v_mfma_f32_16x16x32_bf16 v[64:67], a[96:99], v[32:35], v[64:67]
    v_mfma_f32_16x16x32_bf16 v[68:71], a[100:103], v[32:35], v[68:71]
    v_mfma_f32_16x16x32_bf16 v[72:75], a[104:107], v[32:35], v[72:75]
    v_mfma_f32_16x16x32_bf16 v[76:79], a[108:111], v[32:35], v[76:79]
    s_waitcnt lgkmcnt(6)
    v_mfma_f32_16x16x32_bf16 v[64:67], a[112:115], v[36:39], v[64:67]
    v_mfma_f32_16x16x32_bf16 v[68:71], a[116:119], v[36:39], v[68:71]
    v_mfma_f32_16x16x32_bf16 v[72:75], a[120:123], v[36:39], v[72:75]
    v_mfma_f32_16x16x32_bf16 v[76:79], a[124:127], v[36:39], v[76:79]
    s_waitcnt lgkmcnt(5)
    v_mfma_f32_16x16x32_bf16 v[64:67], a[128:131], v[40:43], v[64:67]
    v_mfma_f32_16x16x32_bf16 v[68:71], a[132:135], v[40:43], v[68:71]
    v_mfma_f32_16x16x32_bf16 v[72:75], a[136:139], v[40:43], v[72:75]
    v_mfma_f32_16x16x32_bf16 v[76:79], a[140:143], v[40:43], v[76:79]
    s_waitcnt lgkmcnt(4)
    v_mfma_f32_16x16x32_bf16 v[64:67], a[144:147], v[44:47], v[64:67]
    v_mfma_f32_16x16x32_bf16 v[68:71], a[148:151], v[44:47], v[68:71]
    v_mfma_f32_16x16x32_bf16 v[72:75], a[152:155], v[44:47], v[72:75]
    v_mfma_f32_16x16x32_bf16 v[76:79], a[156:159], v[44:47], v[76:79]
    s_waitcnt lgkmcnt(3)
    v_mfma_f32_16x16x32_bf16 v[64:67], a[160:163], v[16:19], v[64:67]
    v_mfma_f32_16x16x32_bf16 v[68:71], a[164:167], v[16:19], v[68:71]
    v_mfma_f32_16x16x32_bf16 v[72:75], a[168:171], v[16:19], v[72:75]
    v_mfma_f32_16x16x32_bf16 v[76:79], a[172:175], v[16:19], v[76:79]
    s_waitcnt lgkmcnt(2)
    v_mfma_f32_16x16x32_bf16 v[64:67], a[176:179], v[20:23], v[64:67]
    v_mfma_f32_16x16x32_bf16 v[68:71], a[180:183], v[20:23], v[68:71]
    v_mfma_f32_16x16x32_bf16 v[72:75], a[184:187], v[20:23], v[72:75]
    v_mfma_f32_16x16x32_bf16 v[76:79], a[188:191], v[20:23], v[76:79]
    s_waitcnt lgkmcnt(1)
    v_mfma_f32_16x16x32_bf16 v[64:67], a[192:195], v[24:27], v[64:67]
    v_mfma_f32_16x16x32_bf16 v[68:71], a[196:199], v[24:27], v[68:71]
    v_mfma_f32_16x16x32_bf16 v[72:75], a[200:203], v[24:27], v[72:75]
    v_mfma_f32_16x16x32_bf16 v[76:79], a[204:207], v[24:27], v[76:79]
    s_waitcnt lgkmcnt(0)
    v_mfma_f32_16x16x32_bf16 v[64:67], a[208:211], v[28:31], v[64:67]
    v_mfma_f32_16x16x32_bf16 v[68:71], a[212:215], v[28:31], v[68:71]
    v_mfma_f32_16x16x32_bf16 v[72:75], a[216:219], v[28:31], v[72:75]
    v_mfma_f32_16x16x32_bf16 v[76:79], a[220:223], v[28:31], v[76:79]
    s_nop 7
    v_cvt_pk_bf16_f32 v80, v48, v49
    v_cvt_pk_bf16_f32 v81, v64, v65
    v_cvt_pk_bf16_f32 v82, v50, v51
    v_cvt_pk_bf16_f32 v83, v66, v67
    v_cvt_pk_bf16_f32 v84, v52, v53
    v_cvt_pk_bf16_f32 v85, v68, v69
    v_cvt_pk_bf16_f32 v86, v54, v55
    v_cvt_pk_bf16_f32 v87, v70, v71
    s_add_u32 s22, s18, 32768
    s_addc_u32 s23, s19, 0
    global_store_dwordx4 v8, v[80:83], s[22:23] sc1
    global_store_dwordx4 v8, v[84:87], s[22:23] offset:1024 sc1
    v_cvt_pk_bf16_f32 v88, v56, v57
    v_cvt_pk_bf16_f32 v89, v72, v73
    v_cvt_pk_bf16_f32 v90, v58, v59
    v_cvt_pk_bf16_f32 v91, v74, v75
    v_cvt_pk_bf16_f32 v92, v60, v61
    v_cvt_pk_bf16_f32 v93, v76, v77
    v_cvt_pk_bf16_f32 v94, v62, v63
    v_cvt_pk_bf16_f32 v95, v78, v79
    s_add_u32 s22, s18, 491520
    s_addc_u32 s23, s19, 0
    global_store_dwordx4 v8, v[88:91], s[22:23] sc1
    global_store_dwordx4 v8, v[92:95], s[22:23] offset:1024 sc1
    s_cmp_eq_u32 s47, 3
    s_cbranch_scc1 L_task_done
    s_waitcnt vmcnt(11)
    s_barrier
    ds_read_b128 v[16:19], v8 offset:0
    ds_read_b128 v[20:23], v8 offset:1024
    ds_read_b128 v[24:27], v8 offset:2048
    ds_read_b128 v[28:31], v8 offset:3072
    ds_read_b128 v[32:35], v8 offset:4096
    ds_read_b128 v[36:39], v8 offset:5120
    ds_read_b128 v[40:43], v8 offset:6144
    ds_read_b128 v[44:47], v8 offset:7168
    s_waitcnt lgkmcnt(7)
    v_mfma_f32_16x16x32_bf16 v[48:51], a[0:3], v[16:19], 0
    v_mfma_f32_16x16x32_bf16 v[52:55], a[4:7], v[16:19], 0
    v_mfma_f32_16x16x32_bf16 v[56:59], a[8:11], v[16:19], 0
    v_mfma_f32_16x16x32_bf16 v[60:63], a[12:15], v[16:19], 0
    ds_read_b128 v[16:19], v8 offset:8192
    s_waitcnt lgkmcnt(7)
    v_mfma_f32_16x16x32_bf16 v[48:51], a[16:19], v[20:23], v[48:51]
    v_mfma_f32_16x16x32_bf16 v[52:55], a[20:23], v[20:23], v[52:55]
    v_mfma_f32_16x16x32_bf16 v[56:59], a[24:27], v[20:23], v[56:59]
    v_mfma_f32_16x16x32_bf16 v[60:63], a[28:31], v[20:23], v[60:63]
    s_add_u32 m0, s24, 57344
    s_add_u32 s20, s16, 0
    s_addc_u32 s21, s17, 0
    global_load_lds_dwordx4 v6, s[20:21]
    ds_read_b128 v[20:23], v8 offset:9216
    s_waitcnt lgkmcnt(7)
    v_mfma_f32_16x16x32_bf16 v[48:51], a[32:35], v[24:27], v[48:51]
    v_mfma_f32_16x16x32_bf16 v[52:55], a[36:39], v[24:27], v[52:55]
    v_mfma_f32_16x16x32_bf16 v[56:59], a[40:43], v[24:27], v[56:59]
    v_mfma_f32_16x16x32_bf16 v[60:63], a[44:47], v[24:27], v[60:63]
    ds_read_b128 v[24:27], v8 offset:10240
    s_waitcnt lgkmcnt(7)
    v_mfma_f32_16x16x32_bf16 v[48:51], a[48:51], v[28:31], v[48:51]
    v_mfma_f32_16x16x32_bf16 v[52:55], a[52:55], v[28:31], v[52:55]
    v_mfma_f32_16x16x32_bf16 v[56:59], a[56:59], v[28:31], v[56:59]
    v_mfma_f32_16x16x32_bf16 v[60:63], a[60:63], v[28:31], v[60:63]
    ds_read_b128 v[28:31], v8 offset:11264
    s_waitcnt lgkmcnt(7)
    v_mfma_f32_16x16x32_bf16 v[48:51], a[64:67], v[32:35], v[48:51]
    v_mfma_f32_16x16x32_bf16 v[52:55], a[68:71], v[32:35], v[52:55]
    v_mfma_f32_16x16x32_bf16 v[56:59], a[72:75], v[32:35], v[56:59]
    v_mfma_f32_16x16x32_bf16 v[60:63], a[76:79], v[32:35], v[60:63]
    s_add_u32 m0, s24, 61440
    s_add_u32 s20, s16, 4096
    s_addc_u32 s21, s17, 0
    global_load_lds_dwordx4 v6, s[20:21]
    ds_read_b128 v[32:35], v8 offset:12288
    s_waitcnt lgkmcnt(7)
    v_mfma_f32_16x16x32_bf16 v[48:51], a[80:83], v[36:39], v[48:51]
    v_mfma_f32_16x16x32_bf16 v[52:55], a[84:87], v[36:39], v[52:55]
    v_mfma_f32_16x16x32_bf16 v[56:59], a[88:91], v[36:39], v[56:59]
    v_mfma_f32_16x16x32_bf16 v[60:63], a[92:95], v[36:39], v[60:63]
    ds_read_b128 v[36:39], v8 offset:13312
    s_waitcnt lgkmcnt(7)
    v_mfma_f32_16x16x32_bf16 v[48:51], a[96:99], v[40:43], v[48:51]
    v_mfma_f32_16x16x32_bf16 v[52:55], a[100:103], v[40:43], v[52:55]
    v_mfma_f32_16x16x32_bf16 v[56:59], a[104:107], v[40:43], v[56:59]
    v_mfma_f32_16x16x32_bf16 v[60:63], a[108:111], v[40:43], v[60:63]
    ds_read_b128 v[40:43], v8 offset:14336
    s_waitcnt lgkmcnt(7)
    v_mfma_f32_16x16x32_bf16 v[48:51], a[112:115], v[44:47], v[48:51]
    v_mfma_f32_16x16x32_bf16 v[52:55], a[116:119], v[44:47], v[52:55]
    v_mfma_f32_16x16x32_bf16 v[56:59], a[120:123], v[44:47], v[56:59]
    v_mfma_f32_16x16x32_bf16 v[60:63], a[124:127], v[44:47], v[60:63]
    s_add_u32 m0, s24, 65536
    s_add_u32 s20, s16, 8192
    s_addc_u32 s21, s17, 0
    global_load_lds_dwordx4 v6, s[20:21]
    ds_read_b128 v[44:47], v8 offset:15360
    s_waitcnt lgkmcnt(7)
    v_mfma_f32_16x16x32_bf16 v[48:51], a[128:131], v[16:19], v[48:51]
    v_mfma_f32_16x16x32_bf16 v[52:55], a[132:135], v[16:19], v[52:55]
    v_mfma_f32_16x16x32_bf16 v[56:59], a[136:139], v[16:19], v[56:59]
    v_mfma_f32_16x16x32_bf16 v[60:63], a[140:143], v[16:19], v[60:63]
    ds_read_b128 v[16:19], v8 offset:16384
    s_waitcnt lgkmcnt(7)
    v_mfma_f32_16x16x32_bf16 v[48:51], a[144:147], v[20:23], v[48:51]
    v_mfma_f32_16x16x32_bf16 v[52:55], a[148:151], v[20:23], v[52:55]
    v_mfma_f32_16x16x32_bf16 v[56:59], a[152:155], v[20:23], v[56:59]
    v_mfma_f32_16x16x32_bf16 v[60:63], a[156:159], v[20:23], v[60:63]
    ds_read_b128 v[20:23], v8 offset:17408
    s_waitcnt lgkmcnt(7)
    v_mfma_f32_16x16x32_bf16 v[48:51], a[160:163], v[24:27], v[48:51]
    v_mfma_f32_16x16x32_bf16 v[52:55], a[164:167], v[24:27], v[52:55]
    v_mfma_f32_16x16x32_bf16 v[56:59], a[168:171], v[24:27], v[56:59]
    v_mfma_f32_16x16x32_bf16 v[60:63], a[172:175], v[24:27], v[60:63]
    s_add_u32 m0, s24, 69632
    s_add_u32 s20, s16, 12288
    s_addc_u32 s21, s17, 0
    global_load_lds_dwordx4 v6, s[20:21]
    ds_read_b128 v[24:27], v8 offset:18432
    s_waitcnt lgkmcnt(7)
    v_mfma_f32_16x16x32_bf16 v[48:51], a[176:179], v[28:31], v[48:51]
    v_mfma_f32_16x16x32_bf16 v[52:55], a[180:183], v[28:31], v[52:55]
    v_mfma_f32_16x16x32_bf16 v[56:59], a[184:187], v[28:31], v[56:59]
    v_mfma_f32_16x16x32_bf16 v[60:63], a[188:191], v[28:31], v[60:63]
    ds_read_b128 v[28:31], v8 offset:19456
    s_waitcnt lgkmcnt(7)
    v_mfma_f32_16x16x32_bf16 v[48:51], a[192:195], v[32:35], v[48:51]
    v_mfma_f32_16x16x32_bf16 v[52:55], a[196:199], v[32:35], v[52:55]
    v_mfma_f32_16x16x32_bf16 v[56:59], a[200:203], v[32:35], v[56:59]
    v_mfma_f32_16x16x32_bf16 v[60:63], a[204:207], v[32:35], v[60:63]
    ds_read_b128 v[32:35], v8 offset:20480
    s_waitcnt lgkmcnt(7)
    v_mfma_f32_16x16x32_bf16 v[48:51], a[208:211], v[36:39], v[48:51]
    v_mfma_f32_16x16x32_bf16 v[52:55], a[212:215], v[36:39], v[52:55]
    v_mfma_f32_16x16x32_bf16 v[56:59], a[216:219], v[36:39], v[56:59]
    v_mfma_f32_16x16x32_bf16 v[60:63], a[220:223], v[36:39], v[60:63]
    s_add_u32 m0, s24, 73728
    s_add_u32 s20, s16, 16384
    s_addc_u32 s21, s17, 0
    global_load_lds_dwordx4 v6, s[20:21]
    ds_read_b128 v[36:39], v8 offset:21504
    s_waitcnt lgkmcnt(7)
    v_mfma_f32_16x16x32_bf16 v[64:67], a[0:3], v[40:43], 0
    v_mfma_f32_16x16x32_bf16 v[68:71], a[4:7], v[40:43], 0
    v_mfma_f32_16x16x32_bf16 v[72:75], a[8:11], v[40:43], 0
    v_mfma_f32_16x16x32_bf16 v[76:79], a[12:15], v[40:43], 0
    ds_read_b128 v[40:43], v8 offset:22528
    s_waitcnt lgkmcnt(7)
    v_mfma_f32_16x16x32_bf16 v[64:67], a[16:19], v[44:47], v[64:67]
    v_mfma_f32_16x16x32_bf16 v[68:71], a[20:23], v[44:47], v[68:71]
    v_mfma_f32_16x16x32_bf16 v[72:75], a[24:27], v[44:47], v[72:75]
    v_mfma_f32_16x16x32_bf16 v[76:79], a[28:31], v[44:47], v[76:79]
    ds_read_b128 v[44:47], v8 offset:23552
    s_waitcnt lgkmcnt(7)
    v_mfma_f32_16x16x32_bf16 v[64:67], a[32:35], v[16:19], v[64:67]
    v_mfma_f32_16x16x32_bf16 v[68:71], a[36:39], v[16:19], v[68:71]
    v_mfma_f32_16x16x32_bf16 v[72:75], a[40:43], v[16:19], v[72:75]
    v_mfma_f32_16x16x32_bf16 v[76:79], a[44:47], v[16:19], v[76:79]
    s_add_u32 m0, s24, 77824
    s_add_u32 s20, s16, 20480
    s_addc_u32 s21, s17, 0
    global_load_lds_dwordx4 v6, s[20:21]
    ds_read_b128 v[16:19], v8 offset:24576
    s_waitcnt lgkmcnt(7)
    v_mfma_f32_16x16x32_bf16 v[64:67], a[48:51], v[20:23], v[64:67]
    v_mfma_f32_16x16x32_bf16 v[68:71], a[52:55], v[20:23], v[68:71]
    v_mfma_f32_16x16x32_bf16 v[72:75], a[56:59], v[20:23], v[72:75]
    v_mfma_f32_16x16x32_bf16 v[76:79], a[60:63], v[20:23], v[76:79]
    ds_read_b128 v[20:23], v8 offset:25600
    s_waitcnt lgkmcnt(7)
    v_mfma_f32_16x16x32_bf16 v[64:67], a[64:67], v[24:27], v[64:67]
    v_mfma_f32_16x16x32_bf16 v[68:71], a[68:71], v[24:27], v[68:71]
    v_mfma_f32_16x16x32_bf16 v[72:75], a[72:75], v[24:27], v[72:75]
    v_mfma_f32_16x16x32_bf16 v[76:79], a[76:79], v[24:27], v[76:79]
    ds_read_b128 v[24:27], v8 offset:26624
    s_waitcnt lgkmcnt(7)
    v_mfma_f32_16x16x32_bf16 v[64:67], a[80:83], v[28:31], v[64:67]
    v_mfma_f32_16x16x32_bf16 v[68:71], a[84:87], v[28:31], v[68:71]
    v_mfma_f32_16x16x32_bf16 v[72:75], a[88:91], v[28:31], v[72:75]
    v_mfma_f32_16x16x32_bf16 v[76:79], a[92:95], v[28:31], v[76:79]
    s_add_u32 m0, s24, 81920
    s_add_u32 s20, s16, 24576
    s_addc_u32 s21, s17, 0
    global_load_lds_dwordx4 v6, s[20:21]
    s_add_u32 s16, s16, s13
    s_addc_u32 s17, s17, 0
    ds_read_b128 v[28:31], v8 offset:27648
    s_waitcnt lgkmcnt(7)
    v_mfma_f32_16x16x32_bf16 v[64:67], a[96:99], v[32:35], v[64:67]
    v_mfma_f32_16x16x32_bf16 v[68:71], a[100:103], v[32:35], v[68:71]
    v_mfma_f32_16x16x32_bf16 v[72:75], a[104:107], v[32:35], v[72:75]
    v_mfma_f32_16x16x32_bf16 v[76:79], a[108:111], v[32:35], v[76:79]
    s_waitcnt lgkmcnt(6)
    v_mfma_f32_16x16x32_bf16 v[64:67], a[112:115], v[36:39], v[64:67]
    v_mfma_f32_16x16x32_bf16 v[68:71], a[116:119], v[36:39], v[68:71]
    v_mfma_f32_16x16x32_bf16 v[72:75], a[120:123], v[36:39], v[72:75]
    v_mfma_f32_16x16x32_bf16 v[76:79], a[124:127], v[36:39], v[76:79]
    s_waitcnt lgkmcnt(5)
    v_mfma_f32_16x16x32_bf16 v[64:67], a[128:131], v[40:43], v[64:67]
    v_mfma_f32_16x16x32_bf16 v[68:71], a[132:135], v[40:43], v[68:71]
    v_mfma_f32_16x16x32_bf16 v[72:75], a[136:139], v[40:43], v[72:75]
    v_mfma_f32_16x16x32_bf16 v[76:79], a[140:143], v[40:43], v[76:79]
    s_waitcnt lgkmcnt(4)
    v_mfma_f32_16x16x32_bf16 v[64:67], a[144:147], v[44:47], v[64:67]
    v_mfma_f32_16x16x32_bf16 v[68:71], a[148:151], v[44:47], v[68:71]
    v_mfma_f32_16x16x32_bf16 v[72:75], a[152:155], v[44:47], v[72:75]
    v_mfma_f32_16x16x32_bf16 v[76:79], a[156:159], v[44:47], v[76:79]
    s_waitcnt lgkmcnt(3)
    v_mfma_f32_16x16x32_bf16 v[64:67], a[160:163], v[16:19], v[64:67]
    v_mfma_f32_16x16x32_bf16 v[68:71], a[164:167], v[16:19], v[68:71]
    v_mfma_f32_16x16x32_bf16 v[72:75], a[168:171], v[16:19], v[72:75]
    v_mfma_f32_16x16x32_bf16 v[76:79], a[172:175], v[16:19], v[76:79]
    s_waitcnt lgkmcnt(2)
    v_mfma_f32_16x16x32_bf16 v[64:67], a[176:179], v[20:23], v[64:67]
    v_mfma_f32_16x16x32_bf16 v[68:71], a[180:183], v[20:23], v[68:71]
    v_mfma_f32_16x16x32_bf16 v[72:75], a[184:187], v[20:23], v[72:75]
    v_mfma_f32_16x16x32_bf16 v[76:79], a[188:191], v[20:23], v[76:79]
    s_waitcnt lgkmcnt(1)
    v_mfma_f32_16x16x32_bf16 v[64:67], a[192:195], v[24:27], v[64:67]
    v_mfma_f32_16x16x32_bf16 v[68:71], a[196:199], v[24:27], v[68:71]
    v_mfma_f32_16x16x32_bf16 v[72:75], a[200:203], v[24:27], v[72:75]
    v_mfma_f32_16x16x32_bf16 v[76:79], a[204:207], v[24:27], v[76:79]
    s_waitcnt lgkmcnt(0)
    v_mfma_f32_16x16x32_bf16 v[64:67], a[208:211], v[28:31], v[64:67]
    v_mfma_f32_16x16x32_bf16 v[68:71], a[212:215], v[28:31], v[68:71]
    v_mfma_f32_16x16x32_bf16 v[72:75], a[216:219], v[28:31], v[72:75]
    v_mfma_f32_16x16x32_bf16 v[76:79], a[220:223], v[28:31], v[76:79]
    s_nop 7
    v_cvt_pk_bf16_f32 v80, v48, v49
    v_cvt_pk_bf16_f32 v81, v64, v65
    v_cvt_pk_bf16_f32 v82, v50, v51
    v_cvt_pk_bf16_f32 v83, v66, v67
    v_cvt_pk_bf16_f32 v84, v52, v53
    v_cvt_pk_bf16_f32 v85, v68, v69
    v_cvt_pk_bf16_f32 v86, v54, v55
    v_cvt_pk_bf16_f32 v87, v70, v71
    s_add_u32 s22, s18, 49152
    s_addc_u32 s23, s19, 0
    global_store_dwordx4 v8, v[80:83], s[22:23] sc1
    global_store_dwordx4 v8, v[84:87], s[22:23] offset:1024 sc1
    v_cvt_pk_bf16_f32 v88, v56, v57
    v_cvt_pk_bf16_f32 v89, v72, v73
    v_cvt_pk_bf16_f32 v90, v58, v59
    v_cvt_pk_bf16_f32 v91, v74, v75
    v_cvt_pk_bf16_f32 v92, v60, v61
    v_cvt_pk_bf16_f32 v93, v76, v77
    v_cvt_pk_bf16_f32 v94, v62, v63
    v_cvt_pk_bf16_f32 v95, v78, v79
    s_add_u32 s22, s18, 507904
    s_addc_u32 s23, s19, 0
    global_store_dwordx4 v8, v[88:91], s[22:23] sc1
    global_store_dwordx4 v8, v[92:95], s[22:23] offset:1024 sc1
    s_cmp_eq_u32 s47, 4
    s_cbranch_scc1 L_task_done
    s_waitcnt vmcnt(11)
    s_barrier
    ds_read_b128 v[16:19], v8 offset:28672
    ds_read_b128 v[20:23], v8 offset:29696
    ds_read_b128 v[24:27], v8 offset:30720
    ds_read_b128 v[28:31], v8 offset:31744
    ds_read_b128 v[32:35], v8 offset:32768
    ds_read_b128 v[36:39], v8 offset:33792
    ds_read_b128 v[40:43], v8 offset:34816
    ds_read_b128 v[44:47], v8 offset:35840
    s_waitcnt lgkmcnt(7)
    v_mfma_f32_16x16x32_bf16 v[48:51], a[0:3], v[16:19], 0
    v_mfma_f32_16x16x32_bf16 v[52:55], a[4:7], v[16:19], 0
    v_mfma_f32_16x16x32_bf16 v[56:59], a[8:11], v[16:19], 0
    v_mfma_f32_16x16x32_bf16 v[60:63], a[12:15], v[16:19], 0
    ds_read_b128 v[16:19], v8 offset:36864
    s_waitcnt lgkmcnt(7)
    v_mfma_f32_16x16x32_bf16 v[48:51], a[16:19], v[20:23], v[48:51]
    v_mfma_f32_16x16x32_bf16 v[52:55], a[20:23], v[20:23], v[52:55]
    v_mfma_f32_16x16x32_bf16 v[56:59], a[24:27], v[20:23], v[56:59]
    v_mfma_f32_16x16x32_bf16 v[60:63], a[28:31], v[20:23], v[60:63]
    s_add_u32 m0, s24, 0
    s_add_u32 s20, s16, 0
    s_addc_u32 s21, s17, 0
    global_load_lds_dwordx4 v6, s[20:21]
    ds_read_b128 v[20:23], v8 offset:37888
    s_waitcnt lgkmcnt(7)
    v_mfma_f32_16x16x32_bf16 v[48:51], a[32:35], v[24:27], v[48:51]
    v_mfma_f32_16x16x32_bf16 v[52:55], a[36:39], v[24:27], v[52:55]
    v_mfma_f32_16x16x32_bf16 v[56:59], a[40:43], v[24:27], v[56:59]
    v_mfma_f32_16x16x32_bf16 v[60:63], a[44:47], v[24:27], v[60:63]
    ds_read_b128 v[24:27], v8 offset:38912
    s_waitcnt lgkmcnt(7)
    v_mfma_f32_16x16x32_bf16 v[48:51], a[48:51], v[28:31], v[48:51]
    v_mfma_f32_16x16x32_bf16 v[52:55], a[52:55], v[28:31], v[52:55]
    v_mfma_f32_16x16x32_bf16 v[56:59], a[56:59], v[28:31], v[56:59]
    v_mfma_f32_16x16x32_bf16 v[60:63], a[60:63], v[28:31], v[60:63]
    ds_read_b128 v[28:31], v8 offset:39936
    s_waitcnt lgkmcnt(7)
    v_mfma_f32_16x16x32_bf16 v[48:51], a[64:67], v[32:35], v[48:51]
    v_mfma_f32_16x16x32_bf16 v[52:55], a[68:71], v[32:35], v[52:55]
    v_mfma_f32_16x16x32_bf16 v[56:59], a[72:75], v[32:35], v[56:59]
    v_mfma_f32_16x16x32_bf16 v[60:63], a[76:79], v[32:35], v[60:63]
    s_add_u32 m0, s24, 4096
    s_add_u32 s20, s16, 4096
    s_addc_u32 s21, s17, 0
    global_load_lds_dwordx4 v6, s[20:21]
    ds_read_b128 v[32:35], v8 offset:40960
    s_waitcnt lgkmcnt(7)
    v_mfma_f32_16x16x32_bf16 v[48:51], a[80:83], v[36:39], v[48:51]
    v_mfma_f32_16x16x32_bf16 v[52:55], a[84:87], v[36:39], v[52:55]
    v_mfma_f32_16x16x32_bf16 v[56:59], a[88:91], v[36:39], v[56:59]
    v_mfma_f32_16x16x32_bf16 v[60:63], a[92:95], v[36:39], v[60:63]
    ds_read_b128 v[36:39], v8 offset:41984
    s_waitcnt lgkmcnt(7)
    v_mfma_f32_16x16x32_bf16 v[48:51], a[96:99], v[40:43], v[48:51]
    v_mfma_f32_16x16x32_bf16 v[52:55], a[100:103], v[40:43], v[52:55]
    v_mfma_f32_16x16x32_bf16 v[56:59], a[104:107], v[40:43], v[56:59]
    v_mfma_f32_16x16x32_bf16 v[60:63], a[108:111], v[40:43], v[60:63]
    ds_read_b128 v[40:43], v8 offset:43008
    s_waitcnt lgkmcnt(7)
    v_mfma_f32_16x16x32_bf16 v[48:51], a[112:115], v[44:47], v[48:51]
    v_mfma_f32_16x16x32_bf16 v[52:55], a[116:119], v[44:47], v[52:55]
    v_mfma_f32_16x16x32_bf16 v[56:59], a[120:123], v[44:47], v[56:59]
    v_mfma_f32_16x16x32_bf16 v[60:63], a[124:127], v[44:47], v[60:63]
    s_add_u32 m0, s24, 8192
    s_add_u32 s20, s16, 8192
    s_addc_u32 s21, s17, 0
    global_load_lds_dwordx4 v6, s[20:21]
    ds_read_b128 v[44:47], v8 offset:44032
    s_waitcnt lgkmcnt(7)
    v_mfma_f32_16x16x32_bf16 v[48:51], a[128:131], v[16:19], v[48:51]
    v_mfma_f32_16x16x32_bf16 v[52:55], a[132:135], v[16:19], v[52:55]
    v_mfma_f32_16x16x32_bf16 v[56:59], a[136:139], v[16:19], v[56:59]
    v_mfma_f32_16x16x32_bf16 v[60:63], a[140:143], v[16:19], v[60:63]
    ds_read_b128 v[16:19], v8 offset:45056
    s_waitcnt lgkmcnt(7)
    v_mfma_f32_16x16x32_bf16 v[48:51], a[144:147], v[20:23], v[48:51]
    v_mfma_f32_16x16x32_bf16 v[52:55], a[148:151], v[20:23], v[52:55]
    v_mfma_f32_16x16x32_bf16 v[56:59], a[152:155], v[20:23], v[56:59]
    v_mfma_f32_16x16x32_bf16 v[60:63], a[156:159], v[20:23], v[60:63]
    ds_read_b128 v[20:23], v8 offset:46080
    s_waitcnt lgkmcnt(7)
    v_mfma_f32_16x16x32_bf16 v[48:51], a[160:163], v[24:27], v[48:51]
    v_mfma_f32_16x16x32_bf16 v[52:55], a[164:167], v[24:27], v[52:55]
    v_mfma_f32_16x16x32_bf16 v[56:59], a[168:171], v[24:27], v[56:59]
    v_mfma_f32_16x16x32_bf16 v[60:63], a[172:175], v[24:27], v[60:63]
    s_add_u32 m0, s24, 12288
    s_add_u32 s20, s16, 12288
    s_addc_u32 s21, s17, 0
    global_load_lds_dwordx4 v6, s[20:21]
    ds_read_b128 v[24:27], v8 offset:47104
    s_waitcnt lgkmcnt(7)
    v_mfma_f32_16x16x32_bf16 v[48:51], a[176:179], v[28:31], v[48:51]
    v_mfma_f32_16x16x32_bf16 v[52:55], a[180:183], v[28:31], v[52:55]
    v_mfma_f32_16x16x32_bf16 v[56:59], a[184:187], v[28:31], v[56:59]
    v_mfma_f32_16x16x32_bf16 v[60:63], a[188:191], v[28:31], v[60:63]
    ds_read_b128 v[28:31], v8 offset:48128
    s_waitcnt lgkmcnt(7)
    v_mfma_f32_16x16x32_bf16 v[48:51], a[192:195], v[32:35], v[48:51]
    v_mfma_f32_16x16x32_bf16 v[52:55], a[196:199], v[32:35], v[52:55]
    v_mfma_f32_16x16x32_bf16 v[56:59], a[200:203], v[32:35], v[56:59]
    v_mfma_f32_16x16x32_bf16 v[60:63], a[204:207], v[32:35], v[60:63]
    ds_read_b128 v[32:35], v8 offset:49152
    s_waitcnt lgkmcnt(7)
    v_mfma_f32_16x16x32_bf16 v[48:51], a[208:211], v[36:39], v[48:51]
    v_mfma_f32_16x16x32_bf16 v[52:55], a[212:215], v[36:39], v[52:55]
    v_mfma_f32_16x16x32_bf16 v[56:59], a[216:219], v[36:39], v[56:59]
    v_mfma_f32_16x16x32_bf16 v[60:63], a[220:223], v[36:39], v[60:63]
    s_add_u32 m0, s24, 16384
    s_add_u32 s20, s16, 16384
    s_addc_u32 s21, s17, 0
    global_load_lds_dwordx4 v6, s[20:21]
    ds_read_b128 v[36:39], v8 offset:50176
    s_waitcnt lgkmcnt(7)
    v_mfma_f32_16x16x32_bf16 v[64:67], a[0:3], v[40:43], 0
    v_mfma_f32_16x16x32_bf16 v[68:71], a[4:7], v[40:43], 0
    v_mfma_f32_16x16x32_bf16 v[72:75], a[8:11], v[40:43], 0
    v_mfma_f32_16x16x32_bf16 v[76:79], a[12:15], v[40:43], 0
    ds_read_b128 v[40:43], v8 offset:51200
    s_waitcnt lgkmcnt(7)
    v_mfma_f32_16x16x32_bf16 v[64:67], a[16:19], v[44:47], v[64:67]
    v_mfma_f32_16x16x32_bf16 v[68:71], a[20:23], v[44:47], v[68:71]
    v_mfma_f32_16x16x32_bf16 v[72:75], a[24:27], v[44:47], v[72:75]
    v_mfma_f32_16x16x32_bf16 v[76:79], a[28:31], v[44:47], v[76:79]
    ds_read_b128 v[44:47], v8 offset:52224
    s_waitcnt lgkmcnt(7)
    v_mfma_f32_16x16x32_bf16 v[64:67], a[32:35], v[16:19], v[64:67]
    v_mfma_f32_16x16x32_bf16 v[68:71], a[36:39], v[16:19], v[68:71]
    v_mfma_f32_16x16x32_bf16 v[72:75], a[40:43], v[16:19], v[72:75]
    v_mfma_f32_16x16x32_bf16 v[76:79], a[44:47], v[16:19], v[76:79]
    s_add_u32 m0, s24, 20480
    s_add_u32 s20, s16, 20480
    s_addc_u32 s21, s17, 0
    global_load_lds_dwordx4 v6, s[20:21]
    ds_read_b128 v[16:19], v8 offset:53248
    s_waitcnt lgkmcnt(7)
    v_mfma_f32_16x16x32_bf16 v[64:67], a[48:51], v[20:23], v[64:67]
    v_mfma_f32_16x16x32_bf16 v[68:71], a[52:55], v[20:23], v[68:71]
    v_mfma_f32_16x16x32_bf16 v[72:75], a[56:59], v[20:23], v[72:75]
    v_mfma_f32_16x16x32_bf16 v[76:79], a[60:63], v[20:23], v[76:79]
    ds_read_b128 v[20:23], v8 offset:54272
    s_waitcnt lgkmcnt(7)
    v_mfma_f32_16x16x32_bf16 v[64:67], a[64:67], v[24:27], v[64:67]
    v_mfma_f32_16x16x32_bf16 v[68:71], a[68:71], v[24:27], v[68:71]
    v_mfma_f32_16x16x32_bf16 v[72:75], a[72:75], v[24:27], v[72:75]
    v_mfma_f32_16x16x32_bf16 v[76:79], a[76:79], v[24:27], v[76:79]
    ds_read_b128 v[24:27], v8 offset:55296
    s_waitcnt lgkmcnt(7)
    v_mfma_f32_16x16x32_bf16 v[64:67], a[80:83], v[28:31], v[64:67]
    v_mfma_f32_16x16x32_bf16 v[68:71], a[84:87], v[28:31], v[68:71]
    v_mfma_f32_16x16x32_bf16 v[72:75], a[88:91], v[28:31], v[72:75]
    v_mfma_f32_16x16x32_bf16 v[76:79], a[92:95], v[28:31], v[76:79]
    s_add_u32 m0, s24, 24576
    s_add_u32 s20, s16, 24576
    s_addc_u32 s21, s17, 0
    global_load_lds_dwordx4 v6, s[20:21]
    s_add_u32 s16, s16, s13
    s_addc_u32 s17, s17, 0
    ds_read_b128 v[28:31], v8 offset:56320
    s_waitcnt lgkmcnt(7)
    v_mfma_f32_16x16x32_bf16 v[64:67], a[96:99], v[32:35], v[64:67]
    v_mfma_f32_16x16x32_bf16 v[68:71], a[100:103], v[32:35], v[68:71]
    v_mfma_f32_16x16x32_bf16 v[72:75], a[104:107], v[32:35], v[72:75]
    v_mfma_f32_16x16x32_bf16 v[76:79], a[108:111], v[32:35], v[76:79]
    s_waitcnt lgkmcnt(6)
    v_mfma_f32_16x16x32_bf16 v[64:67], a[112:115], v[36:39], v[64:67]
    v_mfma_f32_16x16x32_bf16 v[68:71], a[116:119], v[36:39], v[68:71]
    v_mfma_f32_16x16x32_bf16 v[72:75], a[120:123], v[36:39], v[72:75]
    v_mfma_f32_16x16x32_bf16 v[76:79], a[124:127], v[36:39], v[76:79]
    s_waitcnt lgkmcnt(5)
    v_mfma_f32_16x16x32_bf16 v[64:67], a[128:131], v[40:43], v[64:67]
    v_mfma_f32_16x16x32_bf16 v[68:71], a[132:135], v[40:43], v[68:71]
    v_mfma_f32_16x16x32_bf16 v[72:75], a[136:139], v[40:43], v[72:75]
    v_mfma_f32_16x16x32_bf16 v[76:79], a[140:143], v[40:43], v[76:79]
    s_waitcnt lgkmcnt(4)
    v_mfma_f32_16x16x32_bf16 v[64:67], a[144:147], v[44:47], v[64:67]
    v_mfma_f32_16x16x32_bf16 v[68:71], a[148:151], v[44:47], v[68:71]
    v_mfma_f32_16x16x32_bf16 v[72:75], a[152:155], v[44:47], v[72:75]
    v_mfma_f32_16x16x32_bf16 v[76:79], a[156:159], v[44:47], v[76:79]
    s_waitcnt lgkmcnt(3)
    v_mfma_f32_16x16x32_bf16 v[64:67], a[160:163], v[16:19], v[64:67]
    v_mfma_f32_16x16x32_bf16 v[68:71], a[164:167], v[16:19], v[68:71]
    v_mfma_f32_16x16x32_bf16 v[72:75], a[168:171], v[16:19], v[72:75]
    v_mfma_f32_16x16x32_bf16 v[76:79], a[172:175], v[16:19], v[76:79]
    s_waitcnt lgkmcnt(2)
    v_mfma_f32_16x16x32_bf16 v[64:67], a[176:179], v[20:23], v[64:67]
    v_mfma_f32_16x16x32_bf16 v[68:71], a[180:183], v[20:23], v[68:71]
    v_mfma_f32_16x16x32_bf16 v[72:75], a[184:187], v[20:23], v[72:75]
    v_mfma_f32_16x16x32_bf16 v[76:79], a[188:191], v[20:23], v[76:79]
    s_waitcnt lgkmcnt(1)
    v_mfma_f32_16x16x32_bf16 v[64:67], a[192:195], v[24:27], v[64:67]
    v_mfma_f32_16x16x32_bf16 v[68:71], a[196:199], v[24:27], v[68:71]
    v_mfma_f32_16x16x32_bf16 v[72:75], a[200:203], v[24:27], v[72:75]
    v_mfma_f32_16x16x32_bf16 v[76:79], a[204:207], v[24:27], v[76:79]
    s_waitcnt lgkmcnt(0)
    v_mfma_f32_16x16x32_bf16 v[64:67], a[208:211], v[28:31], v[64:67]
    v_mfma_f32_16x16x32_bf16 v[68:71], a[212:215], v[28:31], v[68:71]
    v_mfma_f32_16x16x32_bf16 v[72:75], a[216:219], v[28:31], v[72:75]
    v_mfma_f32_16x16x32_bf16 v[76:79], a[220:223], v[28:31], v[76:79]
    s_nop 7
    v_cvt_pk_bf16_f32 v80, v48, v49
    v_cvt_pk_bf16_f32 v81, v64, v65
    v_cvt_pk_bf16_f32 v82, v50, v51
    v_cvt_pk_bf16_f32 v83, v66, v67
    v_cvt_pk_bf16_f32 v84, v52, v53
    v_cvt_pk_bf16_f32 v85, v68, v69
    v_cvt_pk_bf16_f32 v86, v54, v55
    v_cvt_pk_bf16_f32 v87, v70, v71
    s_add_u32 s22, s18, 65536
    s_addc_u32 s23, s19, 0
    global_store_dwordx4 v8, v[80:83], s[22:23] sc1
    global_store_dwordx4 v8, v[84:87], s[22:23] offset:1024 sc1
    v_cvt_pk_bf16_f32 v88, v56, v57
    v_cvt_pk_bf16_f32 v89, v72, v73
    v_cvt_pk_bf16_f32 v90, v58, v59
    v_cvt_pk_bf16_f32 v91, v74, v75
    v_cvt_pk_bf16_f32 v92, v60, v61
    v_cvt_pk_bf16_f32 v93, v76, v77
    v_cvt_pk_bf16_f32 v94, v62, v63
    v_cvt_pk_bf16_f32 v95, v78, v79
    s_add_u32 s22, s18, 524288
    s_addc_u32 s23, s19, 0
    global_store_dwordx4 v8, v[88:91], s[22:23] sc1
    global_store_dwordx4 v8, v[92:95], s[22:23] offset:1024 sc1
    s_waitcnt vmcnt(11)
    s_barrier
    ds_read_b128 v[16:19], v13 offset:0
    ds_read_b128 v[20:23], v13 offset:1024
    ds_read_b128 v[24:27], v13 offset:2048
    ds_read_b128 v[28:31], v13 offset:3072
    ds_read_b128 v[32:35], v13 offset:4096
    ds_read_b128 v[36:39], v13 offset:5120
    ds_read_b128 v[40:43], v13 offset:6144
    ds_read_b128 v[44:47], v13 offset:7168
    s_waitcnt lgkmcnt(7)
    v_mfma_f32_16x16x32_bf16 v[48:51], a[0:3], v[16:19], 0
    v_mfma_f32_16x16x32_bf16 v[52:55], a[4:7], v[16:19], 0
    v_mfma_f32_16x16x32_bf16 v[56:59], a[8:11], v[16:19], 0
    v_mfma_f32_16x16x32_bf16 v[60:63], a[12:15], v[16:19], 0
    ds_read_b128 v[16:19], v13 offset:8192
    s_waitcnt lgkmcnt(7)
    v_mfma_f32_16x16x32_bf16 v[48:51], a[16:19], v[20:23], v[48:51]
    v_mfma_f32_16x16x32_bf16 v[52:55], a[20:23], v[20:23], v[52:55]
    v_mfma_f32_16x16x32_bf16 v[56:59], a[24:27], v[20:23], v[56:59]
    v_mfma_f32_16x16x32_bf16 v[60:63], a[28:31], v[20:23], v[60:63]
    ds_read_b128 v[20:23], v13 offset:9216
    s_waitcnt lgkmcnt(7)
    v_mfma_f32_16x16x32_bf16 v[48:51], a[32:35], v[24:27], v[48:51]
    v_mfma_f32_16x16x32_bf16 v[52:55], a[36:39], v[24:27], v[52:55]
    v_mfma_f32_16x16x32_bf16 v[56:59], a[40:43], v[24:27], v[56:59]
    v_mfma_f32_16x16x32_bf16 v[60:63], a[44:47], v[24:27], v[60:63]
    ds_read_b128 v[24:27], v13 offset:10240
    s_waitcnt lgkmcnt(7)
    v_mfma_f32_16x16x32_bf16 v[48:51], a[48:51], v[28:31], v[48:51]
    v_mfma_f32_16x16x32_bf16 v[52:55], a[52:55], v[28:31], v[52:55]
    v_mfma_f32_16x16x32_bf16 v[56:59], a[56:59], v[28:31], v[56:59]
    v_mfma_f32_16x16x32_bf16 v[60:63], a[60:63], v[28:31], v[60:63]
    ds_read_b128 v[28:31], v13 offset:11264
    s_waitcnt lgkmcnt(7)
    v_mfma_f32_16x16x32_bf16 v[48:51], a[64:67], v[32:35], v[48:51]
    v_mfma_f32_16x16x32_bf16 v[52:55], a[68:71], v[32:35], v[52:55]
    v_mfma_f32_16x16x32_bf16 v[56:59], a[72:75], v[32:35], v[56:59]
    v_mfma_f32_16x16x32_bf16 v[60:63], a[76:79], v[32:35], v[60:63]
    ds_read_b128 v[32:35], v13 offset:12288
    s_waitcnt lgkmcnt(7)
    v_mfma_f32_16x16x32_bf16 v[48:51], a[80:83], v[36:39], v[48:51]
    v_mfma_f32_16x16x32_bf16 v[52:55], a[84:87], v[36:39], v[52:55]
    v_mfma_f32_16x16x32_bf16 v[56:59], a[88:91], v[36:39], v[56:59]
    v_mfma_f32_16x16x32_bf16 v[60:63], a[92:95], v[36:39], v[60:63]
    ds_read_b128 v[36:39], v13 offset:13312
    s_waitcnt lgkmcnt(7)
    v_mfma_f32_16x16x32_bf16 v[48:51], a[96:99], v[40:43], v[48:51]
    v_mfma_f32_16x16x32_bf16 v[52:55], a[100:103], v[40:43], v[52:55]
    v_mfma_f32_16x16x32_bf16 v[56:59], a[104:107], v[40:43], v[56:59]
    v_mfma_f32_16x16x32_bf16 v[60:63], a[108:111], v[40:43], v[60:63]
    ds_read_b128 v[40:43], v13 offset:14336
    s_waitcnt lgkmcnt(7)
    v_mfma_f32_16x16x32_bf16 v[48:51], a[112:115], v[44:47], v[48:51]
    v_mfma_f32_16x16x32_bf16 v[52:55], a[116:119], v[44:47], v[52:55]
    v_mfma_f32_16x16x32_bf16 v[56:59], a[120:123], v[44:47], v[56:59]
    v_mfma_f32_16x16x32_bf16 v[60:63], a[124:127], v[44:47], v[60:63]
    ds_read_b128 v[44:47], v13 offset:15360
    s_waitcnt lgkmcnt(7)
    v_mfma_f32_16x16x32_bf16 v[48:51], a[128:131], v[16:19], v[48:51]
    v_mfma_f32_16x16x32_bf16 v[52:55], a[132:135], v[16:19], v[52:55]
    v_mfma_f32_16x16x32_bf16 v[56:59], a[136:139], v[16:19], v[56:59]
    v_mfma_f32_16x16x32_bf16 v[60:63], a[140:143], v[16:19], v[60:63]
    ds_read_b128 v[16:19], v13 offset:16384
    s_waitcnt lgkmcnt(7)
    v_mfma_f32_16x16x32_bf16 v[48:51], a[144:147], v[20:23], v[48:51]
    v_mfma_f32_16x16x32_bf16 v[52:55], a[148:151], v[20:23], v[52:55]
    v_mfma_f32_16x16x32_bf16 v[56:59], a[152:155], v[20:23], v[56:59]
    v_mfma_f32_16x16x32_bf16 v[60:63], a[156:159], v[20:23], v[60:63]
    ds_read_b128 v[20:23], v13 offset:17408
    s_waitcnt lgkmcnt(7)
    v_mfma_f32_16x16x32_bf16 v[48:51], a[160:163], v[24:27], v[48:51]
    v_mfma_f32_16x16x32_bf16 v[52:55], a[164:167], v[24:27], v[52:55]
    v_mfma_f32_16x16x32_bf16 v[56:59], a[168:171], v[24:27], v[56:59]
    v_mfma_f32_16x16x32_bf16 v[60:63], a[172:175], v[24:27], v[60:63]
    ds_read_b128 v[24:27], v13 offset:18432
    s_waitcnt lgkmcnt(7)
    v_mfma_f32_16x16x32_bf16 v[48:51], a[176:179], v[28:31], v[48:51]
    v_mfma_f32_16x16x32_bf16 v[52:55], a[180:183], v[28:31], v[52:55]
    v_mfma_f32_16x16x32_bf16 v[56:59], a[184:187], v[28:31], v[56:59]
    v_mfma_f32_16x16x32_bf16 v[60:63], a[188:191], v[28:31], v[60:63]
    ds_read_b128 v[28:31], v13 offset:19456
    s_waitcnt lgkmcnt(7)
    v_mfma_f32_16x16x32_bf16 v[48:51], a[192:195], v[32:35], v[48:51]
    v_mfma_f32_16x16x32_bf16 v[52:55], a[196:199], v[32:35], v[52:55]
    v_mfma_f32_16x16x32_bf16 v[56:59], a[200:203], v[32:35], v[56:59]
    v_mfma_f32_16x16x32_bf16 v[60:63], a[204:207], v[32:35], v[60:63]
    ds_read_b128 v[32:35], v13 offset:20480
    s_waitcnt lgkmcnt(7)
    v_mfma_f32_16x16x32_bf16 v[48:51], a[208:211], v[36:39], v[48:51]
    v_mfma_f32_16x16x32_bf16 v[52:55], a[212:215], v[36:39], v[52:55]
    v_mfma_f32_16x16x32_bf16 v[56:59], a[216:219], v[36:39], v[56:59]
    v_mfma_f32_16x16x32_bf16 v[60:63], a[220:223], v[36:39], v[60:63]
    ds_read_b128 v[36:39], v13 offset:21504
    s_waitcnt lgkmcnt(7)
    v_mfma_f32_16x16x32_bf16 v[64:67], a[0:3], v[40:43], 0
    v_mfma_f32_16x16x32_bf16 v[68:71], a[4:7], v[40:43], 0
    v_mfma_f32_16x16x32_bf16 v[72:75], a[8:11], v[40:43], 0
    v_mfma_f32_16x16x32_bf16 v[76:79], a[12:15], v[40:43], 0
    ds_read_b128 v[40:43], v13 offset:22528
    s_waitcnt lgkmcnt(7)
    v_mfma_f32_16x16x32_bf16 v[64:67], a[16:19], v[44:47], v[64:67]
    v_mfma_f32_16x16x32_bf16 v[68:71], a[20:23], v[44:47], v[68:71]
    v_mfma_f32_16x16x32_bf16 v[72:75], a[24:27], v[44:47], v[72:75]
    v_mfma_f32_16x16x32_bf16 v[76:79], a[28:31], v[44:47], v[76:79]
    ds_read_b128 v[44:47], v13 offset:23552
    s_waitcnt lgkmcnt(7)
    v_mfma_f32_16x16x32_bf16 v[64:67], a[32:35], v[16:19], v[64:67]
    v_mfma_f32_16x16x32_bf16 v[68:71], a[36:39], v[16:19], v[68:71]
    v_mfma_f32_16x16x32_bf16 v[72:75], a[40:43], v[16:19], v[72:75]
    v_mfma_f32_16x16x32_bf16 v[76:79], a[44:47], v[16:19], v[76:79]
    ds_read_b128 v[16:19], v13 offset:24576
    s_waitcnt lgkmcnt(7)
    v_mfma_f32_16x16x32_bf16 v[64:67], a[48:51], v[20:23], v[64:67]
    v_mfma_f32_16x16x32_bf16 v[68:71], a[52:55], v[20:23], v[68:71]
    v_mfma_f32_16x16x32_bf16 v[72:75], a[56:59], v[20:23], v[72:75]
    v_mfma_f32_16x16x32_bf16 v[76:79], a[60:63], v[20:23], v[76:79]
    ds_read_b128 v[20:23], v13 offset:25600
    s_waitcnt lgkmcnt(7)
    v_mfma_f32_16x16x32_bf16 v[64:67], a[64:67], v[24:27], v[64:67]
    v_mfma_f32_16x16x32_bf16 v[68:71], a[68:71], v[24:27], v[68:71]
    v_mfma_f32_16x16x32_bf16 v[72:75], a[72:75], v[24:27], v[72:75]
    v_mfma_f32_16x16x32_bf16 v[76:79], a[76:79], v[24:27], v[76:79]
    ds_read_b128 v[24:27], v13 offset:26624
    s_waitcnt lgkmcnt(7)
    v_mfma_f32_16x16x32_bf16 v[64:67], a[80:83], v[28:31], v[64:67]
    v_mfma_f32_16x16x32_bf16 v[68:71], a[84:87], v[28:31], v[68:71]
    v_mfma_f32_16x16x32_bf16 v[72:75], a[88:91], v[28:31], v[72:75]
    v_mfma_f32_16x16x32_bf16 v[76:79], a[92:95], v[28:31], v[76:79]
    ds_read_b128 v[28:31], v13 offset:27648
    s_waitcnt lgkmcnt(7)
    v_mfma_f32_16x16x32_bf16 v[64:67], a[96:99], v[32:35], v[64:67]
    v_mfma_f32_16x16x32_bf16 v[68:71], a[100:103], v[32:35], v[68:71]
    v_mfma_f32_16x16x32_bf16 v[72:75], a[104:107], v[32:35], v[72:75]
    v_mfma_f32_16x16x32_bf16 v[76:79], a[108:111], v[32:35], v[76:79]
    s_waitcnt lgkmcnt(6)
    v_mfma_f32_16x16x32_bf16 v[64:67], a[112:115], v[36:39], v[64:67]
    v_mfma_f32_16x16x32_bf16 v[68:71], a[116:119], v[36:39], v[68:71]
    v_mfma_f32_16x16x32_bf16 v[72:75], a[120:123], v[36:39], v[72:75]
    v_mfma_f32_16x16x32_bf16 v[76:79], a[124:127], v[36:39], v[76:79]
    s_waitcnt lgkmcnt(5)
    v_mfma_f32_16x16x32_bf16 v[64:67], a[128:131], v[40:43], v[64:67]
    v_mfma_f32_16x16x32_bf16 v[68:71], a[132:135], v[40:43], v[68:71]
    v_mfma_f32_16x16x32_bf16 v[72:75], a[136:139], v[40:43], v[72:75]
    v_mfma_f32_16x16x32_bf16 v[76:79], a[140:143], v[40:43], v[76:79]
    s_waitcnt lgkmcnt(4)
    v_mfma_f32_16x16x32_bf16 v[64:67], a[144:147], v[44:47], v[64:67]
    v_mfma_f32_16x16x32_bf16 v[68:71], a[148:151], v[44:47], v[68:71]
    v_mfma_f32_16x16x32_bf16 v[72:75], a[152:155], v[44:47], v[72:75]
    v_mfma_f32_16x16x32_bf16 v[76:79], a[156:159], v[44:47], v[76:79]
    s_waitcnt lgkmcnt(3)
    v_mfma_f32_16x16x32_bf16 v[64:67], a[160:163], v[16:19], v[64:67]
    v_mfma_f32_16x16x32_bf16 v[68:71], a[164:167], v[16:19], v[68:71]
    v_mfma_f32_16x16x32_bf16 v[72:75], a[168:171], v[16:19], v[72:75]
    v_mfma_f32_16x16x32_bf16 v[76:79], a[172:175], v[16:19], v[76:79]
    s_waitcnt lgkmcnt(2)
    v_mfma_f32_16x16x32_bf16 v[64:67], a[176:179], v[20:23], v[64:67]
    v_mfma_f32_16x16x32_bf16 v[68:71], a[180:183], v[20:23], v[68:71]
    v_mfma_f32_16x16x32_bf16 v[72:75], a[184:187], v[20:23], v[72:75]
    v_mfma_f32_16x16x32_bf16 v[76:79], a[188:191], v[20:23], v[76:79]
    s_waitcnt lgkmcnt(1)
    v_mfma_f32_16x16x32_bf16 v[64:67], a[192:195], v[24:27], v[64:67]
    v_mfma_f32_16x16x32_bf16 v[68:71], a[196:199], v[24:27], v[68:71]
    v_mfma_f32_16x16x32_bf16 v[72:75], a[200:203], v[24:27], v[72:75]
    v_mfma_f32_16x16x32_bf16 v[76:79], a[204:207], v[24:27], v[76:79]
    s_waitcnt lgkmcnt(0)
    v_mfma_f32_16x16x32_bf16 v[64:67], a[208:211], v[28:31], v[64:67]
    v_mfma_f32_16x16x32_bf16 v[68:71], a[212:215], v[28:31], v[68:71]
    v_mfma_f32_16x16x32_bf16 v[72:75], a[216:219], v[28:31], v[72:75]
    v_mfma_f32_16x16x32_bf16 v[76:79], a[220:223], v[28:31], v[76:79]
    s_nop 7
    v_cvt_pk_bf16_f32 v80, v48, v49
    v_cvt_pk_bf16_f32 v81, v64, v65
    v_cvt_pk_bf16_f32 v82, v50, v51
    v_cvt_pk_bf16_f32 v83, v66, v67
    v_cvt_pk_bf16_f32 v84, v52, v53
    v_cvt_pk_bf16_f32 v85, v68, v69
    v_cvt_pk_bf16_f32 v86, v54, v55
    v_cvt_pk_bf16_f32 v87, v70, v71
    s_add_u32 s22, s18, 81920
    s_addc_u32 s23, s19, 0
    global_store_dwordx4 v8, v[80:83], s[22:23] sc1
    global_store_dwordx4 v8, v[84:87], s[22:23] offset:1024 sc1
    v_cvt_pk_bf16_f32 v88, v56, v57
    v_cvt_pk_bf16_f32 v89, v72, v73
    v_cvt_pk_bf16_f32 v90, v58, v59
    v_cvt_pk_bf16_f32 v91, v74, v75
    v_cvt_pk_bf16_f32 v92, v60, v61
    v_cvt_pk_bf16_f32 v93, v76, v77
    v_cvt_pk_bf16_f32 v94, v62, v63
    v_cvt_pk_bf16_f32 v95, v78, v79
    s_add_u32 s22, s18, 540672
    s_addc_u32 s23, s19, 0
    global_store_dwordx4 v8, v[88:91], s[22:23] sc1
    global_store_dwordx4 v8, v[92:95], s[22:23] offset:1024 sc1
    s_waitcnt vmcnt(4)
    s_barrier
    ds_read_b128 v[16:19], v8 offset:0
    ds_read_b128 v[20:23], v8 offset:1024
    ds_read_b128 v[24:27], v8 offset:2048
    ds_read_b128 v[28:31], v8 offset:3072
    ds_read_b128 v[32:35], v8 offset:4096
    ds_read_b128 v[36:39], v8 offset:5120
    ds_read_b128 v[40:43], v8 offset:6144
    ds_read_b128 v[44:47], v8 offset:7168
    s_waitcnt lgkmcnt(7)
    v_mfma_f32_16x16x32_bf16 v[48:51], a[0:3], v[16:19], 0
    v_mfma_f32_16x16x32_bf16 v[52:55], a[4:7], v[16:19], 0
    v_mfma_f32_16x16x32_bf16 v[56:59], a[8:11], v[16:19], 0
    v_mfma_f32_16x16x32_bf16 v[60:63], a[12:15], v[16:19], 0
    ds_read_b128 v[16:19], v8 offset:8192
    s_waitcnt lgkmcnt(7)
    v_mfma_f32_16x16x32_bf16 v[48:51], a[16:19], v[20:23], v[48:51]
    v_mfma_f32_16x16x32_bf16 v[52:55], a[20:23], v[20:23], v[52:55]
    v_mfma_f32_16x16x32_bf16 v[56:59], a[24:27], v[20:23], v[56:59]
    v_mfma_f32_16x16x32_bf16 v[60:63], a[28:31], v[20:23], v[60:63]
    ds_read_b128 v[20:23], v8 offset:9216
    s_waitcnt lgkmcnt(7)
    v_mfma_f32_16x16x32_bf16 v[48:51], a[32:35], v[24:27], v[48:51]
    v_mfma_f32_16x16x32_bf16 v[52:55], a[36:39], v[24:27], v[52:55]
    v_mfma_f32_16x16x32_bf16 v[56:59], a[40:43], v[24:27], v[56:59]
    v_mfma_f32_16x16x32_bf16 v[60:63], a[44:47], v[24:27], v[60:63]
    ds_read_b128 v[24:27], v8 offset:10240
    s_waitcnt lgkmcnt(7)
    v_mfma_f32_16x16x32_bf16 v[48:51], a[48:51], v[28:31], v[48:51]
    v_mfma_f32_16x16x32_bf16 v[52:55], a[52:55], v[28:31], v[52:55]
    v_mfma_f32_16x16x32_bf16 v[56:59], a[56:59], v[28:31], v[56:59]
    v_mfma_f32_16x16x32_bf16 v[60:63], a[60:63], v[28:31], v[60:63]
    ds_read_b128 v[28:31], v8 offset:11264
    s_waitcnt lgkmcnt(7)
    v_mfma_f32_16x16x32_bf16 v[48:51], a[64:67], v[32:35], v[48:51]
    v_mfma_f32_16x16x32_bf16 v[52:55], a[68:71], v[32:35], v[52:55]
    v_mfma_f32_16x16x32_bf16 v[56:59], a[72:75], v[32:35], v[56:59]
    v_mfma_f32_16x16x32_bf16 v[60:63], a[76:79], v[32:35], v[60:63]
    ds_read_b128 v[32:35], v8 offset:12288
    s_waitcnt lgkmcnt(7)
    v_mfma_f32_16x16x32_bf16 v[48:51], a[80:83], v[36:39], v[48:51]
    v_mfma_f32_16x16x32_bf16 v[52:55], a[84:87], v[36:39], v[52:55]
    v_mfma_f32_16x16x32_bf16 v[56:59], a[88:91], v[36:39], v[56:59]
    v_mfma_f32_16x16x32_bf16 v[60:63], a[92:95], v[36:39], v[60:63]
    ds_read_b128 v[36:39], v8 offset:13312
    s_waitcnt lgkmcnt(7)
    v_mfma_f32_16x16x32_bf16 v[48:51], a[96:99], v[40:43], v[48:51]
    v_mfma_f32_16x16x32_bf16 v[52:55], a[100:103], v[40:43], v[52:55]
    v_mfma_f32_16x16x32_bf16 v[56:59], a[104:107], v[40:43], v[56:59]
    v_mfma_f32_16x16x32_bf16 v[60:63], a[108:111], v[40:43], v[60:63]
    ds_read_b128 v[40:43], v8 offset:14336
    s_waitcnt lgkmcnt(7)
    v_mfma_f32_16x16x32_bf16 v[48:51], a[112:115], v[44:47], v[48:51]
    v_mfma_f32_16x16x32_bf16 v[52:55], a[116:119], v[44:47], v[52:55]
    v_mfma_f32_16x16x32_bf16 v[56:59], a[120:123], v[44:47], v[56:59]
    v_mfma_f32_16x16x32_bf16 v[60:63], a[124:127], v[44:47], v[60:63]
    ds_read_b128 v[44:47], v8 offset:15360
    s_waitcnt lgkmcnt(7)
    v_mfma_f32_16x16x32_bf16 v[48:51], a[128:131], v[16:19], v[48:51]
    v_mfma_f32_16x16x32_bf16 v[52:55], a[132:135], v[16:19], v[52:55]
    v_mfma_f32_16x16x32_bf16 v[56:59], a[136:139], v[16:19], v[56:59]
    v_mfma_f32_16x16x32_bf16 v[60:63], a[140:143], v[16:19], v[60:63]
    ds_read_b128 v[16:19], v8 offset:16384
    s_waitcnt lgkmcnt(7)
    v_mfma_f32_16x16x32_bf16 v[48:51], a[144:147], v[20:23], v[48:51]
    v_mfma_f32_16x16x32_bf16 v[52:55], a[148:151], v[20:23], v[52:55]
    v_mfma_f32_16x16x32_bf16 v[56:59], a[152:155], v[20:23], v[56:59]
    v_mfma_f32_16x16x32_bf16 v[60:63], a[156:159], v[20:23], v[60:63]
    ds_read_b128 v[20:23], v8 offset:17408
    s_waitcnt lgkmcnt(7)
    v_mfma_f32_16x16x32_bf16 v[48:51], a[160:163], v[24:27], v[48:51]
    v_mfma_f32_16x16x32_bf16 v[52:55], a[164:167], v[24:27], v[52:55]
    v_mfma_f32_16x16x32_bf16 v[56:59], a[168:171], v[24:27], v[56:59]
    v_mfma_f32_16x16x32_bf16 v[60:63], a[172:175], v[24:27], v[60:63]
    ds_read_b128 v[24:27], v8 offset:18432
    s_waitcnt lgkmcnt(7)
    v_mfma_f32_16x16x32_bf16 v[48:51], a[176:179], v[28:31], v[48:51]
    v_mfma_f32_16x16x32_bf16 v[52:55], a[180:183], v[28:31], v[52:55]
    v_mfma_f32_16x16x32_bf16 v[56:59], a[184:187], v[28:31], v[56:59]
    v_mfma_f32_16x16x32_bf16 v[60:63], a[188:191], v[28:31], v[60:63]
    ds_read_b128 v[28:31], v8 offset:19456
    s_waitcnt lgkmcnt(7)
    v_mfma_f32_16x16x32_bf16 v[48:51], a[192:195], v[32:35], v[48:51]
    v_mfma_f32_16x16x32_bf16 v[52:55], a[196:199], v[32:35], v[52:55]
    v_mfma_f32_16x16x32_bf16 v[56:59], a[200:203], v[32:35], v[56:59]
    v_mfma_f32_16x16x32_bf16 v[60:63], a[204:207], v[32:35], v[60:63]
    ds_read_b128 v[32:35], v8 offset:20480
    s_waitcnt lgkmcnt(7)
    v_mfma_f32_16x16x32_bf16 v[48:51], a[208:211], v[36:39], v[48:51]
    v_mfma_f32_16x16x32_bf16 v[52:55], a[212:215], v[36:39], v[52:55]
    v_mfma_f32_16x16x32_bf16 v[56:59], a[216:219], v[36:39], v[56:59]
    v_mfma_f32_16x16x32_bf16 v[60:63], a[220:223], v[36:39], v[60:63]
    ds_read_b128 v[36:39], v8 offset:21504
    s_waitcnt lgkmcnt(7)
    v_mfma_f32_16x16x32_bf16 v[64:67], a[0:3], v[40:43], 0
    v_mfma_f32_16x16x32_bf16 v[68:71], a[4:7], v[40:43], 0
    v_mfma_f32_16x16x32_bf16 v[72:75], a[8:11], v[40:43], 0
    v_mfma_f32_16x16x32_bf16 v[76:79], a[12:15], v[40:43], 0
    ds_read_b128 v[40:43], v8 offset:22528
    s_waitcnt lgkmcnt(7)
    v_mfma_f32_16x16x32_bf16 v[64:67], a[16:19], v[44:47], v[64:67]
    v_mfma_f32_16x16x32_bf16 v[68:71], a[20:23], v[44:47], v[68:71]
    v_mfma_f32_16x16x32_bf16 v[72:75], a[24:27], v[44:47], v[72:75]
    v_mfma_f32_16x16x32_bf16 v[76:79], a[28:31], v[44:47], v[76:79]
    ds_read_b128 v[44:47], v8 offset:23552
    s_waitcnt lgkmcnt(7)
    v_mfma_f32_16x16x32_bf16 v[64:67], a[32:35], v[16:19], v[64:67]
    v_mfma_f32_16x16x32_bf16 v[68:71], a[36:39], v[16:19], v[68:71]
    v_mfma_f32_16x16x32_bf16 v[72:75], a[40:43], v[16:19], v[72:75]
    v_mfma_f32_16x16x32_bf16 v[76:79], a[44:47], v[16:19], v[76:79]
    ds_read_b128 v[16:19], v8 offset:24576
    s_waitcnt lgkmcnt(7)
    v_mfma_f32_16x16x32_bf16 v[64:67], a[48:51], v[20:23], v[64:67]
    v_mfma_f32_16x16x32_bf16 v[68:71], a[52:55], v[20:23], v[68:71]
    v_mfma_f32_16x16x32_bf16 v[72:75], a[56:59], v[20:23], v[72:75]
    v_mfma_f32_16x16x32_bf16 v[76:79], a[60:63], v[20:23], v[76:79]
    ds_read_b128 v[20:23], v8 offset:25600
    s_waitcnt lgkmcnt(7)
    v_mfma_f32_16x16x32_bf16 v[64:67], a[64:67], v[24:27], v[64:67]
    v_mfma_f32_16x16x32_bf16 v[68:71], a[68:71], v[24:27], v[68:71]
    v_mfma_f32_16x16x32_bf16 v[72:75], a[72:75], v[24:27], v[72:75]
    v_mfma_f32_16x16x32_bf16 v[76:79], a[76:79], v[24:27], v[76:79]
    ds_read_b128 v[24:27], v8 offset:26624
    s_waitcnt lgkmcnt(7)
    v_mfma_f32_16x16x32_bf16 v[64:67], a[80:83], v[28:31], v[64:67]
    v_mfma_f32_16x16x32_bf16 v[68:71], a[84:87], v[28:31], v[68:71]
    v_mfma_f32_16x16x32_bf16 v[72:75], a[88:91], v[28:31], v[72:75]
    v_mfma_f32_16x16x32_bf16 v[76:79], a[92:95], v[28:31], v[76:79]
    ds_read_b128 v[28:31], v8 offset:27648
    s_waitcnt lgkmcnt(7)
    v_mfma_f32_16x16x32_bf16 v[64:67], a[96:99], v[32:35], v[64:67]
    v_mfma_f32_16x16x32_bf16 v[68:71], a[100:103], v[32:35], v[68:71]
    v_mfma_f32_16x16x32_bf16 v[72:75], a[104:107], v[32:35], v[72:75]
    v_mfma_f32_16x16x32_bf16 v[76:79], a[108:111], v[32:35], v[76:79]
    s_waitcnt lgkmcnt(6)
    v_mfma_f32_16x16x32_bf16 v[64:67], a[112:115], v[36:39], v[64:67]
    v_mfma_f32_16x16x32_bf16 v[68:71], a[116:119], v[36:39], v[68:71]
    v_mfma_f32_16x16x32_bf16 v[72:75], a[120:123], v[36:39], v[72:75]
    v_mfma_f32_16x16x32_bf16 v[76:79], a[124:127], v[36:39], v[76:79]
    s_waitcnt lgkmcnt(5)
    v_mfma_f32_16x16x32_bf16 v[64:67], a[128:131], v[40:43], v[64:67]
    v_mfma_f32_16x16x32_bf16 v[68:71], a[132:135], v[40:43], v[68:71]
    v_mfma_f32_16x16x32_bf16 v[72:75], a[136:139], v[40:43], v[72:75]
    v_mfma_f32_16x16x32_bf16 v[76:79], a[140:143], v[40:43], v[76:79]
    s_waitcnt lgkmcnt(4)
    v_mfma_f32_16x16x32_bf16 v[64:67], a[144:147], v[44:47], v[64:67]
    v_mfma_f32_16x16x32_bf16 v[68:71], a[148:151], v[44:47], v[68:71]
    v_mfma_f32_16x16x32_bf16 v[72:75], a[152:155], v[44:47], v[72:75]
    v_mfma_f32_16x16x32_bf16 v[76:79], a[156:159], v[44:47], v[76:79]
    s_waitcnt lgkmcnt(3)
    v_mfma_f32_16x16x32_bf16 v[64:67], a[160:163], v[16:19], v[64:67]
    v_mfma_f32_16x16x32_bf16 v[68:71], a[164:167], v[16:19], v[68:71]
    v_mfma_f32_16x16x32_bf16 v[72:75], a[168:171], v[16:19], v[72:75]
    v_mfma_f32_16x16x32_bf16 v[76:79], a[172:175], v[16:19], v[76:79]
    s_waitcnt lgkmcnt(2)
    v_mfma_f32_16x16x32_bf16 v[64:67], a[176:179], v[20:23], v[64:67]
    v_mfma_f32_16x16x32_bf16 v[68:71], a[180:183], v[20:23], v[68:71]
    v_mfma_f32_16x16x32_bf16 v[72:75], a[184:187], v[20:23], v[72:75]
    v_mfma_f32_16x16x32_bf16 v[76:79], a[188:191], v[20:23], v[76:79]
    s_waitcnt lgkmcnt(1)
    v_mfma_f32_16x16x32_bf16 v[64:67], a[192:195], v[24:27], v[64:67]
    v_mfma_f32_16x16x32_bf16 v[68:71], a[196:199], v[24:27], v[68:71]
    v_mfma_f32_16x16x32_bf16 v[72:75], a[200:203], v[24:27], v[72:75]
    v_mfma_f32_16x16x32_bf16 v[76:79], a[204:207], v[24:27], v[76:79]
    s_waitcnt lgkmcnt(0)
    v_mfma_f32_16x16x32_bf16 v[64:67], a[208:211], v[28:31], v[64:67]
    v_mfma_f32_16x16x32_bf16 v[68:71], a[212:215], v[28:31], v[68:71]
    v_mfma_f32_16x16x32_bf16 v[72:75], a[216:219], v[28:31], v[72:75]
    v_mfma_f32_16x16x32_bf16 v[76:79], a[220:223], v[28:31], v[76:79]
    s_nop 7
    v_cvt_pk_bf16_f32 v80, v48, v49
    v_cvt_pk_bf16_f32 v81, v64, v65
    v_cvt_pk_bf16_f32 v82, v50, v51
    v_cvt_pk_bf16_f32 v83, v66, v67
    v_cvt_pk_bf16_f32 v84, v52, v53
    v_cvt_pk_bf16_f32 v85, v68, v69
    v_cvt_pk_bf16_f32 v86, v54, v55
    v_cvt_pk_bf16_f32 v87, v70, v71
    s_add_u32 s22, s18, 98304
    s_addc_u32 s23, s19, 0
    global_store_dwordx4 v8, v[80:83], s[22:23] sc1
    global_store_dwordx4 v8, v[84:87], s[22:23] offset:1024 sc1
    v_cvt_pk_bf16_f32 v88, v56, v57
    v_cvt_pk_bf16_f32 v89, v72, v73
    v_cvt_pk_bf16_f32 v90, v58, v59
    v_cvt_pk_bf16_f32 v91, v74, v75
    v_cvt_pk_bf16_f32 v92, v60, v61
    v_cvt_pk_bf16_f32 v93, v76, v77
    v_cvt_pk_bf16_f32 v94, v62, v63
    v_cvt_pk_bf16_f32 v95, v78, v79
    s_add_u32 s22, s18, 557056
    s_addc_u32 s23, s19, 0
    global_store_dwordx4 v8, v[88:91], s[22:23] sc1
    global_store_dwordx4 v8, v[92:95], s[22:23] offset:1024 sc1
    s_branch L_task_done
L_t_pb:
    s_cmp_ge_u32 s41, 563
    s_cbranch_scc1 L_t_b1
    s_mov_b32 s70, 1216
    s_mov_b32 s2, s41

    s_load_dwordx4 s[16:19], s[0:1], 64
    s_load_dwordx2 s[20:21], s[0:1], 80
    s_sub_u32 s9, s2, 544
    s_lshl_b32 s9, s9, 2
    s_add_u32 s9, s9, s8
    v_and_b32 v2, 15, v1
    v_lshrrev_b32 v3, 4, v1
    s_waitcnt lgkmcnt(0)
    s_cmp_ge_u32 s9, 48
    s_cbranch_scc1 L_pb_wof

    s_lshr_b32 s10, s9, 4
    s_and_b32 s11, s9, 15
    s_mul_i32 s12, s11, 1568

    v_lshl_add_u32 v4, v3, 3, 0
    v_add_u32 v5, 0, v2
    v_cmp_gt_u32 vcc, 28, v4
    v_cmp_gt_u32 s[22:23], 28, v5
    s_nop 1
    s_and_b64 s[22:23], s[22:23], vcc
    v_mul_u32_u24 v6, 56, v4
    v_lshl_add_u32 v6, v5, 1, v6
    v_add_u32 v6, s12, v6
    v_cndmask_b32 v6, 0, v6, s[22:23]
    global_load_ushort v40, v6, s[18:19]
    v_cmp_eq_u32 vcc, v4, v5
    v_mov_b32 v7, 0x3f80
    s_nop 1
    v_cndmask_b32 v60, 0, v7, vcc
    s_waitcnt vmcnt(0)
    v_cndmask_b32 v40, 0, v40, s[22:23]
    v_cndmask_b32 v60, 0, v60, s[22:23]
    v_lshl_add_u32 v4, v3, 3, 1
    v_add_u32 v5, 0, v2
    v_cmp_gt_u32 vcc, 28, v4
    v_cmp_gt_u32 s[22:23], 28, v5
    s_nop 1
    s_and_b64 s[22:23], s[22:23], vcc
    v_mul_u32_u24 v6, 56, v4
    v_lshl_add_u32 v6, v5, 1, v6
    v_add_u32 v6, s12, v6
    v_cndmask_b32 v6, 0, v6, s[22:23]
    global_load_ushort v41, v6, s[18:19]
    v_cmp_eq_u32 vcc, v4, v5
    v_mov_b32 v7, 0x3f80
    s_nop 1
    v_cndmask_b32 v61, 0, v7, vcc
    s_waitcnt vmcnt(0)
    v_cndmask_b32 v41, 0, v41, s[22:23]
    v_cndmask_b32 v61, 0, v61, s[22:23]
    v_lshl_add_u32 v4, v3, 3, 2
    v_add_u32 v5, 0, v2
    v_cmp_gt_u32 vcc, 28, v4
    v_cmp_gt_u32 s[22:23], 28, v5
    s_nop 1
    s_and_b64 s[22:23], s[22:23], vcc
    v_mul_u32_u24 v6, 56, v4
    v_lshl_add_u32 v6, v5, 1, v6
    v_add_u32 v6, s12, v6
    v_cndmask_b32 v6, 0, v6, s[22:23]
    global_load_ushort v42, v6, s[18:19]
    v_cmp_eq_u32 vcc, v4, v5
    v_mov_b32 v7, 0x3f80
    s_nop 1
    v_cndmask_b32 v62, 0, v7, vcc
    s_waitcnt vmcnt(0)
    v_cndmask_b32 v42, 0, v42, s[22:23]
    v_cndmask_b32 v62, 0, v62, s[22:23]
    v_lshl_add_u32 v4, v3, 3, 3
    v_add_u32 v5, 0, v2
    v_cmp_gt_u32 vcc, 28, v4
    v_cmp_gt_u32 s[22:23], 28, v5
    s_nop 1
    s_and_b64 s[22:23], s[22:23], vcc
    v_mul_u32_u24 v6, 56, v4
    v_lshl_add_u32 v6, v5, 1, v6
    v_add_u32 v6, s12, v6
    v_cndmask_b32 v6, 0, v6, s[22:23]
    global_load_ushort v43, v6, s[18:19]
    v_cmp_eq_u32 vcc, v4, v5
    v_mov_b32 v7, 0x3f80
    s_nop 1
    v_cndmask_b32 v63, 0, v7, vcc
    s_waitcnt vmcnt(0)
    v_cndmask_b32 v43, 0, v43, s[22:23]
    v_cndmask_b32 v63, 0, v63, s[22:23]
    v_lshl_add_u32 v4, v3, 3, 4
    v_add_u32 v5, 0, v2
    v_cmp_gt_u32 vcc, 28, v4
    v_cmp_gt_u32 s[22:23], 28, v5
    s_nop 1
    s_and_b64 s[22:23], s[22:23], vcc
    v_mul_u32_u24 v6, 56, v4
    v_lshl_add_u32 v6, v5, 1, v6
    v_add_u32 v6, s12, v6
    v_cndmask_b32 v6, 0, v6, s[22:23]
    global_load_ushort v44, v6, s[18:19]
    v_cmp_eq_u32 vcc, v4, v5
    v_mov_b32 v7, 0x3f80
    s_nop 1
    v_cndmask_b32 v64, 0, v7, vcc
    s_waitcnt vmcnt(0)
    v_cndmask_b32 v44, 0, v44, s[22:23]
    v_cndmask_b32 v64, 0, v64, s[22:23]
    v_lshl_add_u32 v4, v3, 3, 5
    v_add_u32 v5, 0, v2
    v_cmp_gt_u32 vcc, 28, v4
    v_cmp_gt_u32 s[22:23], 28, v5
    s_nop 1
    s_and_b64 s[22:23], s[22:23], vcc
    v_mul_u32_u24 v6, 56, v4
    v_lshl_add_u32 v6, v5, 1, v6
    v_add_u32 v6, s12, v6
    v_cndmask_b32 v6, 0, v6, s[22:23]
    global_load_ushort v45, v6, s[18:19]
    v_cmp_eq_u32 vcc, v4, v5
    v_mov_b32 v7, 0x3f80
    s_nop 1
    v_cndmask_b32 v65, 0, v7, vcc
    s_waitcnt vmcnt(0)
    v_cndmask_b32 v45, 0, v45, s[22:23]
    v_cndmask_b32 v65, 0, v65, s[22:23]
    v_lshl_add_u32 v4, v3, 3, 6
    v_add_u32 v5, 0, v2
    v_cmp_gt_u32 vcc, 28, v4
    v_cmp_gt_u32 s[22:23], 28, v5
    s_nop 1
    s_and_b64 s[22:23], s[22:23], vcc
    v_mul_u32_u24 v6, 56, v4
    v_lshl_add_u32 v6, v5, 1, v6
    v_add_u32 v6, s12, v6
    v_cndmask_b32 v6, 0, v6, s[22:23]
    global_load_ushort v46, v6, s[18:19]
    v_cmp_eq_u32 vcc, v4, v5
    v_mov_b32 v7, 0x3f80
    s_nop 1
    v_cndmask_b32 v66, 0, v7, vcc
    s_waitcnt vmcnt(0)
    v_cndmask_b32 v46, 0, v46, s[22:23]
    v_cndmask_b32 v66, 0, v66, s[22:23]
    v_lshl_add_u32 v4, v3, 3, 7
    v_add_u32 v5, 0, v2
    v_cmp_gt_u32 vcc, 28, v4
    v_cmp_gt_u32 s[22:23], 28, v5
    s_nop 1
    s_and_b64 s[22:23], s[22:23], vcc
    v_mul_u32_u24 v6, 56, v4
    v_lshl_add_u32 v6, v5, 1, v6
    v_add_u32 v6, s12, v6
    v_cndmask_b32 v6, 0, v6, s[22:23]
    global_load_ushort v47, v6, s[18:19]
    v_cmp_eq_u32 vcc, v4, v5
    v_mov_b32 v7, 0x3f80
    s_nop 1
    v_cndmask_b32 v67, 0, v7, vcc
    s_waitcnt vmcnt(0)
    v_cndmask_b32 v47, 0, v47, s[22:23]
    v_cndmask_b32 v67, 0, v67, s[22:23]
    v_lshl_add_u32 v4, v3, 3, 0
    v_add_u32 v5, 16, v2
    v_cmp_gt_u32 vcc, 28, v4
    v_cmp_gt_u32 s[22:23], 28, v5
    s_nop 1
    s_and_b64 s[22:23], s[22:23], vcc
    v_mul_u32_u24 v6, 56, v4
    v_lshl_add_u32 v6, v5, 1, v6
    v_add_u32 v6, s12, v6
    v_cndmask_b32 v6, 0, v6, s[22:23]
    global_load_ushort v48, v6, s[18:19]
    v_cmp_eq_u32 vcc, v4, v5
    v_mov_b32 v7, 0x3f80
    s_nop 1
    v_cndmask_b32 v68, 0, v7, vcc
    s_waitcnt vmcnt(0)
    v_cndmask_b32 v48, 0, v48, s[22:23]
    v_cndmask_b32 v68, 0, v68, s[22:23]
    v_lshl_add_u32 v4, v3, 3, 1
    v_add_u32 v5, 16, v2
    v_cmp_gt_u32 vcc, 28, v4
    v_cmp_gt_u32 s[22:23], 28, v5
    s_nop 1
    s_and_b64 s[22:23], s[22:23], vcc
    v_mul_u32_u24 v6, 56, v4
    v_lshl_add_u32 v6, v5, 1, v6
    v_add_u32 v6, s12, v6
    v_cndmask_b32 v6, 0, v6, s[22:23]
    global_load_ushort v49, v6, s[18:19]
    v_cmp_eq_u32 vcc, v4, v5
    v_mov_b32 v7, 0x3f80
    s_nop 1
    v_cndmask_b32 v69, 0, v7, vcc
    s_waitcnt vmcnt(0)
    v_cndmask_b32 v49, 0, v49, s[22:23]
    v_cndmask_b32 v69, 0, v69, s[22:23]
    v_lshl_add_u32 v4, v3, 3, 2
    v_add_u32 v5, 16, v2
    v_cmp_gt_u32 vcc, 28, v4
    v_cmp_gt_u32 s[22:23], 28, v5
    s_nop 1
    s_and_b64 s[22:23], s[22:23], vcc
    v_mul_u32_u24 v6, 56, v4
    v_lshl_add_u32 v6, v5, 1, v6
    v_add_u32 v6, s12, v6
    v_cndmask_b32 v6, 0, v6, s[22:23]
    global_load_ushort v50, v6, s[18:19]
    v_cmp_eq_u32 vcc, v4, v5
    v_mov_b32 v7, 0x3f80
    s_nop 1
    v_cndmask_b32 v70, 0, v7, vcc
    s_waitcnt vmcnt(0)
    v_cndmask_b32 v50, 0, v50, s[22:23]
    v_cndmask_b32 v70, 0, v70, s[22:23]
    v_lshl_add_u32 v4, v3, 3, 3
    v_add_u32 v5, 16, v2
    v_cmp_gt_u32 vcc, 28, v4
    v_cmp_gt_u32 s[22:23], 28, v5
    s_nop 1
    s_and_b64 s[22:23], s[22:23], vcc
    v_mul_u32_u24 v6, 56, v4
    v_lshl_add_u32 v6, v5, 1, v6
    v_add_u32 v6, s12, v6
    v_cndmask_b32 v6, 0, v6, s[22:23]
    global_load_ushort v51, v6, s[18:19]
    v_cmp_eq_u32 vcc, v4, v5
    v_mov_b32 v7, 0x3f80
    s_nop 1
    v_cndmask_b32 v71, 0, v7, vcc
    s_waitcnt vmcnt(0)
    v_cndmask_b32 v51, 0, v51, s[22:23]
    v_cndmask_b32 v71, 0, v71, s[22:23]
    v_lshl_add_u32 v4, v3, 3, 4
    v_add_u32 v5, 16, v2
    v_cmp_gt_u32 vcc, 28, v4
    v_cmp_gt_u32 s[22:23], 28, v5
    s_nop 1
    s_and_b64 s[22:23], s[22:23], vcc
    v_mul_u32_u24 v6, 56, v4
    v_lshl_add_u32 v6, v5, 1, v6
    v_add_u32 v6, s12, v6
    v_cndmask_b32 v6, 0, v6, s[22:23]
    global_load_ushort v52, v6, s[18:19]
    v_cmp_eq_u32 vcc, v4, v5
    v_mov_b32 v7, 0x3f80
    s_nop 1
    v_cndmask_b32 v72, 0, v7, vcc
    s_waitcnt vmcnt(0)
    v_cndmask_b32 v52, 0, v52, s[22:23]
    v_cndmask_b32 v72, 0, v72, s[22:23]
    v_lshl_add_u32 v4, v3, 3, 5
    v_add_u32 v5, 16, v2
    v_cmp_gt_u32 vcc, 28, v4
    v_cmp_gt_u32 s[22:23], 28, v5
    s_nop 1
    s_and_b64 s[22:23], s[22:23], vcc
    v_mul_u32_u24 v6, 56, v4
    v_lshl_add_u32 v6, v5, 1, v6
    v_add_u32 v6, s12, v6
    v_cndmask_b32 v6, 0, v6, s[22:23]
    global_load_ushort v53, v6, s[18:19]
    v_cmp_eq_u32 vcc, v4, v5
    v_mov_b32 v7, 0x3f80
    s_nop 1
    v_cndmask_b32 v73, 0, v7, vcc
    s_waitcnt vmcnt(0)
    v_cndmask_b32 v53, 0, v53, s[22:23]
    v_cndmask_b32 v73, 0, v73, s[22:23]
    v_lshl_add_u32 v4, v3, 3, 6
    v_add_u32 v5, 16, v2
    v_cmp_gt_u32 vcc, 28, v4
    v_cmp_gt_u32 s[22:23], 28, v5
    s_nop 1
    s_and_b64 s[22:23], s[22:23], vcc
    v_mul_u32_u24 v6, 56, v4
    v_lshl_add_u32 v6, v5, 1, v6
    v_add_u32 v6, s12, v6
    v_cndmask_b32 v6, 0, v6, s[22:23]
    global_load_ushort v54, v6, s[18:19]
    v_cmp_eq_u32 vcc, v4, v5
    v_mov_b32 v7, 0x3f80
    s_nop 1
    v_cndmask_b32 v74, 0, v7, vcc
    s_waitcnt vmcnt(0)
    v_cndmask_b32 v54, 0, v54, s[22:23]
    v_cndmask_b32 v74, 0, v74, s[22:23]
    v_lshl_add_u32 v4, v3, 3, 7
    v_add_u32 v5, 16, v2
    v_cmp_gt_u32 vcc, 28, v4
    v_cmp_gt_u32 s[22:23], 28, v5
    s_nop 1
    s_and_b64 s[22:23], s[22:23], vcc
    v_mul_u32_u24 v6, 56, v4
    v_lshl_add_u32 v6, v5, 1, v6
    v_add_u32 v6, s12, v6
    v_cndmask_b32 v6, 0, v6, s[22:23]
    global_load_ushort v55, v6, s[18:19]
    v_cmp_eq_u32 vcc, v4, v5
    v_mov_b32 v7, 0x3f80
    s_nop 1
    v_cndmask_b32 v75, 0, v7, vcc
    s_waitcnt vmcnt(0)
    v_cndmask_b32 v55, 0, v55, s[22:23]
    v_cndmask_b32 v75, 0, v75, s[22:23]
    s_cmp_lg_u32 s10, 2
    s_cbranch_scc1 L_pb_phi
    v_mov_b32 v40, v60
    v_mov_b32 v41, v61
    v_mov_b32 v42, v62
    v_mov_b32 v43, v63
    v_mov_b32 v44, v64
    v_mov_b32 v45, v65
    v_mov_b32 v46, v66
    v_mov_b32 v47, v67
    v_mov_b32 v48, v68
    v_mov_b32 v49, v69
    v_mov_b32 v50, v70
    v_mov_b32 v51, v71
    v_mov_b32 v52, v72
    v_mov_b32 v53, v73
    v_mov_b32 v54, v74
    v_mov_b32 v55, v75
L_pb_phi:
    v_lshl_or_b32 v16, v41, 16, v40
    v_lshl_or_b32 v17, v43, 16, v42
    v_lshl_or_b32 v18, v45, 16, v44
    v_lshl_or_b32 v19, v47, 16, v46
    v_lshl_or_b32 v20, v49, 16, v48
    v_lshl_or_b32 v21, v51, 16, v50
    v_lshl_or_b32 v22, v53, 16, v52
    v_lshl_or_b32 v23, v55, 16, v54
    v_lshrrev_b32 v4, 2, v2
    v_and_b32 v5, 3, v2
    v_lshl_add_u32 v4, v4, 3, v5
    v_mul_u32_u24 v4, 2688, v4
    s_mul_i32 s12, s10, 896
    s_mul_i32 s13, s11, 56
    s_add_u32 s12, s12, s13
    v_add_u32 v4, s12, v4
    v_lshl_add_u32 v4, v3, 4, v4
    v_add_u32 v5, 8, v4
    v_cmp_eq_u32 vcc, 3, v3
    s_nop 1
    v_cndmask_b32 v5, v5, v4, vcc
    s_lshl_b32 s12, s9, 1
    s_mul_i32 s12, s12, 14336
    s_add_u32 s12, s12, 85983232
    v_lshlrev_b32 v6, 4, v1
    v_add_u32 v6, s12, v6
    v_add_u32 v7, 14336, v6
    s_mov_b32 s14, 0

L_pb_loop:
    v_add_u32 v8, 0, v4
    v_add_u32 v9, 0, v5
    global_load_dwordx2 v[24:25], v8, s[16:17]
    global_load_dwordx2 v[26:27], v9, s[16:17]
    v_add_u32 v8, 10752, v4
    v_add_u32 v9, 10752, v5
    global_load_dwordx2 v[28:29], v8, s[16:17]
    global_load_dwordx2 v[30:31], v9, s[16:17]
    s_waitcnt vmcnt(0)
    v_mfma_f32_16x16x32_bf16 v[40:43], v[24:27], v[16:19], 0
    v_mfma_f32_16x16x32_bf16 v[44:47], v[28:31], v[16:19], 0
    v_mfma_f32_16x16x32_bf16 v[48:51], v[24:27], v[20:23], 0
    v_mfma_f32_16x16x32_bf16 v[52:55], v[28:31], v[20:23], 0
    s_nop 7
    v_cvt_pk_bf16_f32 v60, v40, v41
    v_cvt_pk_bf16_f32 v61, v42, v43
    v_cvt_pk_bf16_f32 v62, v44, v45
    v_cvt_pk_bf16_f32 v63, v46, v47
    v_cvt_pk_bf16_f32 v64, v48, v49
    v_cvt_pk_bf16_f32 v65, v50, v51
    v_cvt_pk_bf16_f32 v66, v52, v53
    v_cvt_pk_bf16_f32 v67, v54, v55
    global_store_dwordx4 v6, v[60:63], s[6:7] sc1
    global_store_dwordx4 v7, v[64:67], s[6:7] sc1
    v_add_u32 v4, 86016, v4
    v_add_u32 v5, 86016, v5
    v_add_u32 v6, 1024, v6
    v_add_u32 v7, 1024, v7
    s_add_u32 s14, s14, 1
    s_cmp_lt_u32 s14, 14
    s_cbranch_scc1 L_pb_loop
    s_branch L_task_done

L_pb_wof:
    s_sub_u32 s10, s9, 48
    s_lshl_b32 s11, s10, 5
    v_lshlrev_b32 v4, 1, v2
    v_add_u32 v4, s11, v4
    v_mul_u32_u24 v5, 3584, v3
    v_add_u32 v4, v4, v5
    v_cmp_gt_u32 s[22:23], 3, v3
    s_lshl_b32 s12, s10, 14
    s_add_u32 s12, s12, 91684864
    v_lshlrev_b32 v6, 4, v1
    v_add_u32 v6, s12, v6
    s_mov_b32 s14, 0

L_pb_wloop:
    v_add_u32 v5, 14336, v4
    v_cndmask_b32 v5, v4, v5, s[22:23]
    global_load_ushort v16, v4, s[20:21] offset:0
    global_load_ushort v17, v4, s[20:21] offset:896
    global_load_ushort v18, v4, s[20:21] offset:1792
    global_load_ushort v19, v4, s[20:21] offset:2688
    global_load_ushort v20, v5, s[20:21] offset:0
    global_load_ushort v21, v5, s[20:21] offset:896
    global_load_ushort v22, v5, s[20:21] offset:1792
    global_load_ushort v23, v5, s[20:21] offset:2688
    s_waitcnt vmcnt(0)
    v_cndmask_b32 v20, 0, v20, s[22:23]
    v_cndmask_b32 v21, 0, v21, s[22:23]
    v_cndmask_b32 v22, 0, v22, s[22:23]
    v_cndmask_b32 v23, 0, v23, s[22:23]
    v_lshl_or_b32 v24, v17, 16, v16
    v_lshl_or_b32 v25, v19, 16, v18
    v_lshl_or_b32 v26, v21, 16, v20
    v_lshl_or_b32 v27, v23, 16, v22
    global_store_dwordx4 v6, v[24:27], s[6:7] sc1
    v_add_u32 v4, 25088, v4
    v_add_u32 v6, 1024, v6
    s_add_u32 s14, s14, 1
    s_cmp_lt_u32 s14, 16
    s_cbranch_scc1 L_pb_wloop
    s_branch L_task_done

L_t_b1:
    s_cmp_ge_u32 s41, 691
    s_cbranch_scc1 L_t_b2
    s_sub_u32 s40, s41, 563
    s_mov_b32 s70, 1152
    s_mov_b32 s4, s66
    s_mov_b32 s5, s67
    s_mov_b32 s42, 1216

    v_mov_b32 v250, s42
    s_mov_b32 s71, 0
L_wc_pb:
    global_load_dword v251, v250, s[6:7] sc1
    s_add_u32 s71, s71, 1
    s_cmp_ge_u32 s71, 4194304
    s_cbranch_scc1 L_main_done
    s_waitcnt vmcnt(0)
    v_cmp_gt_u32 vcc, 19, v251
    s_cbranch_vccz L_wcd_pb
    s_sleep 4
    s_branch L_wc_pb

L_wcd_pb:
    buffer_inv sc1
    s_lshr_b32 s9, s40, 2
    s_and_b32 s10, s40, 3
    s_lshl_b32 s10, s10, 2
    s_add_u32 s10, s10, s8
    v_and_b32 v2, 15, v1
    v_lshrrev_b32 v3, 4, v1
    s_mul_i32 s11, s9, 57344
    v_mul_u32_u24 v4, 896, v2
    v_lshl_add_u32 v4, v3, 4, v4
    v_add_u32 v4, s11, v4
    v_add_u32 v5, 14336, v4
    v_add_u32 v6, 28672, v4
    v_add_u32 v7, 43008, v4
    v_lshlrev_b32 v8, 4, v1
    s_lshl_b32 s11, s10, 1
    s_mul_i32 s11, s11, 14336
    s_add_u32 s11, s11, 85983232
    s_add_u32 s12, s6, s11
    s_addc_u32 s13, s7, 0
    s_add_u32 s14, s12, 458752
    s_addc_u32 s15, s13, 0
    s_add_u32 s16, s14, 458752
    s_addc_u32 s17, s15, 0
    v_add_u32 v9, 14336, v8

    global_load_dwordx4 a[0:3], v4, s[4:5] offset:0
    global_load_dwordx4 a[4:7], v5, s[4:5] offset:0
    global_load_dwordx4 a[8:11], v6, s[4:5] offset:0
    global_load_dwordx4 a[12:15], v7, s[4:5] offset:0
    global_load_dwordx4 a[16:19], v8, s[12:13]
    global_load_dwordx4 a[20:23], v9, s[12:13]
    global_load_dwordx4 a[24:27], v8, s[14:15]
    global_load_dwordx4 a[28:31], v9, s[14:15]
    global_load_dwordx4 a[32:35], v8, s[16:17]
    global_load_dwordx4 a[36:39], v9, s[16:17]
    v_add_u32 v8, 1024, v8
    v_add_u32 v9, 1024, v9
    global_load_dwordx4 a[40:43], v4, s[4:5] offset:64
    global_load_dwordx4 a[44:47], v5, s[4:5] offset:64
    global_load_dwordx4 a[48:51], v6, s[4:5] offset:64
    global_load_dwordx4 a[52:55], v7, s[4:5] offset:64
    global_load_dwordx4 a[56:59], v8, s[12:13]
    global_load_dwordx4 a[60:63], v9, s[12:13]
    global_load_dwordx4 a[64:67], v8, s[14:15]
    global_load_dwordx4 a[68:71], v9, s[14:15]
    global_load_dwordx4 a[72:75], v8, s[16:17]
    global_load_dwordx4 a[76:79], v9, s[16:17]
    v_add_u32 v8, 1024, v8
    v_add_u32 v9, 1024, v9
    global_load_dwordx4 a[80:83], v4, s[4:5] offset:128
    global_load_dwordx4 a[84:87], v5, s[4:5] offset:128
    global_load_dwordx4 a[88:91], v6, s[4:5] offset:128
    global_load_dwordx4 a[92:95], v7, s[4:5] offset:128
    global_load_dwordx4 a[96:99], v8, s[12:13]
    global_load_dwordx4 a[100:103], v9, s[12:13]
    global_load_dwordx4 a[104:107], v8, s[14:15]
    global_load_dwordx4 a[108:111], v9, s[14:15]
    global_load_dwordx4 a[112:115], v8, s[16:17]
    global_load_dwordx4 a[116:119], v9, s[16:17]
    v_add_u32 v8, 1024, v8
    v_add_u32 v9, 1024, v9
    global_load_dwordx4 a[120:123], v4, s[4:5] offset:192
    global_load_dwordx4 a[124:127], v5, s[4:5] offset:192
    global_load_dwordx4 a[128:131], v6, s[4:5] offset:192
    global_load_dwordx4 a[132:135], v7, s[4:5] offset:192
    global_load_dwordx4 a[136:139], v8, s[12:13]
    global_load_dwordx4 a[140:143], v9, s[12:13]
    global_load_dwordx4 a[144:147], v8, s[14:15]
    global_load_dwordx4 a[148:151], v9, s[14:15]
    global_load_dwordx4 a[152:155], v8, s[16:17]
    global_load_dwordx4 a[156:159], v9, s[16:17]
    v_add_u32 v8, 1024, v8
    v_add_u32 v9, 1024, v9
    s_waitcnt vmcnt(30)
    v_mfma_f32_16x16x32_bf16 v[64:67], a[16:19], a[0:3], 0
    v_mfma_f32_16x16x32_bf16 v[68:71], a[16:19], a[4:7], 0
    v_mfma_f32_16x16x32_bf16 v[72:75], a[16:19], a[8:11], 0
    v_mfma_f32_16x16x32_bf16 v[76:79], a[16:19], a[12:15], 0
    v_mfma_f32_16x16x32_bf16 v[80:83], a[20:23], a[0:3], 0
    v_mfma_f32_16x16x32_bf16 v[84:87], a[20:23], a[4:7], 0
    v_mfma_f32_16x16x32_bf16 v[88:91], a[20:23], a[8:11], 0
    v_mfma_f32_16x16x32_bf16 v[92:95], a[20:23], a[12:15], 0
    v_mfma_f32_16x16x32_bf16 v[96:99], a[0:3], a[24:27], 0
    v_mfma_f32_16x16x32_bf16 v[100:103], a[4:7], a[24:27], 0
    v_mfma_f32_16x16x32_bf16 v[104:107], a[8:11], a[24:27], 0
    v_mfma_f32_16x16x32_bf16 v[108:111], a[12:15], a[24:27], 0
    v_mfma_f32_16x16x32_bf16 v[112:115], a[0:3], a[28:31], 0
    v_mfma_f32_16x16x32_bf16 v[116:119], a[4:7], a[28:31], 0
    v_mfma_f32_16x16x32_bf16 v[120:123], a[8:11], a[28:31], 0
    v_mfma_f32_16x16x32_bf16 v[124:127], a[12:15], a[28:31], 0
    v_mfma_f32_16x16x32_bf16 v[128:131], a[0:3], a[32:35], 0
    v_mfma_f32_16x16x32_bf16 v[132:135], a[4:7], a[32:35], 0
    v_mfma_f32_16x16x32_bf16 v[136:139], a[8:11], a[32:35], 0
    v_mfma_f32_16x16x32_bf16 v[140:143], a[12:15], a[32:35], 0
    v_mfma_f32_16x16x32_bf16 v[144:147], a[0:3], a[36:39], 0
    v_mfma_f32_16x16x32_bf16 v[148:151], a[4:7], a[36:39], 0
    v_mfma_f32_16x16x32_bf16 v[152:155], a[8:11], a[36:39], 0
    v_mfma_f32_16x16x32_bf16 v[156:159], a[12:15], a[36:39], 0
    global_load_dwordx4 a[0:3], v4, s[4:5] offset:256
    global_load_dwordx4 a[4:7], v5, s[4:5] offset:256
    global_load_dwordx4 a[8:11], v6, s[4:5] offset:256
    global_load_dwordx4 a[12:15], v7, s[4:5] offset:256
    global_load_dwordx4 a[16:19], v8, s[12:13]
    global_load_dwordx4 a[20:23], v9, s[12:13]
    global_load_dwordx4 a[24:27], v8, s[14:15]
    global_load_dwordx4 a[28:31], v9, s[14:15]
    global_load_dwordx4 a[32:35], v8, s[16:17]
    global_load_dwordx4 a[36:39], v9, s[16:17]
    v_add_u32 v8, 1024, v8
    v_add_u32 v9, 1024, v9
    s_waitcnt vmcnt(30)
    v_mfma_f32_16x16x32_bf16 v[64:67], a[56:59], a[40:43], v[64:67]
    v_mfma_f32_16x16x32_bf16 v[68:71], a[56:59], a[44:47], v[68:71]
    v_mfma_f32_16x16x32_bf16 v[72:75], a[56:59], a[48:51], v[72:75]
    v_mfma_f32_16x16x32_bf16 v[76:79], a[56:59], a[52:55], v[76:79]
    v_mfma_f32_16x16x32_bf16 v[80:83], a[60:63], a[40:43], v[80:83]
    v_mfma_f32_16x16x32_bf16 v[84:87], a[60:63], a[44:47], v[84:87]
    v_mfma_f32_16x16x32_bf16 v[88:91], a[60:63], a[48:51], v[88:91]
    v_mfma_f32_16x16x32_bf16 v[92:95], a[60:63], a[52:55], v[92:95]
    v_mfma_f32_16x16x32_bf16 v[96:99], a[40:43], a[64:67], v[96:99]
    v_mfma_f32_16x16x32_bf16 v[100:103], a[44:47], a[64:67], v[100:103]
    v_mfma_f32_16x16x32_bf16 v[104:107], a[48:51], a[64:67], v[104:107]
    v_mfma_f32_16x16x32_bf16 v[108:111], a[52:55], a[64:67], v[108:111]
    v_mfma_f32_16x16x32_bf16 v[112:115], a[40:43], a[68:71], v[112:115]
    v_mfma_f32_16x16x32_bf16 v[116:119], a[44:47], a[68:71], v[116:119]
    v_mfma_f32_16x16x32_bf16 v[120:123], a[48:51], a[68:71], v[120:123]
    v_mfma_f32_16x16x32_bf16 v[124:127], a[52:55], a[68:71], v[124:127]
    v_mfma_f32_16x16x32_bf16 v[128:131], a[40:43], a[72:75], v[128:131]
    v_mfma_f32_16x16x32_bf16 v[132:135], a[44:47], a[72:75], v[132:135]
    v_mfma_f32_16x16x32_bf16 v[136:139], a[48:51], a[72:75], v[136:139]
    v_mfma_f32_16x16x32_bf16 v[140:143], a[52:55], a[72:75], v[140:143]
    v_mfma_f32_16x16x32_bf16 v[144:147], a[40:43], a[76:79], v[144:147]
    v_mfma_f32_16x16x32_bf16 v[148:151], a[44:47], a[76:79], v[148:151]
    v_mfma_f32_16x16x32_bf16 v[152:155], a[48:51], a[76:79], v[152:155]
    v_mfma_f32_16x16x32_bf16 v[156:159], a[52:55], a[76:79], v[156:159]
    global_load_dwordx4 a[40:43], v4, s[4:5] offset:320
    global_load_dwordx4 a[44:47], v5, s[4:5] offset:320
    global_load_dwordx4 a[48:51], v6, s[4:5] offset:320
    global_load_dwordx4 a[52:55], v7, s[4:5] offset:320
    global_load_dwordx4 a[56:59], v8, s[12:13]
    global_load_dwordx4 a[60:63], v9, s[12:13]
    global_load_dwordx4 a[64:67], v8, s[14:15]
    global_load_dwordx4 a[68:71], v9, s[14:15]
    global_load_dwordx4 a[72:75], v8, s[16:17]
    global_load_dwordx4 a[76:79], v9, s[16:17]
    v_add_u32 v8, 1024, v8
    v_add_u32 v9, 1024, v9
    s_waitcnt vmcnt(30)
    v_mfma_f32_16x16x32_bf16 v[64:67], a[96:99], a[80:83], v[64:67]
    v_mfma_f32_16x16x32_bf16 v[68:71], a[96:99], a[84:87], v[68:71]
    v_mfma_f32_16x16x32_bf16 v[72:75], a[96:99], a[88:91], v[72:75]
    v_mfma_f32_16x16x32_bf16 v[76:79], a[96:99], a[92:95], v[76:79]
    v_mfma_f32_16x16x32_bf16 v[80:83], a[100:103], a[80:83], v[80:83]
    v_mfma_f32_16x16x32_bf16 v[84:87], a[100:103], a[84:87], v[84:87]
    v_mfma_f32_16x16x32_bf16 v[88:91], a[100:103], a[88:91], v[88:91]
    v_mfma_f32_16x16x32_bf16 v[92:95], a[100:103], a[92:95], v[92:95]
    v_mfma_f32_16x16x32_bf16 v[96:99], a[80:83], a[104:107], v[96:99]
    v_mfma_f32_16x16x32_bf16 v[100:103], a[84:87], a[104:107], v[100:103]
    v_mfma_f32_16x16x32_bf16 v[104:107], a[88:91], a[104:107], v[104:107]
    v_mfma_f32_16x16x32_bf16 v[108:111], a[92:95], a[104:107], v[108:111]
    v_mfma_f32_16x16x32_bf16 v[112:115], a[80:83], a[108:111], v[112:115]
    v_mfma_f32_16x16x32_bf16 v[116:119], a[84:87], a[108:111], v[116:119]
    v_mfma_f32_16x16x32_bf16 v[120:123], a[88:91], a[108:111], v[120:123]
    v_mfma_f32_16x16x32_bf16 v[124:127], a[92:95], a[108:111], v[124:127]
    v_mfma_f32_16x16x32_bf16 v[128:131], a[80:83], a[112:115], v[128:131]
    v_mfma_f32_16x16x32_bf16 v[132:135], a[84:87], a[112:115], v[132:135]
    v_mfma_f32_16x16x32_bf16 v[136:139], a[88:91], a[112:115], v[136:139]
    v_mfma_f32_16x16x32_bf16 v[140:143], a[92:95], a[112:115], v[140:143]
    v_mfma_f32_16x16x32_bf16 v[144:147], a[80:83], a[116:119], v[144:147]
    v_mfma_f32_16x16x32_bf16 v[148:151], a[84:87], a[116:119], v[148:151]
    v_mfma_f32_16x16x32_bf16 v[152:155], a[88:91], a[116:119], v[152:155]
    v_mfma_f32_16x16x32_bf16 v[156:159], a[92:95], a[116:119], v[156:159]
    global_load_dwordx4 a[80:83], v4, s[4:5] offset:384
    global_load_dwordx4 a[84:87], v5, s[4:5] offset:384
    global_load_dwordx4 a[88:91], v6, s[4:5] offset:384
    global_load_dwordx4 a[92:95], v7, s[4:5] offset:384
    global_load_dwordx4 a[96:99], v8, s[12:13]
    global_load_dwordx4 a[100:103], v9, s[12:13]
    global_load_dwordx4 a[104:107], v8, s[14:15]
    global_load_dwordx4 a[108:111], v9, s[14:15]
    global_load_dwordx4 a[112:115], v8, s[16:17]
    global_load_dwordx4 a[116:119], v9, s[16:17]
    v_add_u32 v8, 1024, v8
    v_add_u32 v9, 1024, v9
    s_waitcnt vmcnt(30)
    v_mfma_f32_16x16x32_bf16 v[64:67], a[136:139], a[120:123], v[64:67]
    v_mfma_f32_16x16x32_bf16 v[68:71], a[136:139], a[124:127], v[68:71]
    v_mfma_f32_16x16x32_bf16 v[72:75], a[136:139], a[128:131], v[72:75]
    v_mfma_f32_16x16x32_bf16 v[76:79], a[136:139], a[132:135], v[76:79]
    v_mfma_f32_16x16x32_bf16 v[80:83], a[140:143], a[120:123], v[80:83]
    v_mfma_f32_16x16x32_bf16 v[84:87], a[140:143], a[124:127], v[84:87]
    v_mfma_f32_16x16x32_bf16 v[88:91], a[140:143], a[128:131], v[88:91]
    v_mfma_f32_16x16x32_bf16 v[92:95], a[140:143], a[132:135], v[92:95]
    v_mfma_f32_16x16x32_bf16 v[96:99], a[120:123], a[144:147], v[96:99]
    v_mfma_f32_16x16x32_bf16 v[100:103], a[124:127], a[144:147], v[100:103]
    v_mfma_f32_16x16x32_bf16 v[104:107], a[128:131], a[144:147], v[104:107]
    v_mfma_f32_16x16x32_bf16 v[108:111], a[132:135], a[144:147], v[108:111]
    v_mfma_f32_16x16x32_bf16 v[112:115], a[120:123], a[148:151], v[112:115]
    v_mfma_f32_16x16x32_bf16 v[116:119], a[124:127], a[148:151], v[116:119]
    v_mfma_f32_16x16x32_bf16 v[120:123], a[128:131], a[148:151], v[120:123]
    v_mfma_f32_16x16x32_bf16 v[124:127], a[132:135], a[148:151], v[124:127]
    v_mfma_f32_16x16x32_bf16 v[128:131], a[120:123], a[152:155], v[128:131]
    v_mfma_f32_16x16x32_bf16 v[132:135], a[124:127], a[152:155], v[132:135]
    v_mfma_f32_16x16x32_bf16 v[136:139], a[128:131], a[152:155], v[136:139]
    v_mfma_f32_16x16x32_bf16 v[140:143], a[132:135], a[152:155], v[140:143]
    v_mfma_f32_16x16x32_bf16 v[144:147], a[120:123], a[156:159], v[144:147]
    v_mfma_f32_16x16x32_bf16 v[148:151], a[124:127], a[156:159], v[148:151]
    v_mfma_f32_16x16x32_bf16 v[152:155], a[128:131], a[156:159], v[152:155]
    v_mfma_f32_16x16x32_bf16 v[156:159], a[132:135], a[156:159], v[156:159]
    global_load_dwordx4 a[120:123], v4, s[4:5] offset:448
    global_load_dwordx4 a[124:127], v5, s[4:5] offset:448
    global_load_dwordx4 a[128:131], v6, s[4:5] offset:448
    global_load_dwordx4 a[132:135], v7, s[4:5] offset:448
    global_load_dwordx4 a[136:139], v8, s[12:13]
    global_load_dwordx4 a[140:143], v9, s[12:13]
    global_load_dwordx4 a[144:147], v8, s[14:15]
    global_load_dwordx4 a[148:151], v9, s[14:15]
    global_load_dwordx4 a[152:155], v8, s[16:17]
    global_load_dwordx4 a[156:159], v9, s[16:17]
    v_add_u32 v8, 1024, v8
    v_add_u32 v9, 1024, v9
    s_waitcnt vmcnt(30)
    v_mfma_f32_16x16x32_bf16 v[64:67], a[16:19], a[0:3], v[64:67]
    v_mfma_f32_16x16x32_bf16 v[68:71], a[16:19], a[4:7], v[68:71]
    v_mfma_f32_16x16x32_bf16 v[72:75], a[16:19], a[8:11], v[72:75]
    v_mfma_f32_16x16x32_bf16 v[76:79], a[16:19], a[12:15], v[76:79]
    v_mfma_f32_16x16x32_bf16 v[80:83], a[20:23], a[0:3], v[80:83]
    v_mfma_f32_16x16x32_bf16 v[84:87], a[20:23], a[4:7], v[84:87]
    v_mfma_f32_16x16x32_bf16 v[88:91], a[20:23], a[8:11], v[88:91]
    v_mfma_f32_16x16x32_bf16 v[92:95], a[20:23], a[12:15], v[92:95]
    v_mfma_f32_16x16x32_bf16 v[96:99], a[0:3], a[24:27], v[96:99]
    v_mfma_f32_16x16x32_bf16 v[100:103], a[4:7], a[24:27], v[100:103]
    v_mfma_f32_16x16x32_bf16 v[104:107], a[8:11], a[24:27], v[104:107]
    v_mfma_f32_16x16x32_bf16 v[108:111], a[12:15], a[24:27], v[108:111]
    v_mfma_f32_16x16x32_bf16 v[112:115], a[0:3], a[28:31], v[112:115]
    v_mfma_f32_16x16x32_bf16 v[116:119], a[4:7], a[28:31], v[116:119]
    v_mfma_f32_16x16x32_bf16 v[120:123], a[8:11], a[28:31], v[120:123]
    v_mfma_f32_16x16x32_bf16 v[124:127], a[12:15], a[28:31], v[124:127]
    v_mfma_f32_16x16x32_bf16 v[128:131], a[0:3], a[32:35], v[128:131]
    v_mfma_f32_16x16x32_bf16 v[132:135], a[4:7], a[32:35], v[132:135]
    v_mfma_f32_16x16x32_bf16 v[136:139], a[8:11], a[32:35], v[136:139]
    v_mfma_f32_16x16x32_bf16 v[140:143], a[12:15], a[32:35], v[140:143]
    v_mfma_f32_16x16x32_bf16 v[144:147], a[0:3], a[36:39], v[144:147]
    v_mfma_f32_16x16x32_bf16 v[148:151], a[4:7], a[36:39], v[148:151]
    v_mfma_f32_16x16x32_bf16 v[152:155], a[8:11], a[36:39], v[152:155]
    v_mfma_f32_16x16x32_bf16 v[156:159], a[12:15], a[36:39], v[156:159]
    global_load_dwordx4 a[0:3], v4, s[4:5] offset:512
    global_load_dwordx4 a[4:7], v5, s[4:5] offset:512
    global_load_dwordx4 a[8:11], v6, s[4:5] offset:512
    global_load_dwordx4 a[12:15], v7, s[4:5] offset:512
    global_load_dwordx4 a[16:19], v8, s[12:13]
    global_load_dwordx4 a[20:23], v9, s[12:13]
    global_load_dwordx4 a[24:27], v8, s[14:15]
    global_load_dwordx4 a[28:31], v9, s[14:15]
    global_load_dwordx4 a[32:35], v8, s[16:17]
    global_load_dwordx4 a[36:39], v9, s[16:17]
    v_add_u32 v8, 1024, v8
    v_add_u32 v9, 1024, v9
    s_waitcnt vmcnt(30)
    v_mfma_f32_16x16x32_bf16 v[64:67], a[56:59], a[40:43], v[64:67]
    v_mfma_f32_16x16x32_bf16 v[68:71], a[56:59], a[44:47], v[68:71]
    v_mfma_f32_16x16x32_bf16 v[72:75], a[56:59], a[48:51], v[72:75]
    v_mfma_f32_16x16x32_bf16 v[76:79], a[56:59], a[52:55], v[76:79]
    v_mfma_f32_16x16x32_bf16 v[80:83], a[60:63], a[40:43], v[80:83]
    v_mfma_f32_16x16x32_bf16 v[84:87], a[60:63], a[44:47], v[84:87]
    v_mfma_f32_16x16x32_bf16 v[88:91], a[60:63], a[48:51], v[88:91]
    v_mfma_f32_16x16x32_bf16 v[92:95], a[60:63], a[52:55], v[92:95]
    v_mfma_f32_16x16x32_bf16 v[96:99], a[40:43], a[64:67], v[96:99]
    v_mfma_f32_16x16x32_bf16 v[100:103], a[44:47], a[64:67], v[100:103]
    v_mfma_f32_16x16x32_bf16 v[104:107], a[48:51], a[64:67], v[104:107]
    v_mfma_f32_16x16x32_bf16 v[108:111], a[52:55], a[64:67], v[108:111]
    v_mfma_f32_16x16x32_bf16 v[112:115], a[40:43], a[68:71], v[112:115]
    v_mfma_f32_16x16x32_bf16 v[116:119], a[44:47], a[68:71], v[116:119]
    v_mfma_f32_16x16x32_bf16 v[120:123], a[48:51], a[68:71], v[120:123]
    v_mfma_f32_16x16x32_bf16 v[124:127], a[52:55], a[68:71], v[124:127]
    v_mfma_f32_16x16x32_bf16 v[128:131], a[40:43], a[72:75], v[128:131]
    v_mfma_f32_16x16x32_bf16 v[132:135], a[44:47], a[72:75], v[132:135]
    v_mfma_f32_16x16x32_bf16 v[136:139], a[48:51], a[72:75], v[136:139]
    v_mfma_f32_16x16x32_bf16 v[140:143], a[52:55], a[72:75], v[140:143]
    v_mfma_f32_16x16x32_bf16 v[144:147], a[40:43], a[76:79], v[144:147]
    v_mfma_f32_16x16x32_bf16 v[148:151], a[44:47], a[76:79], v[148:151]
    v_mfma_f32_16x16x32_bf16 v[152:155], a[48:51], a[76:79], v[152:155]
    v_mfma_f32_16x16x32_bf16 v[156:159], a[52:55], a[76:79], v[156:159]
    global_load_dwordx4 a[40:43], v4, s[4:5] offset:576
    global_load_dwordx4 a[44:47], v5, s[4:5] offset:576
    global_load_dwordx4 a[48:51], v6, s[4:5] offset:576
    global_load_dwordx4 a[52:55], v7, s[4:5] offset:576
    global_load_dwordx4 a[56:59], v8, s[12:13]
    global_load_dwordx4 a[60:63], v9, s[12:13]
    global_load_dwordx4 a[64:67], v8, s[14:15]
    global_load_dwordx4 a[68:71], v9, s[14:15]
    global_load_dwordx4 a[72:75], v8, s[16:17]
    global_load_dwordx4 a[76:79], v9, s[16:17]
    v_add_u32 v8, 1024, v8
    v_add_u32 v9, 1024, v9
    s_waitcnt vmcnt(30)
    v_mfma_f32_16x16x32_bf16 v[64:67], a[96:99], a[80:83], v[64:67]
    v_mfma_f32_16x16x32_bf16 v[68:71], a[96:99], a[84:87], v[68:71]
    v_mfma_f32_16x16x32_bf16 v[72:75], a[96:99], a[88:91], v[72:75]
    v_mfma_f32_16x16x32_bf16 v[76:79], a[96:99], a[92:95], v[76:79]
    v_mfma_f32_16x16x32_bf16 v[80:83], a[100:103], a[80:83], v[80:83]
    v_mfma_f32_16x16x32_bf16 v[84:87], a[100:103], a[84:87], v[84:87]
    v_mfma_f32_16x16x32_bf16 v[88:91], a[100:103], a[88:91], v[88:91]
    v_mfma_f32_16x16x32_bf16 v[92:95], a[100:103], a[92:95], v[92:95]
    v_mfma_f32_16x16x32_bf16 v[96:99], a[80:83], a[104:107], v[96:99]
    v_mfma_f32_16x16x32_bf16 v[100:103], a[84:87], a[104:107], v[100:103]
    v_mfma_f32_16x16x32_bf16 v[104:107], a[88:91], a[104:107], v[104:107]
    v_mfma_f32_16x16x32_bf16 v[108:111], a[92:95], a[104:107], v[108:111]
    v_mfma_f32_16x16x32_bf16 v[112:115], a[80:83], a[108:111], v[112:115]
    v_mfma_f32_16x16x32_bf16 v[116:119], a[84:87], a[108:111], v[116:119]
    v_mfma_f32_16x16x32_bf16 v[120:123], a[88:91], a[108:111], v[120:123]
    v_mfma_f32_16x16x32_bf16 v[124:127], a[92:95], a[108:111], v[124:127]
    v_mfma_f32_16x16x32_bf16 v[128:131], a[80:83], a[112:115], v[128:131]
    v_mfma_f32_16x16x32_bf16 v[132:135], a[84:87], a[112:115], v[132:135]
    v_mfma_f32_16x16x32_bf16 v[136:139], a[88:91], a[112:115], v[136:139]
    v_mfma_f32_16x16x32_bf16 v[140:143], a[92:95], a[112:115], v[140:143]
    v_mfma_f32_16x16x32_bf16 v[144:147], a[80:83], a[116:119], v[144:147]
    v_mfma_f32_16x16x32_bf16 v[148:151], a[84:87], a[116:119], v[148:151]
    v_mfma_f32_16x16x32_bf16 v[152:155], a[88:91], a[116:119], v[152:155]
    v_mfma_f32_16x16x32_bf16 v[156:159], a[92:95], a[116:119], v[156:159]
    global_load_dwordx4 a[80:83], v4, s[4:5] offset:640
    global_load_dwordx4 a[84:87], v5, s[4:5] offset:640
    global_load_dwordx4 a[88:91], v6, s[4:5] offset:640
    global_load_dwordx4 a[92:95], v7, s[4:5] offset:640
    global_load_dwordx4 a[96:99], v8, s[12:13]
    global_load_dwordx4 a[100:103], v9, s[12:13]
    global_load_dwordx4 a[104:107], v8, s[14:15]
    global_load_dwordx4 a[108:111], v9, s[14:15]
    global_load_dwordx4 a[112:115], v8, s[16:17]
    global_load_dwordx4 a[116:119], v9, s[16:17]
    v_add_u32 v8, 1024, v8
    v_add_u32 v9, 1024, v9
    s_waitcnt vmcnt(30)
    v_mfma_f32_16x16x32_bf16 v[64:67], a[136:139], a[120:123], v[64:67]
    v_mfma_f32_16x16x32_bf16 v[68:71], a[136:139], a[124:127], v[68:71]
    v_mfma_f32_16x16x32_bf16 v[72:75], a[136:139], a[128:131], v[72:75]
    v_mfma_f32_16x16x32_bf16 v[76:79], a[136:139], a[132:135], v[76:79]
    v_mfma_f32_16x16x32_bf16 v[80:83], a[140:143], a[120:123], v[80:83]
    v_mfma_f32_16x16x32_bf16 v[84:87], a[140:143], a[124:127], v[84:87]
    v_mfma_f32_16x16x32_bf16 v[88:91], a[140:143], a[128:131], v[88:91]
    v_mfma_f32_16x16x32_bf16 v[92:95], a[140:143], a[132:135], v[92:95]
    v_mfma_f32_16x16x32_bf16 v[96:99], a[120:123], a[144:147], v[96:99]
    v_mfma_f32_16x16x32_bf16 v[100:103], a[124:127], a[144:147], v[100:103]
    v_mfma_f32_16x16x32_bf16 v[104:107], a[128:131], a[144:147], v[104:107]
    v_mfma_f32_16x16x32_bf16 v[108:111], a[132:135], a[144:147], v[108:111]
    v_mfma_f32_16x16x32_bf16 v[112:115], a[120:123], a[148:151], v[112:115]
    v_mfma_f32_16x16x32_bf16 v[116:119], a[124:127], a[148:151], v[116:119]
    v_mfma_f32_16x16x32_bf16 v[120:123], a[128:131], a[148:151], v[120:123]
    v_mfma_f32_16x16x32_bf16 v[124:127], a[132:135], a[148:151], v[124:127]
    v_mfma_f32_16x16x32_bf16 v[128:131], a[120:123], a[152:155], v[128:131]
    v_mfma_f32_16x16x32_bf16 v[132:135], a[124:127], a[152:155], v[132:135]
    v_mfma_f32_16x16x32_bf16 v[136:139], a[128:131], a[152:155], v[136:139]
    v_mfma_f32_16x16x32_bf16 v[140:143], a[132:135], a[152:155], v[140:143]
    v_mfma_f32_16x16x32_bf16 v[144:147], a[120:123], a[156:159], v[144:147]
    v_mfma_f32_16x16x32_bf16 v[148:151], a[124:127], a[156:159], v[148:151]
    v_mfma_f32_16x16x32_bf16 v[152:155], a[128:131], a[156:159], v[152:155]
    v_mfma_f32_16x16x32_bf16 v[156:159], a[132:135], a[156:159], v[156:159]
    global_load_dwordx4 a[120:123], v4, s[4:5] offset:704
    global_load_dwordx4 a[124:127], v5, s[4:5] offset:704
    global_load_dwordx4 a[128:131], v6, s[4:5] offset:704
    global_load_dwordx4 a[132:135], v7, s[4:5] offset:704
    global_load_dwordx4 a[136:139], v8, s[12:13]
    global_load_dwordx4 a[140:143], v9, s[12:13]
    global_load_dwordx4 a[144:147], v8, s[14:15]
    global_load_dwordx4 a[148:151], v9, s[14:15]
    global_load_dwordx4 a[152:155], v8, s[16:17]
    global_load_dwordx4 a[156:159], v9, s[16:17]
    v_add_u32 v8, 1024, v8
    v_add_u32 v9, 1024, v9
    s_waitcnt vmcnt(30)
    v_mfma_f32_16x16x32_bf16 v[64:67], a[16:19], a[0:3], v[64:67]
    v_mfma_f32_16x16x32_bf16 v[68:71], a[16:19], a[4:7], v[68:71]
    v_mfma_f32_16x16x32_bf16 v[72:75], a[16:19], a[8:11], v[72:75]
    v_mfma_f32_16x16x32_bf16 v[76:79], a[16:19], a[12:15], v[76:79]
    v_mfma_f32_16x16x32_bf16 v[80:83], a[20:23], a[0:3], v[80:83]
    v_mfma_f32_16x16x32_bf16 v[84:87], a[20:23], a[4:7], v[84:87]
    v_mfma_f32_16x16x32_bf16 v[88:91], a[20:23], a[8:11], v[88:91]
    v_mfma_f32_16x16x32_bf16 v[92:95], a[20:23], a[12:15], v[92:95]
    v_mfma_f32_16x16x32_bf16 v[96:99], a[0:3], a[24:27], v[96:99]
    v_mfma_f32_16x16x32_bf16 v[100:103], a[4:7], a[24:27], v[100:103]
    v_mfma_f32_16x16x32_bf16 v[104:107], a[8:11], a[24:27], v[104:107]
    v_mfma_f32_16x16x32_bf16 v[108:111], a[12:15], a[24:27], v[108:111]
    v_mfma_f32_16x16x32_bf16 v[112:115], a[0:3], a[28:31], v[112:115]
    v_mfma_f32_16x16x32_bf16 v[116:119], a[4:7], a[28:31], v[116:119]
    v_mfma_f32_16x16x32_bf16 v[120:123], a[8:11], a[28:31], v[120:123]
    v_mfma_f32_16x16x32_bf16 v[124:127], a[12:15], a[28:31], v[124:127]
    v_mfma_f32_16x16x32_bf16 v[128:131], a[0:3], a[32:35], v[128:131]
    v_mfma_f32_16x16x32_bf16 v[132:135], a[4:7], a[32:35], v[132:135]
    v_mfma_f32_16x16x32_bf16 v[136:139], a[8:11], a[32:35], v[136:139]
    v_mfma_f32_16x16x32_bf16 v[140:143], a[12:15], a[32:35], v[140:143]
    v_mfma_f32_16x16x32_bf16 v[144:147], a[0:3], a[36:39], v[144:147]
    v_mfma_f32_16x16x32_bf16 v[148:151], a[4:7], a[36:39], v[148:151]
    v_mfma_f32_16x16x32_bf16 v[152:155], a[8:11], a[36:39], v[152:155]
    v_mfma_f32_16x16x32_bf16 v[156:159], a[12:15], a[36:39], v[156:159]
    global_load_dwordx4 a[0:3], v4, s[4:5] offset:768
    global_load_dwordx4 a[4:7], v5, s[4:5] offset:768
    global_load_dwordx4 a[8:11], v6, s[4:5] offset:768
    global_load_dwordx4 a[12:15], v7, s[4:5] offset:768
    global_load_dwordx4 a[16:19], v8, s[12:13]
    global_load_dwordx4 a[20:23], v9, s[12:13]
    global_load_dwordx4 a[24:27], v8, s[14:15]
    global_load_dwordx4 a[28:31], v9, s[14:15]
    global_load_dwordx4 a[32:35], v8, s[16:17]
    global_load_dwordx4 a[36:39], v9, s[16:17]
    v_add_u32 v8, 1024, v8
    v_add_u32 v9, 1024, v9
    s_waitcnt vmcnt(30)
    v_mfma_f32_16x16x32_bf16 v[64:67], a[56:59], a[40:43], v[64:67]
    v_mfma_f32_16x16x32_bf16 v[68:71], a[56:59], a[44:47], v[68:71]
    v_mfma_f32_16x16x32_bf16 v[72:75], a[56:59], a[48:51], v[72:75]
    v_mfma_f32_16x16x32_bf16 v[76:79], a[56:59], a[52:55], v[76:79]
    v_mfma_f32_16x16x32_bf16 v[80:83], a[60:63], a[40:43], v[80:83]
    v_mfma_f32_16x16x32_bf16 v[84:87], a[60:63], a[44:47], v[84:87]
    v_mfma_f32_16x16x32_bf16 v[88:91], a[60:63], a[48:51], v[88:91]
    v_mfma_f32_16x16x32_bf16 v[92:95], a[60:63], a[52:55], v[92:95]
    v_mfma_f32_16x16x32_bf16 v[96:99], a[40:43], a[64:67], v[96:99]
    v_mfma_f32_16x16x32_bf16 v[100:103], a[44:47], a[64:67], v[100:103]
    v_mfma_f32_16x16x32_bf16 v[104:107], a[48:51], a[64:67], v[104:107]
    v_mfma_f32_16x16x32_bf16 v[108:111], a[52:55], a[64:67], v[108:111]
    v_mfma_f32_16x16x32_bf16 v[112:115], a[40:43], a[68:71], v[112:115]
    v_mfma_f32_16x16x32_bf16 v[116:119], a[44:47], a[68:71], v[116:119]
    v_mfma_f32_16x16x32_bf16 v[120:123], a[48:51], a[68:71], v[120:123]
    v_mfma_f32_16x16x32_bf16 v[124:127], a[52:55], a[68:71], v[124:127]
    v_mfma_f32_16x16x32_bf16 v[128:131], a[40:43], a[72:75], v[128:131]
    v_mfma_f32_16x16x32_bf16 v[132:135], a[44:47], a[72:75], v[132:135]
    v_mfma_f32_16x16x32_bf16 v[136:139], a[48:51], a[72:75], v[136:139]
    v_mfma_f32_16x16x32_bf16 v[140:143], a[52:55], a[72:75], v[140:143]
    v_mfma_f32_16x16x32_bf16 v[144:147], a[40:43], a[76:79], v[144:147]
    v_mfma_f32_16x16x32_bf16 v[148:151], a[44:47], a[76:79], v[148:151]
    v_mfma_f32_16x16x32_bf16 v[152:155], a[48:51], a[76:79], v[152:155]
    v_mfma_f32_16x16x32_bf16 v[156:159], a[52:55], a[76:79], v[156:159]
    global_load_dwordx4 a[40:43], v4, s[4:5] offset:832
    global_load_dwordx4 a[44:47], v5, s[4:5] offset:832
    global_load_dwordx4 a[48:51], v6, s[4:5] offset:832
    global_load_dwordx4 a[52:55], v7, s[4:5] offset:832
    global_load_dwordx4 a[56:59], v8, s[12:13]
    global_load_dwordx4 a[60:63], v9, s[12:13]
    global_load_dwordx4 a[64:67], v8, s[14:15]
    global_load_dwordx4 a[68:71], v9, s[14:15]
    global_load_dwordx4 a[72:75], v8, s[16:17]
    global_load_dwordx4 a[76:79], v9, s[16:17]
    v_add_u32 v8, 1024, v8
    v_add_u32 v9, 1024, v9
    s_waitcnt vmcnt(30)
    v_mfma_f32_16x16x32_bf16 v[64:67], a[96:99], a[80:83], v[64:67]
    v_mfma_f32_16x16x32_bf16 v[68:71], a[96:99], a[84:87], v[68:71]
    v_mfma_f32_16x16x32_bf16 v[72:75], a[96:99], a[88:91], v[72:75]
    v_mfma_f32_16x16x32_bf16 v[76:79], a[96:99], a[92:95], v[76:79]
    v_mfma_f32_16x16x32_bf16 v[80:83], a[100:103], a[80:83], v[80:83]
    v_mfma_f32_16x16x32_bf16 v[84:87], a[100:103], a[84:87], v[84:87]
    v_mfma_f32_16x16x32_bf16 v[88:91], a[100:103], a[88:91], v[88:91]
    v_mfma_f32_16x16x32_bf16 v[92:95], a[100:103], a[92:95], v[92:95]
    v_mfma_f32_16x16x32_bf16 v[96:99], a[80:83], a[104:107], v[96:99]
    v_mfma_f32_16x16x32_bf16 v[100:103], a[84:87], a[104:107], v[100:103]
    v_mfma_f32_16x16x32_bf16 v[104:107], a[88:91], a[104:107], v[104:107]
    v_mfma_f32_16x16x32_bf16 v[108:111], a[92:95], a[104:107], v[108:111]
    v_mfma_f32_16x16x32_bf16 v[112:115], a[80:83], a[108:111], v[112:115]
    v_mfma_f32_16x16x32_bf16 v[116:119], a[84:87], a[108:111], v[116:119]
    v_mfma_f32_16x16x32_bf16 v[120:123], a[88:91], a[108:111], v[120:123]
    v_mfma_f32_16x16x32_bf16 v[124:127], a[92:95], a[108:111], v[124:127]
    v_mfma_f32_16x16x32_bf16 v[128:131], a[80:83], a[112:115], v[128:131]
    v_mfma_f32_16x16x32_bf16 v[132:135], a[84:87], a[112:115], v[132:135]
    v_mfma_f32_16x16x32_bf16 v[136:139], a[88:91], a[112:115], v[136:139]
    v_mfma_f32_16x16x32_bf16 v[140:143], a[92:95], a[112:115], v[140:143]
    v_mfma_f32_16x16x32_bf16 v[144:147], a[80:83], a[116:119], v[144:147]
    v_mfma_f32_16x16x32_bf16 v[148:151], a[84:87], a[116:119], v[148:151]
    v_mfma_f32_16x16x32_bf16 v[152:155], a[88:91], a[116:119], v[152:155]
    v_mfma_f32_16x16x32_bf16 v[156:159], a[92:95], a[116:119], v[156:159]
    s_waitcnt vmcnt(20)
    v_mfma_f32_16x16x32_bf16 v[64:67], a[136:139], a[120:123], v[64:67]
    v_mfma_f32_16x16x32_bf16 v[68:71], a[136:139], a[124:127], v[68:71]
    v_mfma_f32_16x16x32_bf16 v[72:75], a[136:139], a[128:131], v[72:75]
    v_mfma_f32_16x16x32_bf16 v[76:79], a[136:139], a[132:135], v[76:79]
    v_mfma_f32_16x16x32_bf16 v[80:83], a[140:143], a[120:123], v[80:83]
    v_mfma_f32_16x16x32_bf16 v[84:87], a[140:143], a[124:127], v[84:87]
    v_mfma_f32_16x16x32_bf16 v[88:91], a[140:143], a[128:131], v[88:91]
    v_mfma_f32_16x16x32_bf16 v[92:95], a[140:143], a[132:135], v[92:95]
    v_mfma_f32_16x16x32_bf16 v[96:99], a[120:123], a[144:147], v[96:99]
    v_mfma_f32_16x16x32_bf16 v[100:103], a[124:127], a[144:147], v[100:103]
    v_mfma_f32_16x16x32_bf16 v[104:107], a[128:131], a[144:147], v[104:107]
    v_mfma_f32_16x16x32_bf16 v[108:111], a[132:135], a[144:147], v[108:111]
    v_mfma_f32_16x16x32_bf16 v[112:115], a[120:123], a[148:151], v[112:115]
    v_mfma_f32_16x16x32_bf16 v[116:119], a[124:127], a[148:151], v[116:119]
    v_mfma_f32_16x16x32_bf16 v[120:123], a[128:131], a[148:151], v[120:123]
    v_mfma_f32_16x16x32_bf16 v[124:127], a[132:135], a[148:151], v[124:127]
    v_mfma_f32_16x16x32_bf16 v[128:131], a[120:123], a[152:155], v[128:131]
    v_mfma_f32_16x16x32_bf16 v[132:135], a[124:127], a[152:155], v[132:135]
    v_mfma_f32_16x16x32_bf16 v[136:139], a[128:131], a[152:155], v[136:139]
    v_mfma_f32_16x16x32_bf16 v[140:143], a[132:135], a[152:155], v[140:143]
    v_mfma_f32_16x16x32_bf16 v[144:147], a[120:123], a[156:159], v[144:147]
    v_mfma_f32_16x16x32_bf16 v[148:151], a[124:127], a[156:159], v[148:151]
    v_mfma_f32_16x16x32_bf16 v[152:155], a[128:131], a[156:159], v[152:155]
    v_mfma_f32_16x16x32_bf16 v[156:159], a[132:135], a[156:159], v[156:159]
    s_waitcnt vmcnt(10)
    v_mfma_f32_16x16x32_bf16 v[64:67], a[16:19], a[0:3], v[64:67]
    v_mfma_f32_16x16x32_bf16 v[68:71], a[16:19], a[4:7], v[68:71]
    v_mfma_f32_16x16x32_bf16 v[72:75], a[16:19], a[8:11], v[72:75]
    v_mfma_f32_16x16x32_bf16 v[76:79], a[16:19], a[12:15], v[76:79]
    v_mfma_f32_16x16x32_bf16 v[80:83], a[20:23], a[0:3], v[80:83]
    v_mfma_f32_16x16x32_bf16 v[84:87], a[20:23], a[4:7], v[84:87]
    v_mfma_f32_16x16x32_bf16 v[88:91], a[20:23], a[8:11], v[88:91]
    v_mfma_f32_16x16x32_bf16 v[92:95], a[20:23], a[12:15], v[92:95]
    v_mfma_f32_16x16x32_bf16 v[96:99], a[0:3], a[24:27], v[96:99]
    v_mfma_f32_16x16x32_bf16 v[100:103], a[4:7], a[24:27], v[100:103]
    v_mfma_f32_16x16x32_bf16 v[104:107], a[8:11], a[24:27], v[104:107]
    v_mfma_f32_16x16x32_bf16 v[108:111], a[12:15], a[24:27], v[108:111]
    v_mfma_f32_16x16x32_bf16 v[112:115], a[0:3], a[28:31], v[112:115]
    v_mfma_f32_16x16x32_bf16 v[116:119], a[4:7], a[28:31], v[116:119]
    v_mfma_f32_16x16x32_bf16 v[120:123], a[8:11], a[28:31], v[120:123]
    v_mfma_f32_16x16x32_bf16 v[124:127], a[12:15], a[28:31], v[124:127]
    v_mfma_f32_16x16x32_bf16 v[128:131], a[0:3], a[32:35], v[128:131]
    v_mfma_f32_16x16x32_bf16 v[132:135], a[4:7], a[32:35], v[132:135]
    v_mfma_f32_16x16x32_bf16 v[136:139], a[8:11], a[32:35], v[136:139]
    v_mfma_f32_16x16x32_bf16 v[140:143], a[12:15], a[32:35], v[140:143]
    v_mfma_f32_16x16x32_bf16 v[144:147], a[0:3], a[36:39], v[144:147]
    v_mfma_f32_16x16x32_bf16 v[148:151], a[4:7], a[36:39], v[148:151]
    v_mfma_f32_16x16x32_bf16 v[152:155], a[8:11], a[36:39], v[152:155]
    v_mfma_f32_16x16x32_bf16 v[156:159], a[12:15], a[36:39], v[156:159]
    s_waitcnt vmcnt(0)
    v_mfma_f32_16x16x32_bf16 v[64:67], a[56:59], a[40:43], v[64:67]
    v_mfma_f32_16x16x32_bf16 v[68:71], a[56:59], a[44:47], v[68:71]
    v_mfma_f32_16x16x32_bf16 v[72:75], a[56:59], a[48:51], v[72:75]
    v_mfma_f32_16x16x32_bf16 v[76:79], a[56:59], a[52:55], v[76:79]
    v_mfma_f32_16x16x32_bf16 v[80:83], a[60:63], a[40:43], v[80:83]
    v_mfma_f32_16x16x32_bf16 v[84:87], a[60:63], a[44:47], v[84:87]
    v_mfma_f32_16x16x32_bf16 v[88:91], a[60:63], a[48:51], v[88:91]
    v_mfma_f32_16x16x32_bf16 v[92:95], a[60:63], a[52:55], v[92:95]
    v_mfma_f32_16x16x32_bf16 v[96:99], a[40:43], a[64:67], v[96:99]
    v_mfma_f32_16x16x32_bf16 v[100:103], a[44:47], a[64:67], v[100:103]
    v_mfma_f32_16x16x32_bf16 v[104:107], a[48:51], a[64:67], v[104:107]
    v_mfma_f32_16x16x32_bf16 v[108:111], a[52:55], a[64:67], v[108:111]
    v_mfma_f32_16x16x32_bf16 v[112:115], a[40:43], a[68:71], v[112:115]
    v_mfma_f32_16x16x32_bf16 v[116:119], a[44:47], a[68:71], v[116:119]
    v_mfma_f32_16x16x32_bf16 v[120:123], a[48:51], a[68:71], v[120:123]
    v_mfma_f32_16x16x32_bf16 v[124:127], a[52:55], a[68:71], v[124:127]
    v_mfma_f32_16x16x32_bf16 v[128:131], a[40:43], a[72:75], v[128:131]
    v_mfma_f32_16x16x32_bf16 v[132:135], a[44:47], a[72:75], v[132:135]
    v_mfma_f32_16x16x32_bf16 v[136:139], a[48:51], a[72:75], v[136:139]
    v_mfma_f32_16x16x32_bf16 v[140:143], a[52:55], a[72:75], v[140:143]
    v_mfma_f32_16x16x32_bf16 v[144:147], a[40:43], a[76:79], v[144:147]
    v_mfma_f32_16x16x32_bf16 v[148:151], a[44:47], a[76:79], v[148:151]
    v_mfma_f32_16x16x32_bf16 v[152:155], a[48:51], a[76:79], v[152:155]
    v_mfma_f32_16x16x32_bf16 v[156:159], a[52:55], a[76:79], v[156:159]
    s_mov_b32 s34, 0x3fb8aa3b
    v_mov_b32 v10, 0xff800000
    v_mov_b32 v11, 0x7f800000
    v_cmp_gt_u32 s[24:25], 3, v3
    v_cmp_gt_u32 s[26:27], 12, v2
    v_cmp_eq_u32 s[28:29], 12, v2
    s_nop 7

    s_lshl_b32 s11, s9, 2
    s_lshl_b32 s11, s11, 15
    s_lshl_b32 s18, s10, 11
    s_add_u32 s11, s11, s18
    s_add_u32 s11, s11, 87490560
    s_add_u32 s18, s6, s11
    s_addc_u32 s19, s7, 0
    v_lshlrev_b32 v8, 4, v1

    v_cndmask_b32 v32, v10, v80, s[24:25]
    v_cndmask_b32 v33, v10, v81, s[24:25]
    v_cndmask_b32 v34, v10, v82, s[24:25]
    v_cndmask_b32 v35, v10, v83, s[24:25]
    v_max3_f32 v12, v64, v65, v66
    v_max3_f32 v12, v12, v67, v32
    v_max3_f32 v12, v12, v33, v34
    v_max_f32 v12, v12, v35
    v_mov_b32 v13, v12
    s_nop 1
    v_permlane16_swap_b32 v12, v13
    s_nop 1
    v_max_f32 v12, v12, v13
    v_mov_b32 v13, v12
    s_nop 1
    v_permlane32_swap_b32 v12, v13
    s_nop 1
    v_max_f32 v12, v12, v13
    v_mul_f32 v12, s34, v12
    v_fma_f32 v16, v64, s34, -v12
    v_fma_f32 v17, v65, s34, -v12
    v_fma_f32 v18, v66, s34, -v12
    v_fma_f32 v19, v67, s34, -v12
    v_fma_f32 v20, v32, s34, -v12
    v_fma_f32 v21, v33, s34, -v12
    v_fma_f32 v22, v34, s34, -v12
    v_fma_f32 v23, v35, s34, -v12
    v_exp_f32 v16, v16
    v_exp_f32 v17, v17
    v_exp_f32 v18, v18
    v_exp_f32 v19, v19
    v_exp_f32 v20, v20
    v_exp_f32 v21, v21
    v_exp_f32 v22, v22
    v_exp_f32 v23, v23
    s_nop 0
    v_add_f32 v14, v16, v17
    v_add_f32 v14, v14, v18
    v_add_f32 v14, v14, v19
    v_add_f32 v14, v14, v20
    v_add_f32 v14, v14, v21
    v_add_f32 v14, v14, v22
    v_add_f32 v14, v14, v23
    v_mov_b32 v13, v14
    s_nop 1
    v_permlane16_swap_b32 v14, v13
    s_nop 1
    v_add_f32 v14, v14, v13
    v_mov_b32 v13, v14
    s_nop 1
    v_permlane32_swap_b32 v14, v13
    s_nop 1
    v_add_f32 v14, v14, v13
    v_rcp_f32 v14, v14
    s_nop 0
    v_mul_f32 v16, v16, v14
    v_mul_f32 v17, v17, v14
    v_mul_f32 v18, v18, v14
    v_mul_f32 v19, v19, v14
    v_mul_f32 v20, v20, v14
    v_mul_f32 v21, v21, v14
    v_mul_f32 v22, v22, v14
    v_mul_f32 v23, v23, v14
    v_cvt_pk_bf16_f32 v24, v16, v17
    v_cvt_pk_bf16_f32 v25, v18, v19
    v_cvt_pk_bf16_f32 v26, v20, v21
    v_cvt_pk_bf16_f32 v27, v22, v23
    global_store_dwordx4 v8, v[24:27], s[18:19] offset:0 sc1
    v_cndmask_b32 v32, v11, v80, s[24:25]
    v_cndmask_b32 v33, v11, v81, s[24:25]
    v_cndmask_b32 v34, v11, v82, s[24:25]
    v_cndmask_b32 v35, v11, v83, s[24:25]
    v_min3_f32 v12, v64, v65, v66
    v_min3_f32 v12, v12, v67, v32
    v_min3_f32 v12, v12, v33, v34
    v_min_f32 v12, v12, v35
    v_mov_b32 v13, v12
    s_nop 1
    v_permlane16_swap_b32 v12, v13
    s_nop 1
    v_min_f32 v12, v12, v13
    v_mov_b32 v13, v12
    s_nop 1
    v_permlane32_swap_b32 v12, v13
    s_nop 1
    v_min_f32 v12, v12, v13
    v_mul_f32 v12, s34, v12
    v_fma_f32 v16, -v64, s34, v12
    v_fma_f32 v17, -v65, s34, v12
    v_fma_f32 v18, -v66, s34, v12
    v_fma_f32 v19, -v67, s34, v12
    v_fma_f32 v20, -v32, s34, v12
    v_fma_f32 v21, -v33, s34, v12
    v_fma_f32 v22, -v34, s34, v12
    v_fma_f32 v23, -v35, s34, v12
    v_exp_f32 v16, v16
    v_exp_f32 v17, v17
    v_exp_f32 v18, v18
    v_exp_f32 v19, v19
    v_exp_f32 v20, v20
    v_exp_f32 v21, v21
    v_exp_f32 v22, v22
    v_exp_f32 v23, v23
    s_nop 0
    v_add_f32 v14, v16, v17
    v_add_f32 v14, v14, v18
    v_add_f32 v14, v14, v19
    v_add_f32 v14, v14, v20
    v_add_f32 v14, v14, v21
    v_add_f32 v14, v14, v22
    v_add_f32 v14, v14, v23
    v_mov_b32 v13, v14
    s_nop 1
    v_permlane16_swap_b32 v14, v13
    s_nop 1
    v_add_f32 v14, v14, v13
    v_mov_b32 v13, v14
    s_nop 1
    v_permlane32_swap_b32 v14, v13
    s_nop 1
    v_add_f32 v14, v14, v13
    v_rcp_f32 v14, v14
    s_nop 0
    v_mul_f32 v16, v16, v14
    v_mul_f32 v17, v17, v14
    v_mul_f32 v18, v18, v14
    v_mul_f32 v19, v19, v14
    v_mul_f32 v20, v20, v14
    v_mul_f32 v21, v21, v14
    v_mul_f32 v22, v22, v14
    v_mul_f32 v23, v23, v14
    v_cvt_pk_bf16_f32 v28, v16, v17
    v_cvt_pk_bf16_f32 v29, v18, v19
    v_cvt_pk_bf16_f32 v30, v20, v21
    v_cvt_pk_bf16_f32 v31, v22, v23
    global_store_dwordx4 v8, v[28:31], s[18:19] offset:1024 sc1
    s_add_u32 s18, s18, 32768
    s_addc_u32 s19, s19, 0
    v_cndmask_b32 v32, v10, v84, s[24:25]
    v_cndmask_b32 v33, v10, v85, s[24:25]
    v_cndmask_b32 v34, v10, v86, s[24:25]
    v_cndmask_b32 v35, v10, v87, s[24:25]
    v_max3_f32 v12, v68, v69, v70
    v_max3_f32 v12, v12, v71, v32
    v_max3_f32 v12, v12, v33, v34
    v_max_f32 v12, v12, v35
    v_mov_b32 v13, v12
    s_nop 1
    v_permlane16_swap_b32 v12, v13
    s_nop 1
    v_max_f32 v12, v12, v13
    v_mov_b32 v13, v12
    s_nop 1
    v_permlane32_swap_b32 v12, v13
    s_nop 1
    v_max_f32 v12, v12, v13
    v_mul_f32 v12, s34, v12
    v_fma_f32 v16, v68, s34, -v12
    v_fma_f32 v17, v69, s34, -v12
    v_fma_f32 v18, v70, s34, -v12
    v_fma_f32 v19, v71, s34, -v12
    v_fma_f32 v20, v32, s34, -v12
    v_fma_f32 v21, v33, s34, -v12
    v_fma_f32 v22, v34, s34, -v12
    v_fma_f32 v23, v35, s34, -v12
    v_exp_f32 v16, v16
    v_exp_f32 v17, v17
    v_exp_f32 v18, v18
    v_exp_f32 v19, v19
    v_exp_f32 v20, v20
    v_exp_f32 v21, v21
    v_exp_f32 v22, v22
    v_exp_f32 v23, v23
    s_nop 0
    v_add_f32 v14, v16, v17
    v_add_f32 v14, v14, v18
    v_add_f32 v14, v14, v19
    v_add_f32 v14, v14, v20
    v_add_f32 v14, v14, v21
    v_add_f32 v14, v14, v22
    v_add_f32 v14, v14, v23
    v_mov_b32 v13, v14
    s_nop 1
    v_permlane16_swap_b32 v14, v13
    s_nop 1
    v_add_f32 v14, v14, v13
    v_mov_b32 v13, v14
    s_nop 1
    v_permlane32_swap_b32 v14, v13
    s_nop 1
    v_add_f32 v14, v14, v13
    v_rcp_f32 v14, v14
    s_nop 0
    v_mul_f32 v16, v16, v14
    v_mul_f32 v17, v17, v14
    v_mul_f32 v18, v18, v14
    v_mul_f32 v19, v19, v14
    v_mul_f32 v20, v20, v14
    v_mul_f32 v21, v21, v14
    v_mul_f32 v22, v22, v14
    v_mul_f32 v23, v23, v14
    v_cvt_pk_bf16_f32 v24, v16, v17
    v_cvt_pk_bf16_f32 v25, v18, v19
    v_cvt_pk_bf16_f32 v26, v20, v21
    v_cvt_pk_bf16_f32 v27, v22, v23
    global_store_dwordx4 v8, v[24:27], s[18:19] offset:0 sc1
    v_cndmask_b32 v32, v11, v84, s[24:25]
    v_cndmask_b32 v33, v11, v85, s[24:25]
    v_cndmask_b32 v34, v11, v86, s[24:25]
    v_cndmask_b32 v35, v11, v87, s[24:25]
    v_min3_f32 v12, v68, v69, v70
    v_min3_f32 v12, v12, v71, v32
    v_min3_f32 v12, v12, v33, v34
    v_min_f32 v12, v12, v35
    v_mov_b32 v13, v12
    s_nop 1
    v_permlane16_swap_b32 v12, v13
    s_nop 1
    v_min_f32 v12, v12, v13
    v_mov_b32 v13, v12
    s_nop 1
    v_permlane32_swap_b32 v12, v13
    s_nop 1
    v_min_f32 v12, v12, v13
    v_mul_f32 v12, s34, v12
    v_fma_f32 v16, -v68, s34, v12
    v_fma_f32 v17, -v69, s34, v12
    v_fma_f32 v18, -v70, s34, v12
    v_fma_f32 v19, -v71, s34, v12
    v_fma_f32 v20, -v32, s34, v12
    v_fma_f32 v21, -v33, s34, v12
    v_fma_f32 v22, -v34, s34, v12
    v_fma_f32 v23, -v35, s34, v12
    v_exp_f32 v16, v16
    v_exp_f32 v17, v17
    v_exp_f32 v18, v18
    v_exp_f32 v19, v19
    v_exp_f32 v20, v20
    v_exp_f32 v21, v21
    v_exp_f32 v22, v22
    v_exp_f32 v23, v23
    s_nop 0
    v_add_f32 v14, v16, v17
    v_add_f32 v14, v14, v18
    v_add_f32 v14, v14, v19
    v_add_f32 v14, v14, v20
    v_add_f32 v14, v14, v21
    v_add_f32 v14, v14, v22
    v_add_f32 v14, v14, v23
    v_mov_b32 v13, v14
    s_nop 1
    v_permlane16_swap_b32 v14, v13
    s_nop 1
    v_add_f32 v14, v14, v13
    v_mov_b32 v13, v14
    s_nop 1
    v_permlane32_swap_b32 v14, v13
    s_nop 1
    v_add_f32 v14, v14, v13
    v_rcp_f32 v14, v14
    s_nop 0
    v_mul_f32 v16, v16, v14
    v_mul_f32 v17, v17, v14
    v_mul_f32 v18, v18, v14
    v_mul_f32 v19, v19, v14
    v_mul_f32 v20, v20, v14
    v_mul_f32 v21, v21, v14
    v_mul_f32 v22, v22, v14
    v_mul_f32 v23, v23, v14
    v_cvt_pk_bf16_f32 v28, v16, v17
    v_cvt_pk_bf16_f32 v29, v18, v19
    v_cvt_pk_bf16_f32 v30, v20, v21
    v_cvt_pk_bf16_f32 v31, v22, v23
    global_store_dwordx4 v8, v[28:31], s[18:19] offset:1024 sc1
    s_add_u32 s18, s18, 32768
    s_addc_u32 s19, s19, 0
    v_cndmask_b32 v32, v10, v88, s[24:25]
    v_cndmask_b32 v33, v10, v89, s[24:25]
    v_cndmask_b32 v34, v10, v90, s[24:25]
    v_cndmask_b32 v35, v10, v91, s[24:25]
    v_max3_f32 v12, v72, v73, v74
    v_max3_f32 v12, v12, v75, v32
    v_max3_f32 v12, v12, v33, v34
    v_max_f32 v12, v12, v35
    v_mov_b32 v13, v12
    s_nop 1
    v_permlane16_swap_b32 v12, v13
    s_nop 1
    v_max_f32 v12, v12, v13
    v_mov_b32 v13, v12
    s_nop 1
    v_permlane32_swap_b32 v12, v13
    s_nop 1
    v_max_f32 v12, v12, v13
    v_mul_f32 v12, s34, v12
    v_fma_f32 v16, v72, s34, -v12
    v_fma_f32 v17, v73, s34, -v12
    v_fma_f32 v18, v74, s34, -v12
    v_fma_f32 v19, v75, s34, -v12
    v_fma_f32 v20, v32, s34, -v12
    v_fma_f32 v21, v33, s34, -v12
    v_fma_f32 v22, v34, s34, -v12
    v_fma_f32 v23, v35, s34, -v12
    v_exp_f32 v16, v16
    v_exp_f32 v17, v17
    v_exp_f32 v18, v18
    v_exp_f32 v19, v19
    v_exp_f32 v20, v20
    v_exp_f32 v21, v21
    v_exp_f32 v22, v22
    v_exp_f32 v23, v23
    s_nop 0
    v_add_f32 v14, v16, v17
    v_add_f32 v14, v14, v18
    v_add_f32 v14, v14, v19
    v_add_f32 v14, v14, v20
    v_add_f32 v14, v14, v21
    v_add_f32 v14, v14, v22
    v_add_f32 v14, v14, v23
    v_mov_b32 v13, v14
    s_nop 1
    v_permlane16_swap_b32 v14, v13
    s_nop 1
    v_add_f32 v14, v14, v13
    v_mov_b32 v13, v14
    s_nop 1
    v_permlane32_swap_b32 v14, v13
    s_nop 1
    v_add_f32 v14, v14, v13
    v_rcp_f32 v14, v14
    s_nop 0
    v_mul_f32 v16, v16, v14
    v_mul_f32 v17, v17, v14
    v_mul_f32 v18, v18, v14
    v_mul_f32 v19, v19, v14
    v_mul_f32 v20, v20, v14
    v_mul_f32 v21, v21, v14
    v_mul_f32 v22, v22, v14
    v_mul_f32 v23, v23, v14
    v_cvt_pk_bf16_f32 v24, v16, v17
    v_cvt_pk_bf16_f32 v25, v18, v19
    v_cvt_pk_bf16_f32 v26, v20, v21
    v_cvt_pk_bf16_f32 v27, v22, v23
    global_store_dwordx4 v8, v[24:27], s[18:19] offset:0 sc1
    v_cndmask_b32 v32, v11, v88, s[24:25]
    v_cndmask_b32 v33, v11, v89, s[24:25]
    v_cndmask_b32 v34, v11, v90, s[24:25]
    v_cndmask_b32 v35, v11, v91, s[24:25]
    v_min3_f32 v12, v72, v73, v74
    v_min3_f32 v12, v12, v75, v32
    v_min3_f32 v12, v12, v33, v34
    v_min_f32 v12, v12, v35
    v_mov_b32 v13, v12
    s_nop 1
    v_permlane16_swap_b32 v12, v13
    s_nop 1
    v_min_f32 v12, v12, v13
    v_mov_b32 v13, v12
    s_nop 1
    v_permlane32_swap_b32 v12, v13
    s_nop 1
    v_min_f32 v12, v12, v13
    v_mul_f32 v12, s34, v12
    v_fma_f32 v16, -v72, s34, v12
    v_fma_f32 v17, -v73, s34, v12
    v_fma_f32 v18, -v74, s34, v12
    v_fma_f32 v19, -v75, s34, v12
    v_fma_f32 v20, -v32, s34, v12
    v_fma_f32 v21, -v33, s34, v12
    v_fma_f32 v22, -v34, s34, v12
    v_fma_f32 v23, -v35, s34, v12
    v_exp_f32 v16, v16
    v_exp_f32 v17, v17
    v_exp_f32 v18, v18
    v_exp_f32 v19, v19
    v_exp_f32 v20, v20
    v_exp_f32 v21, v21
    v_exp_f32 v22, v22
    v_exp_f32 v23, v23
    s_nop 0
    v_add_f32 v14, v16, v17
    v_add_f32 v14, v14, v18
    v_add_f32 v14, v14, v19
    v_add_f32 v14, v14, v20
    v_add_f32 v14, v14, v21
    v_add_f32 v14, v14, v22
    v_add_f32 v14, v14, v23
    v_mov_b32 v13, v14
    s_nop 1
    v_permlane16_swap_b32 v14, v13
    s_nop 1
    v_add_f32 v14, v14, v13
    v_mov_b32 v13, v14
    s_nop 1
    v_permlane32_swap_b32 v14, v13
    s_nop 1
    v_add_f32 v14, v14, v13
    v_rcp_f32 v14, v14
    s_nop 0
    v_mul_f32 v16, v16, v14
    v_mul_f32 v17, v17, v14
    v_mul_f32 v18, v18, v14
    v_mul_f32 v19, v19, v14
    v_mul_f32 v20, v20, v14
    v_mul_f32 v21, v21, v14
    v_mul_f32 v22, v22, v14
    v_mul_f32 v23, v23, v14
    v_cvt_pk_bf16_f32 v28, v16, v17
    v_cvt_pk_bf16_f32 v29, v18, v19
    v_cvt_pk_bf16_f32 v30, v20, v21
    v_cvt_pk_bf16_f32 v31, v22, v23
    global_store_dwordx4 v8, v[28:31], s[18:19] offset:1024 sc1
    s_add_u32 s18, s18, 32768
    s_addc_u32 s19, s19, 0
    v_cndmask_b32 v32, v10, v92, s[24:25]
    v_cndmask_b32 v33, v10, v93, s[24:25]
    v_cndmask_b32 v34, v10, v94, s[24:25]
    v_cndmask_b32 v35, v10, v95, s[24:25]
    v_max3_f32 v12, v76, v77, v78
    v_max3_f32 v12, v12, v79, v32
    v_max3_f32 v12, v12, v33, v34
    v_max_f32 v12, v12, v35
    v_mov_b32 v13, v12
    s_nop 1
    v_permlane16_swap_b32 v12, v13
    s_nop 1
    v_max_f32 v12, v12, v13
    v_mov_b32 v13, v12
    s_nop 1
    v_permlane32_swap_b32 v12, v13
    s_nop 1
    v_max_f32 v12, v12, v13
    v_mul_f32 v12, s34, v12
    v_fma_f32 v16, v76, s34, -v12
    v_fma_f32 v17, v77, s34, -v12
    v_fma_f32 v18, v78, s34, -v12
    v_fma_f32 v19, v79, s34, -v12
    v_fma_f32 v20, v32, s34, -v12
    v_fma_f32 v21, v33, s34, -v12
    v_fma_f32 v22, v34, s34, -v12
    v_fma_f32 v23, v35, s34, -v12
    v_exp_f32 v16, v16
    v_exp_f32 v17, v17
    v_exp_f32 v18, v18
    v_exp_f32 v19, v19
    v_exp_f32 v20, v20
    v_exp_f32 v21, v21
    v_exp_f32 v22, v22
    v_exp_f32 v23, v23
    s_nop 0
    v_add_f32 v14, v16, v17
    v_add_f32 v14, v14, v18
    v_add_f32 v14, v14, v19
    v_add_f32 v14, v14, v20
    v_add_f32 v14, v14, v21
    v_add_f32 v14, v14, v22
    v_add_f32 v14, v14, v23
    v_mov_b32 v13, v14
    s_nop 1
    v_permlane16_swap_b32 v14, v13
    s_nop 1
    v_add_f32 v14, v14, v13
    v_mov_b32 v13, v14
    s_nop 1
    v_permlane32_swap_b32 v14, v13
    s_nop 1
    v_add_f32 v14, v14, v13
    v_rcp_f32 v14, v14
    s_nop 0
    v_mul_f32 v16, v16, v14
    v_mul_f32 v17, v17, v14
    v_mul_f32 v18, v18, v14
    v_mul_f32 v19, v19, v14
    v_mul_f32 v20, v20, v14
    v_mul_f32 v21, v21, v14
    v_mul_f32 v22, v22, v14
    v_mul_f32 v23, v23, v14
    v_cvt_pk_bf16_f32 v24, v16, v17
    v_cvt_pk_bf16_f32 v25, v18, v19
    v_cvt_pk_bf16_f32 v26, v20, v21
    v_cvt_pk_bf16_f32 v27, v22, v23
    global_store_dwordx4 v8, v[24:27], s[18:19] offset:0 sc1
    v_cndmask_b32 v32, v11, v92, s[24:25]
    v_cndmask_b32 v33, v11, v93, s[24:25]
    v_cndmask_b32 v34, v11, v94, s[24:25]
    v_cndmask_b32 v35, v11, v95, s[24:25]
    v_min3_f32 v12, v76, v77, v78
    v_min3_f32 v12, v12, v79, v32
    v_min3_f32 v12, v12, v33, v34
    v_min_f32 v12, v12, v35
    v_mov_b32 v13, v12
    s_nop 1
    v_permlane16_swap_b32 v12, v13
    s_nop 1
    v_min_f32 v12, v12, v13
    v_mov_b32 v13, v12
    s_nop 1
    v_permlane32_swap_b32 v12, v13
    s_nop 1
    v_min_f32 v12, v12, v13
    v_mul_f32 v12, s34, v12
    v_fma_f32 v16, -v76, s34, v12
    v_fma_f32 v17, -v77, s34, v12
    v_fma_f32 v18, -v78, s34, v12
    v_fma_f32 v19, -v79, s34, v12
    v_fma_f32 v20, -v32, s34, v12
    v_fma_f32 v21, -v33, s34, v12
    v_fma_f32 v22, -v34, s34, v12
    v_fma_f32 v23, -v35, s34, v12
    v_exp_f32 v16, v16
    v_exp_f32 v17, v17
    v_exp_f32 v18, v18
    v_exp_f32 v19, v19
    v_exp_f32 v20, v20
    v_exp_f32 v21, v21
    v_exp_f32 v22, v22
    v_exp_f32 v23, v23
    s_nop 0
    v_add_f32 v14, v16, v17
    v_add_f32 v14, v14, v18
    v_add_f32 v14, v14, v19
    v_add_f32 v14, v14, v20
    v_add_f32 v14, v14, v21
    v_add_f32 v14, v14, v22
    v_add_f32 v14, v14, v23
    v_mov_b32 v13, v14
    s_nop 1
    v_permlane16_swap_b32 v14, v13
    s_nop 1
    v_add_f32 v14, v14, v13
    v_mov_b32 v13, v14
    s_nop 1
    v_permlane32_swap_b32 v14, v13
    s_nop 1
    v_add_f32 v14, v14, v13
    v_rcp_f32 v14, v14
    s_nop 0
    v_mul_f32 v16, v16, v14
    v_mul_f32 v17, v17, v14
    v_mul_f32 v18, v18, v14
    v_mul_f32 v19, v19, v14
    v_mul_f32 v20, v20, v14
    v_mul_f32 v21, v21, v14
    v_mul_f32 v22, v22, v14
    v_mul_f32 v23, v23, v14
    v_cvt_pk_bf16_f32 v28, v16, v17
    v_cvt_pk_bf16_f32 v29, v18, v19
    v_cvt_pk_bf16_f32 v30, v20, v21
    v_cvt_pk_bf16_f32 v31, v22, v23
    global_store_dwordx4 v8, v[28:31], s[18:19] offset:1024 sc1
    s_add_u32 s18, s18, 32768
    s_addc_u32 s19, s19, 0
    v_cndmask_b32 v32, v10, v112, s[26:27]
    v_max_f32 v12, v96, v32
    v_cndmask_b32 v33, v10, v113, s[26:27]
    v_max_f32 v13, v97, v33
    v_cndmask_b32 v34, v10, v114, s[26:27]
    v_max_f32 v14, v98, v34
    v_cndmask_b32 v35, v10, v115, s[26:27]
    v_max_f32 v15, v99, v35
    v_max_f32_dpp v12, v12, v12 row_ror:1 row_mask:0xf bank_mask:0xf
    v_max_f32_dpp v13, v13, v13 row_ror:1 row_mask:0xf bank_mask:0xf
    v_max_f32_dpp v14, v14, v14 row_ror:1 row_mask:0xf bank_mask:0xf
    v_max_f32_dpp v15, v15, v15 row_ror:1 row_mask:0xf bank_mask:0xf
    v_max_f32_dpp v12, v12, v12 row_ror:2 row_mask:0xf bank_mask:0xf
    v_max_f32_dpp v13, v13, v13 row_ror:2 row_mask:0xf bank_mask:0xf
    v_max_f32_dpp v14, v14, v14 row_ror:2 row_mask:0xf bank_mask:0xf
    v_max_f32_dpp v15, v15, v15 row_ror:2 row_mask:0xf bank_mask:0xf
    v_max_f32_dpp v12, v12, v12 row_ror:4 row_mask:0xf bank_mask:0xf
    v_max_f32_dpp v13, v13, v13 row_ror:4 row_mask:0xf bank_mask:0xf
    v_max_f32_dpp v14, v14, v14 row_ror:4 row_mask:0xf bank_mask:0xf
    v_max_f32_dpp v15, v15, v15 row_ror:4 row_mask:0xf bank_mask:0xf
    v_max_f32_dpp v12, v12, v12 row_ror:8 row_mask:0xf bank_mask:0xf
    v_max_f32_dpp v13, v13, v13 row_ror:8 row_mask:0xf bank_mask:0xf
    v_max_f32_dpp v14, v14, v14 row_ror:8 row_mask:0xf bank_mask:0xf
    v_max_f32_dpp v15, v15, v15 row_ror:8 row_mask:0xf bank_mask:0xf
    v_mul_f32 v12, s34, v12
    v_mul_f32 v13, s34, v13
    v_mul_f32 v14, s34, v14
    v_mul_f32 v15, s34, v15
    v_fma_f32 v16, v96, s34, -v12
    v_fma_f32 v20, v32, s34, -v12
    v_fma_f32 v17, v97, s34, -v13
    v_fma_f32 v21, v33, s34, -v13
    v_fma_f32 v18, v98, s34, -v14
    v_fma_f32 v22, v34, s34, -v14
    v_fma_f32 v19, v99, s34, -v15
    v_fma_f32 v23, v35, s34, -v15
    v_exp_f32 v16, v16
    v_exp_f32 v17, v17
    v_exp_f32 v18, v18
    v_exp_f32 v19, v19
    v_exp_f32 v20, v20
    v_exp_f32 v21, v21
    v_exp_f32 v22, v22
    v_exp_f32 v23, v23
    s_nop 0
    v_add_f32 v12, v16, v20
    v_add_f32 v13, v17, v21
    v_add_f32 v14, v18, v22
    v_add_f32 v15, v19, v23
    s_nop 0
    v_add_f32_dpp v12, v12, v12 row_ror:1 row_mask:0xf bank_mask:0xf
    v_add_f32_dpp v13, v13, v13 row_ror:1 row_mask:0xf bank_mask:0xf
    v_add_f32_dpp v14, v14, v14 row_ror:1 row_mask:0xf bank_mask:0xf
    v_add_f32_dpp v15, v15, v15 row_ror:1 row_mask:0xf bank_mask:0xf
    v_add_f32_dpp v12, v12, v12 row_ror:2 row_mask:0xf bank_mask:0xf
    v_add_f32_dpp v13, v13, v13 row_ror:2 row_mask:0xf bank_mask:0xf
    v_add_f32_dpp v14, v14, v14 row_ror:2 row_mask:0xf bank_mask:0xf
    v_add_f32_dpp v15, v15, v15 row_ror:2 row_mask:0xf bank_mask:0xf
    v_add_f32_dpp v12, v12, v12 row_ror:4 row_mask:0xf bank_mask:0xf
    v_add_f32_dpp v13, v13, v13 row_ror:4 row_mask:0xf bank_mask:0xf
    v_add_f32_dpp v14, v14, v14 row_ror:4 row_mask:0xf bank_mask:0xf
    v_add_f32_dpp v15, v15, v15 row_ror:4 row_mask:0xf bank_mask:0xf
    v_add_f32_dpp v12, v12, v12 row_ror:8 row_mask:0xf bank_mask:0xf
    v_add_f32_dpp v13, v13, v13 row_ror:8 row_mask:0xf bank_mask:0xf
    v_add_f32_dpp v14, v14, v14 row_ror:8 row_mask:0xf bank_mask:0xf
    v_add_f32_dpp v15, v15, v15 row_ror:8 row_mask:0xf bank_mask:0xf
    v_rcp_f32 v12, v12
    v_rcp_f32 v13, v13
    v_rcp_f32 v14, v14
    v_rcp_f32 v15, v15
    s_nop 0
    v_mul_f32 v16, v16, v12
    v_mul_f32 v20, v20, v12
    v_mul_f32 v17, v17, v13
    v_mul_f32 v21, v21, v13
    v_mul_f32 v18, v18, v14
    v_mul_f32 v22, v22, v14
    v_mul_f32 v19, v19, v15
    v_mul_f32 v23, v23, v15
    v_cvt_pk_bf16_f32 v160, v16, v17
    v_cvt_pk_bf16_f32 v161, v18, v19
    v_cvt_pk_bf16_f32 v168, v20, v21
    v_cvt_pk_bf16_f32 v169, v22, v23
    v_cndmask_b32 v32, v11, v112, s[26:27]
    v_min_f32 v12, v96, v32
    v_cndmask_b32 v33, v11, v113, s[26:27]
    v_min_f32 v13, v97, v33
    v_cndmask_b32 v34, v11, v114, s[26:27]
    v_min_f32 v14, v98, v34
    v_cndmask_b32 v35, v11, v115, s[26:27]
    v_min_f32 v15, v99, v35
    v_min_f32_dpp v12, v12, v12 row_ror:1 row_mask:0xf bank_mask:0xf
    v_min_f32_dpp v13, v13, v13 row_ror:1 row_mask:0xf bank_mask:0xf
    v_min_f32_dpp v14, v14, v14 row_ror:1 row_mask:0xf bank_mask:0xf
    v_min_f32_dpp v15, v15, v15 row_ror:1 row_mask:0xf bank_mask:0xf
    v_min_f32_dpp v12, v12, v12 row_ror:2 row_mask:0xf bank_mask:0xf
    v_min_f32_dpp v13, v13, v13 row_ror:2 row_mask:0xf bank_mask:0xf
    v_min_f32_dpp v14, v14, v14 row_ror:2 row_mask:0xf bank_mask:0xf
    v_min_f32_dpp v15, v15, v15 row_ror:2 row_mask:0xf bank_mask:0xf
    v_min_f32_dpp v12, v12, v12 row_ror:4 row_mask:0xf bank_mask:0xf
    v_min_f32_dpp v13, v13, v13 row_ror:4 row_mask:0xf bank_mask:0xf
    v_min_f32_dpp v14, v14, v14 row_ror:4 row_mask:0xf bank_mask:0xf
    v_min_f32_dpp v15, v15, v15 row_ror:4 row_mask:0xf bank_mask:0xf
    v_min_f32_dpp v12, v12, v12 row_ror:8 row_mask:0xf bank_mask:0xf
    v_min_f32_dpp v13, v13, v13 row_ror:8 row_mask:0xf bank_mask:0xf
    v_min_f32_dpp v14, v14, v14 row_ror:8 row_mask:0xf bank_mask:0xf
    v_min_f32_dpp v15, v15, v15 row_ror:8 row_mask:0xf bank_mask:0xf
    v_mul_f32 v12, s34, v12
    v_mul_f32 v13, s34, v13
    v_mul_f32 v14, s34, v14
    v_mul_f32 v15, s34, v15
    v_fma_f32 v16, -v96, s34, v12
    v_fma_f32 v20, -v32, s34, v12
    v_fma_f32 v17, -v97, s34, v13
    v_fma_f32 v21, -v33, s34, v13
    v_fma_f32 v18, -v98, s34, v14
    v_fma_f32 v22, -v34, s34, v14
    v_fma_f32 v19, -v99, s34, v15
    v_fma_f32 v23, -v35, s34, v15
    v_exp_f32 v16, v16
    v_exp_f32 v17, v17
    v_exp_f32 v18, v18
    v_exp_f32 v19, v19
    v_exp_f32 v20, v20
    v_exp_f32 v21, v21
    v_exp_f32 v22, v22
    v_exp_f32 v23, v23
    s_nop 0
    v_add_f32 v12, v16, v20
    v_add_f32 v13, v17, v21
    v_add_f32 v14, v18, v22
    v_add_f32 v15, v19, v23
    s_nop 0
    v_add_f32_dpp v12, v12, v12 row_ror:1 row_mask:0xf bank_mask:0xf
    v_add_f32_dpp v13, v13, v13 row_ror:1 row_mask:0xf bank_mask:0xf
    v_add_f32_dpp v14, v14, v14 row_ror:1 row_mask:0xf bank_mask:0xf
    v_add_f32_dpp v15, v15, v15 row_ror:1 row_mask:0xf bank_mask:0xf
    v_add_f32_dpp v12, v12, v12 row_ror:2 row_mask:0xf bank_mask:0xf
    v_add_f32_dpp v13, v13, v13 row_ror:2 row_mask:0xf bank_mask:0xf
    v_add_f32_dpp v14, v14, v14 row_ror:2 row_mask:0xf bank_mask:0xf
    v_add_f32_dpp v15, v15, v15 row_ror:2 row_mask:0xf bank_mask:0xf
    v_add_f32_dpp v12, v12, v12 row_ror:4 row_mask:0xf bank_mask:0xf
    v_add_f32_dpp v13, v13, v13 row_ror:4 row_mask:0xf bank_mask:0xf
    v_add_f32_dpp v14, v14, v14 row_ror:4 row_mask:0xf bank_mask:0xf
    v_add_f32_dpp v15, v15, v15 row_ror:4 row_mask:0xf bank_mask:0xf
    v_add_f32_dpp v12, v12, v12 row_ror:8 row_mask:0xf bank_mask:0xf
    v_add_f32_dpp v13, v13, v13 row_ror:8 row_mask:0xf bank_mask:0xf
    v_add_f32_dpp v14, v14, v14 row_ror:8 row_mask:0xf bank_mask:0xf
    v_add_f32_dpp v15, v15, v15 row_ror:8 row_mask:0xf bank_mask:0xf
    v_rcp_f32 v12, v12
    v_rcp_f32 v13, v13
    v_rcp_f32 v14, v14
    v_rcp_f32 v15, v15
    s_nop 0
    v_mul_f32 v16, v16, v12
    v_mul_f32 v20, v20, v12
    v_mul_f32 v17, v17, v13
    v_mul_f32 v21, v21, v13
    v_mul_f32 v18, v18, v14
    v_mul_f32 v22, v22, v14
    v_mul_f32 v19, v19, v15
    v_mul_f32 v23, v23, v15
    v_cvt_pk_bf16_f32 v176, v16, v17
    v_cvt_pk_bf16_f32 v177, v18, v19
    v_cvt_pk_bf16_f32 v184, v20, v21
    v_cvt_pk_bf16_f32 v185, v22, v23
    v_cvt_pk_bf16_f32 v192, v128, v129
    v_cvt_pk_bf16_f32 v193, v130, v131
    v_cndmask_b32 v144, v144, 1.0, s[28:29]
    v_cndmask_b32 v145, v145, 1.0, s[28:29]
    v_cndmask_b32 v146, v146, 1.0, s[28:29]
    v_cndmask_b32 v147, v147, 1.0, s[28:29]
    v_cvt_pk_bf16_f32 v200, v144, v145
    v_cvt_pk_bf16_f32 v201, v146, v147
    v_cndmask_b32 v32, v10, v116, s[26:27]
    v_max_f32 v12, v100, v32
    v_cndmask_b32 v33, v10, v117, s[26:27]
    v_max_f32 v13, v101, v33
    v_cndmask_b32 v34, v10, v118, s[26:27]
    v_max_f32 v14, v102, v34
    v_cndmask_b32 v35, v10, v119, s[26:27]
    v_max_f32 v15, v103, v35
    v_max_f32_dpp v12, v12, v12 row_ror:1 row_mask:0xf bank_mask:0xf
    v_max_f32_dpp v13, v13, v13 row_ror:1 row_mask:0xf bank_mask:0xf
    v_max_f32_dpp v14, v14, v14 row_ror:1 row_mask:0xf bank_mask:0xf
    v_max_f32_dpp v15, v15, v15 row_ror:1 row_mask:0xf bank_mask:0xf
    v_max_f32_dpp v12, v12, v12 row_ror:2 row_mask:0xf bank_mask:0xf
    v_max_f32_dpp v13, v13, v13 row_ror:2 row_mask:0xf bank_mask:0xf
    v_max_f32_dpp v14, v14, v14 row_ror:2 row_mask:0xf bank_mask:0xf
    v_max_f32_dpp v15, v15, v15 row_ror:2 row_mask:0xf bank_mask:0xf
    v_max_f32_dpp v12, v12, v12 row_ror:4 row_mask:0xf bank_mask:0xf
    v_max_f32_dpp v13, v13, v13 row_ror:4 row_mask:0xf bank_mask:0xf
    v_max_f32_dpp v14, v14, v14 row_ror:4 row_mask:0xf bank_mask:0xf
    v_max_f32_dpp v15, v15, v15 row_ror:4 row_mask:0xf bank_mask:0xf
    v_max_f32_dpp v12, v12, v12 row_ror:8 row_mask:0xf bank_mask:0xf
    v_max_f32_dpp v13, v13, v13 row_ror:8 row_mask:0xf bank_mask:0xf
    v_max_f32_dpp v14, v14, v14 row_ror:8 row_mask:0xf bank_mask:0xf
    v_max_f32_dpp v15, v15, v15 row_ror:8 row_mask:0xf bank_mask:0xf
    v_mul_f32 v12, s34, v12
    v_mul_f32 v13, s34, v13
    v_mul_f32 v14, s34, v14
    v_mul_f32 v15, s34, v15
    v_fma_f32 v16, v100, s34, -v12
    v_fma_f32 v20, v32, s34, -v12
    v_fma_f32 v17, v101, s34, -v13
    v_fma_f32 v21, v33, s34, -v13
    v_fma_f32 v18, v102, s34, -v14
    v_fma_f32 v22, v34, s34, -v14
    v_fma_f32 v19, v103, s34, -v15
    v_fma_f32 v23, v35, s34, -v15
    v_exp_f32 v16, v16
    v_exp_f32 v17, v17
    v_exp_f32 v18, v18
    v_exp_f32 v19, v19
    v_exp_f32 v20, v20
    v_exp_f32 v21, v21
    v_exp_f32 v22, v22
    v_exp_f32 v23, v23
    s_nop 0
    v_add_f32 v12, v16, v20
    v_add_f32 v13, v17, v21
    v_add_f32 v14, v18, v22
    v_add_f32 v15, v19, v23
    s_nop 0
    v_add_f32_dpp v12, v12, v12 row_ror:1 row_mask:0xf bank_mask:0xf
    v_add_f32_dpp v13, v13, v13 row_ror:1 row_mask:0xf bank_mask:0xf
    v_add_f32_dpp v14, v14, v14 row_ror:1 row_mask:0xf bank_mask:0xf
    v_add_f32_dpp v15, v15, v15 row_ror:1 row_mask:0xf bank_mask:0xf
    v_add_f32_dpp v12, v12, v12 row_ror:2 row_mask:0xf bank_mask:0xf
    v_add_f32_dpp v13, v13, v13 row_ror:2 row_mask:0xf bank_mask:0xf
    v_add_f32_dpp v14, v14, v14 row_ror:2 row_mask:0xf bank_mask:0xf
    v_add_f32_dpp v15, v15, v15 row_ror:2 row_mask:0xf bank_mask:0xf
    v_add_f32_dpp v12, v12, v12 row_ror:4 row_mask:0xf bank_mask:0xf
    v_add_f32_dpp v13, v13, v13 row_ror:4 row_mask:0xf bank_mask:0xf
    v_add_f32_dpp v14, v14, v14 row_ror:4 row_mask:0xf bank_mask:0xf
    v_add_f32_dpp v15, v15, v15 row_ror:4 row_mask:0xf bank_mask:0xf
    v_add_f32_dpp v12, v12, v12 row_ror:8 row_mask:0xf bank_mask:0xf
    v_add_f32_dpp v13, v13, v13 row_ror:8 row_mask:0xf bank_mask:0xf
    v_add_f32_dpp v14, v14, v14 row_ror:8 row_mask:0xf bank_mask:0xf
    v_add_f32_dpp v15, v15, v15 row_ror:8 row_mask:0xf bank_mask:0xf
    v_rcp_f32 v12, v12
    v_rcp_f32 v13, v13
    v_rcp_f32 v14, v14
    v_rcp_f32 v15, v15
    s_nop 0
    v_mul_f32 v16, v16, v12
    v_mul_f32 v20, v20, v12
    v_mul_f32 v17, v17, v13
    v_mul_f32 v21, v21, v13
    v_mul_f32 v18, v18, v14
    v_mul_f32 v22, v22, v14
    v_mul_f32 v19, v19, v15
    v_mul_f32 v23, v23, v15
    v_cvt_pk_bf16_f32 v162, v16, v17
    v_cvt_pk_bf16_f32 v163, v18, v19
    v_cvt_pk_bf16_f32 v170, v20, v21
    v_cvt_pk_bf16_f32 v171, v22, v23
    v_cndmask_b32 v32, v11, v116, s[26:27]
    v_min_f32 v12, v100, v32
    v_cndmask_b32 v33, v11, v117, s[26:27]
    v_min_f32 v13, v101, v33
    v_cndmask_b32 v34, v11, v118, s[26:27]
    v_min_f32 v14, v102, v34
    v_cndmask_b32 v35, v11, v119, s[26:27]
    v_min_f32 v15, v103, v35
    v_min_f32_dpp v12, v12, v12 row_ror:1 row_mask:0xf bank_mask:0xf
    v_min_f32_dpp v13, v13, v13 row_ror:1 row_mask:0xf bank_mask:0xf
    v_min_f32_dpp v14, v14, v14 row_ror:1 row_mask:0xf bank_mask:0xf
    v_min_f32_dpp v15, v15, v15 row_ror:1 row_mask:0xf bank_mask:0xf
    v_min_f32_dpp v12, v12, v12 row_ror:2 row_mask:0xf bank_mask:0xf
    v_min_f32_dpp v13, v13, v13 row_ror:2 row_mask:0xf bank_mask:0xf
    v_min_f32_dpp v14, v14, v14 row_ror:2 row_mask:0xf bank_mask:0xf
    v_min_f32_dpp v15, v15, v15 row_ror:2 row_mask:0xf bank_mask:0xf
    v_min_f32_dpp v12, v12, v12 row_ror:4 row_mask:0xf bank_mask:0xf
    v_min_f32_dpp v13, v13, v13 row_ror:4 row_mask:0xf bank_mask:0xf
    v_min_f32_dpp v14, v14, v14 row_ror:4 row_mask:0xf bank_mask:0xf
    v_min_f32_dpp v15, v15, v15 row_ror:4 row_mask:0xf bank_mask:0xf
    v_min_f32_dpp v12, v12, v12 row_ror:8 row_mask:0xf bank_mask:0xf
    v_min_f32_dpp v13, v13, v13 row_ror:8 row_mask:0xf bank_mask:0xf
    v_min_f32_dpp v14, v14, v14 row_ror:8 row_mask:0xf bank_mask:0xf
    v_min_f32_dpp v15, v15, v15 row_ror:8 row_mask:0xf bank_mask:0xf
    v_mul_f32 v12, s34, v12
    v_mul_f32 v13, s34, v13
    v_mul_f32 v14, s34, v14
    v_mul_f32 v15, s34, v15
    v_fma_f32 v16, -v100, s34, v12
    v_fma_f32 v20, -v32, s34, v12
    v_fma_f32 v17, -v101, s34, v13
    v_fma_f32 v21, -v33, s34, v13
    v_fma_f32 v18, -v102, s34, v14
    v_fma_f32 v22, -v34, s34, v14
    v_fma_f32 v19, -v103, s34, v15
    v_fma_f32 v23, -v35, s34, v15
    v_exp_f32 v16, v16
    v_exp_f32 v17, v17
    v_exp_f32 v18, v18
    v_exp_f32 v19, v19
    v_exp_f32 v20, v20
    v_exp_f32 v21, v21
    v_exp_f32 v22, v22
    v_exp_f32 v23, v23
    s_nop 0
    v_add_f32 v12, v16, v20
    v_add_f32 v13, v17, v21
    v_add_f32 v14, v18, v22
    v_add_f32 v15, v19, v23
    s_nop 0
    v_add_f32_dpp v12, v12, v12 row_ror:1 row_mask:0xf bank_mask:0xf
    v_add_f32_dpp v13, v13, v13 row_ror:1 row_mask:0xf bank_mask:0xf
    v_add_f32_dpp v14, v14, v14 row_ror:1 row_mask:0xf bank_mask:0xf
    v_add_f32_dpp v15, v15, v15 row_ror:1 row_mask:0xf bank_mask:0xf
    v_add_f32_dpp v12, v12, v12 row_ror:2 row_mask:0xf bank_mask:0xf
    v_add_f32_dpp v13, v13, v13 row_ror:2 row_mask:0xf bank_mask:0xf
    v_add_f32_dpp v14, v14, v14 row_ror:2 row_mask:0xf bank_mask:0xf
    v_add_f32_dpp v15, v15, v15 row_ror:2 row_mask:0xf bank_mask:0xf
    v_add_f32_dpp v12, v12, v12 row_ror:4 row_mask:0xf bank_mask:0xf
    v_add_f32_dpp v13, v13, v13 row_ror:4 row_mask:0xf bank_mask:0xf
    v_add_f32_dpp v14, v14, v14 row_ror:4 row_mask:0xf bank_mask:0xf
    v_add_f32_dpp v15, v15, v15 row_ror:4 row_mask:0xf bank_mask:0xf
    v_add_f32_dpp v12, v12, v12 row_ror:8 row_mask:0xf bank_mask:0xf
    v_add_f32_dpp v13, v13, v13 row_ror:8 row_mask:0xf bank_mask:0xf
    v_add_f32_dpp v14, v14, v14 row_ror:8 row_mask:0xf bank_mask:0xf
    v_add_f32_dpp v15, v15, v15 row_ror:8 row_mask:0xf bank_mask:0xf
    v_rcp_f32 v12, v12
    v_rcp_f32 v13, v13
    v_rcp_f32 v14, v14
    v_rcp_f32 v15, v15
    s_nop 0
    v_mul_f32 v16, v16, v12
    v_mul_f32 v20, v20, v12
    v_mul_f32 v17, v17, v13
    v_mul_f32 v21, v21, v13
    v_mul_f32 v18, v18, v14
    v_mul_f32 v22, v22, v14
    v_mul_f32 v19, v19, v15
    v_mul_f32 v23, v23, v15
    v_cvt_pk_bf16_f32 v178, v16, v17
    v_cvt_pk_bf16_f32 v179, v18, v19
    v_cvt_pk_bf16_f32 v186, v20, v21
    v_cvt_pk_bf16_f32 v187, v22, v23
    v_cvt_pk_bf16_f32 v194, v132, v133
    v_cvt_pk_bf16_f32 v195, v134, v135
    v_cndmask_b32 v148, v148, 1.0, s[28:29]
    v_cndmask_b32 v149, v149, 1.0, s[28:29]
    v_cndmask_b32 v150, v150, 1.0, s[28:29]
    v_cndmask_b32 v151, v151, 1.0, s[28:29]
    v_cvt_pk_bf16_f32 v202, v148, v149
    v_cvt_pk_bf16_f32 v203, v150, v151
    v_cndmask_b32 v32, v10, v120, s[26:27]
    v_max_f32 v12, v104, v32
    v_cndmask_b32 v33, v10, v121, s[26:27]
    v_max_f32 v13, v105, v33
    v_cndmask_b32 v34, v10, v122, s[26:27]
    v_max_f32 v14, v106, v34
    v_cndmask_b32 v35, v10, v123, s[26:27]
    v_max_f32 v15, v107, v35
    v_max_f32_dpp v12, v12, v12 row_ror:1 row_mask:0xf bank_mask:0xf
    v_max_f32_dpp v13, v13, v13 row_ror:1 row_mask:0xf bank_mask:0xf
    v_max_f32_dpp v14, v14, v14 row_ror:1 row_mask:0xf bank_mask:0xf
    v_max_f32_dpp v15, v15, v15 row_ror:1 row_mask:0xf bank_mask:0xf
    v_max_f32_dpp v12, v12, v12 row_ror:2 row_mask:0xf bank_mask:0xf
    v_max_f32_dpp v13, v13, v13 row_ror:2 row_mask:0xf bank_mask:0xf
    v_max_f32_dpp v14, v14, v14 row_ror:2 row_mask:0xf bank_mask:0xf
    v_max_f32_dpp v15, v15, v15 row_ror:2 row_mask:0xf bank_mask:0xf
    v_max_f32_dpp v12, v12, v12 row_ror:4 row_mask:0xf bank_mask:0xf
    v_max_f32_dpp v13, v13, v13 row_ror:4 row_mask:0xf bank_mask:0xf
    v_max_f32_dpp v14, v14, v14 row_ror:4 row_mask:0xf bank_mask:0xf
    v_max_f32_dpp v15, v15, v15 row_ror:4 row_mask:0xf bank_mask:0xf
    v_max_f32_dpp v12, v12, v12 row_ror:8 row_mask:0xf bank_mask:0xf
    v_max_f32_dpp v13, v13, v13 row_ror:8 row_mask:0xf bank_mask:0xf
    v_max_f32_dpp v14, v14, v14 row_ror:8 row_mask:0xf bank_mask:0xf
    v_max_f32_dpp v15, v15, v15 row_ror:8 row_mask:0xf bank_mask:0xf
    v_mul_f32 v12, s34, v12
    v_mul_f32 v13, s34, v13
    v_mul_f32 v14, s34, v14
    v_mul_f32 v15, s34, v15
    v_fma_f32 v16, v104, s34, -v12
    v_fma_f32 v20, v32, s34, -v12
    v_fma_f32 v17, v105, s34, -v13
    v_fma_f32 v21, v33, s34, -v13
    v_fma_f32 v18, v106, s34, -v14
    v_fma_f32 v22, v34, s34, -v14
    v_fma_f32 v19, v107, s34, -v15
    v_fma_f32 v23, v35, s34, -v15
    v_exp_f32 v16, v16
    v_exp_f32 v17, v17
    v_exp_f32 v18, v18
    v_exp_f32 v19, v19
    v_exp_f32 v20, v20
    v_exp_f32 v21, v21
    v_exp_f32 v22, v22
    v_exp_f32 v23, v23
    s_nop 0
    v_add_f32 v12, v16, v20
    v_add_f32 v13, v17, v21
    v_add_f32 v14, v18, v22
    v_add_f32 v15, v19, v23
    s_nop 0
    v_add_f32_dpp v12, v12, v12 row_ror:1 row_mask:0xf bank_mask:0xf
    v_add_f32_dpp v13, v13, v13 row_ror:1 row_mask:0xf bank_mask:0xf
    v_add_f32_dpp v14, v14, v14 row_ror:1 row_mask:0xf bank_mask:0xf
    v_add_f32_dpp v15, v15, v15 row_ror:1 row_mask:0xf bank_mask:0xf
    v_add_f32_dpp v12, v12, v12 row_ror:2 row_mask:0xf bank_mask:0xf
    v_add_f32_dpp v13, v13, v13 row_ror:2 row_mask:0xf bank_mask:0xf
    v_add_f32_dpp v14, v14, v14 row_ror:2 row_mask:0xf bank_mask:0xf
    v_add_f32_dpp v15, v15, v15 row_ror:2 row_mask:0xf bank_mask:0xf
    v_add_f32_dpp v12, v12, v12 row_ror:4 row_mask:0xf bank_mask:0xf
    v_add_f32_dpp v13, v13, v13 row_ror:4 row_mask:0xf bank_mask:0xf
    v_add_f32_dpp v14, v14, v14 row_ror:4 row_mask:0xf bank_mask:0xf
    v_add_f32_dpp v15, v15, v15 row_ror:4 row_mask:0xf bank_mask:0xf
    v_add_f32_dpp v12, v12, v12 row_ror:8 row_mask:0xf bank_mask:0xf
    v_add_f32_dpp v13, v13, v13 row_ror:8 row_mask:0xf bank_mask:0xf
    v_add_f32_dpp v14, v14, v14 row_ror:8 row_mask:0xf bank_mask:0xf
    v_add_f32_dpp v15, v15, v15 row_ror:8 row_mask:0xf bank_mask:0xf
    v_rcp_f32 v12, v12
    v_rcp_f32 v13, v13
    v_rcp_f32 v14, v14
    v_rcp_f32 v15, v15
    s_nop 0
    v_mul_f32 v16, v16, v12
    v_mul_f32 v20, v20, v12
    v_mul_f32 v17, v17, v13
    v_mul_f32 v21, v21, v13
    v_mul_f32 v18, v18, v14
    v_mul_f32 v22, v22, v14
    v_mul_f32 v19, v19, v15
    v_mul_f32 v23, v23, v15
    v_cvt_pk_bf16_f32 v164, v16, v17
    v_cvt_pk_bf16_f32 v165, v18, v19
    v_cvt_pk_bf16_f32 v172, v20, v21
    v_cvt_pk_bf16_f32 v173, v22, v23
    v_cndmask_b32 v32, v11, v120, s[26:27]
    v_min_f32 v12, v104, v32
    v_cndmask_b32 v33, v11, v121, s[26:27]
    v_min_f32 v13, v105, v33
    v_cndmask_b32 v34, v11, v122, s[26:27]
    v_min_f32 v14, v106, v34
    v_cndmask_b32 v35, v11, v123, s[26:27]
    v_min_f32 v15, v107, v35
    v_min_f32_dpp v12, v12, v12 row_ror:1 row_mask:0xf bank_mask:0xf
    v_min_f32_dpp v13, v13, v13 row_ror:1 row_mask:0xf bank_mask:0xf
    v_min_f32_dpp v14, v14, v14 row_ror:1 row_mask:0xf bank_mask:0xf
    v_min_f32_dpp v15, v15, v15 row_ror:1 row_mask:0xf bank_mask:0xf
    v_min_f32_dpp v12, v12, v12 row_ror:2 row_mask:0xf bank_mask:0xf
    v_min_f32_dpp v13, v13, v13 row_ror:2 row_mask:0xf bank_mask:0xf
    v_min_f32_dpp v14, v14, v14 row_ror:2 row_mask:0xf bank_mask:0xf
    v_min_f32_dpp v15, v15, v15 row_ror:2 row_mask:0xf bank_mask:0xf
    v_min_f32_dpp v12, v12, v12 row_ror:4 row_mask:0xf bank_mask:0xf
    v_min_f32_dpp v13, v13, v13 row_ror:4 row_mask:0xf bank_mask:0xf
    v_min_f32_dpp v14, v14, v14 row_ror:4 row_mask:0xf bank_mask:0xf
    v_min_f32_dpp v15, v15, v15 row_ror:4 row_mask:0xf bank_mask:0xf
    v_min_f32_dpp v12, v12, v12 row_ror:8 row_mask:0xf bank_mask:0xf
    v_min_f32_dpp v13, v13, v13 row_ror:8 row_mask:0xf bank_mask:0xf
    v_min_f32_dpp v14, v14, v14 row_ror:8 row_mask:0xf bank_mask:0xf
    v_min_f32_dpp v15, v15, v15 row_ror:8 row_mask:0xf bank_mask:0xf
    v_mul_f32 v12, s34, v12
    v_mul_f32 v13, s34, v13
    v_mul_f32 v14, s34, v14
    v_mul_f32 v15, s34, v15
    v_fma_f32 v16, -v104, s34, v12
    v_fma_f32 v20, -v32, s34, v12
    v_fma_f32 v17, -v105, s34, v13
    v_fma_f32 v21, -v33, s34, v13
    v_fma_f32 v18, -v106, s34, v14
    v_fma_f32 v22, -v34, s34, v14
    v_fma_f32 v19, -v107, s34, v15
    v_fma_f32 v23, -v35, s34, v15
    v_exp_f32 v16, v16
    v_exp_f32 v17, v17
    v_exp_f32 v18, v18
    v_exp_f32 v19, v19
    v_exp_f32 v20, v20
    v_exp_f32 v21, v21
    v_exp_f32 v22, v22
    v_exp_f32 v23, v23
    s_nop 0
    v_add_f32 v12, v16, v20
    v_add_f32 v13, v17, v21
    v_add_f32 v14, v18, v22
    v_add_f32 v15, v19, v23
    s_nop 0
    v_add_f32_dpp v12, v12, v12 row_ror:1 row_mask:0xf bank_mask:0xf
    v_add_f32_dpp v13, v13, v13 row_ror:1 row_mask:0xf bank_mask:0xf
    v_add_f32_dpp v14, v14, v14 row_ror:1 row_mask:0xf bank_mask:0xf
    v_add_f32_dpp v15, v15, v15 row_ror:1 row_mask:0xf bank_mask:0xf
    v_add_f32_dpp v12, v12, v12 row_ror:2 row_mask:0xf bank_mask:0xf
    v_add_f32_dpp v13, v13, v13 row_ror:2 row_mask:0xf bank_mask:0xf
    v_add_f32_dpp v14, v14, v14 row_ror:2 row_mask:0xf bank_mask:0xf
    v_add_f32_dpp v15, v15, v15 row_ror:2 row_mask:0xf bank_mask:0xf
    v_add_f32_dpp v12, v12, v12 row_ror:4 row_mask:0xf bank_mask:0xf
    v_add_f32_dpp v13, v13, v13 row_ror:4 row_mask:0xf bank_mask:0xf
    v_add_f32_dpp v14, v14, v14 row_ror:4 row_mask:0xf bank_mask:0xf
    v_add_f32_dpp v15, v15, v15 row_ror:4 row_mask:0xf bank_mask:0xf
    v_add_f32_dpp v12, v12, v12 row_ror:8 row_mask:0xf bank_mask:0xf
    v_add_f32_dpp v13, v13, v13 row_ror:8 row_mask:0xf bank_mask:0xf
    v_add_f32_dpp v14, v14, v14 row_ror:8 row_mask:0xf bank_mask:0xf
    v_add_f32_dpp v15, v15, v15 row_ror:8 row_mask:0xf bank_mask:0xf
    v_rcp_f32 v12, v12
    v_rcp_f32 v13, v13
    v_rcp_f32 v14, v14
    v_rcp_f32 v15, v15
    s_nop 0
    v_mul_f32 v16, v16, v12
    v_mul_f32 v20, v20, v12
    v_mul_f32 v17, v17, v13
    v_mul_f32 v21, v21, v13
    v_mul_f32 v18, v18, v14
    v_mul_f32 v22, v22, v14
    v_mul_f32 v19, v19, v15
    v_mul_f32 v23, v23, v15
    v_cvt_pk_bf16_f32 v180, v16, v17
    v_cvt_pk_bf16_f32 v181, v18, v19
    v_cvt_pk_bf16_f32 v188, v20, v21
    v_cvt_pk_bf16_f32 v189, v22, v23
    v_cvt_pk_bf16_f32 v196, v136, v137
    v_cvt_pk_bf16_f32 v197, v138, v139
    v_cndmask_b32 v152, v152, 1.0, s[28:29]
    v_cndmask_b32 v153, v153, 1.0, s[28:29]
    v_cndmask_b32 v154, v154, 1.0, s[28:29]
    v_cndmask_b32 v155, v155, 1.0, s[28:29]
    v_cvt_pk_bf16_f32 v204, v152, v153
    v_cvt_pk_bf16_f32 v205, v154, v155
    v_cndmask_b32 v32, v10, v124, s[26:27]
    v_max_f32 v12, v108, v32
    v_cndmask_b32 v33, v10, v125, s[26:27]
    v_max_f32 v13, v109, v33
    v_cndmask_b32 v34, v10, v126, s[26:27]
    v_max_f32 v14, v110, v34
    v_cndmask_b32 v35, v10, v127, s[26:27]
    v_max_f32 v15, v111, v35
    v_max_f32_dpp v12, v12, v12 row_ror:1 row_mask:0xf bank_mask:0xf
    v_max_f32_dpp v13, v13, v13 row_ror:1 row_mask:0xf bank_mask:0xf
    v_max_f32_dpp v14, v14, v14 row_ror:1 row_mask:0xf bank_mask:0xf
    v_max_f32_dpp v15, v15, v15 row_ror:1 row_mask:0xf bank_mask:0xf
    v_max_f32_dpp v12, v12, v12 row_ror:2 row_mask:0xf bank_mask:0xf
    v_max_f32_dpp v13, v13, v13 row_ror:2 row_mask:0xf bank_mask:0xf
    v_max_f32_dpp v14, v14, v14 row_ror:2 row_mask:0xf bank_mask:0xf
    v_max_f32_dpp v15, v15, v15 row_ror:2 row_mask:0xf bank_mask:0xf
    v_max_f32_dpp v12, v12, v12 row_ror:4 row_mask:0xf bank_mask:0xf
    v_max_f32_dpp v13, v13, v13 row_ror:4 row_mask:0xf bank_mask:0xf
    v_max_f32_dpp v14, v14, v14 row_ror:4 row_mask:0xf bank_mask:0xf
    v_max_f32_dpp v15, v15, v15 row_ror:4 row_mask:0xf bank_mask:0xf
    v_max_f32_dpp v12, v12, v12 row_ror:8 row_mask:0xf bank_mask:0xf
    v_max_f32_dpp v13, v13, v13 row_ror:8 row_mask:0xf bank_mask:0xf
    v_max_f32_dpp v14, v14, v14 row_ror:8 row_mask:0xf bank_mask:0xf
    v_max_f32_dpp v15, v15, v15 row_ror:8 row_mask:0xf bank_mask:0xf
    v_mul_f32 v12, s34, v12
    v_mul_f32 v13, s34, v13
    v_mul_f32 v14, s34, v14
    v_mul_f32 v15, s34, v15
    v_fma_f32 v16, v108, s34, -v12
    v_fma_f32 v20, v32, s34, -v12
    v_fma_f32 v17, v109, s34, -v13
    v_fma_f32 v21, v33, s34, -v13
    v_fma_f32 v18, v110, s34, -v14
    v_fma_f32 v22, v34, s34, -v14
    v_fma_f32 v19, v111, s34, -v15
    v_fma_f32 v23, v35, s34, -v15
    v_exp_f32 v16, v16
    v_exp_f32 v17, v17
    v_exp_f32 v18, v18
    v_exp_f32 v19, v19
    v_exp_f32 v20, v20
    v_exp_f32 v21, v21
    v_exp_f32 v22, v22
    v_exp_f32 v23, v23
    s_nop 0
    v_add_f32 v12, v16, v20
    v_add_f32 v13, v17, v21
    v_add_f32 v14, v18, v22
    v_add_f32 v15, v19, v23
    s_nop 0
    v_add_f32_dpp v12, v12, v12 row_ror:1 row_mask:0xf bank_mask:0xf
    v_add_f32_dpp v13, v13, v13 row_ror:1 row_mask:0xf bank_mask:0xf
    v_add_f32_dpp v14, v14, v14 row_ror:1 row_mask:0xf bank_mask:0xf
    v_add_f32_dpp v15, v15, v15 row_ror:1 row_mask:0xf bank_mask:0xf
    v_add_f32_dpp v12, v12, v12 row_ror:2 row_mask:0xf bank_mask:0xf
    v_add_f32_dpp v13, v13, v13 row_ror:2 row_mask:0xf bank_mask:0xf
    v_add_f32_dpp v14, v14, v14 row_ror:2 row_mask:0xf bank_mask:0xf
    v_add_f32_dpp v15, v15, v15 row_ror:2 row_mask:0xf bank_mask:0xf
    v_add_f32_dpp v12, v12, v12 row_ror:4 row_mask:0xf bank_mask:0xf
    v_add_f32_dpp v13, v13, v13 row_ror:4 row_mask:0xf bank_mask:0xf
    v_add_f32_dpp v14, v14, v14 row_ror:4 row_mask:0xf bank_mask:0xf
    v_add_f32_dpp v15, v15, v15 row_ror:4 row_mask:0xf bank_mask:0xf
    v_add_f32_dpp v12, v12, v12 row_ror:8 row_mask:0xf bank_mask:0xf
    v_add_f32_dpp v13, v13, v13 row_ror:8 row_mask:0xf bank_mask:0xf
    v_add_f32_dpp v14, v14, v14 row_ror:8 row_mask:0xf bank_mask:0xf
    v_add_f32_dpp v15, v15, v15 row_ror:8 row_mask:0xf bank_mask:0xf
    v_rcp_f32 v12, v12
    v_rcp_f32 v13, v13
    v_rcp_f32 v14, v14
    v_rcp_f32 v15, v15
    s_nop 0
    v_mul_f32 v16, v16, v12
    v_mul_f32 v20, v20, v12
    v_mul_f32 v17, v17, v13
    v_mul_f32 v21, v21, v13
    v_mul_f32 v18, v18, v14
    v_mul_f32 v22, v22, v14
    v_mul_f32 v19, v19, v15
    v_mul_f32 v23, v23, v15
    v_cvt_pk_bf16_f32 v166, v16, v17
    v_cvt_pk_bf16_f32 v167, v18, v19
    v_cvt_pk_bf16_f32 v174, v20, v21
    v_cvt_pk_bf16_f32 v175, v22, v23
    v_cndmask_b32 v32, v11, v124, s[26:27]
    v_min_f32 v12, v108, v32
    v_cndmask_b32 v33, v11, v125, s[26:27]
    v_min_f32 v13, v109, v33
    v_cndmask_b32 v34, v11, v126, s[26:27]
    v_min_f32 v14, v110, v34
    v_cndmask_b32 v35, v11, v127, s[26:27]
    v_min_f32 v15, v111, v35
    v_min_f32_dpp v12, v12, v12 row_ror:1 row_mask:0xf bank_mask:0xf
    v_min_f32_dpp v13, v13, v13 row_ror:1 row_mask:0xf bank_mask:0xf
    v_min_f32_dpp v14, v14, v14 row_ror:1 row_mask:0xf bank_mask:0xf
    v_min_f32_dpp v15, v15, v15 row_ror:1 row_mask:0xf bank_mask:0xf
    v_min_f32_dpp v12, v12, v12 row_ror:2 row_mask:0xf bank_mask:0xf
    v_min_f32_dpp v13, v13, v13 row_ror:2 row_mask:0xf bank_mask:0xf
    v_min_f32_dpp v14, v14, v14 row_ror:2 row_mask:0xf bank_mask:0xf
    v_min_f32_dpp v15, v15, v15 row_ror:2 row_mask:0xf bank_mask:0xf
    v_min_f32_dpp v12, v12, v12 row_ror:4 row_mask:0xf bank_mask:0xf
    v_min_f32_dpp v13, v13, v13 row_ror:4 row_mask:0xf bank_mask:0xf
    v_min_f32_dpp v14, v14, v14 row_ror:4 row_mask:0xf bank_mask:0xf
    v_min_f32_dpp v15, v15, v15 row_ror:4 row_mask:0xf bank_mask:0xf
    v_min_f32_dpp v12, v12, v12 row_ror:8 row_mask:0xf bank_mask:0xf
    v_min_f32_dpp v13, v13, v13 row_ror:8 row_mask:0xf bank_mask:0xf
    v_min_f32_dpp v14, v14, v14 row_ror:8 row_mask:0xf bank_mask:0xf
    v_min_f32_dpp v15, v15, v15 row_ror:8 row_mask:0xf bank_mask:0xf
    v_mul_f32 v12, s34, v12
    v_mul_f32 v13, s34, v13
    v_mul_f32 v14, s34, v14
    v_mul_f32 v15, s34, v15
    v_fma_f32 v16, -v108, s34, v12
    v_fma_f32 v20, -v32, s34, v12
    v_fma_f32 v17, -v109, s34, v13
    v_fma_f32 v21, -v33, s34, v13
    v_fma_f32 v18, -v110, s34, v14
    v_fma_f32 v22, -v34, s34, v14
    v_fma_f32 v19, -v111, s34, v15
    v_fma_f32 v23, -v35, s34, v15
    v_exp_f32 v16, v16
    v_exp_f32 v17, v17
    v_exp_f32 v18, v18
    v_exp_f32 v19, v19
    v_exp_f32 v20, v20
    v_exp_f32 v21, v21
    v_exp_f32 v22, v22
    v_exp_f32 v23, v23
    s_nop 0
    v_add_f32 v12, v16, v20
    v_add_f32 v13, v17, v21
    v_add_f32 v14, v18, v22
    v_add_f32 v15, v19, v23
    s_nop 0
    v_add_f32_dpp v12, v12, v12 row_ror:1 row_mask:0xf bank_mask:0xf
    v_add_f32_dpp v13, v13, v13 row_ror:1 row_mask:0xf bank_mask:0xf
    v_add_f32_dpp v14, v14, v14 row_ror:1 row_mask:0xf bank_mask:0xf
    v_add_f32_dpp v15, v15, v15 row_ror:1 row_mask:0xf bank_mask:0xf
    v_add_f32_dpp v12, v12, v12 row_ror:2 row_mask:0xf bank_mask:0xf
    v_add_f32_dpp v13, v13, v13 row_ror:2 row_mask:0xf bank_mask:0xf
    v_add_f32_dpp v14, v14, v14 row_ror:2 row_mask:0xf bank_mask:0xf
    v_add_f32_dpp v15, v15, v15 row_ror:2 row_mask:0xf bank_mask:0xf
    v_add_f32_dpp v12, v12, v12 row_ror:4 row_mask:0xf bank_mask:0xf
    v_add_f32_dpp v13, v13, v13 row_ror:4 row_mask:0xf bank_mask:0xf
    v_add_f32_dpp v14, v14, v14 row_ror:4 row_mask:0xf bank_mask:0xf
    v_add_f32_dpp v15, v15, v15 row_ror:4 row_mask:0xf bank_mask:0xf
    v_add_f32_dpp v12, v12, v12 row_ror:8 row_mask:0xf bank_mask:0xf
    v_add_f32_dpp v13, v13, v13 row_ror:8 row_mask:0xf bank_mask:0xf
    v_add_f32_dpp v14, v14, v14 row_ror:8 row_mask:0xf bank_mask:0xf
    v_add_f32_dpp v15, v15, v15 row_ror:8 row_mask:0xf bank_mask:0xf
    v_rcp_f32 v12, v12
    v_rcp_f32 v13, v13
    v_rcp_f32 v14, v14
    v_rcp_f32 v15, v15
    s_nop 0
    v_mul_f32 v16, v16, v12
    v_mul_f32 v20, v20, v12
    v_mul_f32 v17, v17, v13
    v_mul_f32 v21, v21, v13
    v_mul_f32 v18, v18, v14
    v_mul_f32 v22, v22, v14
    v_mul_f32 v19, v19, v15
    v_mul_f32 v23, v23, v15
    v_cvt_pk_bf16_f32 v182, v16, v17
    v_cvt_pk_bf16_f32 v183, v18, v19
    v_cvt_pk_bf16_f32 v190, v20, v21
    v_cvt_pk_bf16_f32 v191, v22, v23
    v_cvt_pk_bf16_f32 v198, v140, v141
    v_cvt_pk_bf16_f32 v199, v142, v143
    v_cndmask_b32 v156, v156, 1.0, s[28:29]
    v_cndmask_b32 v157, v157, 1.0, s[28:29]
    v_cndmask_b32 v158, v158, 1.0, s[28:29]
    v_cndmask_b32 v159, v159, 1.0, s[28:29]
    v_cvt_pk_bf16_f32 v206, v156, v157
    v_cvt_pk_bf16_f32 v207, v158, v159
    s_nop 1
    v_mfma_f32_16x16x32_bf16 v[64:67], v[192:195], v[160:163], 0
    v_mfma_f32_16x16x32_bf16 v[64:67], v[196:199], v[164:167], v[64:67]
    v_mfma_f32_16x16x32_bf16 v[68:71], v[200:203], v[160:163], 0
    v_mfma_f32_16x16x32_bf16 v[68:71], v[204:207], v[164:167], v[68:71]
    v_mfma_f32_16x16x32_bf16 v[72:75], v[192:195], v[168:171], 0
    v_mfma_f32_16x16x32_bf16 v[72:75], v[196:199], v[172:175], v[72:75]
    v_mfma_f32_16x16x32_bf16 v[76:79], v[200:203], v[168:171], 0
    v_mfma_f32_16x16x32_bf16 v[76:79], v[204:207], v[172:175], v[76:79]
    v_mfma_f32_16x16x32_bf16 v[80:83], v[192:195], v[176:179], 0
    v_mfma_f32_16x16x32_bf16 v[80:83], v[196:199], v[180:183], v[80:83]
    v_mfma_f32_16x16x32_bf16 v[84:87], v[200:203], v[176:179], 0
    v_mfma_f32_16x16x32_bf16 v[84:87], v[204:207], v[180:183], v[84:87]
    v_mfma_f32_16x16x32_bf16 v[88:91], v[192:195], v[184:187], 0
    v_mfma_f32_16x16x32_bf16 v[88:91], v[196:199], v[188:191], v[88:91]
    v_mfma_f32_16x16x32_bf16 v[92:95], v[200:203], v[184:187], 0
    v_mfma_f32_16x16x32_bf16 v[92:95], v[204:207], v[188:191], v[92:95]
    s_lshl_b32 s11, s10, 13
    s_add_u32 s11, s11, 87359488
    v_lshlrev_b32 v4, 10, v3
    v_lshl_add_u32 v4, v2, 2, v4
    v_add_u32 v4, s11, v4
    v_add_u32 v5, 4096, v4
    s_nop 4

    global_atomic_add_f32 v4, v64, s[6:7] offset:0
    global_atomic_add_f32 v4, v65, s[6:7] offset:256
    global_atomic_add_f32 v4, v66, s[6:7] offset:512
    global_atomic_add_f32 v4, v67, s[6:7] offset:768
    global_atomic_add_f32 v5, v68, s[6:7] offset:0
    global_atomic_add_f32 v5, v69, s[6:7] offset:256
    global_atomic_add_f32 v5, v70, s[6:7] offset:512
    global_atomic_add_f32 v5, v71, s[6:7] offset:768
    global_atomic_add_f32 v4, v72, s[6:7] offset:64
    global_atomic_add_f32 v4, v73, s[6:7] offset:320
    global_atomic_add_f32 v4, v74, s[6:7] offset:576
    global_atomic_add_f32 v4, v75, s[6:7] offset:832
    global_atomic_add_f32 v5, v76, s[6:7] offset:64
    global_atomic_add_f32 v5, v77, s[6:7] offset:320
    global_atomic_add_f32 v5, v78, s[6:7] offset:576
    global_atomic_add_f32 v5, v79, s[6:7] offset:832
    global_atomic_add_f32 v4, v80, s[6:7] offset:128
    global_atomic_add_f32 v4, v81, s[6:7] offset:384
    global_atomic_add_f32 v4, v82, s[6:7] offset:640
    global_atomic_add_f32 v4, v83, s[6:7] offset:896
    global_atomic_add_f32 v5, v84, s[6:7] offset:128
    global_atomic_add_f32 v5, v85, s[6:7] offset:384
    global_atomic_add_f32 v5, v86, s[6:7] offset:640
    global_atomic_add_f32 v5, v87, s[6:7] offset:896
    global_atomic_add_f32 v4, v88, s[6:7] offset:192
    global_atomic_add_f32 v4, v89, s[6:7] offset:448
    global_atomic_add_f32 v4, v90, s[6:7] offset:704
    global_atomic_add_f32 v4, v91, s[6:7] offset:960
    global_atomic_add_f32 v5, v92, s[6:7] offset:192
    global_atomic_add_f32 v5, v93, s[6:7] offset:448
    global_atomic_add_f32 v5, v94, s[6:7] offset:704
    global_atomic_add_f32 v5, v95, s[6:7] offset:960
    s_branch L_task_done
L_t_b2:
    s_cmp_ge_u32 s41, 819
    s_cbranch_scc1 L_t_seg
    s_sub_u32 s40, s41, 691
    s_mov_b32 s70, 0
    s_mov_b32 s4, s68
    s_mov_b32 s5, s69
    s_mov_b32 s42, 1152

    v_mov_b32 v250, s42
    s_mov_b32 s71, 0
L_wc_b2:
    global_load_dword v251, v250, s[6:7] sc1
    s_add_u32 s71, s71, 1
    s_cmp_ge_u32 s71, 4194304
    s_cbranch_scc1 L_main_done
    s_waitcnt vmcnt(0)
    v_cmp_gt_u32 vcc, 128, v251
    s_cbranch_vccz L_wcd_b2
    s_sleep 4
    s_branch L_wc_b2

L_wcd_b2:
    buffer_inv sc1
    v_and_b32 v2, 15, v1
    v_lshrrev_b32 v3, 4, v1
    v_lshlrev_b32 v4, 8, v2
    v_lshl_add_u32 v4, v3, 4, v4
    v_add_u32 v4, 87359488, v4
    v_add_u32 v5, 4096, v4
    v_lshlrev_b32 v6, 4, v1
    s_lshl_b32 s11, s40, 15
    s_add_u32 s11, s11, 87490560
    s_add_u32 s12, s6, s11
    s_addc_u32 s13, s7, 0
    v_add_u32 v7, 48, v2
    v_lshlrev_b32 v7, 2, v7
    v_cmp_gt_u32 s[24:25], 3, v3
    s_mov_b32 s26, 0x358637bd

    global_load_dwordx4 a[0:3], v4, s[6:7] offset:0
    global_load_dwordx4 a[4:7], v4, s[6:7] offset:64
    global_load_dwordx4 a[8:11], v4, s[6:7] offset:128
    global_load_dwordx4 a[12:15], v4, s[6:7] offset:192
    global_load_dwordx4 a[16:19], v5, s[6:7] offset:0
    global_load_dwordx4 a[20:23], v5, s[6:7] offset:64
    global_load_dwordx4 a[24:27], v5, s[6:7] offset:128
    global_load_dwordx4 a[28:31], v5, s[6:7] offset:192
    global_load_dwordx4 a[32:35], v6, s[12:13] offset:0
    global_load_dwordx4 a[36:39], v6, s[12:13] offset:1024
    v_add_u32 v4, 8192, v4
    v_add_u32 v5, 8192, v5
    s_add_u32 s12, s12, 2048
    s_addc_u32 s13, s13, 0
    global_load_dwordx4 a[40:43], v4, s[6:7] offset:0
    global_load_dwordx4 a[44:47], v4, s[6:7] offset:64
    global_load_dwordx4 a[48:51], v4, s[6:7] offset:128
    global_load_dwordx4 a[52:55], v4, s[6:7] offset:192
    global_load_dwordx4 a[56:59], v5, s[6:7] offset:0
    global_load_dwordx4 a[60:63], v5, s[6:7] offset:64
    global_load_dwordx4 a[64:67], v5, s[6:7] offset:128
    global_load_dwordx4 a[68:71], v5, s[6:7] offset:192
    global_load_dwordx4 a[72:75], v6, s[12:13] offset:0
    global_load_dwordx4 a[76:79], v6, s[12:13] offset:1024
    v_add_u32 v4, 8192, v4
    v_add_u32 v5, 8192, v5
    s_add_u32 s12, s12, 2048
    s_addc_u32 s13, s13, 0
    global_load_dwordx4 a[80:83], v4, s[6:7] offset:0
    global_load_dwordx4 a[84:87], v4, s[6:7] offset:64
    global_load_dwordx4 a[88:91], v4, s[6:7] offset:128
    global_load_dwordx4 a[92:95], v4, s[6:7] offset:192
    global_load_dwordx4 a[96:99], v5, s[6:7] offset:0
    global_load_dwordx4 a[100:103], v5, s[6:7] offset:64
    global_load_dwordx4 a[104:107], v5, s[6:7] offset:128
    global_load_dwordx4 a[108:111], v5, s[6:7] offset:192
    global_load_dwordx4 a[112:115], v6, s[12:13] offset:0
    global_load_dwordx4 a[116:119], v6, s[12:13] offset:1024
    v_add_u32 v4, 8192, v4
    v_add_u32 v5, 8192, v5
    s_add_u32 s12, s12, 2048
    s_addc_u32 s13, s13, 0
    global_load_dwordx4 a[120:123], v4, s[6:7] offset:0
    global_load_dwordx4 a[124:127], v4, s[6:7] offset:64
    global_load_dwordx4 a[128:131], v4, s[6:7] offset:128
    global_load_dwordx4 a[132:135], v4, s[6:7] offset:192
    global_load_dwordx4 a[136:139], v5, s[6:7] offset:0
    global_load_dwordx4 a[140:143], v5, s[6:7] offset:64
    global_load_dwordx4 a[144:147], v5, s[6:7] offset:128
    global_load_dwordx4 a[148:151], v5, s[6:7] offset:192
    global_load_dwordx4 a[152:155], v6, s[12:13] offset:0
    global_load_dwordx4 a[156:159], v6, s[12:13] offset:1024
    v_add_u32 v4, 8192, v4
    v_add_u32 v5, 8192, v5
    s_add_u32 s12, s12, 2048
    s_addc_u32 s13, s13, 0
    s_waitcnt vmcnt(30)
    v_accvgpr_read_b32 v16, a0
    v_accvgpr_read_b32 v17, a1
    v_accvgpr_read_b32 v18, a2
    v_accvgpr_read_b32 v19, a3
    v_accvgpr_read_b32 v20, a4
    v_accvgpr_read_b32 v21, a5
    v_accvgpr_read_b32 v22, a6
    v_accvgpr_read_b32 v23, a7
    v_accvgpr_read_b32 v24, a8
    v_accvgpr_read_b32 v25, a9
    v_accvgpr_read_b32 v26, a10
    v_accvgpr_read_b32 v27, a11
    v_accvgpr_read_b32 v28, a12
    v_accvgpr_read_b32 v29, a13
    v_accvgpr_read_b32 v30, a14
    v_accvgpr_read_b32 v31, a15
    v_accvgpr_read_b32 v32, a16
    v_accvgpr_read_b32 v33, a17
    v_accvgpr_read_b32 v34, a18
    v_accvgpr_read_b32 v35, a19
    v_accvgpr_read_b32 v36, a20
    v_accvgpr_read_b32 v37, a21
    v_accvgpr_read_b32 v38, a22
    v_accvgpr_read_b32 v39, a23
    v_accvgpr_read_b32 v40, a24
    v_accvgpr_read_b32 v41, a25
    v_accvgpr_read_b32 v42, a26
    v_accvgpr_read_b32 v43, a27
    v_accvgpr_read_b32 v44, a28
    v_accvgpr_read_b32 v45, a29
    v_accvgpr_read_b32 v46, a30
    v_accvgpr_read_b32 v47, a31
    v_cvt_pk_bf16_f32 v56, v16, v17
    v_cvt_pk_bf16_f32 v57, v18, v19
    v_cvt_pk_bf16_f32 v58, v20, v21
    v_cvt_pk_bf16_f32 v59, v22, v23
    v_cvt_pk_bf16_f32 v60, v24, v25
    v_cvt_pk_bf16_f32 v61, v26, v27
    v_cvt_pk_bf16_f32 v62, v28, v29
    v_cvt_pk_bf16_f32 v63, v30, v31
    v_cvt_pk_bf16_f32 v64, v32, v33
    v_cvt_pk_bf16_f32 v65, v34, v35
    v_cvt_pk_bf16_f32 v66, v36, v37
    v_cvt_pk_bf16_f32 v67, v38, v39
    v_cvt_pk_bf16_f32 v68, v40, v41
    v_cvt_pk_bf16_f32 v69, v42, v43
    v_cvt_pk_bf16_f32 v70, v44, v45
    v_cvt_pk_bf16_f32 v71, v46, v47
    s_nop 1
    v_mfma_f32_16x16x32_bf16 v[72:75], v[56:59], a[32:35], 0
    v_mfma_f32_16x16x32_bf16 v[72:75], v[60:63], a[36:39], v[72:75]
    v_mfma_f32_16x16x32_bf16 v[76:79], v[64:67], a[32:35], 0
    v_mfma_f32_16x16x32_bf16 v[76:79], v[68:71], a[36:39], v[76:79]
    s_nop 7
    ds_bpermute_b32 v80, v7, v76
    s_waitcnt lgkmcnt(0)
    v_add_f32 v80, s26, v80
    v_rcp_f32 v80, v80
    s_nop 0
    v_mul_f32 v72, v72, v80
    v_mul_f32 v73, v73, v80
    v_mul_f32 v74, v74, v80
    v_mul_f32 v75, v75, v80
    v_mul_f32 v76, v76, v80
    v_mul_f32 v77, v77, v80
    v_mul_f32 v78, v78, v80
    v_mul_f32 v79, v79, v80
    v_cndmask_b32 v76, 0, v76, s[24:25]
    v_cndmask_b32 v77, 0, v77, s[24:25]
    v_cndmask_b32 v78, 0, v78, s[24:25]
    v_cndmask_b32 v79, 0, v79, s[24:25]
    v_cvt_pk_bf16_f32 v96, v72, v73
    v_cvt_pk_bf16_f32 v97, v74, v75
    v_cvt_pk_bf16_f32 v98, v76, v77
    v_cvt_pk_bf16_f32 v99, v78, v79
    global_load_dwordx4 a[0:3], v4, s[6:7] offset:0
    global_load_dwordx4 a[4:7], v4, s[6:7] offset:64
    global_load_dwordx4 a[8:11], v4, s[6:7] offset:128
    global_load_dwordx4 a[12:15], v4, s[6:7] offset:192
    global_load_dwordx4 a[16:19], v5, s[6:7] offset:0
    global_load_dwordx4 a[20:23], v5, s[6:7] offset:64
    global_load_dwordx4 a[24:27], v5, s[6:7] offset:128
    global_load_dwordx4 a[28:31], v5, s[6:7] offset:192
    global_load_dwordx4 a[32:35], v6, s[12:13] offset:0
    global_load_dwordx4 a[36:39], v6, s[12:13] offset:1024
    v_add_u32 v4, 8192, v4
    v_add_u32 v5, 8192, v5
    s_add_u32 s12, s12, 2048
    s_addc_u32 s13, s13, 0
    s_waitcnt vmcnt(30)
    v_accvgpr_read_b32 v16, a40
    v_accvgpr_read_b32 v17, a41
    v_accvgpr_read_b32 v18, a42
    v_accvgpr_read_b32 v19, a43
    v_accvgpr_read_b32 v20, a44
    v_accvgpr_read_b32 v21, a45
    v_accvgpr_read_b32 v22, a46
    v_accvgpr_read_b32 v23, a47
    v_accvgpr_read_b32 v24, a48
    v_accvgpr_read_b32 v25, a49
    v_accvgpr_read_b32 v26, a50
    v_accvgpr_read_b32 v27, a51
    v_accvgpr_read_b32 v28, a52
    v_accvgpr_read_b32 v29, a53
    v_accvgpr_read_b32 v30, a54
    v_accvgpr_read_b32 v31, a55
    v_accvgpr_read_b32 v32, a56
    v_accvgpr_read_b32 v33, a57
    v_accvgpr_read_b32 v34, a58
    v_accvgpr_read_b32 v35, a59
    v_accvgpr_read_b32 v36, a60
    v_accvgpr_read_b32 v37, a61
    v_accvgpr_read_b32 v38, a62
    v_accvgpr_read_b32 v39, a63
    v_accvgpr_read_b32 v40, a64
    v_accvgpr_read_b32 v41, a65
    v_accvgpr_read_b32 v42, a66
    v_accvgpr_read_b32 v43, a67
    v_accvgpr_read_b32 v44, a68
    v_accvgpr_read_b32 v45, a69
    v_accvgpr_read_b32 v46, a70
    v_accvgpr_read_b32 v47, a71
    v_cvt_pk_bf16_f32 v56, v16, v17
    v_cvt_pk_bf16_f32 v57, v18, v19
    v_cvt_pk_bf16_f32 v58, v20, v21
    v_cvt_pk_bf16_f32 v59, v22, v23
    v_cvt_pk_bf16_f32 v60, v24, v25
    v_cvt_pk_bf16_f32 v61, v26, v27
    v_cvt_pk_bf16_f32 v62, v28, v29
    v_cvt_pk_bf16_f32 v63, v30, v31
    v_cvt_pk_bf16_f32 v64, v32, v33
    v_cvt_pk_bf16_f32 v65, v34, v35
    v_cvt_pk_bf16_f32 v66, v36, v37
    v_cvt_pk_bf16_f32 v67, v38, v39
    v_cvt_pk_bf16_f32 v68, v40, v41
    v_cvt_pk_bf16_f32 v69, v42, v43
    v_cvt_pk_bf16_f32 v70, v44, v45
    v_cvt_pk_bf16_f32 v71, v46, v47
    s_nop 1
    v_mfma_f32_16x16x32_bf16 v[72:75], v[56:59], a[72:75], 0
    v_mfma_f32_16x16x32_bf16 v[72:75], v[60:63], a[76:79], v[72:75]
    v_mfma_f32_16x16x32_bf16 v[76:79], v[64:67], a[72:75], 0
    v_mfma_f32_16x16x32_bf16 v[76:79], v[68:71], a[76:79], v[76:79]
    s_nop 7
    ds_bpermute_b32 v80, v7, v76
    s_waitcnt lgkmcnt(0)
    v_add_f32 v80, s26, v80
    v_rcp_f32 v80, v80
    s_nop 0
    v_mul_f32 v72, v72, v80
    v_mul_f32 v73, v73, v80
    v_mul_f32 v74, v74, v80
    v_mul_f32 v75, v75, v80
    v_mul_f32 v76, v76, v80
    v_mul_f32 v77, v77, v80
    v_mul_f32 v78, v78, v80
    v_mul_f32 v79, v79, v80
    v_cndmask_b32 v76, 0, v76, s[24:25]
    v_cndmask_b32 v77, 0, v77, s[24:25]
    v_cndmask_b32 v78, 0, v78, s[24:25]
    v_cndmask_b32 v79, 0, v79, s[24:25]
    v_cvt_pk_bf16_f32 v100, v72, v73
    v_cvt_pk_bf16_f32 v101, v74, v75
    v_cvt_pk_bf16_f32 v102, v76, v77
    v_cvt_pk_bf16_f32 v103, v78, v79
    global_load_dwordx4 a[40:43], v4, s[6:7] offset:0
    global_load_dwordx4 a[44:47], v4, s[6:7] offset:64
    global_load_dwordx4 a[48:51], v4, s[6:7] offset:128
    global_load_dwordx4 a[52:55], v4, s[6:7] offset:192
    global_load_dwordx4 a[56:59], v5, s[6:7] offset:0
    global_load_dwordx4 a[60:63], v5, s[6:7] offset:64
    global_load_dwordx4 a[64:67], v5, s[6:7] offset:128
    global_load_dwordx4 a[68:71], v5, s[6:7] offset:192
    global_load_dwordx4 a[72:75], v6, s[12:13] offset:0
    global_load_dwordx4 a[76:79], v6, s[12:13] offset:1024
    v_add_u32 v4, 8192, v4
    v_add_u32 v5, 8192, v5
    s_add_u32 s12, s12, 2048
    s_addc_u32 s13, s13, 0
    s_waitcnt vmcnt(30)
    v_accvgpr_read_b32 v16, a80
    v_accvgpr_read_b32 v17, a81
    v_accvgpr_read_b32 v18, a82
    v_accvgpr_read_b32 v19, a83
    v_accvgpr_read_b32 v20, a84
    v_accvgpr_read_b32 v21, a85
    v_accvgpr_read_b32 v22, a86
    v_accvgpr_read_b32 v23, a87
    v_accvgpr_read_b32 v24, a88
    v_accvgpr_read_b32 v25, a89
    v_accvgpr_read_b32 v26, a90
    v_accvgpr_read_b32 v27, a91
    v_accvgpr_read_b32 v28, a92
    v_accvgpr_read_b32 v29, a93
    v_accvgpr_read_b32 v30, a94
    v_accvgpr_read_b32 v31, a95
    v_accvgpr_read_b32 v32, a96
    v_accvgpr_read_b32 v33, a97
    v_accvgpr_read_b32 v34, a98
    v_accvgpr_read_b32 v35, a99
    v_accvgpr_read_b32 v36, a100
    v_accvgpr_read_b32 v37, a101
    v_accvgpr_read_b32 v38, a102
    v_accvgpr_read_b32 v39, a103
    v_accvgpr_read_b32 v40, a104
    v_accvgpr_read_b32 v41, a105
    v_accvgpr_read_b32 v42, a106
    v_accvgpr_read_b32 v43, a107
    v_accvgpr_read_b32 v44, a108
    v_accvgpr_read_b32 v45, a109
    v_accvgpr_read_b32 v46, a110
    v_accvgpr_read_b32 v47, a111
    v_cvt_pk_bf16_f32 v56, v16, v17
    v_cvt_pk_bf16_f32 v57, v18, v19
    v_cvt_pk_bf16_f32 v58, v20, v21
    v_cvt_pk_bf16_f32 v59, v22, v23
    v_cvt_pk_bf16_f32 v60, v24, v25
    v_cvt_pk_bf16_f32 v61, v26, v27
    v_cvt_pk_bf16_f32 v62, v28, v29
    v_cvt_pk_bf16_f32 v63, v30, v31
    v_cvt_pk_bf16_f32 v64, v32, v33
    v_cvt_pk_bf16_f32 v65, v34, v35
    v_cvt_pk_bf16_f32 v66, v36, v37
    v_cvt_pk_bf16_f32 v67, v38, v39
    v_cvt_pk_bf16_f32 v68, v40, v41
    v_cvt_pk_bf16_f32 v69, v42, v43
    v_cvt_pk_bf16_f32 v70, v44, v45
    v_cvt_pk_bf16_f32 v71, v46, v47
    s_nop 1
    v_mfma_f32_16x16x32_bf16 v[72:75], v[56:59], a[112:115], 0
    v_mfma_f32_16x16x32_bf16 v[72:75], v[60:63], a[116:119], v[72:75]
    v_mfma_f32_16x16x32_bf16 v[76:79], v[64:67], a[112:115], 0
    v_mfma_f32_16x16x32_bf16 v[76:79], v[68:71], a[116:119], v[76:79]
    s_nop 7
    ds_bpermute_b32 v80, v7, v76
    s_waitcnt lgkmcnt(0)
    v_add_f32 v80, s26, v80
    v_rcp_f32 v80, v80
    s_nop 0
    v_mul_f32 v72, v72, v80
    v_mul_f32 v73, v73, v80
    v_mul_f32 v74, v74, v80
    v_mul_f32 v75, v75, v80
    v_mul_f32 v76, v76, v80
    v_mul_f32 v77, v77, v80
    v_mul_f32 v78, v78, v80
    v_mul_f32 v79, v79, v80
    v_cndmask_b32 v76, 0, v76, s[24:25]
    v_cndmask_b32 v77, 0, v77, s[24:25]
    v_cndmask_b32 v78, 0, v78, s[24:25]
    v_cndmask_b32 v79, 0, v79, s[24:25]
    v_cvt_pk_bf16_f32 v104, v72, v73
    v_cvt_pk_bf16_f32 v105, v74, v75
    v_cvt_pk_bf16_f32 v106, v76, v77
    v_cvt_pk_bf16_f32 v107, v78, v79
    global_load_dwordx4 a[80:83], v4, s[6:7] offset:0
    global_load_dwordx4 a[84:87], v4, s[6:7] offset:64
    global_load_dwordx4 a[88:91], v4, s[6:7] offset:128
    global_load_dwordx4 a[92:95], v4, s[6:7] offset:192
    global_load_dwordx4 a[96:99], v5, s[6:7] offset:0
    global_load_dwordx4 a[100:103], v5, s[6:7] offset:64
    global_load_dwordx4 a[104:107], v5, s[6:7] offset:128
    global_load_dwordx4 a[108:111], v5, s[6:7] offset:192
    global_load_dwordx4 a[112:115], v6, s[12:13] offset:0
    global_load_dwordx4 a[116:119], v6, s[12:13] offset:1024
    v_add_u32 v4, 8192, v4
    v_add_u32 v5, 8192, v5
    s_add_u32 s12, s12, 2048
    s_addc_u32 s13, s13, 0
    s_waitcnt vmcnt(30)
    v_accvgpr_read_b32 v16, a120
    v_accvgpr_read_b32 v17, a121
    v_accvgpr_read_b32 v18, a122
    v_accvgpr_read_b32 v19, a123
    v_accvgpr_read_b32 v20, a124
    v_accvgpr_read_b32 v21, a125
    v_accvgpr_read_b32 v22, a126
    v_accvgpr_read_b32 v23, a127
    v_accvgpr_read_b32 v24, a128
    v_accvgpr_read_b32 v25, a129
    v_accvgpr_read_b32 v26, a130
    v_accvgpr_read_b32 v27, a131
    v_accvgpr_read_b32 v28, a132
    v_accvgpr_read_b32 v29, a133
    v_accvgpr_read_b32 v30, a134
    v_accvgpr_read_b32 v31, a135
    v_accvgpr_read_b32 v32, a136
    v_accvgpr_read_b32 v33, a137
    v_accvgpr_read_b32 v34, a138
    v_accvgpr_read_b32 v35, a139
    v_accvgpr_read_b32 v36, a140
    v_accvgpr_read_b32 v37, a141
    v_accvgpr_read_b32 v38, a142
    v_accvgpr_read_b32 v39, a143
    v_accvgpr_read_b32 v40, a144
    v_accvgpr_read_b32 v41, a145
    v_accvgpr_read_b32 v42, a146
    v_accvgpr_read_b32 v43, a147
    v_accvgpr_read_b32 v44, a148
    v_accvgpr_read_b32 v45, a149
    v_accvgpr_read_b32 v46, a150
    v_accvgpr_read_b32 v47, a151
    v_cvt_pk_bf16_f32 v56, v16, v17
    v_cvt_pk_bf16_f32 v57, v18, v19
    v_cvt_pk_bf16_f32 v58, v20, v21
    v_cvt_pk_bf16_f32 v59, v22, v23
    v_cvt_pk_bf16_f32 v60, v24, v25
    v_cvt_pk_bf16_f32 v61, v26, v27
    v_cvt_pk_bf16_f32 v62, v28, v29
    v_cvt_pk_bf16_f32 v63, v30, v31
    v_cvt_pk_bf16_f32 v64, v32, v33
    v_cvt_pk_bf16_f32 v65, v34, v35
    v_cvt_pk_bf16_f32 v66, v36, v37
    v_cvt_pk_bf16_f32 v67, v38, v39
    v_cvt_pk_bf16_f32 v68, v40, v41
    v_cvt_pk_bf16_f32 v69, v42, v43
    v_cvt_pk_bf16_f32 v70, v44, v45
    v_cvt_pk_bf16_f32 v71, v46, v47
    s_nop 1
    v_mfma_f32_16x16x32_bf16 v[72:75], v[56:59], a[152:155], 0
    v_mfma_f32_16x16x32_bf16 v[72:75], v[60:63], a[156:159], v[72:75]
    v_mfma_f32_16x16x32_bf16 v[76:79], v[64:67], a[152:155], 0
    v_mfma_f32_16x16x32_bf16 v[76:79], v[68:71], a[156:159], v[76:79]
    s_nop 7
    ds_bpermute_b32 v80, v7, v76
    s_waitcnt lgkmcnt(0)
    v_add_f32 v80, s26, v80
    v_rcp_f32 v80, v80
    s_nop 0
    v_mul_f32 v72, v72, v80
    v_mul_f32 v73, v73, v80
    v_mul_f32 v74, v74, v80
    v_mul_f32 v75, v75, v80
    v_mul_f32 v76, v76, v80
    v_mul_f32 v77, v77, v80
    v_mul_f32 v78, v78, v80
    v_mul_f32 v79, v79, v80
    v_cndmask_b32 v76, 0, v76, s[24:25]
    v_cndmask_b32 v77, 0, v77, s[24:25]
    v_cndmask_b32 v78, 0, v78, s[24:25]
    v_cndmask_b32 v79, 0, v79, s[24:25]
    v_cvt_pk_bf16_f32 v108, v72, v73
    v_cvt_pk_bf16_f32 v109, v74, v75
    v_cvt_pk_bf16_f32 v110, v76, v77
    v_cvt_pk_bf16_f32 v111, v78, v79
    global_load_dwordx4 a[120:123], v4, s[6:7] offset:0
    global_load_dwordx4 a[124:127], v4, s[6:7] offset:64
    global_load_dwordx4 a[128:131], v4, s[6:7] offset:128
    global_load_dwordx4 a[132:135], v4, s[6:7] offset:192
    global_load_dwordx4 a[136:139], v5, s[6:7] offset:0
    global_load_dwordx4 a[140:143], v5, s[6:7] offset:64
    global_load_dwordx4 a[144:147], v5, s[6:7] offset:128
    global_load_dwordx4 a[148:151], v5, s[6:7] offset:192
    global_load_dwordx4 a[152:155], v6, s[12:13] offset:0
    global_load_dwordx4 a[156:159], v6, s[12:13] offset:1024
    v_add_u32 v4, 8192, v4
    v_add_u32 v5, 8192, v5
    s_add_u32 s12, s12, 2048
    s_addc_u32 s13, s13, 0
    s_waitcnt vmcnt(30)
    v_accvgpr_read_b32 v16, a0
    v_accvgpr_read_b32 v17, a1
    v_accvgpr_read_b32 v18, a2
    v_accvgpr_read_b32 v19, a3
    v_accvgpr_read_b32 v20, a4
    v_accvgpr_read_b32 v21, a5
    v_accvgpr_read_b32 v22, a6
    v_accvgpr_read_b32 v23, a7
    v_accvgpr_read_b32 v24, a8
    v_accvgpr_read_b32 v25, a9
    v_accvgpr_read_b32 v26, a10
    v_accvgpr_read_b32 v27, a11
    v_accvgpr_read_b32 v28, a12
    v_accvgpr_read_b32 v29, a13
    v_accvgpr_read_b32 v30, a14
    v_accvgpr_read_b32 v31, a15
    v_accvgpr_read_b32 v32, a16
    v_accvgpr_read_b32 v33, a17
    v_accvgpr_read_b32 v34, a18
    v_accvgpr_read_b32 v35, a19
    v_accvgpr_read_b32 v36, a20
    v_accvgpr_read_b32 v37, a21
    v_accvgpr_read_b32 v38, a22
    v_accvgpr_read_b32 v39, a23
    v_accvgpr_read_b32 v40, a24
    v_accvgpr_read_b32 v41, a25
    v_accvgpr_read_b32 v42, a26
    v_accvgpr_read_b32 v43, a27
    v_accvgpr_read_b32 v44, a28
    v_accvgpr_read_b32 v45, a29
    v_accvgpr_read_b32 v46, a30
    v_accvgpr_read_b32 v47, a31
    v_cvt_pk_bf16_f32 v56, v16, v17
    v_cvt_pk_bf16_f32 v57, v18, v19
    v_cvt_pk_bf16_f32 v58, v20, v21
    v_cvt_pk_bf16_f32 v59, v22, v23
    v_cvt_pk_bf16_f32 v60, v24, v25
    v_cvt_pk_bf16_f32 v61, v26, v27
    v_cvt_pk_bf16_f32 v62, v28, v29
    v_cvt_pk_bf16_f32 v63, v30, v31
    v_cvt_pk_bf16_f32 v64, v32, v33
    v_cvt_pk_bf16_f32 v65, v34, v35
    v_cvt_pk_bf16_f32 v66, v36, v37
    v_cvt_pk_bf16_f32 v67, v38, v39
    v_cvt_pk_bf16_f32 v68, v40, v41
    v_cvt_pk_bf16_f32 v69, v42, v43
    v_cvt_pk_bf16_f32 v70, v44, v45
    v_cvt_pk_bf16_f32 v71, v46, v47
    s_nop 1
    v_mfma_f32_16x16x32_bf16 v[72:75], v[56:59], a[32:35], 0
    v_mfma_f32_16x16x32_bf16 v[72:75], v[60:63], a[36:39], v[72:75]
    v_mfma_f32_16x16x32_bf16 v[76:79], v[64:67], a[32:35], 0
    v_mfma_f32_16x16x32_bf16 v[76:79], v[68:71], a[36:39], v[76:79]
    s_nop 7
    ds_bpermute_b32 v80, v7, v76
    s_waitcnt lgkmcnt(0)
    v_add_f32 v80, s26, v80
    v_rcp_f32 v80, v80
    s_nop 0
    v_mul_f32 v72, v72, v80
    v_mul_f32 v73, v73, v80
    v_mul_f32 v74, v74, v80
    v_mul_f32 v75, v75, v80
    v_mul_f32 v76, v76, v80
    v_mul_f32 v77, v77, v80
    v_mul_f32 v78, v78, v80
    v_mul_f32 v79, v79, v80
    v_cndmask_b32 v76, 0, v76, s[24:25]
    v_cndmask_b32 v77, 0, v77, s[24:25]
    v_cndmask_b32 v78, 0, v78, s[24:25]
    v_cndmask_b32 v79, 0, v79, s[24:25]
    v_cvt_pk_bf16_f32 v112, v72, v73
    v_cvt_pk_bf16_f32 v113, v74, v75
    v_cvt_pk_bf16_f32 v114, v76, v77
    v_cvt_pk_bf16_f32 v115, v78, v79
    global_load_dwordx4 a[0:3], v4, s[6:7] offset:0
    global_load_dwordx4 a[4:7], v4, s[6:7] offset:64
    global_load_dwordx4 a[8:11], v4, s[6:7] offset:128
    global_load_dwordx4 a[12:15], v4, s[6:7] offset:192
    global_load_dwordx4 a[16:19], v5, s[6:7] offset:0
    global_load_dwordx4 a[20:23], v5, s[6:7] offset:64
    global_load_dwordx4 a[24:27], v5, s[6:7] offset:128
    global_load_dwordx4 a[28:31], v5, s[6:7] offset:192
    global_load_dwordx4 a[32:35], v6, s[12:13] offset:0
    global_load_dwordx4 a[36:39], v6, s[12:13] offset:1024
    v_add_u32 v4, 8192, v4
    v_add_u32 v5, 8192, v5
    s_add_u32 s12, s12, 2048
    s_addc_u32 s13, s13, 0
    s_waitcnt vmcnt(30)
    v_accvgpr_read_b32 v16, a40
    v_accvgpr_read_b32 v17, a41
    v_accvgpr_read_b32 v18, a42
    v_accvgpr_read_b32 v19, a43
    v_accvgpr_read_b32 v20, a44
    v_accvgpr_read_b32 v21, a45
    v_accvgpr_read_b32 v22, a46
    v_accvgpr_read_b32 v23, a47
    v_accvgpr_read_b32 v24, a48
    v_accvgpr_read_b32 v25, a49
    v_accvgpr_read_b32 v26, a50
    v_accvgpr_read_b32 v27, a51
    v_accvgpr_read_b32 v28, a52
    v_accvgpr_read_b32 v29, a53
    v_accvgpr_read_b32 v30, a54
    v_accvgpr_read_b32 v31, a55
    v_accvgpr_read_b32 v32, a56
    v_accvgpr_read_b32 v33, a57
    v_accvgpr_read_b32 v34, a58
    v_accvgpr_read_b32 v35, a59
    v_accvgpr_read_b32 v36, a60
    v_accvgpr_read_b32 v37, a61
    v_accvgpr_read_b32 v38, a62
    v_accvgpr_read_b32 v39, a63
    v_accvgpr_read_b32 v40, a64
    v_accvgpr_read_b32 v41, a65
    v_accvgpr_read_b32 v42, a66
    v_accvgpr_read_b32 v43, a67
    v_accvgpr_read_b32 v44, a68
    v_accvgpr_read_b32 v45, a69
    v_accvgpr_read_b32 v46, a70
    v_accvgpr_read_b32 v47, a71
    v_cvt_pk_bf16_f32 v56, v16, v17
    v_cvt_pk_bf16_f32 v57, v18, v19
    v_cvt_pk_bf16_f32 v58, v20, v21
    v_cvt_pk_bf16_f32 v59, v22, v23
    v_cvt_pk_bf16_f32 v60, v24, v25
    v_cvt_pk_bf16_f32 v61, v26, v27
    v_cvt_pk_bf16_f32 v62, v28, v29
    v_cvt_pk_bf16_f32 v63, v30, v31
    v_cvt_pk_bf16_f32 v64, v32, v33
    v_cvt_pk_bf16_f32 v65, v34, v35
    v_cvt_pk_bf16_f32 v66, v36, v37
    v_cvt_pk_bf16_f32 v67, v38, v39
    v_cvt_pk_bf16_f32 v68, v40, v41
    v_cvt_pk_bf16_f32 v69, v42, v43
    v_cvt_pk_bf16_f32 v70, v44, v45
    v_cvt_pk_bf16_f32 v71, v46, v47
    s_nop 1
    v_mfma_f32_16x16x32_bf16 v[72:75], v[56:59], a[72:75], 0
    v_mfma_f32_16x16x32_bf16 v[72:75], v[60:63], a[76:79], v[72:75]
    v_mfma_f32_16x16x32_bf16 v[76:79], v[64:67], a[72:75], 0
    v_mfma_f32_16x16x32_bf16 v[76:79], v[68:71], a[76:79], v[76:79]
    s_nop 7
    ds_bpermute_b32 v80, v7, v76
    s_waitcnt lgkmcnt(0)
    v_add_f32 v80, s26, v80
    v_rcp_f32 v80, v80
    s_nop 0
    v_mul_f32 v72, v72, v80
    v_mul_f32 v73, v73, v80
    v_mul_f32 v74, v74, v80
    v_mul_f32 v75, v75, v80
    v_mul_f32 v76, v76, v80
    v_mul_f32 v77, v77, v80
    v_mul_f32 v78, v78, v80
    v_mul_f32 v79, v79, v80
    v_cndmask_b32 v76, 0, v76, s[24:25]
    v_cndmask_b32 v77, 0, v77, s[24:25]
    v_cndmask_b32 v78, 0, v78, s[24:25]
    v_cndmask_b32 v79, 0, v79, s[24:25]
    v_cvt_pk_bf16_f32 v116, v72, v73
    v_cvt_pk_bf16_f32 v117, v74, v75
    v_cvt_pk_bf16_f32 v118, v76, v77
    v_cvt_pk_bf16_f32 v119, v78, v79
    global_load_dwordx4 a[40:43], v4, s[6:7] offset:0
    global_load_dwordx4 a[44:47], v4, s[6:7] offset:64
    global_load_dwordx4 a[48:51], v4, s[6:7] offset:128
    global_load_dwordx4 a[52:55], v4, s[6:7] offset:192
    global_load_dwordx4 a[56:59], v5, s[6:7] offset:0
    global_load_dwordx4 a[60:63], v5, s[6:7] offset:64
    global_load_dwordx4 a[64:67], v5, s[6:7] offset:128
    global_load_dwordx4 a[68:71], v5, s[6:7] offset:192
    global_load_dwordx4 a[72:75], v6, s[12:13] offset:0
    global_load_dwordx4 a[76:79], v6, s[12:13] offset:1024
    v_add_u32 v4, 8192, v4
    v_add_u32 v5, 8192, v5
    s_add_u32 s12, s12, 2048
    s_addc_u32 s13, s13, 0
    s_waitcnt vmcnt(30)
    v_accvgpr_read_b32 v16, a80
    v_accvgpr_read_b32 v17, a81
    v_accvgpr_read_b32 v18, a82
    v_accvgpr_read_b32 v19, a83
    v_accvgpr_read_b32 v20, a84
    v_accvgpr_read_b32 v21, a85
    v_accvgpr_read_b32 v22, a86
    v_accvgpr_read_b32 v23, a87
    v_accvgpr_read_b32 v24, a88
    v_accvgpr_read_b32 v25, a89
    v_accvgpr_read_b32 v26, a90
    v_accvgpr_read_b32 v27, a91
    v_accvgpr_read_b32 v28, a92
    v_accvgpr_read_b32 v29, a93
    v_accvgpr_read_b32 v30, a94
    v_accvgpr_read_b32 v31, a95
    v_accvgpr_read_b32 v32, a96
    v_accvgpr_read_b32 v33, a97
    v_accvgpr_read_b32 v34, a98
    v_accvgpr_read_b32 v35, a99
    v_accvgpr_read_b32 v36, a100
    v_accvgpr_read_b32 v37, a101
    v_accvgpr_read_b32 v38, a102
    v_accvgpr_read_b32 v39, a103
    v_accvgpr_read_b32 v40, a104
    v_accvgpr_read_b32 v41, a105
    v_accvgpr_read_b32 v42, a106
    v_accvgpr_read_b32 v43, a107
    v_accvgpr_read_b32 v44, a108
    v_accvgpr_read_b32 v45, a109
    v_accvgpr_read_b32 v46, a110
    v_accvgpr_read_b32 v47, a111
    v_cvt_pk_bf16_f32 v56, v16, v17
    v_cvt_pk_bf16_f32 v57, v18, v19
    v_cvt_pk_bf16_f32 v58, v20, v21
    v_cvt_pk_bf16_f32 v59, v22, v23
    v_cvt_pk_bf16_f32 v60, v24, v25
    v_cvt_pk_bf16_f32 v61, v26, v27
    v_cvt_pk_bf16_f32 v62, v28, v29
    v_cvt_pk_bf16_f32 v63, v30, v31
    v_cvt_pk_bf16_f32 v64, v32, v33
    v_cvt_pk_bf16_f32 v65, v34, v35
    v_cvt_pk_bf16_f32 v66, v36, v37
    v_cvt_pk_bf16_f32 v67, v38, v39
    v_cvt_pk_bf16_f32 v68, v40, v41
    v_cvt_pk_bf16_f32 v69, v42, v43
    v_cvt_pk_bf16_f32 v70, v44, v45
    v_cvt_pk_bf16_f32 v71, v46, v47
    s_nop 1
    v_mfma_f32_16x16x32_bf16 v[72:75], v[56:59], a[112:115], 0
    v_mfma_f32_16x16x32_bf16 v[72:75], v[60:63], a[116:119], v[72:75]
    v_mfma_f32_16x16x32_bf16 v[76:79], v[64:67], a[112:115], 0
    v_mfma_f32_16x16x32_bf16 v[76:79], v[68:71], a[116:119], v[76:79]
    s_nop 7
    ds_bpermute_b32 v80, v7, v76
    s_waitcnt lgkmcnt(0)
    v_add_f32 v80, s26, v80
    v_rcp_f32 v80, v80
    s_nop 0
    v_mul_f32 v72, v72, v80
    v_mul_f32 v73, v73, v80
    v_mul_f32 v74, v74, v80
    v_mul_f32 v75, v75, v80
    v_mul_f32 v76, v76, v80
    v_mul_f32 v77, v77, v80
    v_mul_f32 v78, v78, v80
    v_mul_f32 v79, v79, v80
    v_cndmask_b32 v76, 0, v76, s[24:25]
    v_cndmask_b32 v77, 0, v77, s[24:25]
    v_cndmask_b32 v78, 0, v78, s[24:25]
    v_cndmask_b32 v79, 0, v79, s[24:25]
    v_cvt_pk_bf16_f32 v120, v72, v73
    v_cvt_pk_bf16_f32 v121, v74, v75
    v_cvt_pk_bf16_f32 v122, v76, v77
    v_cvt_pk_bf16_f32 v123, v78, v79
    global_load_dwordx4 a[80:83], v4, s[6:7] offset:0
    global_load_dwordx4 a[84:87], v4, s[6:7] offset:64
    global_load_dwordx4 a[88:91], v4, s[6:7] offset:128
    global_load_dwordx4 a[92:95], v4, s[6:7] offset:192
    global_load_dwordx4 a[96:99], v5, s[6:7] offset:0
    global_load_dwordx4 a[100:103], v5, s[6:7] offset:64
    global_load_dwordx4 a[104:107], v5, s[6:7] offset:128
    global_load_dwordx4 a[108:111], v5, s[6:7] offset:192
    global_load_dwordx4 a[112:115], v6, s[12:13] offset:0
    global_load_dwordx4 a[116:119], v6, s[12:13] offset:1024
    v_add_u32 v4, 8192, v4
    v_add_u32 v5, 8192, v5
    s_add_u32 s12, s12, 2048
    s_addc_u32 s13, s13, 0
    s_waitcnt vmcnt(30)
    v_accvgpr_read_b32 v16, a120
    v_accvgpr_read_b32 v17, a121
    v_accvgpr_read_b32 v18, a122
    v_accvgpr_read_b32 v19, a123
    v_accvgpr_read_b32 v20, a124
    v_accvgpr_read_b32 v21, a125
    v_accvgpr_read_b32 v22, a126
    v_accvgpr_read_b32 v23, a127
    v_accvgpr_read_b32 v24, a128
    v_accvgpr_read_b32 v25, a129
    v_accvgpr_read_b32 v26, a130
    v_accvgpr_read_b32 v27, a131
    v_accvgpr_read_b32 v28, a132
    v_accvgpr_read_b32 v29, a133
    v_accvgpr_read_b32 v30, a134
    v_accvgpr_read_b32 v31, a135
    v_accvgpr_read_b32 v32, a136
    v_accvgpr_read_b32 v33, a137
    v_accvgpr_read_b32 v34, a138
    v_accvgpr_read_b32 v35, a139
    v_accvgpr_read_b32 v36, a140
    v_accvgpr_read_b32 v37, a141
    v_accvgpr_read_b32 v38, a142
    v_accvgpr_read_b32 v39, a143
    v_accvgpr_read_b32 v40, a144
    v_accvgpr_read_b32 v41, a145
    v_accvgpr_read_b32 v42, a146
    v_accvgpr_read_b32 v43, a147
    v_accvgpr_read_b32 v44, a148
    v_accvgpr_read_b32 v45, a149
    v_accvgpr_read_b32 v46, a150
    v_accvgpr_read_b32 v47, a151
    v_cvt_pk_bf16_f32 v56, v16, v17
    v_cvt_pk_bf16_f32 v57, v18, v19
    v_cvt_pk_bf16_f32 v58, v20, v21
    v_cvt_pk_bf16_f32 v59, v22, v23
    v_cvt_pk_bf16_f32 v60, v24, v25
    v_cvt_pk_bf16_f32 v61, v26, v27
    v_cvt_pk_bf16_f32 v62, v28, v29
    v_cvt_pk_bf16_f32 v63, v30, v31
    v_cvt_pk_bf16_f32 v64, v32, v33
    v_cvt_pk_bf16_f32 v65, v34, v35
    v_cvt_pk_bf16_f32 v66, v36, v37
    v_cvt_pk_bf16_f32 v67, v38, v39
    v_cvt_pk_bf16_f32 v68, v40, v41
    v_cvt_pk_bf16_f32 v69, v42, v43
    v_cvt_pk_bf16_f32 v70, v44, v45
    v_cvt_pk_bf16_f32 v71, v46, v47
    s_nop 1
    v_mfma_f32_16x16x32_bf16 v[72:75], v[56:59], a[152:155], 0
    v_mfma_f32_16x16x32_bf16 v[72:75], v[60:63], a[156:159], v[72:75]
    v_mfma_f32_16x16x32_bf16 v[76:79], v[64:67], a[152:155], 0
    v_mfma_f32_16x16x32_bf16 v[76:79], v[68:71], a[156:159], v[76:79]
    s_nop 7
    ds_bpermute_b32 v80, v7, v76
    s_waitcnt lgkmcnt(0)
    v_add_f32 v80, s26, v80
    v_rcp_f32 v80, v80
    s_nop 0
    v_mul_f32 v72, v72, v80
    v_mul_f32 v73, v73, v80
    v_mul_f32 v74, v74, v80
    v_mul_f32 v75, v75, v80
    v_mul_f32 v76, v76, v80
    v_mul_f32 v77, v77, v80
    v_mul_f32 v78, v78, v80
    v_mul_f32 v79, v79, v80
    v_cndmask_b32 v76, 0, v76, s[24:25]
    v_cndmask_b32 v77, 0, v77, s[24:25]
    v_cndmask_b32 v78, 0, v78, s[24:25]
    v_cndmask_b32 v79, 0, v79, s[24:25]
    v_cvt_pk_bf16_f32 v124, v72, v73
    v_cvt_pk_bf16_f32 v125, v74, v75
    v_cvt_pk_bf16_f32 v126, v76, v77
    v_cvt_pk_bf16_f32 v127, v78, v79
    global_load_dwordx4 a[120:123], v4, s[6:7] offset:0
    global_load_dwordx4 a[124:127], v4, s[6:7] offset:64
    global_load_dwordx4 a[128:131], v4, s[6:7] offset:128
    global_load_dwordx4 a[132:135], v4, s[6:7] offset:192
    global_load_dwordx4 a[136:139], v5, s[6:7] offset:0
    global_load_dwordx4 a[140:143], v5, s[6:7] offset:64
    global_load_dwordx4 a[144:147], v5, s[6:7] offset:128
    global_load_dwordx4 a[148:151], v5, s[6:7] offset:192
    global_load_dwordx4 a[152:155], v6, s[12:13] offset:0
    global_load_dwordx4 a[156:159], v6, s[12:13] offset:1024
    v_add_u32 v4, 8192, v4
    v_add_u32 v5, 8192, v5
    s_add_u32 s12, s12, 2048
    s_addc_u32 s13, s13, 0
    s_waitcnt vmcnt(30)
    v_accvgpr_read_b32 v16, a0
    v_accvgpr_read_b32 v17, a1
    v_accvgpr_read_b32 v18, a2
    v_accvgpr_read_b32 v19, a3
    v_accvgpr_read_b32 v20, a4
    v_accvgpr_read_b32 v21, a5
    v_accvgpr_read_b32 v22, a6
    v_accvgpr_read_b32 v23, a7
    v_accvgpr_read_b32 v24, a8
    v_accvgpr_read_b32 v25, a9
    v_accvgpr_read_b32 v26, a10
    v_accvgpr_read_b32 v27, a11
    v_accvgpr_read_b32 v28, a12
    v_accvgpr_read_b32 v29, a13
    v_accvgpr_read_b32 v30, a14
    v_accvgpr_read_b32 v31, a15
    v_accvgpr_read_b32 v32, a16
    v_accvgpr_read_b32 v33, a17
    v_accvgpr_read_b32 v34, a18
    v_accvgpr_read_b32 v35, a19
    v_accvgpr_read_b32 v36, a20
    v_accvgpr_read_b32 v37, a21
    v_accvgpr_read_b32 v38, a22
    v_accvgpr_read_b32 v39, a23
    v_accvgpr_read_b32 v40, a24
    v_accvgpr_read_b32 v41, a25
    v_accvgpr_read_b32 v42, a26
    v_accvgpr_read_b32 v43, a27
    v_accvgpr_read_b32 v44, a28
    v_accvgpr_read_b32 v45, a29
    v_accvgpr_read_b32 v46, a30
    v_accvgpr_read_b32 v47, a31
    v_cvt_pk_bf16_f32 v56, v16, v17
    v_cvt_pk_bf16_f32 v57, v18, v19
    v_cvt_pk_bf16_f32 v58, v20, v21
    v_cvt_pk_bf16_f32 v59, v22, v23
    v_cvt_pk_bf16_f32 v60, v24, v25
    v_cvt_pk_bf16_f32 v61, v26, v27
    v_cvt_pk_bf16_f32 v62, v28, v29
    v_cvt_pk_bf16_f32 v63, v30, v31
    v_cvt_pk_bf16_f32 v64, v32, v33
    v_cvt_pk_bf16_f32 v65, v34, v35
    v_cvt_pk_bf16_f32 v66, v36, v37
    v_cvt_pk_bf16_f32 v67, v38, v39
    v_cvt_pk_bf16_f32 v68, v40, v41
    v_cvt_pk_bf16_f32 v69, v42, v43
    v_cvt_pk_bf16_f32 v70, v44, v45
    v_cvt_pk_bf16_f32 v71, v46, v47
    s_nop 1
    v_mfma_f32_16x16x32_bf16 v[72:75], v[56:59], a[32:35], 0
    v_mfma_f32_16x16x32_bf16 v[72:75], v[60:63], a[36:39], v[72:75]
    v_mfma_f32_16x16x32_bf16 v[76:79], v[64:67], a[32:35], 0
    v_mfma_f32_16x16x32_bf16 v[76:79], v[68:71], a[36:39], v[76:79]
    s_nop 7
    ds_bpermute_b32 v80, v7, v76
    s_waitcnt lgkmcnt(0)
    v_add_f32 v80, s26, v80
    v_rcp_f32 v80, v80
    s_nop 0
    v_mul_f32 v72, v72, v80
    v_mul_f32 v73, v73, v80
    v_mul_f32 v74, v74, v80
    v_mul_f32 v75, v75, v80
    v_mul_f32 v76, v76, v80
    v_mul_f32 v77, v77, v80
    v_mul_f32 v78, v78, v80
    v_mul_f32 v79, v79, v80
    v_cndmask_b32 v76, 0, v76, s[24:25]
    v_cndmask_b32 v77, 0, v77, s[24:25]
    v_cndmask_b32 v78, 0, v78, s[24:25]
    v_cndmask_b32 v79, 0, v79, s[24:25]
    v_cvt_pk_bf16_f32 v128, v72, v73
    v_cvt_pk_bf16_f32 v129, v74, v75
    v_cvt_pk_bf16_f32 v130, v76, v77
    v_cvt_pk_bf16_f32 v131, v78, v79
    global_load_dwordx4 a[0:3], v4, s[6:7] offset:0
    global_load_dwordx4 a[4:7], v4, s[6:7] offset:64
    global_load_dwordx4 a[8:11], v4, s[6:7] offset:128
    global_load_dwordx4 a[12:15], v4, s[6:7] offset:192
    global_load_dwordx4 a[16:19], v5, s[6:7] offset:0
    global_load_dwordx4 a[20:23], v5, s[6:7] offset:64
    global_load_dwordx4 a[24:27], v5, s[6:7] offset:128
    global_load_dwordx4 a[28:31], v5, s[6:7] offset:192
    global_load_dwordx4 a[32:35], v6, s[12:13] offset:0
    global_load_dwordx4 a[36:39], v6, s[12:13] offset:1024
    v_add_u32 v4, 8192, v4
    v_add_u32 v5, 8192, v5
    s_add_u32 s12, s12, 2048
    s_addc_u32 s13, s13, 0
    s_waitcnt vmcnt(30)
    v_accvgpr_read_b32 v16, a40
    v_accvgpr_read_b32 v17, a41
    v_accvgpr_read_b32 v18, a42
    v_accvgpr_read_b32 v19, a43
    v_accvgpr_read_b32 v20, a44
    v_accvgpr_read_b32 v21, a45
    v_accvgpr_read_b32 v22, a46
    v_accvgpr_read_b32 v23, a47
    v_accvgpr_read_b32 v24, a48
    v_accvgpr_read_b32 v25, a49
    v_accvgpr_read_b32 v26, a50
    v_accvgpr_read_b32 v27, a51
    v_accvgpr_read_b32 v28, a52
    v_accvgpr_read_b32 v29, a53
    v_accvgpr_read_b32 v30, a54
    v_accvgpr_read_b32 v31, a55
    v_accvgpr_read_b32 v32, a56
    v_accvgpr_read_b32 v33, a57
    v_accvgpr_read_b32 v34, a58
    v_accvgpr_read_b32 v35, a59
    v_accvgpr_read_b32 v36, a60
    v_accvgpr_read_b32 v37, a61
    v_accvgpr_read_b32 v38, a62
    v_accvgpr_read_b32 v39, a63
    v_accvgpr_read_b32 v40, a64
    v_accvgpr_read_b32 v41, a65
    v_accvgpr_read_b32 v42, a66
    v_accvgpr_read_b32 v43, a67
    v_accvgpr_read_b32 v44, a68
    v_accvgpr_read_b32 v45, a69
    v_accvgpr_read_b32 v46, a70
    v_accvgpr_read_b32 v47, a71
    v_cvt_pk_bf16_f32 v56, v16, v17
    v_cvt_pk_bf16_f32 v57, v18, v19
    v_cvt_pk_bf16_f32 v58, v20, v21
    v_cvt_pk_bf16_f32 v59, v22, v23
    v_cvt_pk_bf16_f32 v60, v24, v25
    v_cvt_pk_bf16_f32 v61, v26, v27
    v_cvt_pk_bf16_f32 v62, v28, v29
    v_cvt_pk_bf16_f32 v63, v30, v31
    v_cvt_pk_bf16_f32 v64, v32, v33
    v_cvt_pk_bf16_f32 v65, v34, v35
    v_cvt_pk_bf16_f32 v66, v36, v37
    v_cvt_pk_bf16_f32 v67, v38, v39
    v_cvt_pk_bf16_f32 v68, v40, v41
    v_cvt_pk_bf16_f32 v69, v42, v43
    v_cvt_pk_bf16_f32 v70, v44, v45
    v_cvt_pk_bf16_f32 v71, v46, v47
    s_nop 1
    v_mfma_f32_16x16x32_bf16 v[72:75], v[56:59], a[72:75], 0
    v_mfma_f32_16x16x32_bf16 v[72:75], v[60:63], a[76:79], v[72:75]
    v_mfma_f32_16x16x32_bf16 v[76:79], v[64:67], a[72:75], 0
    v_mfma_f32_16x16x32_bf16 v[76:79], v[68:71], a[76:79], v[76:79]
    s_nop 7
    ds_bpermute_b32 v80, v7, v76
    s_waitcnt lgkmcnt(0)
    v_add_f32 v80, s26, v80
    v_rcp_f32 v80, v80
    s_nop 0
    v_mul_f32 v72, v72, v80
    v_mul_f32 v73, v73, v80
    v_mul_f32 v74, v74, v80
    v_mul_f32 v75, v75, v80
    v_mul_f32 v76, v76, v80
    v_mul_f32 v77, v77, v80
    v_mul_f32 v78, v78, v80
    v_mul_f32 v79, v79, v80
    v_cndmask_b32 v76, 0, v76, s[24:25]
    v_cndmask_b32 v77, 0, v77, s[24:25]
    v_cndmask_b32 v78, 0, v78, s[24:25]
    v_cndmask_b32 v79, 0, v79, s[24:25]
    v_cvt_pk_bf16_f32 v132, v72, v73
    v_cvt_pk_bf16_f32 v133, v74, v75
    v_cvt_pk_bf16_f32 v134, v76, v77
    v_cvt_pk_bf16_f32 v135, v78, v79
    global_load_dwordx4 a[40:43], v4, s[6:7] offset:0
    global_load_dwordx4 a[44:47], v4, s[6:7] offset:64
    global_load_dwordx4 a[48:51], v4, s[6:7] offset:128
    global_load_dwordx4 a[52:55], v4, s[6:7] offset:192
    global_load_dwordx4 a[56:59], v5, s[6:7] offset:0
    global_load_dwordx4 a[60:63], v5, s[6:7] offset:64
    global_load_dwordx4 a[64:67], v5, s[6:7] offset:128
    global_load_dwordx4 a[68:71], v5, s[6:7] offset:192
    global_load_dwordx4 a[72:75], v6, s[12:13] offset:0
    global_load_dwordx4 a[76:79], v6, s[12:13] offset:1024
    v_add_u32 v4, 8192, v4
    v_add_u32 v5, 8192, v5
    s_add_u32 s12, s12, 2048
    s_addc_u32 s13, s13, 0
    s_waitcnt vmcnt(30)
    v_accvgpr_read_b32 v16, a80
    v_accvgpr_read_b32 v17, a81
    v_accvgpr_read_b32 v18, a82
    v_accvgpr_read_b32 v19, a83
    v_accvgpr_read_b32 v20, a84
    v_accvgpr_read_b32 v21, a85
    v_accvgpr_read_b32 v22, a86
    v_accvgpr_read_b32 v23, a87
    v_accvgpr_read_b32 v24, a88
    v_accvgpr_read_b32 v25, a89
    v_accvgpr_read_b32 v26, a90
    v_accvgpr_read_b32 v27, a91
    v_accvgpr_read_b32 v28, a92
    v_accvgpr_read_b32 v29, a93
    v_accvgpr_read_b32 v30, a94
    v_accvgpr_read_b32 v31, a95
    v_accvgpr_read_b32 v32, a96
    v_accvgpr_read_b32 v33, a97
    v_accvgpr_read_b32 v34, a98
    v_accvgpr_read_b32 v35, a99
    v_accvgpr_read_b32 v36, a100
    v_accvgpr_read_b32 v37, a101
    v_accvgpr_read_b32 v38, a102
    v_accvgpr_read_b32 v39, a103
    v_accvgpr_read_b32 v40, a104
    v_accvgpr_read_b32 v41, a105
    v_accvgpr_read_b32 v42, a106
    v_accvgpr_read_b32 v43, a107
    v_accvgpr_read_b32 v44, a108
    v_accvgpr_read_b32 v45, a109
    v_accvgpr_read_b32 v46, a110
    v_accvgpr_read_b32 v47, a111
    v_cvt_pk_bf16_f32 v56, v16, v17
    v_cvt_pk_bf16_f32 v57, v18, v19
    v_cvt_pk_bf16_f32 v58, v20, v21
    v_cvt_pk_bf16_f32 v59, v22, v23
    v_cvt_pk_bf16_f32 v60, v24, v25
    v_cvt_pk_bf16_f32 v61, v26, v27
    v_cvt_pk_bf16_f32 v62, v28, v29
    v_cvt_pk_bf16_f32 v63, v30, v31
    v_cvt_pk_bf16_f32 v64, v32, v33
    v_cvt_pk_bf16_f32 v65, v34, v35
    v_cvt_pk_bf16_f32 v66, v36, v37
    v_cvt_pk_bf16_f32 v67, v38, v39
    v_cvt_pk_bf16_f32 v68, v40, v41
    v_cvt_pk_bf16_f32 v69, v42, v43
    v_cvt_pk_bf16_f32 v70, v44, v45
    v_cvt_pk_bf16_f32 v71, v46, v47
    s_nop 1
    v_mfma_f32_16x16x32_bf16 v[72:75], v[56:59], a[112:115], 0
    v_mfma_f32_16x16x32_bf16 v[72:75], v[60:63], a[116:119], v[72:75]
    v_mfma_f32_16x16x32_bf16 v[76:79], v[64:67], a[112:115], 0
    v_mfma_f32_16x16x32_bf16 v[76:79], v[68:71], a[116:119], v[76:79]
    s_nop 7
    ds_bpermute_b32 v80, v7, v76
    s_waitcnt lgkmcnt(0)
    v_add_f32 v80, s26, v80
    v_rcp_f32 v80, v80
    s_nop 0
    v_mul_f32 v72, v72, v80
    v_mul_f32 v73, v73, v80
    v_mul_f32 v74, v74, v80
    v_mul_f32 v75, v75, v80
    v_mul_f32 v76, v76, v80
    v_mul_f32 v77, v77, v80
    v_mul_f32 v78, v78, v80
    v_mul_f32 v79, v79, v80
    v_cndmask_b32 v76, 0, v76, s[24:25]
    v_cndmask_b32 v77, 0, v77, s[24:25]
    v_cndmask_b32 v78, 0, v78, s[24:25]
    v_cndmask_b32 v79, 0, v79, s[24:25]
    v_cvt_pk_bf16_f32 v136, v72, v73
    v_cvt_pk_bf16_f32 v137, v74, v75
    v_cvt_pk_bf16_f32 v138, v76, v77
    v_cvt_pk_bf16_f32 v139, v78, v79
    global_load_dwordx4 a[80:83], v4, s[6:7] offset:0
    global_load_dwordx4 a[84:87], v4, s[6:7] offset:64
    global_load_dwordx4 a[88:91], v4, s[6:7] offset:128
    global_load_dwordx4 a[92:95], v4, s[6:7] offset:192
    global_load_dwordx4 a[96:99], v5, s[6:7] offset:0
    global_load_dwordx4 a[100:103], v5, s[6:7] offset:64
    global_load_dwordx4 a[104:107], v5, s[6:7] offset:128
    global_load_dwordx4 a[108:111], v5, s[6:7] offset:192
    global_load_dwordx4 a[112:115], v6, s[12:13] offset:0
    global_load_dwordx4 a[116:119], v6, s[12:13] offset:1024
    v_add_u32 v4, 8192, v4
    v_add_u32 v5, 8192, v5
    s_add_u32 s12, s12, 2048
    s_addc_u32 s13, s13, 0
    s_waitcnt vmcnt(30)
    v_accvgpr_read_b32 v16, a120
    v_accvgpr_read_b32 v17, a121
    v_accvgpr_read_b32 v18, a122
    v_accvgpr_read_b32 v19, a123
    v_accvgpr_read_b32 v20, a124
    v_accvgpr_read_b32 v21, a125
    v_accvgpr_read_b32 v22, a126
    v_accvgpr_read_b32 v23, a127
    v_accvgpr_read_b32 v24, a128
    v_accvgpr_read_b32 v25, a129
    v_accvgpr_read_b32 v26, a130
    v_accvgpr_read_b32 v27, a131
    v_accvgpr_read_b32 v28, a132
    v_accvgpr_read_b32 v29, a133
    v_accvgpr_read_b32 v30, a134
    v_accvgpr_read_b32 v31, a135
    v_accvgpr_read_b32 v32, a136
    v_accvgpr_read_b32 v33, a137
    v_accvgpr_read_b32 v34, a138
    v_accvgpr_read_b32 v35, a139
    v_accvgpr_read_b32 v36, a140
    v_accvgpr_read_b32 v37, a141
    v_accvgpr_read_b32 v38, a142
    v_accvgpr_read_b32 v39, a143
    v_accvgpr_read_b32 v40, a144
    v_accvgpr_read_b32 v41, a145
    v_accvgpr_read_b32 v42, a146
    v_accvgpr_read_b32 v43, a147
    v_accvgpr_read_b32 v44, a148
    v_accvgpr_read_b32 v45, a149
    v_accvgpr_read_b32 v46, a150
    v_accvgpr_read_b32 v47, a151
    v_cvt_pk_bf16_f32 v56, v16, v17
    v_cvt_pk_bf16_f32 v57, v18, v19
    v_cvt_pk_bf16_f32 v58, v20, v21
    v_cvt_pk_bf16_f32 v59, v22, v23
    v_cvt_pk_bf16_f32 v60, v24, v25
    v_cvt_pk_bf16_f32 v61, v26, v27
    v_cvt_pk_bf16_f32 v62, v28, v29
    v_cvt_pk_bf16_f32 v63, v30, v31
    v_cvt_pk_bf16_f32 v64, v32, v33
    v_cvt_pk_bf16_f32 v65, v34, v35
    v_cvt_pk_bf16_f32 v66, v36, v37
    v_cvt_pk_bf16_f32 v67, v38, v39
    v_cvt_pk_bf16_f32 v68, v40, v41
    v_cvt_pk_bf16_f32 v69, v42, v43
    v_cvt_pk_bf16_f32 v70, v44, v45
    v_cvt_pk_bf16_f32 v71, v46, v47
    s_nop 1
    v_mfma_f32_16x16x32_bf16 v[72:75], v[56:59], a[152:155], 0
    v_mfma_f32_16x16x32_bf16 v[72:75], v[60:63], a[156:159], v[72:75]
    v_mfma_f32_16x16x32_bf16 v[76:79], v[64:67], a[152:155], 0
    v_mfma_f32_16x16x32_bf16 v[76:79], v[68:71], a[156:159], v[76:79]
    s_nop 7
    ds_bpermute_b32 v80, v7, v76
    s_waitcnt lgkmcnt(0)
    v_add_f32 v80, s26, v80
    v_rcp_f32 v80, v80
    s_nop 0
    v_mul_f32 v72, v72, v80
    v_mul_f32 v73, v73, v80
    v_mul_f32 v74, v74, v80
    v_mul_f32 v75, v75, v80
    v_mul_f32 v76, v76, v80
    v_mul_f32 v77, v77, v80
    v_mul_f32 v78, v78, v80
    v_mul_f32 v79, v79, v80
    v_cndmask_b32 v76, 0, v76, s[24:25]
    v_cndmask_b32 v77, 0, v77, s[24:25]
    v_cndmask_b32 v78, 0, v78, s[24:25]
    v_cndmask_b32 v79, 0, v79, s[24:25]
    v_cvt_pk_bf16_f32 v140, v72, v73
    v_cvt_pk_bf16_f32 v141, v74, v75
    v_cvt_pk_bf16_f32 v142, v76, v77
    v_cvt_pk_bf16_f32 v143, v78, v79
    global_load_dwordx4 a[120:123], v4, s[6:7] offset:0
    global_load_dwordx4 a[124:127], v4, s[6:7] offset:64
    global_load_dwordx4 a[128:131], v4, s[6:7] offset:128
    global_load_dwordx4 a[132:135], v4, s[6:7] offset:192
    global_load_dwordx4 a[136:139], v5, s[6:7] offset:0
    global_load_dwordx4 a[140:143], v5, s[6:7] offset:64
    global_load_dwordx4 a[144:147], v5, s[6:7] offset:128
    global_load_dwordx4 a[148:151], v5, s[6:7] offset:192
    global_load_dwordx4 a[152:155], v6, s[12:13] offset:0
    global_load_dwordx4 a[156:159], v6, s[12:13] offset:1024
    v_add_u32 v4, 8192, v4
    v_add_u32 v5, 8192, v5
    s_add_u32 s12, s12, 2048
    s_addc_u32 s13, s13, 0
    s_waitcnt vmcnt(30)
    v_accvgpr_read_b32 v16, a0
    v_accvgpr_read_b32 v17, a1
    v_accvgpr_read_b32 v18, a2
    v_accvgpr_read_b32 v19, a3
    v_accvgpr_read_b32 v20, a4
    v_accvgpr_read_b32 v21, a5
    v_accvgpr_read_b32 v22, a6
    v_accvgpr_read_b32 v23, a7
    v_accvgpr_read_b32 v24, a8
    v_accvgpr_read_b32 v25, a9
    v_accvgpr_read_b32 v26, a10
    v_accvgpr_read_b32 v27, a11
    v_accvgpr_read_b32 v28, a12
    v_accvgpr_read_b32 v29, a13
    v_accvgpr_read_b32 v30, a14
    v_accvgpr_read_b32 v31, a15
    v_accvgpr_read_b32 v32, a16
    v_accvgpr_read_b32 v33, a17
    v_accvgpr_read_b32 v34, a18
    v_accvgpr_read_b32 v35, a19
    v_accvgpr_read_b32 v36, a20
    v_accvgpr_read_b32 v37, a21
    v_accvgpr_read_b32 v38, a22
    v_accvgpr_read_b32 v39, a23
    v_accvgpr_read_b32 v40, a24
    v_accvgpr_read_b32 v41, a25
    v_accvgpr_read_b32 v42, a26
    v_accvgpr_read_b32 v43, a27
    v_accvgpr_read_b32 v44, a28
    v_accvgpr_read_b32 v45, a29
    v_accvgpr_read_b32 v46, a30
    v_accvgpr_read_b32 v47, a31
    v_cvt_pk_bf16_f32 v56, v16, v17
    v_cvt_pk_bf16_f32 v57, v18, v19
    v_cvt_pk_bf16_f32 v58, v20, v21
    v_cvt_pk_bf16_f32 v59, v22, v23
    v_cvt_pk_bf16_f32 v60, v24, v25
    v_cvt_pk_bf16_f32 v61, v26, v27
    v_cvt_pk_bf16_f32 v62, v28, v29
    v_cvt_pk_bf16_f32 v63, v30, v31
    v_cvt_pk_bf16_f32 v64, v32, v33
    v_cvt_pk_bf16_f32 v65, v34, v35
    v_cvt_pk_bf16_f32 v66, v36, v37
    v_cvt_pk_bf16_f32 v67, v38, v39
    v_cvt_pk_bf16_f32 v68, v40, v41
    v_cvt_pk_bf16_f32 v69, v42, v43
    v_cvt_pk_bf16_f32 v70, v44, v45
    v_cvt_pk_bf16_f32 v71, v46, v47
    s_nop 1
    v_mfma_f32_16x16x32_bf16 v[72:75], v[56:59], a[32:35], 0
    v_mfma_f32_16x16x32_bf16 v[72:75], v[60:63], a[36:39], v[72:75]
    v_mfma_f32_16x16x32_bf16 v[76:79], v[64:67], a[32:35], 0
    v_mfma_f32_16x16x32_bf16 v[76:79], v[68:71], a[36:39], v[76:79]
    s_nop 7
    ds_bpermute_b32 v80, v7, v76
    s_waitcnt lgkmcnt(0)
    v_add_f32 v80, s26, v80
    v_rcp_f32 v80, v80
    s_nop 0
    v_mul_f32 v72, v72, v80
    v_mul_f32 v73, v73, v80
    v_mul_f32 v74, v74, v80
    v_mul_f32 v75, v75, v80
    v_mul_f32 v76, v76, v80
    v_mul_f32 v77, v77, v80
    v_mul_f32 v78, v78, v80
    v_mul_f32 v79, v79, v80
    v_cndmask_b32 v76, 0, v76, s[24:25]
    v_cndmask_b32 v77, 0, v77, s[24:25]
    v_cndmask_b32 v78, 0, v78, s[24:25]
    v_cndmask_b32 v79, 0, v79, s[24:25]
    v_cvt_pk_bf16_f32 v144, v72, v73
    v_cvt_pk_bf16_f32 v145, v74, v75
    v_cvt_pk_bf16_f32 v146, v76, v77
    v_cvt_pk_bf16_f32 v147, v78, v79
    s_waitcnt vmcnt(20)
    v_accvgpr_read_b32 v16, a40
    v_accvgpr_read_b32 v17, a41
    v_accvgpr_read_b32 v18, a42
    v_accvgpr_read_b32 v19, a43
    v_accvgpr_read_b32 v20, a44
    v_accvgpr_read_b32 v21, a45
    v_accvgpr_read_b32 v22, a46
    v_accvgpr_read_b32 v23, a47
    v_accvgpr_read_b32 v24, a48
    v_accvgpr_read_b32 v25, a49
    v_accvgpr_read_b32 v26, a50
    v_accvgpr_read_b32 v27, a51
    v_accvgpr_read_b32 v28, a52
    v_accvgpr_read_b32 v29, a53
    v_accvgpr_read_b32 v30, a54
    v_accvgpr_read_b32 v31, a55
    v_accvgpr_read_b32 v32, a56
    v_accvgpr_read_b32 v33, a57
    v_accvgpr_read_b32 v34, a58
    v_accvgpr_read_b32 v35, a59
    v_accvgpr_read_b32 v36, a60
    v_accvgpr_read_b32 v37, a61
    v_accvgpr_read_b32 v38, a62
    v_accvgpr_read_b32 v39, a63
    v_accvgpr_read_b32 v40, a64
    v_accvgpr_read_b32 v41, a65
    v_accvgpr_read_b32 v42, a66
    v_accvgpr_read_b32 v43, a67
    v_accvgpr_read_b32 v44, a68
    v_accvgpr_read_b32 v45, a69
    v_accvgpr_read_b32 v46, a70
    v_accvgpr_read_b32 v47, a71
    v_cvt_pk_bf16_f32 v56, v16, v17
    v_cvt_pk_bf16_f32 v57, v18, v19
    v_cvt_pk_bf16_f32 v58, v20, v21
    v_cvt_pk_bf16_f32 v59, v22, v23
    v_cvt_pk_bf16_f32 v60, v24, v25
    v_cvt_pk_bf16_f32 v61, v26, v27
    v_cvt_pk_bf16_f32 v62, v28, v29
    v_cvt_pk_bf16_f32 v63, v30, v31
    v_cvt_pk_bf16_f32 v64, v32, v33
    v_cvt_pk_bf16_f32 v65, v34, v35
    v_cvt_pk_bf16_f32 v66, v36, v37
    v_cvt_pk_bf16_f32 v67, v38, v39
    v_cvt_pk_bf16_f32 v68, v40, v41
    v_cvt_pk_bf16_f32 v69, v42, v43
    v_cvt_pk_bf16_f32 v70, v44, v45
    v_cvt_pk_bf16_f32 v71, v46, v47
    s_nop 1
    v_mfma_f32_16x16x32_bf16 v[72:75], v[56:59], a[72:75], 0
    v_mfma_f32_16x16x32_bf16 v[72:75], v[60:63], a[76:79], v[72:75]
    v_mfma_f32_16x16x32_bf16 v[76:79], v[64:67], a[72:75], 0
    v_mfma_f32_16x16x32_bf16 v[76:79], v[68:71], a[76:79], v[76:79]
    s_nop 7
    ds_bpermute_b32 v80, v7, v76
    s_waitcnt lgkmcnt(0)
    v_add_f32 v80, s26, v80
    v_rcp_f32 v80, v80
    s_nop 0
    v_mul_f32 v72, v72, v80
    v_mul_f32 v73, v73, v80
    v_mul_f32 v74, v74, v80
    v_mul_f32 v75, v75, v80
    v_mul_f32 v76, v76, v80
    v_mul_f32 v77, v77, v80
    v_mul_f32 v78, v78, v80
    v_mul_f32 v79, v79, v80
    v_cndmask_b32 v76, 0, v76, s[24:25]
    v_cndmask_b32 v77, 0, v77, s[24:25]
    v_cndmask_b32 v78, 0, v78, s[24:25]
    v_cndmask_b32 v79, 0, v79, s[24:25]
    v_cvt_pk_bf16_f32 v148, v72, v73
    v_cvt_pk_bf16_f32 v149, v74, v75
    v_cvt_pk_bf16_f32 v150, v76, v77
    v_cvt_pk_bf16_f32 v151, v78, v79
    s_waitcnt vmcnt(10)
    v_accvgpr_read_b32 v16, a80
    v_accvgpr_read_b32 v17, a81
    v_accvgpr_read_b32 v18, a82
    v_accvgpr_read_b32 v19, a83
    v_accvgpr_read_b32 v20, a84
    v_accvgpr_read_b32 v21, a85
    v_accvgpr_read_b32 v22, a86
    v_accvgpr_read_b32 v23, a87
    v_accvgpr_read_b32 v24, a88
    v_accvgpr_read_b32 v25, a89
    v_accvgpr_read_b32 v26, a90
    v_accvgpr_read_b32 v27, a91
    v_accvgpr_read_b32 v28, a92
    v_accvgpr_read_b32 v29, a93
    v_accvgpr_read_b32 v30, a94
    v_accvgpr_read_b32 v31, a95
    v_accvgpr_read_b32 v32, a96
    v_accvgpr_read_b32 v33, a97
    v_accvgpr_read_b32 v34, a98
    v_accvgpr_read_b32 v35, a99
    v_accvgpr_read_b32 v36, a100
    v_accvgpr_read_b32 v37, a101
    v_accvgpr_read_b32 v38, a102
    v_accvgpr_read_b32 v39, a103
    v_accvgpr_read_b32 v40, a104
    v_accvgpr_read_b32 v41, a105
    v_accvgpr_read_b32 v42, a106
    v_accvgpr_read_b32 v43, a107
    v_accvgpr_read_b32 v44, a108
    v_accvgpr_read_b32 v45, a109
    v_accvgpr_read_b32 v46, a110
    v_accvgpr_read_b32 v47, a111
    v_cvt_pk_bf16_f32 v56, v16, v17
    v_cvt_pk_bf16_f32 v57, v18, v19
    v_cvt_pk_bf16_f32 v58, v20, v21
    v_cvt_pk_bf16_f32 v59, v22, v23
    v_cvt_pk_bf16_f32 v60, v24, v25
    v_cvt_pk_bf16_f32 v61, v26, v27
    v_cvt_pk_bf16_f32 v62, v28, v29
    v_cvt_pk_bf16_f32 v63, v30, v31
    v_cvt_pk_bf16_f32 v64, v32, v33
    v_cvt_pk_bf16_f32 v65, v34, v35
    v_cvt_pk_bf16_f32 v66, v36, v37
    v_cvt_pk_bf16_f32 v67, v38, v39
    v_cvt_pk_bf16_f32 v68, v40, v41
    v_cvt_pk_bf16_f32 v69, v42, v43
    v_cvt_pk_bf16_f32 v70, v44, v45
    v_cvt_pk_bf16_f32 v71, v46, v47
    s_nop 1
    v_mfma_f32_16x16x32_bf16 v[72:75], v[56:59], a[112:115], 0
    v_mfma_f32_16x16x32_bf16 v[72:75], v[60:63], a[116:119], v[72:75]
    v_mfma_f32_16x16x32_bf16 v[76:79], v[64:67], a[112:115], 0
    v_mfma_f32_16x16x32_bf16 v[76:79], v[68:71], a[116:119], v[76:79]
    s_nop 7
    ds_bpermute_b32 v80, v7, v76
    s_waitcnt lgkmcnt(0)
    v_add_f32 v80, s26, v80
    v_rcp_f32 v80, v80
    s_nop 0
    v_mul_f32 v72, v72, v80
    v_mul_f32 v73, v73, v80
    v_mul_f32 v74, v74, v80
    v_mul_f32 v75, v75, v80
    v_mul_f32 v76, v76, v80
    v_mul_f32 v77, v77, v80
    v_mul_f32 v78, v78, v80
    v_mul_f32 v79, v79, v80
    v_cndmask_b32 v76, 0, v76, s[24:25]
    v_cndmask_b32 v77, 0, v77, s[24:25]
    v_cndmask_b32 v78, 0, v78, s[24:25]
    v_cndmask_b32 v79, 0, v79, s[24:25]
    v_cvt_pk_bf16_f32 v152, v72, v73
    v_cvt_pk_bf16_f32 v153, v74, v75
    v_cvt_pk_bf16_f32 v154, v76, v77
    v_cvt_pk_bf16_f32 v155, v78, v79
    s_waitcnt vmcnt(0)
    v_accvgpr_read_b32 v16, a120
    v_accvgpr_read_b32 v17, a121
    v_accvgpr_read_b32 v18, a122
    v_accvgpr_read_b32 v19, a123
    v_accvgpr_read_b32 v20, a124
    v_accvgpr_read_b32 v21, a125
    v_accvgpr_read_b32 v22, a126
    v_accvgpr_read_b32 v23, a127
    v_accvgpr_read_b32 v24, a128
    v_accvgpr_read_b32 v25, a129
    v_accvgpr_read_b32 v26, a130
    v_accvgpr_read_b32 v27, a131
    v_accvgpr_read_b32 v28, a132
    v_accvgpr_read_b32 v29, a133
    v_accvgpr_read_b32 v30, a134
    v_accvgpr_read_b32 v31, a135
    v_accvgpr_read_b32 v32, a136
    v_accvgpr_read_b32 v33, a137
    v_accvgpr_read_b32 v34, a138
    v_accvgpr_read_b32 v35, a139
    v_accvgpr_read_b32 v36, a140
    v_accvgpr_read_b32 v37, a141
    v_accvgpr_read_b32 v38, a142
    v_accvgpr_read_b32 v39, a143
    v_accvgpr_read_b32 v40, a144
    v_accvgpr_read_b32 v41, a145
    v_accvgpr_read_b32 v42, a146
    v_accvgpr_read_b32 v43, a147
    v_accvgpr_read_b32 v44, a148
    v_accvgpr_read_b32 v45, a149
    v_accvgpr_read_b32 v46, a150
    v_accvgpr_read_b32 v47, a151
    v_cvt_pk_bf16_f32 v56, v16, v17
    v_cvt_pk_bf16_f32 v57, v18, v19
    v_cvt_pk_bf16_f32 v58, v20, v21
    v_cvt_pk_bf16_f32 v59, v22, v23
    v_cvt_pk_bf16_f32 v60, v24, v25
    v_cvt_pk_bf16_f32 v61, v26, v27
    v_cvt_pk_bf16_f32 v62, v28, v29
    v_cvt_pk_bf16_f32 v63, v30, v31
    v_cvt_pk_bf16_f32 v64, v32, v33
    v_cvt_pk_bf16_f32 v65, v34, v35
    v_cvt_pk_bf16_f32 v66, v36, v37
    v_cvt_pk_bf16_f32 v67, v38, v39
    v_cvt_pk_bf16_f32 v68, v40, v41
    v_cvt_pk_bf16_f32 v69, v42, v43
    v_cvt_pk_bf16_f32 v70, v44, v45
    v_cvt_pk_bf16_f32 v71, v46, v47
    s_nop 1
    v_mfma_f32_16x16x32_bf16 v[72:75], v[56:59], a[152:155], 0
    v_mfma_f32_16x16x32_bf16 v[72:75], v[60:63], a[156:159], v[72:75]
    v_mfma_f32_16x16x32_bf16 v[76:79], v[64:67], a[152:155], 0
    v_mfma_f32_16x16x32_bf16 v[76:79], v[68:71], a[156:159], v[76:79]
    s_nop 7
    ds_bpermute_b32 v80, v7, v76
    s_waitcnt lgkmcnt(0)
    v_add_f32 v80, s26, v80
    v_rcp_f32 v80, v80
    s_nop 0
    v_mul_f32 v72, v72, v80
    v_mul_f32 v73, v73, v80
    v_mul_f32 v74, v74, v80
    v_mul_f32 v75, v75, v80
    v_mul_f32 v76, v76, v80
    v_mul_f32 v77, v77, v80
    v_mul_f32 v78, v78, v80
    v_mul_f32 v79, v79, v80
    v_cndmask_b32 v76, 0, v76, s[24:25]
    v_cndmask_b32 v77, 0, v77, s[24:25]
    v_cndmask_b32 v78, 0, v78, s[24:25]
    v_cndmask_b32 v79, 0, v79, s[24:25]
    v_cvt_pk_bf16_f32 v156, v72, v73
    v_cvt_pk_bf16_f32 v157, v74, v75
    v_cvt_pk_bf16_f32 v158, v76, v77
    v_cvt_pk_bf16_f32 v159, v78, v79
    s_mul_i32 s11, s8, 114688
    s_add_u32 s11, s11, 91684864
    s_add_u32 s12, s6, s11
    s_addc_u32 s13, s7, 0
    s_mul_i32 s11, s40, 28672
    s_mul_i32 s14, s8, 224
    s_add_u32 s11, s11, s14
    s_add_u32 s11, s11, 896
    v_mul_u32_u24 v8, 1792, v2
    v_lshl_add_u32 v8, v3, 3, v8
    v_add_u32 v8, s11, v8

    global_load_dwordx4 a[0:3], v6, s[12:13] offset:0
    global_load_dwordx4 a[4:7], v6, s[12:13] offset:1024
    global_load_dwordx4 a[8:11], v6, s[12:13] offset:2048
    global_load_dwordx4 a[12:15], v6, s[12:13] offset:3072
    s_add_u32 s12, s12, 4096
    s_addc_u32 s13, s13, 0
    global_load_dwordx4 a[16:19], v6, s[12:13] offset:0
    global_load_dwordx4 a[20:23], v6, s[12:13] offset:1024
    global_load_dwordx4 a[24:27], v6, s[12:13] offset:2048
    global_load_dwordx4 a[28:31], v6, s[12:13] offset:3072
    s_add_u32 s12, s12, 4096
    s_addc_u32 s13, s13, 0
    global_load_dwordx4 a[32:35], v6, s[12:13] offset:0
    global_load_dwordx4 a[36:39], v6, s[12:13] offset:1024
    global_load_dwordx4 a[40:43], v6, s[12:13] offset:2048
    global_load_dwordx4 a[44:47], v6, s[12:13] offset:3072
    s_add_u32 s12, s12, 4096
    s_addc_u32 s13, s13, 0
    global_load_dwordx4 a[48:51], v6, s[12:13] offset:0
    global_load_dwordx4 a[52:55], v6, s[12:13] offset:1024
    global_load_dwordx4 a[56:59], v6, s[12:13] offset:2048
    global_load_dwordx4 a[60:63], v6, s[12:13] offset:3072
    s_add_u32 s12, s12, 4096
    s_addc_u32 s13, s13, 0
    global_load_dwordx4 a[64:67], v6, s[12:13] offset:0
    global_load_dwordx4 a[68:71], v6, s[12:13] offset:1024
    global_load_dwordx4 a[72:75], v6, s[12:13] offset:2048
    global_load_dwordx4 a[76:79], v6, s[12:13] offset:3072
    s_add_u32 s12, s12, 4096
    s_addc_u32 s13, s13, 0
    global_load_dwordx4 a[80:83], v6, s[12:13] offset:0
    global_load_dwordx4 a[84:87], v6, s[12:13] offset:1024
    global_load_dwordx4 a[88:91], v6, s[12:13] offset:2048
    global_load_dwordx4 a[92:95], v6, s[12:13] offset:3072
    s_add_u32 s12, s12, 4096
    s_addc_u32 s13, s13, 0
    global_load_dwordx4 a[96:99], v6, s[12:13] offset:0
    global_load_dwordx4 a[100:103], v6, s[12:13] offset:1024
    global_load_dwordx4 a[104:107], v6, s[12:13] offset:2048
    global_load_dwordx4 a[108:111], v6, s[12:13] offset:3072
    s_add_u32 s12, s12, 4096
    s_addc_u32 s13, s13, 0
    global_load_dwordx4 a[112:115], v6, s[12:13] offset:0
    global_load_dwordx4 a[116:119], v6, s[12:13] offset:1024
    global_load_dwordx4 a[120:123], v6, s[12:13] offset:2048
    global_load_dwordx4 a[124:127], v6, s[12:13] offset:3072
    s_add_u32 s12, s12, 4096
    s_addc_u32 s13, s13, 0
    global_load_dwordx4 a[128:131], v6, s[12:13] offset:0
    global_load_dwordx4 a[132:135], v6, s[12:13] offset:1024
    global_load_dwordx4 a[136:139], v6, s[12:13] offset:2048
    global_load_dwordx4 a[140:143], v6, s[12:13] offset:3072
    s_add_u32 s12, s12, 4096
    s_addc_u32 s13, s13, 0
    global_load_dwordx4 a[144:147], v6, s[12:13] offset:0
    global_load_dwordx4 a[148:151], v6, s[12:13] offset:1024
    global_load_dwordx4 a[152:155], v6, s[12:13] offset:2048
    global_load_dwordx4 a[156:159], v6, s[12:13] offset:3072
    s_add_u32 s12, s12, 4096
    s_addc_u32 s13, s13, 0
    global_load_dwordx4 a[160:163], v6, s[12:13] offset:0
    global_load_dwordx4 a[164:167], v6, s[12:13] offset:1024
    global_load_dwordx4 a[168:171], v6, s[12:13] offset:2048
    global_load_dwordx4 a[172:175], v6, s[12:13] offset:3072
    s_add_u32 s12, s12, 4096
    s_addc_u32 s13, s13, 0
    global_load_dwordx4 a[176:179], v6, s[12:13] offset:0
    global_load_dwordx4 a[180:183], v6, s[12:13] offset:1024
    global_load_dwordx4 a[184:187], v6, s[12:13] offset:2048
    global_load_dwordx4 a[188:191], v6, s[12:13] offset:3072
    s_add_u32 s12, s12, 4096
    s_addc_u32 s13, s13, 0
    global_load_dwordx4 a[192:195], v6, s[12:13] offset:0
    global_load_dwordx4 a[196:199], v6, s[12:13] offset:1024
    global_load_dwordx4 a[200:203], v6, s[12:13] offset:2048
    global_load_dwordx4 a[204:207], v6, s[12:13] offset:3072
    s_add_u32 s12, s12, 4096
    s_addc_u32 s13, s13, 0
    global_load_dwordx4 a[208:211], v6, s[12:13] offset:0
    global_load_dwordx4 a[212:215], v6, s[12:13] offset:1024
    global_load_dwordx4 a[216:219], v6, s[12:13] offset:2048
    global_load_dwordx4 a[220:223], v6, s[12:13] offset:3072
    s_add_u32 s12, s12, 4096
    s_addc_u32 s13, s13, 0
    global_load_dwordx4 a[224:227], v6, s[12:13] offset:0
    global_load_dwordx4 a[228:231], v6, s[12:13] offset:1024
    global_load_dwordx4 a[232:235], v6, s[12:13] offset:2048
    global_load_dwordx4 a[236:239], v6, s[12:13] offset:3072
    s_add_u32 s12, s12, 4096
    s_addc_u32 s13, s13, 0
    global_load_dwordx4 a[240:243], v6, s[12:13] offset:0
    global_load_dwordx4 a[244:247], v6, s[12:13] offset:1024
    global_load_dwordx4 a[248:251], v6, s[12:13] offset:2048
    global_load_dwordx4 a[252:255], v6, s[12:13] offset:3072
    s_add_u32 s12, s12, 4096
    s_addc_u32 s13, s13, 0
    s_waitcnt vmcnt(48)
    v_mfma_f32_16x16x32_bf16 v[80:83], a[0:3], v[96:99], 0
    v_mfma_f32_16x16x32_bf16 v[80:83], a[4:7], v[100:103], v[80:83]
    v_mfma_f32_16x16x32_bf16 v[80:83], a[8:11], v[104:107], v[80:83]
    v_mfma_f32_16x16x32_bf16 v[80:83], a[12:15], v[108:111], v[80:83]
    v_mfma_f32_16x16x32_bf16 v[80:83], a[16:19], v[112:115], v[80:83]
    v_mfma_f32_16x16x32_bf16 v[80:83], a[20:23], v[116:119], v[80:83]
    v_mfma_f32_16x16x32_bf16 v[80:83], a[24:27], v[120:123], v[80:83]
    v_mfma_f32_16x16x32_bf16 v[80:83], a[28:31], v[124:127], v[80:83]
    v_mfma_f32_16x16x32_bf16 v[80:83], a[32:35], v[128:131], v[80:83]
    v_mfma_f32_16x16x32_bf16 v[80:83], a[36:39], v[132:135], v[80:83]
    v_mfma_f32_16x16x32_bf16 v[80:83], a[40:43], v[136:139], v[80:83]
    v_mfma_f32_16x16x32_bf16 v[80:83], a[44:47], v[140:143], v[80:83]
    v_mfma_f32_16x16x32_bf16 v[80:83], a[48:51], v[144:147], v[80:83]
    v_mfma_f32_16x16x32_bf16 v[80:83], a[52:55], v[148:151], v[80:83]
    v_mfma_f32_16x16x32_bf16 v[80:83], a[56:59], v[152:155], v[80:83]
    v_mfma_f32_16x16x32_bf16 v[80:83], a[60:63], v[156:159], v[80:83]
    s_nop 7
    v_cvt_pk_bf16_f32 v84, v80, v81
    v_cvt_pk_bf16_f32 v85, v82, v83
    global_store_dwordx2 v8, v[84:85], s[4:5] offset:0
    global_load_dwordx4 a[0:3], v6, s[12:13] offset:0
    global_load_dwordx4 a[4:7], v6, s[12:13] offset:1024
    global_load_dwordx4 a[8:11], v6, s[12:13] offset:2048
    global_load_dwordx4 a[12:15], v6, s[12:13] offset:3072
    s_add_u32 s12, s12, 4096
    s_addc_u32 s13, s13, 0
    global_load_dwordx4 a[16:19], v6, s[12:13] offset:0
    global_load_dwordx4 a[20:23], v6, s[12:13] offset:1024
    global_load_dwordx4 a[24:27], v6, s[12:13] offset:2048
    global_load_dwordx4 a[28:31], v6, s[12:13] offset:3072
    s_add_u32 s12, s12, 4096
    s_addc_u32 s13, s13, 0
    global_load_dwordx4 a[32:35], v6, s[12:13] offset:0
    global_load_dwordx4 a[36:39], v6, s[12:13] offset:1024
    global_load_dwordx4 a[40:43], v6, s[12:13] offset:2048
    global_load_dwordx4 a[44:47], v6, s[12:13] offset:3072
    s_add_u32 s12, s12, 4096
    s_addc_u32 s13, s13, 0
    global_load_dwordx4 a[48:51], v6, s[12:13] offset:0
    global_load_dwordx4 a[52:55], v6, s[12:13] offset:1024
    global_load_dwordx4 a[56:59], v6, s[12:13] offset:2048
    global_load_dwordx4 a[60:63], v6, s[12:13] offset:3072
    s_add_u32 s12, s12, 4096
    s_addc_u32 s13, s13, 0
    s_waitcnt vmcnt(48)
    v_mfma_f32_16x16x32_bf16 v[80:83], a[64:67], v[96:99], 0
    v_mfma_f32_16x16x32_bf16 v[80:83], a[68:71], v[100:103], v[80:83]
    v_mfma_f32_16x16x32_bf16 v[80:83], a[72:75], v[104:107], v[80:83]
    v_mfma_f32_16x16x32_bf16 v[80:83], a[76:79], v[108:111], v[80:83]
    v_mfma_f32_16x16x32_bf16 v[80:83], a[80:83], v[112:115], v[80:83]
    v_mfma_f32_16x16x32_bf16 v[80:83], a[84:87], v[116:119], v[80:83]
    v_mfma_f32_16x16x32_bf16 v[80:83], a[88:91], v[120:123], v[80:83]
    v_mfma_f32_16x16x32_bf16 v[80:83], a[92:95], v[124:127], v[80:83]
    v_mfma_f32_16x16x32_bf16 v[80:83], a[96:99], v[128:131], v[80:83]
    v_mfma_f32_16x16x32_bf16 v[80:83], a[100:103], v[132:135], v[80:83]
    v_mfma_f32_16x16x32_bf16 v[80:83], a[104:107], v[136:139], v[80:83]
    v_mfma_f32_16x16x32_bf16 v[80:83], a[108:111], v[140:143], v[80:83]
    v_mfma_f32_16x16x32_bf16 v[80:83], a[112:115], v[144:147], v[80:83]
    v_mfma_f32_16x16x32_bf16 v[80:83], a[116:119], v[148:151], v[80:83]
    v_mfma_f32_16x16x32_bf16 v[80:83], a[120:123], v[152:155], v[80:83]
    v_mfma_f32_16x16x32_bf16 v[80:83], a[124:127], v[156:159], v[80:83]
    s_nop 7
    v_cvt_pk_bf16_f32 v86, v80, v81
    v_cvt_pk_bf16_f32 v87, v82, v83
    global_store_dwordx2 v8, v[86:87], s[4:5] offset:32
    global_load_dwordx4 a[64:67], v6, s[12:13] offset:0
    global_load_dwordx4 a[68:71], v6, s[12:13] offset:1024
    global_load_dwordx4 a[72:75], v6, s[12:13] offset:2048
    global_load_dwordx4 a[76:79], v6, s[12:13] offset:3072
    s_add_u32 s12, s12, 4096
    s_addc_u32 s13, s13, 0
    global_load_dwordx4 a[80:83], v6, s[12:13] offset:0
    global_load_dwordx4 a[84:87], v6, s[12:13] offset:1024
    global_load_dwordx4 a[88:91], v6, s[12:13] offset:2048
    global_load_dwordx4 a[92:95], v6, s[12:13] offset:3072
    s_add_u32 s12, s12, 4096
    s_addc_u32 s13, s13, 0
    global_load_dwordx4 a[96:99], v6, s[12:13] offset:0
    global_load_dwordx4 a[100:103], v6, s[12:13] offset:1024
    global_load_dwordx4 a[104:107], v6, s[12:13] offset:2048
    global_load_dwordx4 a[108:111], v6, s[12:13] offset:3072
    s_add_u32 s12, s12, 4096
    s_addc_u32 s13, s13, 0
    global_load_dwordx4 a[112:115], v6, s[12:13] offset:0
    global_load_dwordx4 a[116:119], v6, s[12:13] offset:1024
    global_load_dwordx4 a[120:123], v6, s[12:13] offset:2048
    global_load_dwordx4 a[124:127], v6, s[12:13] offset:3072
    s_add_u32 s12, s12, 4096
    s_addc_u32 s13, s13, 0
    s_waitcnt vmcnt(48)
    v_mfma_f32_16x16x32_bf16 v[80:83], a[128:131], v[96:99], 0
    v_mfma_f32_16x16x32_bf16 v[80:83], a[132:135], v[100:103], v[80:83]
    v_mfma_f32_16x16x32_bf16 v[80:83], a[136:139], v[104:107], v[80:83]
    v_mfma_f32_16x16x32_bf16 v[80:83], a[140:143], v[108:111], v[80:83]
    v_mfma_f32_16x16x32_bf16 v[80:83], a[144:147], v[112:115], v[80:83]
    v_mfma_f32_16x16x32_bf16 v[80:83], a[148:151], v[116:119], v[80:83]
    v_mfma_f32_16x16x32_bf16 v[80:83], a[152:155], v[120:123], v[80:83]
    v_mfma_f32_16x16x32_bf16 v[80:83], a[156:159], v[124:127], v[80:83]
    v_mfma_f32_16x16x32_bf16 v[80:83], a[160:163], v[128:131], v[80:83]
    v_mfma_f32_16x16x32_bf16 v[80:83], a[164:167], v[132:135], v[80:83]
    v_mfma_f32_16x16x32_bf16 v[80:83], a[168:171], v[136:139], v[80:83]
    v_mfma_f32_16x16x32_bf16 v[80:83], a[172:175], v[140:143], v[80:83]
    v_mfma_f32_16x16x32_bf16 v[80:83], a[176:179], v[144:147], v[80:83]
    v_mfma_f32_16x16x32_bf16 v[80:83], a[180:183], v[148:151], v[80:83]
    v_mfma_f32_16x16x32_bf16 v[80:83], a[184:187], v[152:155], v[80:83]
    v_mfma_f32_16x16x32_bf16 v[80:83], a[188:191], v[156:159], v[80:83]
    s_nop 7
    v_cvt_pk_bf16_f32 v84, v80, v81
    v_cvt_pk_bf16_f32 v85, v82, v83
    global_store_dwordx2 v8, v[84:85], s[4:5] offset:64
    global_load_dwordx4 a[128:131], v6, s[12:13] offset:0
    global_load_dwordx4 a[132:135], v6, s[12:13] offset:1024
    global_load_dwordx4 a[136:139], v6, s[12:13] offset:2048
    global_load_dwordx4 a[140:143], v6, s[12:13] offset:3072
    s_add_u32 s12, s12, 4096
    s_addc_u32 s13, s13, 0
    global_load_dwordx4 a[144:147], v6, s[12:13] offset:0
    global_load_dwordx4 a[148:151], v6, s[12:13] offset:1024
    global_load_dwordx4 a[152:155], v6, s[12:13] offset:2048
    global_load_dwordx4 a[156:159], v6, s[12:13] offset:3072
    s_add_u32 s12, s12, 4096
    s_addc_u32 s13, s13, 0
    global_load_dwordx4 a[160:163], v6, s[12:13] offset:0
    global_load_dwordx4 a[164:167], v6, s[12:13] offset:1024
    global_load_dwordx4 a[168:171], v6, s[12:13] offset:2048
    global_load_dwordx4 a[172:175], v6, s[12:13] offset:3072
    s_add_u32 s12, s12, 4096
    s_addc_u32 s13, s13, 0
    global_load_dwordx4 a[176:179], v6, s[12:13] offset:0
    global_load_dwordx4 a[180:183], v6, s[12:13] offset:1024
    global_load_dwordx4 a[184:187], v6, s[12:13] offset:2048
    global_load_dwordx4 a[188:191], v6, s[12:13] offset:3072
    s_add_u32 s12, s12, 4096
    s_addc_u32 s13, s13, 0
    s_waitcnt vmcnt(48)
    v_mfma_f32_16x16x32_bf16 v[80:83], a[192:195], v[96:99], 0
    v_mfma_f32_16x16x32_bf16 v[80:83], a[196:199], v[100:103], v[80:83]
    v_mfma_f32_16x16x32_bf16 v[80:83], a[200:203], v[104:107], v[80:83]
    v_mfma_f32_16x16x32_bf16 v[80:83], a[204:207], v[108:111], v[80:83]
    v_mfma_f32_16x16x32_bf16 v[80:83], a[208:211], v[112:115], v[80:83]
    v_mfma_f32_16x16x32_bf16 v[80:83], a[212:215], v[116:119], v[80:83]
    v_mfma_f32_16x16x32_bf16 v[80:83], a[216:219], v[120:123], v[80:83]
    v_mfma_f32_16x16x32_bf16 v[80:83], a[220:223], v[124:127], v[80:83]
    v_mfma_f32_16x16x32_bf16 v[80:83], a[224:227], v[128:131], v[80:83]
    v_mfma_f32_16x16x32_bf16 v[80:83], a[228:231], v[132:135], v[80:83]
    v_mfma_f32_16x16x32_bf16 v[80:83], a[232:235], v[136:139], v[80:83]
    v_mfma_f32_16x16x32_bf16 v[80:83], a[236:239], v[140:143], v[80:83]
    v_mfma_f32_16x16x32_bf16 v[80:83], a[240:243], v[144:147], v[80:83]
    v_mfma_f32_16x16x32_bf16 v[80:83], a[244:247], v[148:151], v[80:83]
    v_mfma_f32_16x16x32_bf16 v[80:83], a[248:251], v[152:155], v[80:83]
    v_mfma_f32_16x16x32_bf16 v[80:83], a[252:255], v[156:159], v[80:83]
    s_nop 7
    v_cvt_pk_bf16_f32 v86, v80, v81
    v_cvt_pk_bf16_f32 v87, v82, v83
    global_store_dwordx2 v8, v[86:87], s[4:5] offset:96
    s_waitcnt vmcnt(32)
    v_mfma_f32_16x16x32_bf16 v[80:83], a[0:3], v[96:99], 0
    v_mfma_f32_16x16x32_bf16 v[80:83], a[4:7], v[100:103], v[80:83]
    v_mfma_f32_16x16x32_bf16 v[80:83], a[8:11], v[104:107], v[80:83]
    v_mfma_f32_16x16x32_bf16 v[80:83], a[12:15], v[108:111], v[80:83]
    v_mfma_f32_16x16x32_bf16 v[80:83], a[16:19], v[112:115], v[80:83]
    v_mfma_f32_16x16x32_bf16 v[80:83], a[20:23], v[116:119], v[80:83]
    v_mfma_f32_16x16x32_bf16 v[80:83], a[24:27], v[120:123], v[80:83]
    v_mfma_f32_16x16x32_bf16 v[80:83], a[28:31], v[124:127], v[80:83]
    v_mfma_f32_16x16x32_bf16 v[80:83], a[32:35], v[128:131], v[80:83]
    v_mfma_f32_16x16x32_bf16 v[80:83], a[36:39], v[132:135], v[80:83]
    v_mfma_f32_16x16x32_bf16 v[80:83], a[40:43], v[136:139], v[80:83]
    v_mfma_f32_16x16x32_bf16 v[80:83], a[44:47], v[140:143], v[80:83]
    v_mfma_f32_16x16x32_bf16 v[80:83], a[48:51], v[144:147], v[80:83]
    v_mfma_f32_16x16x32_bf16 v[80:83], a[52:55], v[148:151], v[80:83]
    v_mfma_f32_16x16x32_bf16 v[80:83], a[56:59], v[152:155], v[80:83]
    v_mfma_f32_16x16x32_bf16 v[80:83], a[60:63], v[156:159], v[80:83]
    s_nop 7
    v_cvt_pk_bf16_f32 v84, v80, v81
    v_cvt_pk_bf16_f32 v85, v82, v83
    global_store_dwordx2 v8, v[84:85], s[4:5] offset:128
    s_waitcnt vmcnt(16)
    v_mfma_f32_16x16x32_bf16 v[80:83], a[64:67], v[96:99], 0
    v_mfma_f32_16x16x32_bf16 v[80:83], a[68:71], v[100:103], v[80:83]
    v_mfma_f32_16x16x32_bf16 v[80:83], a[72:75], v[104:107], v[80:83]
    v_mfma_f32_16x16x32_bf16 v[80:83], a[76:79], v[108:111], v[80:83]
    v_mfma_f32_16x16x32_bf16 v[80:83], a[80:83], v[112:115], v[80:83]
    v_mfma_f32_16x16x32_bf16 v[80:83], a[84:87], v[116:119], v[80:83]
    v_mfma_f32_16x16x32_bf16 v[80:83], a[88:91], v[120:123], v[80:83]
    v_mfma_f32_16x16x32_bf16 v[80:83], a[92:95], v[124:127], v[80:83]
    v_mfma_f32_16x16x32_bf16 v[80:83], a[96:99], v[128:131], v[80:83]
    v_mfma_f32_16x16x32_bf16 v[80:83], a[100:103], v[132:135], v[80:83]
    v_mfma_f32_16x16x32_bf16 v[80:83], a[104:107], v[136:139], v[80:83]
    v_mfma_f32_16x16x32_bf16 v[80:83], a[108:111], v[140:143], v[80:83]
    v_mfma_f32_16x16x32_bf16 v[80:83], a[112:115], v[144:147], v[80:83]
    v_mfma_f32_16x16x32_bf16 v[80:83], a[116:119], v[148:151], v[80:83]
    v_mfma_f32_16x16x32_bf16 v[80:83], a[120:123], v[152:155], v[80:83]
    v_mfma_f32_16x16x32_bf16 v[80:83], a[124:127], v[156:159], v[80:83]
    s_nop 7
    v_cvt_pk_bf16_f32 v86, v80, v81
    v_cvt_pk_bf16_f32 v87, v82, v83
    global_store_dwordx2 v8, v[86:87], s[4:5] offset:160
    s_waitcnt vmcnt(0)
    v_mfma_f32_16x16x32_bf16 v[80:83], a[128:131], v[96:99], 0
    v_mfma_f32_16x16x32_bf16 v[80:83], a[132:135], v[100:103], v[80:83]
    v_mfma_f32_16x16x32_bf16 v[80:83], a[136:139], v[104:107], v[80:83]
    v_mfma_f32_16x16x32_bf16 v[80:83], a[140:143], v[108:111], v[80:83]
    v_mfma_f32_16x16x32_bf16 v[80:83], a[144:147], v[112:115], v[80:83]
    v_mfma_f32_16x16x32_bf16 v[80:83], a[148:151], v[116:119], v[80:83]
    v_mfma_f32_16x16x32_bf16 v[80:83], a[152:155], v[120:123], v[80:83]
    v_mfma_f32_16x16x32_bf16 v[80:83], a[156:159], v[124:127], v[80:83]
    v_mfma_f32_16x16x32_bf16 v[80:83], a[160:163], v[128:131], v[80:83]
    v_mfma_f32_16x16x32_bf16 v[80:83], a[164:167], v[132:135], v[80:83]
    v_mfma_f32_16x16x32_bf16 v[80:83], a[168:171], v[136:139], v[80:83]
    v_mfma_f32_16x16x32_bf16 v[80:83], a[172:175], v[140:143], v[80:83]
    v_mfma_f32_16x16x32_bf16 v[80:83], a[176:179], v[144:147], v[80:83]
    v_mfma_f32_16x16x32_bf16 v[80:83], a[180:183], v[148:151], v[80:83]
    v_mfma_f32_16x16x32_bf16 v[80:83], a[184:187], v[152:155], v[80:83]
    v_mfma_f32_16x16x32_bf16 v[80:83], a[188:191], v[156:159], v[80:83]
    s_nop 7
    v_cvt_pk_bf16_f32 v84, v80, v81
    v_cvt_pk_bf16_f32 v85, v82, v83
    global_store_dwordx2 v8, v[84:85], s[4:5] offset:192
    s_branch L_task_done
L_t_seg:
    s_sub_u32 s42, s41, 819
    s_mul_hi_u32 s43, s42, 0x1745d175
    s_mul_i32 s44, s43, 11
    s_sub_u32 s44, s42, s44
    s_lshl_b32 s45, s43, 6
    s_cmp_ge_u32 s44, 4
    s_cbranch_scc1 L_t_pv
    s_lshr_b32 s42, s43, 3
    s_lshl_b32 s42, s42, 2
    s_add_u32 s42, s42, 2432

    v_mov_b32 v250, s42
    s_mov_b32 s71, 0
L_wc_gx:
    global_load_dword v251, v250, s[6:7] sc1
    s_add_u32 s71, s71, 1
    s_cmp_ge_u32 s71, 4194304
    s_cbranch_scc1 L_main_done
    s_waitcnt vmcnt(0)
    v_cmp_gt_u32 vcc, 32, v251
    s_cbranch_vccz L_wcd_gx
    s_sleep 4
    s_branch L_wc_gx

L_wcd_gx:
    buffer_inv sc1
    s_lshl_b32 s40, s43, 2
    s_add_u32 s40, s40, s44
    s_add_u32 s70, s45, 4096

    s_lshr_b32 s9, s40, 2
    s_and_b32 s10, s40, 3
    s_lshl_b32 s10, s10, 2
    s_add_u32 s10, s10, s8
    s_mul_i32 s11, s9, 7168
    s_add_u32 s11, s11, 92143616
    s_add_u32 s12, s6, s11
    s_addc_u32 s13, s7, 0
    s_mul_i32 s11, s9, 28672
    s_add_u32 s11, s11, 51642368
    s_add_u32 s14, s6, s11
    s_addc_u32 s15, s7, 0
    s_mul_i32 s11, s9, 458752
    s_mul_i32 s22, s10, 28672
    s_add_u32 s11, s11, s22
    s_add_u32 s11, s11, 53477376
    s_add_u32 s16, s6, s11
    s_addc_u32 s17, s7, 0
    s_mul_i32 s11, s9, 49152
    s_mul_i32 s22, s10, 3072
    s_add_u32 s11, s11, s22
    s_add_u32 s11, s11, 82837504
    s_add_u32 s18, s6, s11
    s_addc_u32 s19, s7, 0
    v_and_b32 v2, 15, v1
    v_lshrrev_b32 v3, 4, v1
    v_and_b32 v4, 7, v1
    v_mul_u32_u24 v4, 896, v4
    v_lshl_add_u32 v5, v3, 3, v4
    v_lshl_add_u32 v4, v3, 4, v4
    v_lshlrev_b32 v6, 4, v1
    v_lshlrev_b32 v7, 3, v1
    v_add_u32 v8, 3584, v6
    v_add_u32 v9, 3584, v7

    global_load_dwordx4 a[0:3], v6, s[14:15] offset:0
    global_load_dwordx4 a[4:7], v6, s[14:15] offset:1024
    global_load_dwordx4 a[8:11], v6, s[14:15] offset:2048
    global_load_dwordx2 a[12:13], v7, s[14:15] offset:3072
    global_load_dwordx4 a[16:19], v8, s[14:15] offset:0
    global_load_dwordx4 a[20:23], v8, s[14:15] offset:1024
    global_load_dwordx4 a[24:27], v8, s[14:15] offset:2048
    global_load_dwordx2 a[28:29], v9, s[14:15] offset:3072
    global_load_dwordx4 a[32:35], v6, s[16:17] offset:0
    global_load_dwordx4 a[36:39], v6, s[16:17] offset:1024
    global_load_dwordx4 a[40:43], v6, s[16:17] offset:2048
    global_load_dwordx2 a[44:45], v7, s[16:17] offset:3072
    global_load_dwordx4 a[48:51], v8, s[16:17] offset:0
    global_load_dwordx4 a[52:55], v8, s[16:17] offset:1024
    global_load_dwordx4 a[56:59], v8, s[16:17] offset:2048
    global_load_dwordx2 a[60:61], v9, s[16:17] offset:3072
    s_add_u32 s14, s14, 7168
    s_addc_u32 s15, s15, 0
    s_add_u32 s16, s16, 7168
    s_addc_u32 s17, s17, 0

    global_load_dwordx4 a[64:67], v6, s[14:15] offset:0
    global_load_dwordx4 a[68:71], v6, s[14:15] offset:1024
    global_load_dwordx4 a[72:75], v6, s[14:15] offset:2048
    global_load_dwordx2 a[76:77], v7, s[14:15] offset:3072
    global_load_dwordx4 a[80:83], v8, s[14:15] offset:0
    global_load_dwordx4 a[84:87], v8, s[14:15] offset:1024
    global_load_dwordx4 a[88:91], v8, s[14:15] offset:2048
    global_load_dwordx2 a[92:93], v9, s[14:15] offset:3072
    global_load_dwordx4 a[96:99], v6, s[16:17] offset:0
    global_load_dwordx4 a[100:103], v6, s[16:17] offset:1024
    global_load_dwordx4 a[104:107], v6, s[16:17] offset:2048
    global_load_dwordx2 a[108:109], v7, s[16:17] offset:3072
    global_load_dwordx4 a[112:115], v8, s[16:17] offset:0
    global_load_dwordx4 a[116:119], v8, s[16:17] offset:1024
    global_load_dwordx4 a[120:123], v8, s[16:17] offset:2048
    global_load_dwordx2 a[124:125], v9, s[16:17] offset:3072
    s_add_u32 s14, s14, 7168
    s_addc_u32 s15, s15, 0
    s_add_u32 s16, s16, 7168
    s_addc_u32 s17, s17, 0

    global_load_dwordx4 a[128:131], v6, s[14:15] offset:0
    global_load_dwordx4 a[132:135], v6, s[14:15] offset:1024
    global_load_dwordx4 a[136:139], v6, s[14:15] offset:2048
    global_load_dwordx2 a[140:141], v7, s[14:15] offset:3072
    global_load_dwordx4 a[144:147], v8, s[14:15] offset:0
    global_load_dwordx4 a[148:151], v8, s[14:15] offset:1024
    global_load_dwordx4 a[152:155], v8, s[14:15] offset:2048
    global_load_dwordx2 a[156:157], v9, s[14:15] offset:3072
    global_load_dwordx4 a[160:163], v6, s[16:17] offset:0
    global_load_dwordx4 a[164:167], v6, s[16:17] offset:1024
    global_load_dwordx4 a[168:171], v6, s[16:17] offset:2048
    global_load_dwordx2 a[172:173], v7, s[16:17] offset:3072
    global_load_dwordx4 a[176:179], v8, s[16:17] offset:0
    global_load_dwordx4 a[180:183], v8, s[16:17] offset:1024
    global_load_dwordx4 a[184:187], v8, s[16:17] offset:2048
    global_load_dwordx2 a[188:189], v9, s[16:17] offset:3072
    s_add_u32 s14, s14, 7168
    s_addc_u32 s15, s15, 0
    s_add_u32 s16, s16, 7168
    s_addc_u32 s17, s17, 0

    global_load_dwordx4 a[192:195], v6, s[14:15] offset:0
    global_load_dwordx4 a[196:199], v6, s[14:15] offset:1024
    global_load_dwordx4 a[200:203], v6, s[14:15] offset:2048
    global_load_dwordx2 a[204:205], v7, s[14:15] offset:3072
    global_load_dwordx4 a[208:211], v8, s[14:15] offset:0
    global_load_dwordx4 a[212:215], v8, s[14:15] offset:1024
    global_load_dwordx4 a[216:219], v8, s[14:15] offset:2048
    global_load_dwordx2 a[220:221], v9, s[14:15] offset:3072
    global_load_dwordx4 a[224:227], v6, s[16:17] offset:0
    global_load_dwordx4 a[228:231], v6, s[16:17] offset:1024
    global_load_dwordx4 a[232:235], v6, s[16:17] offset:2048
    global_load_dwordx2 a[236:237], v7, s[16:17] offset:3072
    global_load_dwordx4 a[240:243], v8, s[16:17] offset:0
    global_load_dwordx4 a[244:247], v8, s[16:17] offset:1024
    global_load_dwordx4 a[248:251], v8, s[16:17] offset:2048
    global_load_dwordx2 a[252:253], v9, s[16:17] offset:3072
    s_add_u32 s14, s14, 7168
    s_addc_u32 s15, s15, 0
    s_add_u32 s16, s16, 7168
    s_addc_u32 s17, s17, 0

    s_waitcnt vmcnt(48)
    v_mfma_f32_16x16x32_bf16 v[104:107], a[0:3], a[32:35], 0
    v_mfma_f32_16x16x32_bf16 v[108:111], a[0:3], a[48:51], 0
    v_mfma_f32_16x16x32_bf16 v[116:119], a[16:19], a[48:51], 0
    v_mfma_f32_16x16x32_bf16 v[104:107], a[4:7], a[36:39], v[104:107]
    v_mfma_f32_16x16x32_bf16 v[108:111], a[4:7], a[52:55], v[108:111]
    v_mfma_f32_16x16x32_bf16 v[116:119], a[20:23], a[52:55], v[116:119]
    v_mfma_f32_16x16x32_bf16 v[104:107], a[8:11], a[40:43], v[104:107]
    v_mfma_f32_16x16x32_bf16 v[108:111], a[8:11], a[56:59], v[108:111]
    v_mfma_f32_16x16x32_bf16 v[116:119], a[24:27], a[56:59], v[116:119]
    s_nop 5
    v_mfma_f32_16x16x16_bf16 v[104:107], a[12:13], a[44:45], v[104:107]
    v_mfma_f32_16x16x16_bf16 v[108:111], a[12:13], a[60:61], v[108:111]
    v_mfma_f32_16x16x16_bf16 v[116:119], a[28:29], a[60:61], v[116:119]
    s_nop 5
    s_waitcnt vmcnt(32)
    v_mfma_f32_16x16x32_bf16 v[104:107], a[64:67], a[96:99], v[104:107]
    v_mfma_f32_16x16x32_bf16 v[108:111], a[64:67], a[112:115], v[108:111]
    v_mfma_f32_16x16x32_bf16 v[116:119], a[80:83], a[112:115], v[116:119]
    v_mfma_f32_16x16x32_bf16 v[104:107], a[68:71], a[100:103], v[104:107]
    v_mfma_f32_16x16x32_bf16 v[108:111], a[68:71], a[116:119], v[108:111]
    v_mfma_f32_16x16x32_bf16 v[116:119], a[84:87], a[116:119], v[116:119]
    v_mfma_f32_16x16x32_bf16 v[104:107], a[72:75], a[104:107], v[104:107]
    v_mfma_f32_16x16x32_bf16 v[108:111], a[72:75], a[120:123], v[108:111]
    v_mfma_f32_16x16x32_bf16 v[116:119], a[88:91], a[120:123], v[116:119]
    s_nop 5
    v_mfma_f32_16x16x16_bf16 v[104:107], a[76:77], a[108:109], v[104:107]
    v_mfma_f32_16x16x16_bf16 v[108:111], a[76:77], a[124:125], v[108:111]
    v_mfma_f32_16x16x16_bf16 v[116:119], a[92:93], a[124:125], v[116:119]
    s_nop 5
    s_waitcnt vmcnt(16)
    v_mfma_f32_16x16x32_bf16 v[104:107], a[128:131], a[160:163], v[104:107]
    v_mfma_f32_16x16x32_bf16 v[108:111], a[128:131], a[176:179], v[108:111]
    v_mfma_f32_16x16x32_bf16 v[116:119], a[144:147], a[176:179], v[116:119]
    v_mfma_f32_16x16x32_bf16 v[104:107], a[132:135], a[164:167], v[104:107]
    v_mfma_f32_16x16x32_bf16 v[108:111], a[132:135], a[180:183], v[108:111]
    v_mfma_f32_16x16x32_bf16 v[116:119], a[148:151], a[180:183], v[116:119]
    v_mfma_f32_16x16x32_bf16 v[104:107], a[136:139], a[168:171], v[104:107]
    v_mfma_f32_16x16x32_bf16 v[108:111], a[136:139], a[184:187], v[108:111]
    v_mfma_f32_16x16x32_bf16 v[116:119], a[152:155], a[184:187], v[116:119]
    s_nop 5
    v_mfma_f32_16x16x16_bf16 v[104:107], a[140:141], a[172:173], v[104:107]
    v_mfma_f32_16x16x16_bf16 v[108:111], a[140:141], a[188:189], v[108:111]
    v_mfma_f32_16x16x16_bf16 v[116:119], a[156:157], a[188:189], v[116:119]
    s_nop 5
    s_waitcnt vmcnt(0)
    v_mfma_f32_16x16x32_bf16 v[104:107], a[192:195], a[224:227], v[104:107]
    v_mfma_f32_16x16x32_bf16 v[108:111], a[192:195], a[240:243], v[108:111]
    v_mfma_f32_16x16x32_bf16 v[116:119], a[208:211], a[240:243], v[116:119]
    v_mfma_f32_16x16x32_bf16 v[104:107], a[196:199], a[228:231], v[104:107]
    v_mfma_f32_16x16x32_bf16 v[108:111], a[196:199], a[244:247], v[108:111]
    v_mfma_f32_16x16x32_bf16 v[116:119], a[212:215], a[244:247], v[116:119]
    v_mfma_f32_16x16x32_bf16 v[104:107], a[200:203], a[232:235], v[104:107]
    v_mfma_f32_16x16x32_bf16 v[108:111], a[200:203], a[248:251], v[108:111]
    v_mfma_f32_16x16x32_bf16 v[116:119], a[216:219], a[248:251], v[116:119]
    s_nop 5
    v_mfma_f32_16x16x16_bf16 v[104:107], a[204:205], a[236:237], v[104:107]
    v_mfma_f32_16x16x16_bf16 v[108:111], a[204:205], a[252:253], v[108:111]
    v_mfma_f32_16x16x16_bf16 v[116:119], a[220:221], a[252:253], v[116:119]
    s_nop 5
    s_mov_b32 s71, 0
L_xs_mp:
    global_load_dwordx4 v[128:131], v4, s[12:13] offset:0 sc1
    global_load_dwordx4 v[132:135], v4, s[12:13] offset:64 sc1
    global_load_dwordx4 v[136:139], v4, s[12:13] offset:128 sc1
    global_load_dwordx2 v[140:141], v5, s[12:13] offset:192 sc1
    global_load_dwordx4 v[144:147], v4, s[12:13] offset:224 sc1
    global_load_dwordx4 v[148:151], v4, s[12:13] offset:288 sc1
    global_load_dwordx4 v[152:155], v4, s[12:13] offset:352 sc1
    global_load_dwordx2 v[156:157], v5, s[12:13] offset:416 sc1
    global_load_dwordx4 v[160:163], v4, s[12:13] offset:448 sc1
    global_load_dwordx4 v[164:167], v4, s[12:13] offset:512 sc1
    global_load_dwordx4 v[168:171], v4, s[12:13] offset:576 sc1
    global_load_dwordx2 v[172:173], v5, s[12:13] offset:640 sc1
    global_load_dwordx4 v[176:179], v4, s[12:13] offset:672 sc1
    global_load_dwordx4 v[180:183], v4, s[12:13] offset:736 sc1
    global_load_dwordx4 v[184:187], v4, s[12:13] offset:800 sc1
    global_load_dwordx2 v[188:189], v5, s[12:13] offset:864 sc1
    s_add_u32 s71, s71, 1
    s_cmp_ge_u32 s71, 1048576
    s_cbranch_scc1 L_task_done
    s_waitcnt vmcnt(0)
    v_max3_u32 v250, v128, v130, v132
    v_max3_u32 v250, v250, v134, v136
    v_max3_u32 v250, v250, v138, v140
    v_max3_u32 v250, v250, v144, v146
    v_max3_u32 v250, v250, v148, v150
    v_max3_u32 v250, v250, v152, v154
    v_max3_u32 v250, v250, v156, v160
    v_max3_u32 v250, v250, v162, v164
    v_max3_u32 v250, v250, v166, v168
    v_max3_u32 v250, v250, v170, v172
    v_max3_u32 v250, v250, v176, v178
    v_max3_u32 v250, v250, v180, v182
    v_max3_u32 v250, v250, v184, v186
    v_max_u32 v250, v250, v188
    v_cmp_eq_u32 vcc, -1, v250
    s_cbranch_vccz L_xs_mok
    s_sleep 8
    s_branch L_xs_mp
L_xs_mok:
    v_mfma_f32_16x16x32_bf16 v[96:99], v[128:131], a[32:35], 0
    v_mfma_f32_16x16x32_bf16 v[100:103], v[128:131], a[48:51], 0
    v_mfma_f32_16x16x32_bf16 v[96:99], v[132:135], a[36:39], v[96:99]
    v_mfma_f32_16x16x32_bf16 v[100:103], v[132:135], a[52:55], v[100:103]
    v_mfma_f32_16x16x32_bf16 v[96:99], v[136:139], a[40:43], v[96:99]
    v_mfma_f32_16x16x32_bf16 v[100:103], v[136:139], a[56:59], v[100:103]
    v_mfma_f32_16x16x32_bf16 v[96:99], v[144:147], a[96:99], v[96:99]
    v_mfma_f32_16x16x32_bf16 v[100:103], v[144:147], a[112:115], v[100:103]
    v_mfma_f32_16x16x32_bf16 v[96:99], v[148:151], a[100:103], v[96:99]
    v_mfma_f32_16x16x32_bf16 v[100:103], v[148:151], a[116:119], v[100:103]
    v_mfma_f32_16x16x32_bf16 v[96:99], v[152:155], a[104:107], v[96:99]
    v_mfma_f32_16x16x32_bf16 v[100:103], v[152:155], a[120:123], v[100:103]
    v_mfma_f32_16x16x32_bf16 v[96:99], v[160:163], a[160:163], v[96:99]
    v_mfma_f32_16x16x32_bf16 v[100:103], v[160:163], a[176:179], v[100:103]
    v_mfma_f32_16x16x32_bf16 v[96:99], v[164:167], a[164:167], v[96:99]
    v_mfma_f32_16x16x32_bf16 v[100:103], v[164:167], a[180:183], v[100:103]
    v_mfma_f32_16x16x32_bf16 v[96:99], v[168:171], a[168:171], v[96:99]
    v_mfma_f32_16x16x32_bf16 v[100:103], v[168:171], a[184:187], v[100:103]
    v_mfma_f32_16x16x32_bf16 v[96:99], v[176:179], a[224:227], v[96:99]
    v_mfma_f32_16x16x32_bf16 v[100:103], v[176:179], a[240:243], v[100:103]
    v_mfma_f32_16x16x32_bf16 v[96:99], v[180:183], a[228:231], v[96:99]
    v_mfma_f32_16x16x32_bf16 v[100:103], v[180:183], a[244:247], v[100:103]
    v_mfma_f32_16x16x32_bf16 v[96:99], v[184:187], a[232:235], v[96:99]
    v_mfma_f32_16x16x32_bf16 v[100:103], v[184:187], a[248:251], v[100:103]
    s_nop 7
    v_mfma_f32_16x16x16_bf16 v[96:99], v[140:141], a[44:45], v[96:99]
    v_mfma_f32_16x16x16_bf16 v[100:103], v[140:141], a[60:61], v[100:103]
    v_mfma_f32_16x16x16_bf16 v[96:99], v[156:157], a[108:109], v[96:99]
    v_mfma_f32_16x16x16_bf16 v[100:103], v[156:157], a[124:125], v[100:103]
    v_mfma_f32_16x16x16_bf16 v[96:99], v[172:173], a[172:173], v[96:99]
    v_mfma_f32_16x16x16_bf16 v[100:103], v[172:173], a[188:189], v[100:103]
    v_mfma_f32_16x16x16_bf16 v[96:99], v[188:189], a[236:237], v[96:99]
    v_mfma_f32_16x16x16_bf16 v[100:103], v[188:189], a[252:253], v[100:103]
    v_lshlrev_b32 v10, 2, v3
    v_add_u32 v11, 0, v10
    v_cmp_le_u32 s[24:25], v11, v2
    v_add_u32 v11, 1, v10
    v_cmp_le_u32 s[26:27], v11, v2
    v_add_u32 v11, 2, v10
    v_cmp_le_u32 s[28:29], v11, v2
    v_add_u32 v11, 3, v10
    v_cmp_le_u32 s[30:31], v11, v2
    v_cmp_gt_u32 s[32:33], 2, v3
    v_mov_b32 v12, 0xff800000
    s_mov_b32 s34, 0x3fb8aa3b
    s_nop 4
    v_cndmask_b32 v96, v12, v96, s[32:33]
    v_cndmask_b32 v97, v12, v97, s[32:33]
    v_cndmask_b32 v98, v12, v98, s[32:33]
    v_cndmask_b32 v99, v12, v99, s[32:33]
    v_cndmask_b32 v104, v12, v104, s[24:25]
    v_cndmask_b32 v105, v12, v105, s[26:27]
    v_cndmask_b32 v106, v12, v106, s[28:29]
    v_cndmask_b32 v107, v12, v107, s[30:31]
    v_max3_f32 v13, v96, v97, v98
    v_max3_f32 v13, v13, v99, v104
    v_max3_f32 v13, v13, v105, v106
    v_max_f32 v13, v13, v107
    v_mov_b32 v14, v13
    s_nop 1
    v_permlane16_swap_b32 v13, v14
    s_nop 1
    v_max_f32 v13, v13, v14
    v_mov_b32 v14, v13
    s_nop 1
    v_permlane32_swap_b32 v13, v14
    s_nop 1
    v_max_f32 v13, v13, v14
    v_mul_f32 v13, s34, v13
    v_fma_f32 v96, v96, s34, -v13
    v_fma_f32 v97, v97, s34, -v13
    v_fma_f32 v98, v98, s34, -v13
    v_fma_f32 v99, v99, s34, -v13
    v_fma_f32 v104, v104, s34, -v13
    v_fma_f32 v105, v105, s34, -v13
    v_fma_f32 v106, v106, s34, -v13
    v_fma_f32 v107, v107, s34, -v13
    v_exp_f32 v96, v96
    v_exp_f32 v97, v97
    v_exp_f32 v98, v98
    v_exp_f32 v99, v99
    v_exp_f32 v104, v104
    v_exp_f32 v105, v105
    v_exp_f32 v106, v106
    v_exp_f32 v107, v107
    s_nop 0
    v_add_f32 v13, v96, v97
    v_add_f32 v13, v13, v98
    v_add_f32 v13, v13, v99
    v_add_f32 v13, v13, v104
    v_add_f32 v13, v13, v105
    v_add_f32 v13, v13, v106
    v_add_f32 v13, v13, v107
    v_mov_b32 v14, v13
    s_nop 1
    v_permlane16_swap_b32 v13, v14
    s_nop 1
    v_add_f32 v13, v13, v14
    v_mov_b32 v14, v13
    s_nop 1
    v_permlane32_swap_b32 v13, v14
    s_nop 1
    v_add_f32 v13, v13, v14
    v_rcp_f32 v13, v13
    s_nop 0
    v_mul_f32 v96, v96, v13
    v_mul_f32 v97, v97, v13
    v_mul_f32 v98, v98, v13
    v_mul_f32 v99, v99, v13
    v_mul_f32 v104, v104, v13
    v_mul_f32 v105, v105, v13
    v_mul_f32 v106, v106, v13
    v_mul_f32 v107, v107, v13
    v_cvt_pk_bf16_f32 v16, v104, v105
    v_cvt_pk_bf16_f32 v17, v106, v107
    v_mov_b32 v18, 0
    v_mov_b32 v19, 0
    v_cvt_pk_bf16_f32 v20, v96, v97
    v_cvt_pk_bf16_f32 v21, v98, v99
    global_store_dwordx4 v6, v[16:19], s[18:19] offset:0 sc1
    global_store_dwordx2 v7, v[20:21], s[18:19] offset:1024 sc1
    v_cndmask_b32 v100, v12, v100, s[32:33]
    v_cndmask_b32 v101, v12, v101, s[32:33]
    v_cndmask_b32 v102, v12, v102, s[32:33]
    v_cndmask_b32 v103, v12, v103, s[32:33]
    v_cndmask_b32 v116, v12, v116, s[24:25]
    v_cndmask_b32 v117, v12, v117, s[26:27]
    v_cndmask_b32 v118, v12, v118, s[28:29]
    v_cndmask_b32 v119, v12, v119, s[30:31]
    v_max3_f32 v13, v100, v101, v102
    v_max3_f32 v13, v13, v103, v108
    v_max3_f32 v13, v13, v109, v110
    v_max3_f32 v13, v13, v111, v116
    v_max3_f32 v13, v13, v117, v118
    v_max_f32 v13, v13, v119
    v_mov_b32 v14, v13
    s_nop 1
    v_permlane16_swap_b32 v13, v14
    s_nop 1
    v_max_f32 v13, v13, v14
    v_mov_b32 v14, v13
    s_nop 1
    v_permlane32_swap_b32 v13, v14
    s_nop 1
    v_max_f32 v13, v13, v14
    v_mul_f32 v13, s34, v13
    v_fma_f32 v100, v100, s34, -v13
    v_fma_f32 v101, v101, s34, -v13
    v_fma_f32 v102, v102, s34, -v13
    v_fma_f32 v103, v103, s34, -v13
    v_fma_f32 v108, v108, s34, -v13
    v_fma_f32 v109, v109, s34, -v13
    v_fma_f32 v110, v110, s34, -v13
    v_fma_f32 v111, v111, s34, -v13
    v_fma_f32 v116, v116, s34, -v13
    v_fma_f32 v117, v117, s34, -v13
    v_fma_f32 v118, v118, s34, -v13
    v_fma_f32 v119, v119, s34, -v13
    v_exp_f32 v100, v100
    v_exp_f32 v101, v101
    v_exp_f32 v102, v102
    v_exp_f32 v103, v103
    v_exp_f32 v108, v108
    v_exp_f32 v109, v109
    v_exp_f32 v110, v110
    v_exp_f32 v111, v111
    v_exp_f32 v116, v116
    v_exp_f32 v117, v117
    v_exp_f32 v118, v118
    v_exp_f32 v119, v119
    s_nop 0
    v_add_f32 v13, v100, v101
    v_add_f32 v13, v13, v102
    v_add_f32 v13, v13, v103
    v_add_f32 v13, v13, v108
    v_add_f32 v13, v13, v109
    v_add_f32 v13, v13, v110
    v_add_f32 v13, v13, v111
    v_add_f32 v13, v13, v116
    v_add_f32 v13, v13, v117
    v_add_f32 v13, v13, v118
    v_add_f32 v13, v13, v119
    v_mov_b32 v14, v13
    s_nop 1
    v_permlane16_swap_b32 v13, v14
    s_nop 1
    v_add_f32 v13, v13, v14
    v_mov_b32 v14, v13
    s_nop 1
    v_permlane32_swap_b32 v13, v14
    s_nop 1
    v_add_f32 v13, v13, v14
    v_rcp_f32 v13, v13
    s_nop 0
    v_mul_f32 v100, v100, v13
    v_mul_f32 v101, v101, v13
    v_mul_f32 v102, v102, v13
    v_mul_f32 v103, v103, v13
    v_mul_f32 v108, v108, v13
    v_mul_f32 v109, v109, v13
    v_mul_f32 v110, v110, v13
    v_mul_f32 v111, v111, v13
    v_mul_f32 v116, v116, v13
    v_mul_f32 v117, v117, v13
    v_mul_f32 v118, v118, v13
    v_mul_f32 v119, v119, v13
    v_cvt_pk_bf16_f32 v24, v108, v109
    v_cvt_pk_bf16_f32 v25, v110, v111
    v_cvt_pk_bf16_f32 v26, v116, v117
    v_cvt_pk_bf16_f32 v27, v118, v119
    v_cvt_pk_bf16_f32 v28, v100, v101
    v_cvt_pk_bf16_f32 v29, v102, v103
    global_store_dwordx4 v6, v[24:27], s[18:19] offset:1536 sc1
    global_store_dwordx2 v7, v[28:29], s[18:19] offset:2560 sc1
    s_branch L_task_done
L_t_pv:
    s_lshr_b32 s42, s43, 3
    s_lshl_b32 s42, s42, 2
    s_add_u32 s42, s42, 2304
    s_cmp_lt_u32 s43, 8
    s_cselect_b32 s46, 64, 32
    v_mov_b32 v250, s42
    s_mov_b32 s71, 0
L_wc_yx:
    global_load_dword v251, v250, s[6:7] sc1
    s_add_u32 s71, s71, 1
    s_cmp_ge_u32 s71, 4194304
    s_cbranch_scc1 L_main_done
    s_waitcnt vmcnt(0)
    v_cmp_gt_u32 vcc, s46, v251
    s_cbranch_vccz L_wcd_yx
    s_sleep 4
    s_branch L_wc_yx

L_wcd_yx:
    buffer_inv sc1
    s_mul_i32 s40, s43, 7
    s_add_u32 s40, s40, s44
    s_sub_u32 s40, s40, 4
    s_mov_b32 s70, 0
    s_mov_b32 s4, s68
    s_mov_b32 s5, s69

    s_mul_hi_u32 s9, s40, 0x24924925
    s_mul_i32 s10, s9, 7
    s_sub_u32 s10, s40, s10
    s_lshl_b32 s10, s10, 2
    s_add_u32 s10, s10, s8
    s_mul_i32 s11, s9, 458752
    s_lshl_b32 s22, s10, 14
    s_add_u32 s11, s11, s22
    s_add_u32 s11, s11, 14942208
    s_add_u32 s12, s6, s11
    s_addc_u32 s13, s7, 0
    s_mul_i32 s11, s9, 114688
    s_lshl_b32 s22, s10, 12
    s_add_u32 s11, s11, s22
    s_add_u32 s11, s11, 44302336
    s_add_u32 s14, s6, s11
    s_addc_u32 s15, s7, 0
    s_mul_i32 s11, s9, 49152
    s_add_u32 s11, s11, 82837504
    s_add_u32 s16, s6, s11
    s_addc_u32 s17, s7, 0
    v_and_b32 v2, 15, v1
    v_lshrrev_b32 v3, 4, v1
    v_lshlrev_b32 v6, 4, v1
    v_lshlrev_b32 v7, 3, v1
    v_and_b32 v4, 1, v3
    v_lshlrev_b32 v4, 9, v4
    v_lshl_add_u32 v4, v2, 4, v4
    s_mul_i32 s11, s9, 57344
    s_lshl_b32 s22, s10, 5
    s_add_u32 s11, s11, s22
    v_mul_u32_u24 v5, 1792, v2
    v_lshl_add_u32 v5, v3, 3, v5
    v_add_u32 v5, s11, v5
    v_add_u32 v8, 28672, v5

    global_load_dwordx4 v[128:131], v6, s[12:13]
    global_load_dwordx4 v[132:135], v6, s[12:13] offset:1024
    s_add_u32 s12, s12, 2048
    s_addc_u32 s13, s13, 0
    global_load_dwordx4 v[136:139], v6, s[12:13]
    global_load_dwordx4 v[140:143], v6, s[12:13] offset:1024
    s_add_u32 s12, s12, 2048
    s_addc_u32 s13, s13, 0
    global_load_dwordx4 v[144:147], v6, s[12:13]
    global_load_dwordx4 v[148:151], v6, s[12:13] offset:1024
    s_add_u32 s12, s12, 2048
    s_addc_u32 s13, s13, 0
    global_load_dwordx4 v[152:155], v6, s[12:13]
    global_load_dwordx4 v[156:159], v6, s[12:13] offset:1024
    s_add_u32 s12, s12, 2048
    s_addc_u32 s13, s13, 0
    global_load_dwordx4 v[160:163], v6, s[12:13]
    global_load_dwordx4 v[164:167], v6, s[12:13] offset:1024
    s_add_u32 s12, s12, 2048
    s_addc_u32 s13, s13, 0
    global_load_dwordx4 v[168:171], v6, s[12:13]
    global_load_dwordx4 v[172:175], v6, s[12:13] offset:1024
    s_add_u32 s12, s12, 2048
    s_addc_u32 s13, s13, 0
    global_load_dwordx4 v[176:179], v6, s[12:13]
    global_load_dwordx4 v[180:183], v6, s[12:13] offset:1024
    s_add_u32 s12, s12, 2048
    s_addc_u32 s13, s13, 0
    global_load_dwordx4 v[184:187], v6, s[12:13]
    global_load_dwordx4 v[188:191], v6, s[12:13] offset:1024
    s_add_u32 s12, s12, 2048
    s_addc_u32 s13, s13, 0
    s_add_u32 s42, s45, 28672
    v_mov_b32 v250, s42
    s_mov_b32 s71, 0
L_wc_ym:
    global_load_dword v251, v250, s[6:7] sc1
    s_add_u32 s71, s71, 1
    s_cmp_ge_u32 s71, 4194304
    s_cbranch_scc1 L_main_done
    s_waitcnt vmcnt(0)
    v_cmp_gt_u32 vcc, 1, v251
    s_cbranch_vccz L_wcd_ym
    s_sleep 4
    s_branch L_wc_ym

L_wcd_ym:
    global_load_dwordx4 v[72:75], v4, s[14:15] offset:0 sc1
    global_load_dwordx4 v[76:79], v4, s[14:15] offset:256 sc1
    global_load_dwordx4 v[80:83], v4, s[14:15] offset:1024 sc1
    global_load_dwordx4 v[84:87], v4, s[14:15] offset:1280 sc1
    global_load_dwordx4 v[88:91], v4, s[14:15] offset:2048 sc1
    global_load_dwordx4 v[92:95], v4, s[14:15] offset:2304 sc1
    global_load_dwordx4 v[96:99], v4, s[14:15] offset:3072 sc1
    global_load_dwordx4 v[100:103], v4, s[14:15] offset:3328 sc1
    s_waitcnt vmcnt(0)
    v_swap_b32 v129, v130
    v_swap_b32 v133, v134
    v_swap_b32 v130, v132
    v_swap_b32 v131, v133
    v_swap_b32 v137, v138
    v_swap_b32 v141, v142
    v_swap_b32 v138, v140
    v_swap_b32 v139, v141
    v_swap_b32 v145, v146
    v_swap_b32 v149, v150
    v_swap_b32 v146, v148
    v_swap_b32 v147, v149
    v_swap_b32 v153, v154
    v_swap_b32 v157, v158
    v_swap_b32 v154, v156
    v_swap_b32 v155, v157
    v_swap_b32 v161, v162
    v_swap_b32 v165, v166
    v_swap_b32 v162, v164
    v_swap_b32 v163, v165
    v_swap_b32 v169, v170
    v_swap_b32 v173, v174
    v_swap_b32 v170, v172
    v_swap_b32 v171, v173
    v_swap_b32 v177, v178
    v_swap_b32 v181, v182
    v_swap_b32 v178, v180
    v_swap_b32 v179, v181
    v_swap_b32 v185, v186
    v_swap_b32 v189, v190
    v_swap_b32 v186, v188
    v_swap_b32 v187, v189
    v_mov_b32 v16, v72
    v_mov_b32 v17, v76
    v_mov_b32 v18, v73
    v_mov_b32 v19, v77
    v_mov_b32 v20, v74
    v_mov_b32 v21, v78
    v_mov_b32 v22, v75
    v_mov_b32 v23, v79
    v_mov_b32 v24, v80
    v_mov_b32 v25, v84
    v_mov_b32 v26, v81
    v_mov_b32 v27, v85
    v_mov_b32 v28, v82
    v_mov_b32 v29, v86
    v_mov_b32 v30, v83
    v_mov_b32 v31, v87
    v_mov_b32 v32, v88
    v_mov_b32 v33, v92
    v_mov_b32 v34, v89
    v_mov_b32 v35, v93
    v_mov_b32 v36, v90
    v_mov_b32 v37, v94
    v_mov_b32 v38, v91
    v_mov_b32 v39, v95
    v_mov_b32 v40, v96
    v_mov_b32 v41, v100
    v_mov_b32 v42, v97
    v_mov_b32 v43, v101
    v_mov_b32 v44, v98
    v_mov_b32 v45, v102
    v_mov_b32 v46, v99
    v_mov_b32 v47, v103
    s_add_u32 s42, s45, 4096
    v_mov_b32 v250, s42
    s_mov_b32 s71, 0
L_wc_xs:
    global_load_dword v251, v250, s[6:7] sc1
    s_add_u32 s71, s71, 1
    s_cmp_ge_u32 s71, 4194304
    s_cbranch_scc1 L_main_done
    s_waitcnt vmcnt(0)
    v_cmp_gt_u32 vcc, 4, v251
    s_cbranch_vccz L_wcd_xs
    s_sleep 4
    s_branch L_wc_xs

L_wcd_xs:
    global_load_dwordx4 a[0:3], v6, s[16:17] offset:0 sc1
    global_load_dwordx2 a[4:5], v7, s[16:17] offset:1024 sc1
    global_load_dwordx4 a[8:11], v6, s[16:17] offset:1536 sc1
    global_load_dwordx2 a[12:13], v7, s[16:17] offset:2560 sc1
    s_add_u32 s16, s16, 3072
    s_addc_u32 s17, s17, 0
    global_load_dwordx4 a[16:19], v6, s[16:17] offset:0 sc1
    global_load_dwordx2 a[20:21], v7, s[16:17] offset:1024 sc1
    global_load_dwordx4 a[24:27], v6, s[16:17] offset:1536 sc1
    global_load_dwordx2 a[28:29], v7, s[16:17] offset:2560 sc1
    s_add_u32 s16, s16, 3072
    s_addc_u32 s17, s17, 0
    global_load_dwordx4 a[32:35], v6, s[16:17] offset:0 sc1
    global_load_dwordx2 a[36:37], v7, s[16:17] offset:1024 sc1
    global_load_dwordx4 a[40:43], v6, s[16:17] offset:1536 sc1
    global_load_dwordx2 a[44:45], v7, s[16:17] offset:2560 sc1
    s_add_u32 s16, s16, 3072
    s_addc_u32 s17, s17, 0
    global_load_dwordx4 a[48:51], v6, s[16:17] offset:0 sc1
    global_load_dwordx2 a[52:53], v7, s[16:17] offset:1024 sc1
    global_load_dwordx4 a[56:59], v6, s[16:17] offset:1536 sc1
    global_load_dwordx2 a[60:61], v7, s[16:17] offset:2560 sc1
    s_add_u32 s16, s16, 3072
    s_addc_u32 s17, s17, 0
    global_load_dwordx4 a[64:67], v6, s[16:17] offset:0 sc1
    global_load_dwordx2 a[68:69], v7, s[16:17] offset:1024 sc1
    global_load_dwordx4 a[72:75], v6, s[16:17] offset:1536 sc1
    global_load_dwordx2 a[76:77], v7, s[16:17] offset:2560 sc1
    s_add_u32 s16, s16, 3072
    s_addc_u32 s17, s17, 0
    global_load_dwordx4 a[80:83], v6, s[16:17] offset:0 sc1
    global_load_dwordx2 a[84:85], v7, s[16:17] offset:1024 sc1
    global_load_dwordx4 a[88:91], v6, s[16:17] offset:1536 sc1
    global_load_dwordx2 a[92:93], v7, s[16:17] offset:2560 sc1
    s_add_u32 s16, s16, 3072
    s_addc_u32 s17, s17, 0
    global_load_dwordx4 a[96:99], v6, s[16:17] offset:0 sc1
    global_load_dwordx2 a[100:101], v7, s[16:17] offset:1024 sc1
    global_load_dwordx4 a[104:107], v6, s[16:17] offset:1536 sc1
    global_load_dwordx2 a[108:109], v7, s[16:17] offset:2560 sc1
    s_add_u32 s16, s16, 3072
    s_addc_u32 s17, s17, 0
    global_load_dwordx4 a[112:115], v6, s[16:17] offset:0 sc1
    global_load_dwordx2 a[116:117], v7, s[16:17] offset:1024 sc1
    global_load_dwordx4 a[120:123], v6, s[16:17] offset:1536 sc1
    global_load_dwordx2 a[124:125], v7, s[16:17] offset:2560 sc1
    s_add_u32 s16, s16, 3072
    s_addc_u32 s17, s17, 0
    global_load_dwordx4 a[128:131], v6, s[16:17] offset:0 sc1
    global_load_dwordx2 a[132:133], v7, s[16:17] offset:1024 sc1
    global_load_dwordx4 a[136:139], v6, s[16:17] offset:1536 sc1
    global_load_dwordx2 a[140:141], v7, s[16:17] offset:2560 sc1
    s_add_u32 s16, s16, 3072
    s_addc_u32 s17, s17, 0
    global_load_dwordx4 a[144:147], v6, s[16:17] offset:0 sc1
    global_load_dwordx2 a[148:149], v7, s[16:17] offset:1024 sc1
    global_load_dwordx4 a[152:155], v6, s[16:17] offset:1536 sc1
    global_load_dwordx2 a[156:157], v7, s[16:17] offset:2560 sc1
    s_add_u32 s16, s16, 3072
    s_addc_u32 s17, s17, 0
    global_load_dwordx4 a[160:163], v6, s[16:17] offset:0 sc1
    global_load_dwordx2 a[164:165], v7, s[16:17] offset:1024 sc1
    global_load_dwordx4 a[168:171], v6, s[16:17] offset:1536 sc1
    global_load_dwordx2 a[172:173], v7, s[16:17] offset:2560 sc1
    s_add_u32 s16, s16, 3072
    s_addc_u32 s17, s17, 0
    global_load_dwordx4 a[176:179], v6, s[16:17] offset:0 sc1
    global_load_dwordx2 a[180:181], v7, s[16:17] offset:1024 sc1
    global_load_dwordx4 a[184:187], v6, s[16:17] offset:1536 sc1
    global_load_dwordx2 a[188:189], v7, s[16:17] offset:2560 sc1
    s_add_u32 s16, s16, 3072
    s_addc_u32 s17, s17, 0
    global_load_dwordx4 a[192:195], v6, s[16:17] offset:0 sc1
    global_load_dwordx2 a[196:197], v7, s[16:17] offset:1024 sc1
    global_load_dwordx4 a[200:203], v6, s[16:17] offset:1536 sc1
    global_load_dwordx2 a[204:205], v7, s[16:17] offset:2560 sc1
    s_add_u32 s16, s16, 3072
    s_addc_u32 s17, s17, 0
    global_load_dwordx4 a[208:211], v6, s[16:17] offset:0 sc1
    global_load_dwordx2 a[212:213], v7, s[16:17] offset:1024 sc1
    global_load_dwordx4 a[216:219], v6, s[16:17] offset:1536 sc1
    global_load_dwordx2 a[220:221], v7, s[16:17] offset:2560 sc1
    s_add_u32 s16, s16, 3072
    s_addc_u32 s17, s17, 0
    global_load_dwordx4 a[224:227], v6, s[16:17] offset:0 sc1
    global_load_dwordx2 a[228:229], v7, s[16:17] offset:1024 sc1
    global_load_dwordx4 a[232:235], v6, s[16:17] offset:1536 sc1
    global_load_dwordx2 a[236:237], v7, s[16:17] offset:2560 sc1
    s_add_u32 s16, s16, 3072
    s_addc_u32 s17, s17, 0
    global_load_dwordx4 a[240:243], v6, s[16:17] offset:0 sc1
    global_load_dwordx2 a[244:245], v7, s[16:17] offset:1024 sc1
    global_load_dwordx4 a[248:251], v6, s[16:17] offset:1536 sc1
    global_load_dwordx2 a[252:253], v7, s[16:17] offset:2560 sc1
    s_add_u32 s16, s16, 3072
    s_addc_u32 s17, s17, 0
    s_waitcnt vmcnt(56)
    v_mfma_f32_16x16x32_bf16 v[60:63], v[128:131], a[0:3], 0
    v_mfma_f32_16x16x32_bf16 v[64:67], v[128:131], a[8:11], 0
    v_mfma_f32_16x16x32_bf16 v[60:63], v[132:135], a[16:19], v[60:63]
    v_mfma_f32_16x16x32_bf16 v[64:67], v[132:135], a[24:27], v[64:67]
    v_mfma_f32_16x16x16_bf16 v[104:107], v[16:17], a[4:5], 0
    v_mfma_f32_16x16x16_bf16 v[108:111], v[16:17], a[12:13], 0
    v_mfma_f32_16x16x16_bf16 v[104:107], v[18:19], a[20:21], v[104:107]
    v_mfma_f32_16x16x16_bf16 v[108:111], v[18:19], a[28:29], v[108:111]
    s_waitcnt vmcnt(48)
    v_mfma_f32_16x16x32_bf16 v[60:63], v[136:139], a[32:35], v[60:63]
    v_mfma_f32_16x16x32_bf16 v[64:67], v[136:139], a[40:43], v[64:67]
    v_mfma_f32_16x16x32_bf16 v[60:63], v[140:143], a[48:51], v[60:63]
    v_mfma_f32_16x16x32_bf16 v[64:67], v[140:143], a[56:59], v[64:67]
    v_mfma_f32_16x16x16_bf16 v[104:107], v[20:21], a[36:37], v[104:107]
    v_mfma_f32_16x16x16_bf16 v[108:111], v[20:21], a[44:45], v[108:111]
    v_mfma_f32_16x16x16_bf16 v[104:107], v[22:23], a[52:53], v[104:107]
    v_mfma_f32_16x16x16_bf16 v[108:111], v[22:23], a[60:61], v[108:111]
    s_waitcnt vmcnt(40)
    v_mfma_f32_16x16x32_bf16 v[60:63], v[144:147], a[64:67], v[60:63]
    v_mfma_f32_16x16x32_bf16 v[64:67], v[144:147], a[72:75], v[64:67]
    v_mfma_f32_16x16x32_bf16 v[60:63], v[148:151], a[80:83], v[60:63]
    v_mfma_f32_16x16x32_bf16 v[64:67], v[148:151], a[88:91], v[64:67]
    v_mfma_f32_16x16x16_bf16 v[104:107], v[24:25], a[68:69], v[104:107]
    v_mfma_f32_16x16x16_bf16 v[108:111], v[24:25], a[76:77], v[108:111]
    v_mfma_f32_16x16x16_bf16 v[104:107], v[26:27], a[84:85], v[104:107]
    v_mfma_f32_16x16x16_bf16 v[108:111], v[26:27], a[92:93], v[108:111]
    s_waitcnt vmcnt(32)
    v_mfma_f32_16x16x32_bf16 v[60:63], v[152:155], a[96:99], v[60:63]
    v_mfma_f32_16x16x32_bf16 v[64:67], v[152:155], a[104:107], v[64:67]
    v_mfma_f32_16x16x32_bf16 v[60:63], v[156:159], a[112:115], v[60:63]
    v_mfma_f32_16x16x32_bf16 v[64:67], v[156:159], a[120:123], v[64:67]
    v_mfma_f32_16x16x16_bf16 v[104:107], v[28:29], a[100:101], v[104:107]
    v_mfma_f32_16x16x16_bf16 v[108:111], v[28:29], a[108:109], v[108:111]
    v_mfma_f32_16x16x16_bf16 v[104:107], v[30:31], a[116:117], v[104:107]
    v_mfma_f32_16x16x16_bf16 v[108:111], v[30:31], a[124:125], v[108:111]
    s_waitcnt vmcnt(24)
    v_mfma_f32_16x16x32_bf16 v[60:63], v[160:163], a[128:131], v[60:63]
    v_mfma_f32_16x16x32_bf16 v[64:67], v[160:163], a[136:139], v[64:67]
    v_mfma_f32_16x16x32_bf16 v[60:63], v[164:167], a[144:147], v[60:63]
    v_mfma_f32_16x16x32_bf16 v[64:67], v[164:167], a[152:155], v[64:67]
    v_mfma_f32_16x16x16_bf16 v[104:107], v[32:33], a[132:133], v[104:107]
    v_mfma_f32_16x16x16_bf16 v[108:111], v[32:33], a[140:141], v[108:111]
    v_mfma_f32_16x16x16_bf16 v[104:107], v[34:35], a[148:149], v[104:107]
    v_mfma_f32_16x16x16_bf16 v[108:111], v[34:35], a[156:157], v[108:111]
    s_waitcnt vmcnt(16)
    v_mfma_f32_16x16x32_bf16 v[60:63], v[168:171], a[160:163], v[60:63]
    v_mfma_f32_16x16x32_bf16 v[64:67], v[168:171], a[168:171], v[64:67]
    v_mfma_f32_16x16x32_bf16 v[60:63], v[172:175], a[176:179], v[60:63]
    v_mfma_f32_16x16x32_bf16 v[64:67], v[172:175], a[184:187], v[64:67]
    v_mfma_f32_16x16x16_bf16 v[104:107], v[36:37], a[164:165], v[104:107]
    v_mfma_f32_16x16x16_bf16 v[108:111], v[36:37], a[172:173], v[108:111]
    v_mfma_f32_16x16x16_bf16 v[104:107], v[38:39], a[180:181], v[104:107]
    v_mfma_f32_16x16x16_bf16 v[108:111], v[38:39], a[188:189], v[108:111]
    s_waitcnt vmcnt(8)
    v_mfma_f32_16x16x32_bf16 v[60:63], v[176:179], a[192:195], v[60:63]
    v_mfma_f32_16x16x32_bf16 v[64:67], v[176:179], a[200:203], v[64:67]
    v_mfma_f32_16x16x32_bf16 v[60:63], v[180:183], a[208:211], v[60:63]
    v_mfma_f32_16x16x32_bf16 v[64:67], v[180:183], a[216:219], v[64:67]
    v_mfma_f32_16x16x16_bf16 v[104:107], v[40:41], a[196:197], v[104:107]
    v_mfma_f32_16x16x16_bf16 v[108:111], v[40:41], a[204:205], v[108:111]
    v_mfma_f32_16x16x16_bf16 v[104:107], v[42:43], a[212:213], v[104:107]
    v_mfma_f32_16x16x16_bf16 v[108:111], v[42:43], a[220:221], v[108:111]
    s_waitcnt vmcnt(0)
    v_mfma_f32_16x16x32_bf16 v[60:63], v[184:187], a[224:227], v[60:63]
    v_mfma_f32_16x16x32_bf16 v[64:67], v[184:187], a[232:235], v[64:67]
    v_mfma_f32_16x16x32_bf16 v[60:63], v[188:191], a[240:243], v[60:63]
    v_mfma_f32_16x16x32_bf16 v[64:67], v[188:191], a[248:251], v[64:67]
    v_mfma_f32_16x16x16_bf16 v[104:107], v[44:45], a[228:229], v[104:107]
    v_mfma_f32_16x16x16_bf16 v[108:111], v[44:45], a[236:237], v[108:111]
    v_mfma_f32_16x16x16_bf16 v[104:107], v[46:47], a[244:245], v[104:107]
    v_mfma_f32_16x16x16_bf16 v[108:111], v[46:47], a[252:253], v[108:111]
    s_nop 7
    v_pk_add_f32 v[60:61], v[60:61], v[104:105]
    v_pk_add_f32 v[62:63], v[62:63], v[106:107]
    v_pk_add_f32 v[64:65], v[64:65], v[108:109]
    v_pk_add_f32 v[66:67], v[66:67], v[110:111]
    s_nop 7
    v_cvt_pk_bf16_f32 v16, v60, v61
    v_cvt_pk_bf16_f32 v17, v62, v63
    v_cvt_pk_bf16_f32 v18, v64, v65
    v_cvt_pk_bf16_f32 v19, v66, v67
    global_store_dwordx2 v5, v[16:17], s[4:5]
    global_store_dwordx2 v8, v[18:19], s[4:5]
    s_branch L_task_done
L_main_done:
    s_endpgm
.section .rodata,"a"
.p2align 6
.amdhsa_kernel main_kernel
  .amdhsa_next_free_vgpr 512
  .amdhsa_next_free_sgpr 102
  .amdhsa_accum_offset 256
  .amdhsa_group_segment_fixed_size 0
  .amdhsa_kernarg_size 112
  .amdhsa_user_sgpr_count 2
  .amdhsa_user_sgpr_kernarg_segment_ptr 1
  .amdhsa_system_sgpr_workgroup_id_x 1
.end_amdhsa_kernel
```
